```python
import torch

def _softmax(x, axis=-1):
    return torch.softmax(x, dim=axis)
def _gelu(x):
    return torch.nn.functional.gelu(x, approximate="tanh")
def _silu(x):
    return torch.nn.functional.silu(x)
def _sigmoid(x):
    return torch.sigmoid(x)
def _layernorm(x, axis=-1, eps=1e-5):
    m = x.mean(dim=axis, keepdim=True)
    v = x.var(dim=axis, keepdim=True, unbiased=False)
    return (x - m) / torch.sqrt(v + eps)
def _scatter_add(tgt, idx, src, axis=0):
    return tgt.clone().index_add_(axis, idx, src)
def _segment_sum(src, seg, n):
    out = torch.zeros((n,) + src.shape[1:], dtype=src.dtype)
    return out.index_add_(0, seg, src)
def _pad(x, pw):
    flat = tuple(v for pair in reversed(pw) for v in pair)
    return torch.nn.functional.pad(x, flat)

kernel_name = 'concat_heads__gqa_block_cached__mha_block_cached__near_ridge'

def setup_inputs():

    _w = (lambda a: (lambda t: t.to(torch.bfloat16) if t.is_floating_point() else t)(torch.as_tensor(a)))
    def _A_setup():
        B, Sq, D = 32, 96, 576
        Hq, Hkv, Sk, Dh = 32, 16, 512, 128
        assert Hq % Hkv == 0, (Hq, Hkv)
        return {
            "x": _w((lambda *s: torch.randn(*s, dtype=torch.bfloat16) * 0.8)(B, Sq, D)),
            "k_cache": _w((lambda *s: torch.randn(*s, dtype=torch.bfloat16) * 0.8)(B, Hkv, Sk, Dh)),
            "v_cache": _w((lambda *s: torch.randn(*s, dtype=torch.bfloat16) * 0.05)(B, Hkv, Sk, Dh)),
            "wq": _w((lambda *s: torch.randn(*s, dtype=torch.bfloat16) * 0.8)(D, Hq * Dh) * (D ** -0.5)),
            "wo": _w((lambda *s: torch.randn(*s, dtype=torch.bfloat16) * 0.05)(Hq * Dh, D) * ((Hq * Dh) ** -0.5)),
        }
    _A_in = _A_setup()

    def _B_setup():
        B, Sq, D = 32, 96, 576
        H, Sk, Dh = 32, 512, 128
        return {
            "x": _w((lambda *s: torch.randn(*s, dtype=torch.bfloat16) * 0.8)(B, Sq, D)),
            "k_cache": _w((lambda *s: torch.randn(*s, dtype=torch.bfloat16) * 0.8)(B, H, Sk, Dh)),
            "v_cache": _w((lambda *s: torch.randn(*s, dtype=torch.bfloat16) * 0.05)(B, H, Sk, Dh)),
            "wq": _w((lambda *s: torch.randn(*s, dtype=torch.bfloat16) * 0.8)(D, H * Dh) * (D ** -0.5)),
            "wo": _w((lambda *s: torch.randn(*s, dtype=torch.bfloat16) * 0.05)(H * Dh, D) * ((H * Dh) ** -0.5)),
        }
    _B_in = _B_setup()

    return {
        "A_x": _A_in["x"],
        "A_k_cache": _A_in["k_cache"],
        "A_v_cache": _A_in["v_cache"],
        "A_wq": _A_in["wq"],
        "A_wo": _A_in["wo"],
        "B_x": _B_in["x"],
        "B_k_cache": _B_in["k_cache"],
        "B_v_cache": _B_in["v_cache"],
        "B_wq": _B_in["wq"],
        "B_wo": _B_in["wo"],
    }

def reference(A_x, A_k_cache, A_v_cache, A_wq, A_wo, B_x, B_k_cache, B_v_cache, B_wq, B_wo):
    def _A_ref(x, k_cache, v_cache, wq, wo):
        B, Sq, D = x.shape
        Hq, Dh = 32, 128
        Hkv = k_cache.shape[1]
        rep = Hq // Hkv
        q = (lambda x, *d: x.permute(*d))((x @ wq).reshape(B, Sq, Hq, Dh), 0, 2, 1, 3)
        k = (lambda x, n, axis: torch.repeat_interleave(x, n, dim=axis))(k_cache, rep, axis=1)
        v = (lambda x, n, axis: torch.repeat_interleave(x, n, dim=axis))(v_cache, rep, axis=1)
        scores = torch.einsum("bhqd,bhkd->bhqk", q, k) * (Dh ** -0.5)
        p = _softmax(scores, axis=-1)
        o = torch.einsum("bhqk,bhkd->bhqd", p, v)
        return (lambda x, *d: x.permute(*d))(o, 0, 2, 1, 3).reshape(B, Sq, Hq * Dh) @ wo

    def _B_ref(x, k_cache, v_cache, wq, wo):
        B, Sq, D = x.shape
        H, Dh = 32, 128
        q = (lambda x, *d: x.permute(*d))((x @ wq).reshape(B, Sq, H, Dh), 0, 2, 1, 3)
        scores = torch.einsum("bhqd,bhkd->bhqk", q, k_cache) * (Dh ** -0.5)
        p = _softmax(scores, axis=-1)
        o = torch.einsum("bhqk,bhkd->bhqd", p, v_cache)
        return (lambda x, *d: x.permute(*d))(o, 0, 2, 1, 3).reshape(B, Sq, H * Dh) @ wo

    a = _A_ref(A_x, A_k_cache, A_v_cache, A_wq, A_wo)
    b = _B_ref(B_x, B_k_cache, B_v_cache, B_wq, B_wo)
    return torch.concatenate([a, b], axis=-1)
```

```asm
; @launch grid=(256,1,1) block=(256,1,1) lds=163840
.amdgcn_target "amdgcn-amd-amdhsa--gfx950"
.text
.globl concat_heads__gqa_block_cached__mha_block_cached__near_ridge_kernel
.p2align 8
.type concat_heads__gqa_block_cached__mha_block_cached__near_ridge_kernel,@function
concat_heads__gqa_block_cached__mha_block_cached__near_ridge_kernel:
    s_cmp_lt_u32 s2, 256
    s_cbranch_scc1 L_go
    s_endpgm
L_go:
    s_load_dwordx16 s[72:87], s[0:1], 0
    s_load_dwordx8 s[88:95], s[0:1], 64
    s_load_dwordx2 s[96:97], s[0:1], 96
    v_lshrrev_b32 v2, 6, v0
    v_and_b32 v1, 63, v0
    v_readfirstlane_b32 s65, v2
    s_and_b32 s3, s2, 7
    s_lshr_b32 s54, s2, 3
    s_and_b32 s66, s3, 3
    s_lshr_b32 s3, s3, 2
    s_lshl_b32 s99, s3, 4
    s_lshr_b32 s71, s54, 1
    s_add_u32 s99, s99, s71
    s_bfe_u32 s98, s54, 65536
    s_lshr_b32 s100, s65, 1
    s_and_b32 s101, s65, 1
    s_lshl_b32 s52, s65, 10
    s_mul_i32 s51, s100, 40960
    s_lshl_b32 s3, s101, 12
    s_add_u32 s51, s51, s3
    s_add_u32 s51, s51, 49152
    s_mul_i32 s47, s99, 110592
    s_add_u32 s48, s47, 36864
    s_add_u32 s49, s47, 73728
    s_lshl_b32 s46, s101, 17
    s_lshl_b32 s3, s66, 3
    s_add_u32 s3, s3, s100
    s_lshl_b32 s3, s3, 8
    s_add_u32 s46, s46, s3
    v_lshrrev_b32 v247, 3, v1
    v_and_b32 v248, 7, v1
    v_and_b32 v249, 6, v247
    v_xor_b32 v249, v248, v249
    v_lshlrev_b32 v249, 4, v249
    v_lshl_add_u32 v238, v247, 8, v249
    v_lshl_add_u32 v250, v2, 3, v247
    v_mul_u32_u24 v250, 1152, v250
    v_add_u32 v239, v250, v249
    v_and_b32 v249, 2, v247
    v_xor_b32 v249, v248, v249
    v_xor_b32 v250, 4, v249
    v_lshlrev_b32 v249, 4, v249
    v_lshlrev_b32 v250, 4, v250
    v_lshl_add_u32 v240, v247, 13, v249
    v_lshl_add_u32 v241, v247, 13, v250
    v_add_u32 v241, 63488, v241
    s_mov_b32 s14, 4718592
    s_mov_b32 s15, 0x20000
    s_mov_b32 s18, 3538944
    s_mov_b32 s19, 0x20000
    s_cmp_eq_u32 s98, 0
    s_waitcnt lgkmcnt(0)
    s_cselect_b32 s12, s78, s88
    s_cselect_b32 s13, s79, s89
    s_cselect_b32 s16, s72, s82
    s_cselect_b32 s17, s73, s83
    s_add_u32 m0, s51, 0
    s_nop 0
    buffer_load_dwordx4 v240, s[12:15], s46 offen lds
    buffer_load_dwordx4 v241, s[12:15], s46 offen offset:2048 lds
    s_add_u32 m0, s51, 896
    s_nop 0
    buffer_load_dwordx4 v240, s[12:15], s46 offen offset:128 lds
    buffer_load_dwordx4 v241, s[12:15], s46 offen offset:2176 lds
    s_add_u32 s46, s46, 262144
    s_add_u32 m0, s52, 131072
    s_nop 0
    buffer_load_dwordx4 v239, s[16:19], s47 offen lds
    s_add_u32 m0, s52, 135168
    s_nop 0
    buffer_load_dwordx4 v239, s[16:19], s48 offen lds
    s_add_u32 m0, s52, 139264
    s_nop 0
    buffer_load_dwordx4 v239, s[16:19], s49 offen lds
    s_add_u32 m0, s51, 8192
    s_nop 0
    buffer_load_dwordx4 v240, s[12:15], s46 offen lds
    buffer_load_dwordx4 v241, s[12:15], s46 offen offset:2048 lds
    s_add_u32 m0, s51, 9088
    s_nop 0
    buffer_load_dwordx4 v240, s[12:15], s46 offen offset:128 lds
    buffer_load_dwordx4 v241, s[12:15], s46 offen offset:2176 lds
    s_add_u32 s46, s46, 262144
    s_add_u32 m0, s52, 143232
    s_nop 0
    buffer_load_dwordx4 v239, s[16:19], s47 offen offset:128 lds
    s_add_u32 m0, s52, 147328
    s_nop 0
    buffer_load_dwordx4 v239, s[16:19], s48 offen offset:128 lds
    s_add_u32 m0, s52, 151424
    s_nop 0
    buffer_load_dwordx4 v239, s[16:19], s49 offen offset:128 lds
    s_lshl_b32 s54, s71, 2
    s_add_u32 s54, s54, s65
    s_mul_i32 s54, s54, 9
    v_lshrrev_b32 v12, 2, v1
    v_and_b32 v248, 3, v1
    v_lshlrev_b32 v248, 7, v248
    v_add_u32 v247, s54, v12
    v_lshl_add_u32 v11, v247, 13, v248
    v_add_u32 v247, s54, v12
    v_lshl_add_u32 v227, v247, 13, v248
    s_lshl_b32 s54, s54, 2
    v_add_u32 v247, s54, v1
    v_lshlrev_b32 v228, 7, v247
    v_lshlrev_b32 v229, 7, v1
    v_mov_b32 v247, 0x40000000
    v_cmp_gt_u32 vcc, 36, v1
    s_lshl_b32 s69, s66, 11
    s_lshl_b32 s3, s66, 2
    v_cndmask_b32 v227, v247, v227, vcc
    v_cndmask_b32 v228, v247, v228, vcc
    v_cndmask_b32 v11, v247, v11, vcc
    v_cmp_gt_u32 vcc, 54, v1
    s_add_u32 s3, s3, s65
    s_mul_i32 s3, s3, 6912
    v_cndmask_b32 v229, v247, v229, vcc
    s_add_u32 s3, s3, s47
    s_add_u32 m0, s51, 16384
    s_nop 0
    buffer_load_dwordx4 v240, s[12:15], s46 offen lds
    buffer_load_dwordx4 v241, s[12:15], s46 offen offset:2048 lds
    s_add_u32 m0, s51, 17280
    s_nop 0
    buffer_load_dwordx4 v240, s[12:15], s46 offen offset:128 lds
    buffer_load_dwordx4 v241, s[12:15], s46 offen offset:2176 lds
    s_add_u32 s46, s46, 262144
    s_add_u32 m0, s51, 24576
    s_nop 0
    buffer_load_dwordx4 v240, s[12:15], s46 offen lds
    buffer_load_dwordx4 v241, s[12:15], s46 offen offset:2048 lds
    s_add_u32 m0, s51, 25472
    s_nop 0
    buffer_load_dwordx4 v240, s[12:15], s46 offen offset:128 lds
    buffer_load_dwordx4 v241, s[12:15], s46 offen offset:2176 lds
    s_add_u32 s46, s46, 262144
    buffer_load_dword v251, v11, s[12:15], s69 offen
    buffer_load_dword v251, v229, s[16:19], s3 offen
    s_getpc_b64 s[28:29]
L_pc:
    s_sub_u32 s28, s28, L_pc-concat_heads__gqa_block_cached__mha_block_cached__near_ridge_kernel
    s_subb_u32 s29, s29, 0
    s_lshr_b32 s3, s2, 3
    s_lshl_b32 s3, s3, 2
    s_add_u32 s3, s3, s65
    s_lshl_b32 s3, s3, 10
    v_lshl_add_u32 v12, v1, 4, s3
    v_min_u32 v12, L_end-concat_heads__gqa_block_cached__mha_block_cached__near_ridge_kernel-16, v12
    v_mov_b32 v13, s29
    v_add_co_u32 v12, vcc, s28, v12
    s_nop 1
    v_addc_co_u32 v13, vcc, 0, v13, vcc
    global_load_dword v251, v[12:13], off
    s_cmp_eq_u32 s98, 0
    s_cselect_b32 s4, s74, s84
    s_cselect_b32 s5, s75, s85
    s_mov_b32 s7, 0x20000
    s_cselect_b32 s8, s76, s86
    s_cselect_b32 s9, s77, s87
    s_mov_b32 s11, 0x20000
    s_cselect_b32 s20, s80, s90
    s_cselect_b32 s21, s81, s91
    s_mov_b32 s23, 0x20000
    s_mov_b32 s22, 4718592
    s_mov_b32 s40, 0x8000000
    s_cselect_b32 s40, 0x4000000, s40
    s_cselect_b32 s3, s100, 0
    s_cmp_eq_u32 s3, 0
    s_cselect_b32 s6, s40, 0
    s_mov_b32 s10, s6
    s_mov_b32 s28, s92
    s_mov_b32 s29, s93
    s_mov_b32 s30, 7077888
    s_mov_b32 s31, 0x20000
    s_mov_b32 s32, s94
    s_mov_b32 s33, s95
    s_mov_b32 s34, 256
    s_mov_b32 s35, 0x20000
    s_mov_b32 s24, s96
    s_mov_b32 s25, s97
    s_mov_b32 s26, 536870912
    s_mov_b32 s27, 0x20000
    s_lshl_b32 s3, s98, 5
    s_add_u32 s3, s3, s99
    s_mov_b32 s55, s3
    s_mul_i32 s67, s3, 442368
    s_lshl_b32 s3, s66, 2
    s_add_u32 s3, s3, s65
    s_mul_i32 s3, s3, 3072
    s_add_u32 s67, s67, s3
    s_mul_i32 s50, s66, 1179648
    s_lshl_b32 s3, s66, 1
    s_add_u32 s3, s3, 3
    s_add_u32 s54, s3, 0
    s_sub_u32 s56, s54, 9
    s_cmp_ge_u32 s54, 9
    s_cselect_b32 s56, s56, s54
    s_lshl_b32 s56, s56, 7
    s_add_u32 s54, s3, 1
    s_sub_u32 s57, s54, 9
    s_cmp_ge_u32 s54, 9
    s_cselect_b32 s57, s57, s54
    s_lshl_b32 s57, s57, 7
    s_add_u32 s54, s3, 2
    s_sub_u32 s58, s54, 9
    s_cmp_ge_u32 s54, 9
    s_cselect_b32 s58, s58, s54
    s_lshl_b32 s58, s58, 7
    s_add_u32 s54, s3, 3
    s_sub_u32 s59, s54, 9
    s_cmp_ge_u32 s54, 9
    s_cselect_b32 s59, s59, s54
    s_lshl_b32 s59, s59, 7
    s_add_u32 s54, s3, 4
    s_sub_u32 s60, s54, 9
    s_cmp_ge_u32 s54, 9
    s_cselect_b32 s60, s60, s54
    s_lshl_b32 s60, s60, 7
    s_add_u32 s54, s3, 5
    s_sub_u32 s61, s54, 9
    s_cmp_ge_u32 s54, 9
    s_cselect_b32 s61, s61, s54
    s_lshl_b32 s61, s61, 7
    s_add_u32 s54, s3, 6
    s_sub_u32 s62, s54, 9
    s_cmp_ge_u32 s54, 9
    s_cselect_b32 s62, s62, s54
    s_lshl_b32 s62, s62, 7
    s_add_u32 s54, s3, 7
    s_sub_u32 s63, s54, 9
    s_cmp_ge_u32 s54, 9
    s_cselect_b32 s63, s63, s54
    s_lshl_b32 s63, s63, 7
    s_add_u32 s54, s3, 8
    s_sub_u32 s64, s54, 9
    s_cmp_ge_u32 s54, 9
    s_cselect_b32 s64, s64, s54
    s_lshl_b32 s64, s64, 7
    s_lshl_b32 s44, s99, 5
    s_lshl_b32 s3, s66, 3
    s_add_u32 s44, s44, s3
    s_lshr_b32 s3, s44, 1
    s_add_u32 s44, s44, s100
    s_cmp_eq_u32 s98, 0
    s_cselect_b32 s44, s3, s44
    s_cselect_b32 s68, 0, 131072
    s_lshl_b32 s44, s44, 17
    s_lshl_b32 s3, s101, 12
    s_add_u32 s44, s44, s3
    s_mov_b32 s45, s44
    s_mov_b32 s70, 0x3e0293ee
    s_mov_b32 s53, 0
    s_lshl_b32 s94, s66, 11
    s_add_u32 s94, s94, 512
    s_mov_b32 s95, s50
    s_mul_i32 s3, s99, 221184
    s_mul_i32 s54, s98, 1152
    s_add_u32 s71, s3, s54
    s_mul_i32 s3, s100, 40960
    s_add_u32 s3, s3, 49152
    v_and_b32 v3, 15, v1
    v_lshrrev_b32 v4, 4, v1
    v_and_b32 v5, 6, v3
    v_xor_b32 v5, v4, v5
    v_lshlrev_b32 v5, 4, v5
    v_lshrrev_b32 v6, 3, v3
    v_lshlrev_b32 v6, 11, v6
    v_and_b32 v7, 7, v3
    v_lshl_add_u32 v6, v7, 7, v6
    s_mul_i32 s69, s100, s98
    s_mul_i32 s69, s69, 40960
    s_add_u32 s69, s69, 49152
    v_add3_u32 v230, v6, v5, s69
    v_xor_b32 v231, 64, v230
    s_mul_i32 s54, s101, 6144
    s_add_u32 s54, s54, 131072
    v_lshl_add_u32 v6, v3, 7, v5
    v_add_u32 v244, s54, v6
    v_xor_b32 v245, 64, v244
    v_lshrrev_b32 v3, 2, v1
    v_and_b32 v5, 3, v1
    v_lshrrev_b32 v6, 1, v5
    v_and_b32 v7, 6, v3
    v_xor_b32 v6, v6, v7
    v_lshlrev_b32 v6, 4, v6
    v_and_b32 v7, 1, v5
    v_lshl_add_u32 v6, v7, 3, v6
    v_lshrrev_b32 v7, 3, v3
    v_lshlrev_b32 v7, 11, v7
    v_and_b32 v8, 7, v3
    v_lshl_add_u32 v7, v8, 7, v7
    v_add3_u32 v232, v7, v6, s69
    v_xor_b32 v233, 32, v232
    v_xor_b32 v234, 64, v232
    v_xor_b32 v235, 96, v232
    v_lshlrev_b32 v7, 5, v2
    v_xor_b32 v6, v6, v7
    v_lshl_add_u32 v6, v3, 7, v6
    v_add_u32 v236, 131072, v6
    v_and_b32 v6, 3, v3
    v_and_b32 v7, 2, v6
    v_and_b32 v8, 1, v4
    v_lshl_or_b32 v7, v8, 2, v7
    v_xor_b32 v7, v5, v7
    v_lshlrev_b32 v7, 4, v7
    v_lshl_add_u32 v7, v6, 7, v7
    v_lshl_add_u32 v7, v4, 11, v7
    v_add_u32 v242, s3, v7
    v_xor_b32 v243, 64, v242
    v_lshlrev_b32 v237, 4, v1
    s_mul_i32 s3, s100, 24
    s_mul_i32 s54, s101, 3
    s_add_u32 s3, s3, s54
    s_lshl_b32 s3, s3, 10
    v_add_u32 v246, s3, v237
    s_mul_i32 s3, s66, 1179648
    s_add_u32 s3, s3, 884736
    s_add_u32 s82, s3, s56
    s_mul_i32 s72, s56, 384
    s_add_u32 s72, s72, s67
    s_sub_u32 s56, s82, 1179648
    s_add_u32 s83, s3, s57
    s_mul_i32 s73, s57, 384
    s_add_u32 s73, s73, s67
    s_sub_u32 s57, s83, 1179648
    s_add_u32 s84, s3, s58
    s_mul_i32 s74, s58, 384
    s_add_u32 s74, s74, s67
    s_sub_u32 s58, s84, 1179648
    s_add_u32 s85, s3, s59
    s_mul_i32 s75, s59, 384
    s_add_u32 s75, s75, s67
    s_sub_u32 s59, s85, 1179648
    s_add_u32 s86, s3, s60
    s_mul_i32 s76, s60, 384
    s_add_u32 s76, s76, s67
    s_sub_u32 s60, s86, 1179648
    s_add_u32 s87, s3, s61
    s_mul_i32 s77, s61, 384
    s_add_u32 s77, s77, s67
    s_sub_u32 s61, s87, 1179648
    s_add_u32 s88, s3, s62
    s_mul_i32 s78, s62, 384
    s_add_u32 s78, s78, s67
    s_mov_b32 s41, s62
    s_sub_u32 s62, s88, 1179648
    s_add_u32 s89, s3, s63
    s_mul_i32 s79, s63, 384
    s_add_u32 s79, s79, s67
    s_mov_b32 s42, s63
    s_sub_u32 s63, s89, 1179648
    s_add_u32 s90, s3, s64
    s_mul_i32 s80, s64, 384
    s_add_u32 s80, s80, s67
    s_mov_b32 s43, s64
    s_sub_u32 s64, s90, 1179648
    s_lshl_b32 s54, s55, 8
    s_add_u32 s54, s54, 67108864
    s_lshl_b32 s3, s66, 2
    v_mov_b32 v20, s3
    v_mov_b32 v21, 0
    s_and_b32 s3, s55, 3
    s_lshl_b32 s3, s3, 3
    s_lshl_b32 s3, 1, s3
    v_mov_b32 v252, s3
    s_cmp_lg_u32 s65, 0
    s_cbranch_scc1 L_noinit
    s_mov_b64 exec, 1
    s_nop 0
    buffer_store_dword v21, v20, s[24:27], s54 offen sc1
    s_mov_b64 exec, -1
L_noinit:
    s_mov_b32 s50, 0x53800000
    s_cmp_eq_u32 s98, 0
    s_cselect_b64 vcc, -1, 0
    s_mov_b32 s91, 1
    s_waitcnt vmcnt(18)
    s_barrier
    ds_read_b64_tr_b16 a[240:241], v242
    ds_read_b64_tr_b16 a[242:243], v242 offset:512
    ds_read_b64_tr_b16 a[244:245], v242 offset:8
    ds_read_b64_tr_b16 a[246:247], v242 offset:520
    ds_read_b64_tr_b16 a[248:249], v243
    ds_read_b64_tr_b16 a[250:251], v243 offset:512
    ds_read_b128 a[216:219], v244
    ds_read_b128 a[220:223], v244 offset:2048
    ds_read_b128 a[224:227], v244 offset:4096
    ds_read_b128 a[228:231], v245
    ds_read_b128 a[232:235], v245 offset:2048
    ds_read_b128 a[236:239], v245 offset:4096
    s_waitcnt lgkmcnt(5)
    ds_read_b64_tr_b16 a[252:253], v243 offset:8
    ds_read_b64_tr_b16 a[254:255], v243 offset:520
    v_mfma_f32_16x16x32_bf16 v[96:99], a[240:243], a[216:219], 0
    s_waitcnt lgkmcnt(6)
    ds_read_b64_tr_b16 v[216:217], v242 offset:1024
    ds_read_b64_tr_b16 v[218:219], v242 offset:1536
    v_mfma_f32_16x16x32_bf16 v[100:103], a[240:243], a[220:223], 0
    s_waitcnt lgkmcnt(7)
    ds_read_b64_tr_b16 v[220:221], v242 offset:1032
    ds_read_b64_tr_b16 v[222:223], v242 offset:1544
    v_mfma_f32_16x16x32_bf16 v[104:107], a[240:243], a[224:227], 0
    s_waitcnt lgkmcnt(9)
    ds_read_b64_tr_b16 a[240:241], v243 offset:1024
    v_accvgpr_write_b32 a0, 0
    v_mfma_f32_16x16x32_bf16 v[144:147], a[244:247], a[216:219], 0
    ds_read_b64_tr_b16 a[242:243], v243 offset:1536
    v_accvgpr_write_b32 a1, 0
    v_mfma_f32_16x16x32_bf16 v[148:151], a[244:247], a[220:223], 0
    v_accvgpr_write_b32 a2, 0
    v_accvgpr_write_b32 a3, 0
    v_mfma_f32_16x16x32_bf16 v[152:155], a[244:247], a[224:227], 0
    s_waitcnt lgkmcnt(11)
    ds_read_b64_tr_b16 a[244:245], v243 offset:1032
    ds_read_b64_tr_b16 a[246:247], v243 offset:1544
    v_mfma_f32_16x16x32_bf16 v[108:111], a[248:251], a[216:219], 0
    v_accvgpr_write_b32 a4, 0
    v_accvgpr_write_b32 a5, 0
    v_mfma_f32_16x16x32_bf16 v[112:115], a[248:251], a[220:223], 0
    v_accvgpr_write_b32 a6, 0
    v_accvgpr_write_b32 a7, 0
    v_mfma_f32_16x16x32_bf16 v[116:119], a[248:251], a[224:227], 0
    s_waitcnt lgkmcnt(8)
    v_accvgpr_write_b32 a8, 0
    v_accvgpr_write_b32 a9, 0
    v_mfma_f32_16x16x32_bf16 v[156:159], a[252:255], a[216:219], 0
    v_accvgpr_write_b32 a10, 0
    v_accvgpr_write_b32 a11, 0
    v_mfma_f32_16x16x32_bf16 v[160:163], a[252:255], a[220:223], 0
    v_accvgpr_write_b32 a12, 0
    v_accvgpr_write_b32 a13, 0
    v_mfma_f32_16x16x32_bf16 v[164:167], a[252:255], a[224:227], 0
    s_waitcnt lgkmcnt(6)
    v_accvgpr_write_b32 a14, 0
    v_accvgpr_write_b32 a15, 0
    v_mfma_f32_16x16x32_bf16 v[120:123], v[216:219], a[216:219], 0
    v_accvgpr_write_b32 a16, 0
    v_accvgpr_write_b32 a17, 0
    v_mfma_f32_16x16x32_bf16 v[124:127], v[216:219], a[220:223], 0
    s_waitcnt vmcnt(14)
    s_barrier
    ds_read_b64_tr_b16 a[248:249], v242 offset:8192
    v_mfma_f32_16x16x32_bf16 v[128:131], v[216:219], a[224:227], 0
    s_waitcnt lgkmcnt(5)
    ds_read_b64_tr_b16 a[250:251], v242 offset:8704
    ds_read_b64_tr_b16 a[252:253], v242 offset:8200
    v_mfma_f32_16x16x32_bf16 v[168:171], v[220:223], a[216:219], 0
    s_add_u32 m0, s51, 32768
    ds_read_b64_tr_b16 a[254:255], v242 offset:8712
    ds_read_b64_tr_b16 v[216:217], v243 offset:8192
    v_mfma_f32_16x16x32_bf16 v[172:175], v[220:223], a[220:223], 0
    buffer_load_dwordx4 v240, s[12:15], s46 offen lds
    v_mfma_f32_16x16x32_bf16 v[176:179], v[220:223], a[224:227], 0
    s_waitcnt lgkmcnt(7)
    buffer_load_dwordx4 v241, s[12:15], s46 offen offset:2048 lds
    v_mfma_f32_16x16x32_bf16 v[132:135], a[240:243], a[216:219], 0
    s_add_u32 m0, s51, 33664
    ds_read_b64_tr_b16 v[218:219], v243 offset:8704
    ds_read_b64_tr_b16 v[220:221], v243 offset:8200
    v_mfma_f32_16x16x32_bf16 v[136:139], a[240:243], a[220:223], 0
    ds_read_b64_tr_b16 v[222:223], v243 offset:8712
    v_accvgpr_write_b32 a18, 0
    v_mfma_f32_16x16x32_bf16 v[140:143], a[240:243], a[224:227], 0
    s_waitcnt lgkmcnt(8)
    buffer_load_dwordx4 v240, s[12:15], s46 offen offset:128 lds
    v_mfma_f32_16x16x32_bf16 v[180:183], a[244:247], a[216:219], 0
    ds_read_b64_tr_b16 a[240:241], v242 offset:9216
    ds_read_b64_tr_b16 a[242:243], v242 offset:9728
    v_mfma_f32_16x16x32_bf16 v[184:187], a[244:247], a[220:223], 0
    v_accvgpr_write_b32 a19, 0
    v_accvgpr_write_b32 a20, 0
    v_mfma_f32_16x16x32_bf16 v[188:191], a[244:247], a[224:227], 0
    s_waitcnt lgkmcnt(8)
    buffer_load_dwordx4 v241, s[12:15], s46 offen offset:2176 lds
    v_mfma_f32_16x16x32_bf16 v[96:99], a[248:251], a[228:231], v[96:99]
    s_add_u32 m0, s52, 130816
    ds_read_b64_tr_b16 a[244:245], v242 offset:9224
    ds_read_b64_tr_b16 a[246:247], v242 offset:9736
    v_mfma_f32_16x16x32_bf16 v[100:103], a[248:251], a[232:235], v[100:103]
    s_add_u32 s46, s46, 262144
    v_accvgpr_write_b32 a21, 0
    v_accvgpr_write_b32 a22, 0
    v_mfma_f32_16x16x32_bf16 v[104:107], a[248:251], a[236:239], v[104:107]
    s_waitcnt lgkmcnt(8)
    buffer_load_dwordx4 v239, s[16:19], s47 offen offset:256 lds
    v_mfma_f32_16x16x32_bf16 v[144:147], a[252:255], a[228:231], v[144:147]
    s_add_u32 m0, s52, 134912
    ds_read_b64_tr_b16 a[248:249], v243 offset:9216
    ds_read_b64_tr_b16 a[250:251], v243 offset:9728
    v_mfma_f32_16x16x32_bf16 v[148:151], a[252:255], a[232:235], v[148:151]
    v_accvgpr_write_b32 a23, 0
    v_accvgpr_write_b32 a24, 0
    v_mfma_f32_16x16x32_bf16 v[152:155], a[252:255], a[236:239], v[152:155]
    s_waitcnt lgkmcnt(8)
    buffer_load_dwordx4 v239, s[16:19], s48 offen offset:256 lds
    v_mfma_f32_16x16x32_bf16 v[108:111], v[216:219], a[228:231], v[108:111]
    s_add_u32 m0, s52, 139008
    ds_read_b64_tr_b16 a[252:253], v243 offset:9224
    ds_read_b64_tr_b16 a[254:255], v243 offset:9736
    v_mfma_f32_16x16x32_bf16 v[112:115], v[216:219], a[232:235], v[112:115]
    v_accvgpr_write_b32 a25, 0
    v_accvgpr_write_b32 a26, 0
    v_mfma_f32_16x16x32_bf16 v[116:119], v[216:219], a[236:239], v[116:119]
    s_waitcnt lgkmcnt(8)
    buffer_load_dwordx4 v239, s[16:19], s49 offen offset:256 lds
    v_mfma_f32_16x16x32_bf16 v[156:159], v[220:223], a[228:231], v[156:159]
    v_accvgpr_write_b32 a27, 0
    v_accvgpr_write_b32 a28, 0
    v_mfma_f32_16x16x32_bf16 v[160:163], v[220:223], a[232:235], v[160:163]
    v_accvgpr_write_b32 a29, 0
    v_accvgpr_write_b32 a30, 0
    v_mfma_f32_16x16x32_bf16 v[164:167], v[220:223], a[236:239], v[164:167]
    s_waitcnt lgkmcnt(6)
    v_accvgpr_write_b32 a31, 0
    v_accvgpr_write_b32 a32, 0
    v_mfma_f32_16x16x32_bf16 v[120:123], a[240:243], a[228:231], v[120:123]
    v_accvgpr_write_b32 a33, 0
    v_accvgpr_write_b32 a34, 0
    v_mfma_f32_16x16x32_bf16 v[124:127], a[240:243], a[232:235], v[124:127]
    s_waitcnt vmcnt(14)
    s_barrier
    ds_read_b128 v[192:195], v244 offset:12288
    v_mfma_f32_16x16x32_bf16 v[128:131], a[240:243], a[236:239], v[128:131]
    s_waitcnt lgkmcnt(5)
    ds_read_b64_tr_b16 v[216:217], v242 offset:16384
    ds_read_b64_tr_b16 v[218:219], v242 offset:16896
    v_mfma_f32_16x16x32_bf16 v[168:171], a[244:247], a[228:231], v[168:171]
    s_add_u32 m0, s51, 0
    ds_read_b128 v[196:199], v244 offset:14336
    ds_read_b128 v[200:203], v244 offset:16384
    v_mfma_f32_16x16x32_bf16 v[172:175], a[244:247], a[232:235], v[172:175]
    buffer_load_dwordx4 v240, s[12:15], s46 offen lds
    v_mfma_f32_16x16x32_bf16 v[176:179], a[244:247], a[236:239], v[176:179]
    s_waitcnt lgkmcnt(7)
    buffer_load_dwordx4 v241, s[12:15], s46 offen offset:2048 lds
    v_mfma_f32_16x16x32_bf16 v[132:135], a[248:251], a[228:231], v[132:135]
    s_add_u32 m0, s51, 896
    ds_read_b64_tr_b16 v[220:221], v242 offset:16392
    ds_read_b64_tr_b16 v[222:223], v242 offset:16904
    v_mfma_f32_16x16x32_bf16 v[136:139], a[248:251], a[232:235], v[136:139]
    ds_read_b64_tr_b16 a[240:241], v243 offset:16384
    ds_read_b64_tr_b16 a[242:243], v243 offset:16896
    v_mfma_f32_16x16x32_bf16 v[140:143], a[248:251], a[236:239], v[140:143]
    s_waitcnt lgkmcnt(9)
    buffer_load_dwordx4 v240, s[12:15], s46 offen offset:128 lds
    v_mfma_f32_16x16x32_bf16 v[180:183], a[252:255], a[228:231], v[180:183]
    ds_read_b64_tr_b16 a[244:245], v243 offset:16392
    ds_read_b64_tr_b16 a[246:247], v243 offset:16904
    v_mfma_f32_16x16x32_bf16 v[184:187], a[252:255], a[232:235], v[184:187]
    ds_read_b64_tr_b16 a[248:249], v242 offset:17408
    ds_read_b64_tr_b16 a[250:251], v242 offset:17920
    v_mfma_f32_16x16x32_bf16 v[188:191], a[252:255], a[236:239], v[188:191]
    s_waitcnt lgkmcnt(10)
    buffer_load_dwordx4 v241, s[12:15], s46 offen offset:2176 lds
    v_mfma_f32_16x16x32_bf16 v[96:99], v[216:219], v[192:195], v[96:99]
    s_waitcnt lgkmcnt(9)
    ds_read_b64_tr_b16 a[252:253], v242 offset:17416
    ds_read_b64_tr_b16 a[254:255], v242 offset:17928
    v_mfma_f32_16x16x32_bf16 v[100:103], v[216:219], v[196:199], v[100:103]
    s_waitcnt lgkmcnt(10)
    ds_read_b128 a[216:219], v245 offset:12288
    ds_read_b128 a[220:223], v245 offset:14336
    v_mfma_f32_16x16x32_bf16 v[104:107], v[216:219], v[200:203], v[104:107]
    s_waitcnt lgkmcnt(10)
    buffer_load_dword v251, v228, s[20:23], s95 offen
    v_mfma_f32_16x16x32_bf16 v[144:147], v[220:223], v[192:195], v[144:147]
    s_add_u32 s46, s46, 262144
    ds_read_b128 a[224:227], v245 offset:16384
    ds_read_b64_tr_b16 v[216:217], v243 offset:17408
    v_mfma_f32_16x16x32_bf16 v[148:151], v[220:223], v[196:199], v[148:151]
    ds_read_b64_tr_b16 v[218:219], v243 offset:17920
    v_accvgpr_write_b32 a35, 0
    v_mfma_f32_16x16x32_bf16 v[152:155], v[220:223], v[200:203], v[152:155]
    s_waitcnt lgkmcnt(11)
    ds_read_b64_tr_b16 v[220:221], v243 offset:17416
    ds_read_b64_tr_b16 v[222:223], v243 offset:17928
    v_mfma_f32_16x16x32_bf16 v[108:111], a[240:243], v[192:195], v[108:111]
    v_accvgpr_write_b32 a36, 0
    v_accvgpr_write_b32 a37, 0
    v_mfma_f32_16x16x32_bf16 v[112:115], a[240:243], v[196:199], v[112:115]
    v_accvgpr_write_b32 a38, 0
    v_accvgpr_write_b32 a39, 0
    v_mfma_f32_16x16x32_bf16 v[116:119], a[240:243], v[200:203], v[116:119]
    s_waitcnt lgkmcnt(11)
    v_accvgpr_write_b32 a40, 0
    v_accvgpr_write_b32 a41, 0
    v_mfma_f32_16x16x32_bf16 v[156:159], a[244:247], v[192:195], v[156:159]
    v_accvgpr_write_b32 a42, 0
    v_accvgpr_write_b32 a43, 0
    v_mfma_f32_16x16x32_bf16 v[160:163], a[244:247], v[196:199], v[160:163]
    v_accvgpr_write_b32 a44, 0
    v_accvgpr_write_b32 a45, 0
    v_mfma_f32_16x16x32_bf16 v[164:167], a[244:247], v[200:203], v[164:167]
    s_waitcnt lgkmcnt(9)
    v_accvgpr_write_b32 a46, 0
    v_accvgpr_write_b32 a47, 0
    v_mfma_f32_16x16x32_bf16 v[120:123], a[248:251], v[192:195], v[120:123]
    v_accvgpr_write_b32 a48, 0
    v_accvgpr_write_b32 a49, 0
    v_mfma_f32_16x16x32_bf16 v[124:127], a[248:251], v[196:199], v[124:127]
    s_waitcnt vmcnt(15) lgkmcnt(4)
    s_barrier
    ds_read_b64_tr_b16 a[240:241], v242 offset:24576
    v_mfma_f32_16x16x32_bf16 v[128:131], a[248:251], v[200:203], v[128:131]
    s_add_u32 m0, s51, 8192
    ds_read_b64_tr_b16 a[242:243], v242 offset:25088
    ds_read_b64_tr_b16 a[244:245], v242 offset:24584
    v_mfma_f32_16x16x32_bf16 v[168:171], a[252:255], v[192:195], v[168:171]
    buffer_load_dwordx4 v240, s[12:15], s46 offen lds
    v_mfma_f32_16x16x32_bf16 v[172:175], a[252:255], v[196:199], v[172:175]
    ds_read_b64_tr_b16 a[246:247], v242 offset:25096
    ds_read_b64_tr_b16 a[248:249], v243 offset:24576
    v_mfma_f32_16x16x32_bf16 v[176:179], a[252:255], v[200:203], v[176:179]
    s_waitcnt lgkmcnt(7)
    buffer_load_dwordx4 v241, s[12:15], s46 offen offset:2048 lds
    v_mfma_f32_16x16x32_bf16 v[132:135], v[216:219], v[192:195], v[132:135]
    s_add_u32 m0, s51, 9088
    ds_read_b64_tr_b16 a[250:251], v243 offset:25088
    ds_read_b64_tr_b16 a[252:253], v243 offset:24584
    v_mfma_f32_16x16x32_bf16 v[136:139], v[216:219], v[196:199], v[136:139]
    ds_read_b64_tr_b16 a[254:255], v243 offset:25096
    v_accvgpr_write_b32 a50, 0
    v_mfma_f32_16x16x32_bf16 v[140:143], v[216:219], v[200:203], v[140:143]
    s_waitcnt lgkmcnt(8)
    buffer_load_dwordx4 v240, s[12:15], s46 offen offset:128 lds
    v_mfma_f32_16x16x32_bf16 v[180:183], v[220:223], v[192:195], v[180:183]
    ds_read_b64_tr_b16 v[216:217], v242 offset:25600
    ds_read_b64_tr_b16 v[218:219], v242 offset:26112
    v_mfma_f32_16x16x32_bf16 v[184:187], v[220:223], v[196:199], v[184:187]
    v_accvgpr_write_b32 a51, 0
    v_accvgpr_write_b32 a52, 0
    v_mfma_f32_16x16x32_bf16 v[188:191], v[220:223], v[200:203], v[188:191]
    s_waitcnt lgkmcnt(8)
    buffer_load_dwordx4 v241, s[12:15], s46 offen offset:2176 lds
    v_mfma_f32_16x16x32_bf16 v[96:99], a[240:243], a[216:219], v[96:99]
    s_add_u32 m0, s52, 142976
    ds_read_b64_tr_b16 v[220:221], v242 offset:25608
    ds_read_b64_tr_b16 v[222:223], v242 offset:26120
    v_mfma_f32_16x16x32_bf16 v[100:103], a[240:243], a[220:223], v[100:103]
    s_add_u32 s46, s46, 262144
    v_accvgpr_write_b32 a53, 0
    v_accvgpr_write_b32 a54, 0
    v_mfma_f32_16x16x32_bf16 v[104:107], a[240:243], a[224:227], v[104:107]
    s_waitcnt lgkmcnt(8)
    buffer_load_dwordx4 v239, s[16:19], s47 offen offset:384 lds
    v_mfma_f32_16x16x32_bf16 v[144:147], a[244:247], a[216:219], v[144:147]
    s_add_u32 m0, s52, 147072
    ds_read_b64_tr_b16 a[240:241], v243 offset:25600
    ds_read_b64_tr_b16 a[242:243], v243 offset:26112
    v_mfma_f32_16x16x32_bf16 v[148:151], a[244:247], a[220:223], v[148:151]
    v_accvgpr_write_b32 a55, 0
    v_accvgpr_write_b32 a56, 0
    v_mfma_f32_16x16x32_bf16 v[152:155], a[244:247], a[224:227], v[152:155]
    s_waitcnt lgkmcnt(8)
    buffer_load_dwordx4 v239, s[16:19], s48 offen offset:384 lds
    v_mfma_f32_16x16x32_bf16 v[108:111], a[248:251], a[216:219], v[108:111]
    s_add_u32 m0, s52, 151168
    ds_read_b64_tr_b16 a[244:245], v243 offset:25608
    ds_read_b64_tr_b16 a[246:247], v243 offset:26120
    v_mfma_f32_16x16x32_bf16 v[112:115], a[248:251], a[220:223], v[112:115]
    v_accvgpr_write_b32 a57, 0
    v_accvgpr_write_b32 a58, 0
    v_mfma_f32_16x16x32_bf16 v[116:119], a[248:251], a[224:227], v[116:119]
    s_waitcnt lgkmcnt(8)
    buffer_load_dwordx4 v239, s[16:19], s49 offen offset:384 lds
    v_mfma_f32_16x16x32_bf16 v[156:159], a[252:255], a[216:219], v[156:159]
    v_accvgpr_write_b32 a59, 0
    v_accvgpr_write_b32 a60, 0
    v_mfma_f32_16x16x32_bf16 v[160:163], a[252:255], a[220:223], v[160:163]
    v_accvgpr_write_b32 a61, 0
    v_accvgpr_write_b32 a62, 0
    v_mfma_f32_16x16x32_bf16 v[164:167], a[252:255], a[224:227], v[164:167]
    s_waitcnt lgkmcnt(6)
    v_accvgpr_write_b32 a63, 0
    v_accvgpr_write_b32 a64, 0
    v_mfma_f32_16x16x32_bf16 v[120:123], v[216:219], a[216:219], v[120:123]
    v_accvgpr_write_b32 a65, 0
    v_accvgpr_write_b32 a66, 0
    v_mfma_f32_16x16x32_bf16 v[124:127], v[216:219], a[220:223], v[124:127]
    s_waitcnt vmcnt(12)
    s_barrier
    ds_read_b128 a[228:231], v244
    v_mfma_f32_16x16x32_bf16 v[128:131], v[216:219], a[224:227], v[128:131]
    s_waitcnt lgkmcnt(5)
    ds_read_b64_tr_b16 a[248:249], v242 offset:32768
    ds_read_b64_tr_b16 a[250:251], v242 offset:33280
    v_mfma_f32_16x16x32_bf16 v[168:171], v[220:223], a[216:219], v[168:171]
    s_add_u32 m0, s51, 16384
    ds_read_b128 a[232:235], v244 offset:2048
    ds_read_b128 a[236:239], v244 offset:4096
    v_mfma_f32_16x16x32_bf16 v[172:175], v[220:223], a[220:223], v[172:175]
    buffer_load_dwordx4 v240, s[12:15], s46 offen lds
    v_mfma_f32_16x16x32_bf16 v[176:179], v[220:223], a[224:227], v[176:179]
    s_waitcnt lgkmcnt(7)
    buffer_load_dwordx4 v241, s[12:15], s46 offen offset:2048 lds
    v_mfma_f32_16x16x32_bf16 v[132:135], a[240:243], a[216:219], v[132:135]
    s_add_u32 m0, s51, 17280
    ds_read_b64_tr_b16 a[252:253], v242 offset:32776
    ds_read_b64_tr_b16 a[254:255], v242 offset:33288
    v_mfma_f32_16x16x32_bf16 v[136:139], a[240:243], a[220:223], v[136:139]
    ds_read_b64_tr_b16 v[216:217], v243 offset:32768
    ds_read_b64_tr_b16 v[218:219], v243 offset:33280
    v_mfma_f32_16x16x32_bf16 v[140:143], a[240:243], a[224:227], v[140:143]
    s_waitcnt lgkmcnt(9)
    buffer_load_dwordx4 v240, s[12:15], s46 offen offset:128 lds
    v_mfma_f32_16x16x32_bf16 v[180:183], a[244:247], a[216:219], v[180:183]
    ds_read_b64_tr_b16 v[220:221], v243 offset:32776
    ds_read_b64_tr_b16 v[222:223], v243 offset:33288
    v_mfma_f32_16x16x32_bf16 v[184:187], a[244:247], a[220:223], v[184:187]
    ds_read_b64_tr_b16 a[240:241], v242 offset:33792
    ds_read_b64_tr_b16 a[242:243], v242 offset:34304
    v_mfma_f32_16x16x32_bf16 v[188:191], a[244:247], a[224:227], v[188:191]
    s_waitcnt lgkmcnt(10)
    buffer_load_dwordx4 v241, s[12:15], s46 offen offset:2176 lds
    v_mfma_f32_16x16x32_bf16 v[96:99], a[248:251], a[228:231], v[96:99]
    s_waitcnt lgkmcnt(9)
    ds_read_b64_tr_b16 a[244:245], v242 offset:33800
    ds_read_b64_tr_b16 a[246:247], v242 offset:34312
    v_mfma_f32_16x16x32_bf16 v[100:103], a[248:251], a[232:235], v[100:103]
    s_waitcnt lgkmcnt(10)
    ds_read_b128 v[192:195], v245
    ds_read_b128 v[196:199], v245 offset:2048
    v_mfma_f32_16x16x32_bf16 v[104:107], a[248:251], a[236:239], v[104:107]
    s_waitcnt lgkmcnt(10)
    ds_read_b128 v[200:203], v245 offset:4096
    ds_read_b64_tr_b16 a[248:249], v243 offset:33792
    v_mfma_f32_16x16x32_bf16 v[144:147], a[252:255], a[228:231], v[144:147]
    s_add_u32 s46, s46, 262144
    ds_read_b64_tr_b16 a[250:251], v243 offset:34304
    v_accvgpr_write_b32 a67, 0
    v_mfma_f32_16x16x32_bf16 v[148:151], a[252:255], a[232:235], v[148:151]
    v_accvgpr_write_b32 a68, 0
    v_accvgpr_write_b32 a69, 0
    v_mfma_f32_16x16x32_bf16 v[152:155], a[252:255], a[236:239], v[152:155]
    s_waitcnt lgkmcnt(11)
    ds_read_b64_tr_b16 a[252:253], v243 offset:33800
    ds_read_b64_tr_b16 a[254:255], v243 offset:34312
    v_mfma_f32_16x16x32_bf16 v[108:111], v[216:219], a[228:231], v[108:111]
    v_accvgpr_write_b32 a70, 0
    v_accvgpr_write_b32 a71, 0
    v_mfma_f32_16x16x32_bf16 v[112:115], v[216:219], a[232:235], v[112:115]
    v_accvgpr_write_b32 a72, 0
    v_accvgpr_write_b32 a73, 0
    v_mfma_f32_16x16x32_bf16 v[116:119], v[216:219], a[236:239], v[116:119]
    s_waitcnt lgkmcnt(11)
    v_accvgpr_write_b32 a74, 0
    v_accvgpr_write_b32 a75, 0
    v_mfma_f32_16x16x32_bf16 v[156:159], v[220:223], a[228:231], v[156:159]
    v_accvgpr_write_b32 a76, 0
    v_accvgpr_write_b32 a77, 0
    v_mfma_f32_16x16x32_bf16 v[160:163], v[220:223], a[232:235], v[160:163]
    v_accvgpr_write_b32 a78, 0
    v_accvgpr_write_b32 a79, 0
    v_mfma_f32_16x16x32_bf16 v[164:167], v[220:223], a[236:239], v[164:167]
    s_waitcnt lgkmcnt(9)
    v_accvgpr_write_b32 a80, 0
    v_accvgpr_write_b32 a81, 0
    v_mfma_f32_16x16x32_bf16 v[120:123], a[240:243], a[228:231], v[120:123]
    v_accvgpr_write_b32 a82, 0
    v_accvgpr_write_b32 a83, 0
    v_mfma_f32_16x16x32_bf16 v[124:127], a[240:243], a[232:235], v[124:127]
    s_waitcnt vmcnt(12) lgkmcnt(4)
    s_barrier
    ds_read_b64_tr_b16 v[216:217], v242
    v_mfma_f32_16x16x32_bf16 v[128:131], a[240:243], a[236:239], v[128:131]
    s_add_u32 m0, s51, 24576
    ds_read_b64_tr_b16 v[218:219], v242 offset:512
    ds_read_b64_tr_b16 v[220:221], v242 offset:8
    v_mfma_f32_16x16x32_bf16 v[168:171], a[244:247], a[228:231], v[168:171]
    buffer_load_dwordx4 v240, s[12:15], s46 offen lds
    v_mfma_f32_16x16x32_bf16 v[172:175], a[244:247], a[232:235], v[172:175]
    ds_read_b64_tr_b16 v[222:223], v242 offset:520
    ds_read_b64_tr_b16 a[240:241], v243
    v_mfma_f32_16x16x32_bf16 v[176:179], a[244:247], a[236:239], v[176:179]
    s_waitcnt lgkmcnt(7)
    buffer_load_dwordx4 v241, s[12:15], s46 offen offset:2048 lds
    v_mfma_f32_16x16x32_bf16 v[132:135], a[248:251], a[228:231], v[132:135]
    s_add_u32 m0, s51, 25472
    ds_read_b64_tr_b16 a[242:243], v243 offset:512
    ds_read_b64_tr_b16 a[244:245], v243 offset:8
    v_mfma_f32_16x16x32_bf16 v[136:139], a[248:251], a[232:235], v[136:139]
    ds_read_b64_tr_b16 a[246:247], v243 offset:520
    v_accvgpr_write_b32 a84, 0
    v_mfma_f32_16x16x32_bf16 v[140:143], a[248:251], a[236:239], v[140:143]
    s_waitcnt lgkmcnt(8)
    buffer_load_dwordx4 v240, s[12:15], s46 offen offset:128 lds
    v_mfma_f32_16x16x32_bf16 v[180:183], a[252:255], a[228:231], v[180:183]
    ds_read_b64_tr_b16 a[248:249], v242 offset:1024
    ds_read_b64_tr_b16 a[250:251], v242 offset:1536
    v_mfma_f32_16x16x32_bf16 v[184:187], a[252:255], a[232:235], v[184:187]
    v_accvgpr_write_b32 a85, 0
    v_accvgpr_write_b32 a86, 0
    v_mfma_f32_16x16x32_bf16 v[188:191], a[252:255], a[236:239], v[188:191]
    s_waitcnt lgkmcnt(8)
    buffer_load_dwordx4 v241, s[12:15], s46 offen offset:2176 lds
    v_mfma_f32_16x16x32_bf16 v[96:99], v[216:219], v[192:195], v[96:99]
    s_add_u32 m0, s52, 130560
    ds_read_b64_tr_b16 a[252:253], v242 offset:1032
    ds_read_b64_tr_b16 a[254:255], v242 offset:1544
    v_mfma_f32_16x16x32_bf16 v[100:103], v[216:219], v[196:199], v[100:103]
    s_add_u32 s46, s46, 262144
    v_accvgpr_write_b32 a87, 0
    v_accvgpr_write_b32 a88, 0
    v_mfma_f32_16x16x32_bf16 v[104:107], v[216:219], v[200:203], v[104:107]
    s_waitcnt lgkmcnt(8)
    buffer_load_dwordx4 v239, s[16:19], s47 offen offset:512 lds
    v_mfma_f32_16x16x32_bf16 v[144:147], v[220:223], v[192:195], v[144:147]
    s_add_u32 m0, s52, 134656
    ds_read_b64_tr_b16 v[216:217], v243 offset:1024
    ds_read_b64_tr_b16 v[218:219], v243 offset:1536
    v_mfma_f32_16x16x32_bf16 v[148:151], v[220:223], v[196:199], v[148:151]
    v_accvgpr_write_b32 a89, 0
    v_accvgpr_write_b32 a90, 0
    v_mfma_f32_16x16x32_bf16 v[152:155], v[220:223], v[200:203], v[152:155]
    s_waitcnt lgkmcnt(8)
    buffer_load_dwordx4 v239, s[16:19], s48 offen offset:512 lds
    v_mfma_f32_16x16x32_bf16 v[108:111], a[240:243], v[192:195], v[108:111]
    s_add_u32 m0, s52, 138752
    ds_read_b64_tr_b16 v[220:221], v243 offset:1032
    ds_read_b64_tr_b16 v[222:223], v243 offset:1544
    v_mfma_f32_16x16x32_bf16 v[112:115], a[240:243], v[196:199], v[112:115]
    v_accvgpr_write_b32 a91, 0
    v_accvgpr_write_b32 a92, 0
    v_mfma_f32_16x16x32_bf16 v[116:119], a[240:243], v[200:203], v[116:119]
    s_waitcnt lgkmcnt(8)
    buffer_load_dwordx4 v239, s[16:19], s49 offen offset:512 lds
    v_mfma_f32_16x16x32_bf16 v[156:159], a[244:247], v[192:195], v[156:159]
    v_accvgpr_write_b32 a93, 0
    v_accvgpr_write_b32 a94, 0
    v_mfma_f32_16x16x32_bf16 v[160:163], a[244:247], v[196:199], v[160:163]
    v_accvgpr_write_b32 a95, 0
    v_accvgpr_write_b32 a96, 0
    v_mfma_f32_16x16x32_bf16 v[164:167], a[244:247], v[200:203], v[164:167]
    s_waitcnt lgkmcnt(6)
    v_accvgpr_write_b32 a97, 0
    v_accvgpr_write_b32 a98, 0
    v_mfma_f32_16x16x32_bf16 v[120:123], a[248:251], v[192:195], v[120:123]
    v_accvgpr_write_b32 a99, 0
    v_accvgpr_write_b32 a100, 0
    v_mfma_f32_16x16x32_bf16 v[124:127], a[248:251], v[196:199], v[124:127]
    s_waitcnt vmcnt(11)
    s_barrier
    ds_read_b128 a[216:219], v244 offset:12288
    v_mfma_f32_16x16x32_bf16 v[128:131], a[248:251], v[200:203], v[128:131]
    s_waitcnt lgkmcnt(5)
    ds_read_b64_tr_b16 a[240:241], v242 offset:8192
    ds_read_b64_tr_b16 a[242:243], v242 offset:8704
    v_mfma_f32_16x16x32_bf16 v[168:171], a[252:255], v[192:195], v[168:171]
    s_add_u32 m0, s51, 32768
    ds_read_b128 a[220:223], v244 offset:14336
    ds_read_b128 a[224:227], v244 offset:16384
    v_mfma_f32_16x16x32_bf16 v[172:175], a[252:255], v[196:199], v[172:175]
    buffer_load_dwordx4 v240, s[12:15], s46 offen lds
    v_mfma_f32_16x16x32_bf16 v[176:179], a[252:255], v[200:203], v[176:179]
    s_waitcnt lgkmcnt(7)
    buffer_load_dwordx4 v241, s[12:15], s46 offen offset:2048 lds
    v_mfma_f32_16x16x32_bf16 v[132:135], v[216:219], v[192:195], v[132:135]
    s_add_u32 m0, s51, 33664
    ds_read_b64_tr_b16 a[244:245], v242 offset:8200
    ds_read_b64_tr_b16 a[246:247], v242 offset:8712
    v_mfma_f32_16x16x32_bf16 v[136:139], v[216:219], v[196:199], v[136:139]
    ds_read_b64_tr_b16 a[248:249], v243 offset:8192
    ds_read_b64_tr_b16 a[250:251], v243 offset:8704
    v_mfma_f32_16x16x32_bf16 v[140:143], v[216:219], v[200:203], v[140:143]
    s_waitcnt lgkmcnt(9)
    buffer_load_dwordx4 v240, s[12:15], s46 offen offset:128 lds
    v_mfma_f32_16x16x32_bf16 v[180:183], v[220:223], v[192:195], v[180:183]
    ds_read_b64_tr_b16 a[252:253], v243 offset:8200
    ds_read_b64_tr_b16 a[254:255], v243 offset:8712
    v_mfma_f32_16x16x32_bf16 v[184:187], v[220:223], v[196:199], v[184:187]
    ds_read_b64_tr_b16 v[216:217], v242 offset:9216
    ds_read_b64_tr_b16 v[218:219], v242 offset:9728
    v_mfma_f32_16x16x32_bf16 v[188:191], v[220:223], v[200:203], v[188:191]
    s_waitcnt lgkmcnt(10)
    buffer_load_dwordx4 v241, s[12:15], s46 offen offset:2176 lds
    v_mfma_f32_16x16x32_bf16 v[96:99], a[240:243], a[216:219], v[96:99]
    s_waitcnt lgkmcnt(9)
    ds_read_b64_tr_b16 v[220:221], v242 offset:9224
    ds_read_b64_tr_b16 v[222:223], v242 offset:9736
    v_mfma_f32_16x16x32_bf16 v[100:103], a[240:243], a[220:223], v[100:103]
    s_waitcnt lgkmcnt(10)
    ds_read_b128 a[228:231], v245 offset:12288
    ds_read_b128 a[232:235], v245 offset:14336
    v_mfma_f32_16x16x32_bf16 v[104:107], a[240:243], a[224:227], v[104:107]
    s_waitcnt lgkmcnt(10)
    ds_read_b128 a[236:239], v245 offset:16384
    ds_read_b64_tr_b16 a[240:241], v243 offset:9216
    v_mfma_f32_16x16x32_bf16 v[144:147], a[244:247], a[216:219], v[144:147]
    s_add_u32 s46, s46, 262144
    ds_read_b64_tr_b16 a[242:243], v243 offset:9728
    v_accvgpr_write_b32 a101, 0
    v_mfma_f32_16x16x32_bf16 v[148:151], a[244:247], a[220:223], v[148:151]
    v_accvgpr_write_b32 a102, 0
    v_accvgpr_write_b32 a103, 0
    v_mfma_f32_16x16x32_bf16 v[152:155], a[244:247], a[224:227], v[152:155]
    s_waitcnt lgkmcnt(11)
    ds_read_b64_tr_b16 a[244:245], v243 offset:9224
    ds_read_b64_tr_b16 a[246:247], v243 offset:9736
    v_mfma_f32_16x16x32_bf16 v[108:111], a[248:251], a[216:219], v[108:111]
    v_accvgpr_write_b32 a104, 0
    v_accvgpr_write_b32 a105, 0
    v_mfma_f32_16x16x32_bf16 v[112:115], a[248:251], a[220:223], v[112:115]
    v_accvgpr_write_b32 a106, 0
    v_accvgpr_write_b32 a107, 0
    v_mfma_f32_16x16x32_bf16 v[116:119], a[248:251], a[224:227], v[116:119]
    s_waitcnt lgkmcnt(11)
    v_accvgpr_write_b32 a108, 0
    v_accvgpr_write_b32 a109, 0
    v_mfma_f32_16x16x32_bf16 v[156:159], a[252:255], a[216:219], v[156:159]
    v_accvgpr_write_b32 a110, 0
    v_accvgpr_write_b32 a111, 0
    v_mfma_f32_16x16x32_bf16 v[160:163], a[252:255], a[220:223], v[160:163]
    v_accvgpr_write_b32 a112, 0
    v_accvgpr_write_b32 a113, 0
    v_mfma_f32_16x16x32_bf16 v[164:167], a[252:255], a[224:227], v[164:167]
    s_waitcnt lgkmcnt(9)
    v_accvgpr_write_b32 a114, 0
    v_accvgpr_write_b32 a115, 0
    v_mfma_f32_16x16x32_bf16 v[120:123], v[216:219], a[216:219], v[120:123]
    v_accvgpr_write_b32 a116, 0
    v_accvgpr_write_b32 a117, 0
    v_mfma_f32_16x16x32_bf16 v[124:127], v[216:219], a[220:223], v[124:127]
    s_waitcnt vmcnt(11) lgkmcnt(4)
    s_barrier
    ds_read_b64_tr_b16 a[248:249], v242 offset:16384
    v_mfma_f32_16x16x32_bf16 v[128:131], v[216:219], a[224:227], v[128:131]
    s_add_u32 m0, s51, 0
    ds_read_b64_tr_b16 a[250:251], v242 offset:16896
    ds_read_b64_tr_b16 a[252:253], v242 offset:16392
    v_mfma_f32_16x16x32_bf16 v[168:171], v[220:223], a[216:219], v[168:171]
    buffer_load_dwordx4 v240, s[12:15], s46 offen lds
    v_mfma_f32_16x16x32_bf16 v[172:175], v[220:223], a[220:223], v[172:175]
    ds_read_b64_tr_b16 a[254:255], v242 offset:16904
    ds_read_b64_tr_b16 v[216:217], v243 offset:16384
    v_mfma_f32_16x16x32_bf16 v[176:179], v[220:223], a[224:227], v[176:179]
    s_waitcnt lgkmcnt(7)
    buffer_load_dwordx4 v241, s[12:15], s46 offen offset:2048 lds
    v_mfma_f32_16x16x32_bf16 v[132:135], a[240:243], a[216:219], v[132:135]
    s_add_u32 m0, s51, 896
    ds_read_b64_tr_b16 v[218:219], v243 offset:16896
    ds_read_b64_tr_b16 v[220:221], v243 offset:16392
    v_mfma_f32_16x16x32_bf16 v[136:139], a[240:243], a[220:223], v[136:139]
    ds_read_b64_tr_b16 v[222:223], v243 offset:16904
    v_accvgpr_write_b32 a118, 0
    v_mfma_f32_16x16x32_bf16 v[140:143], a[240:243], a[224:227], v[140:143]
    s_waitcnt lgkmcnt(8)
    buffer_load_dwordx4 v240, s[12:15], s46 offen offset:128 lds
    v_mfma_f32_16x16x32_bf16 v[180:183], a[244:247], a[216:219], v[180:183]
    ds_read_b64_tr_b16 a[240:241], v242 offset:17408
    ds_read_b64_tr_b16 a[242:243], v242 offset:17920
    v_mfma_f32_16x16x32_bf16 v[184:187], a[244:247], a[220:223], v[184:187]
    v_accvgpr_write_b32 a119, 0
    v_accvgpr_write_b32 a120, 0
    v_mfma_f32_16x16x32_bf16 v[188:191], a[244:247], a[224:227], v[188:191]
    s_waitcnt lgkmcnt(8)
    buffer_load_dwordx4 v241, s[12:15], s46 offen offset:2176 lds
    v_mfma_f32_16x16x32_bf16 v[96:99], a[248:251], a[228:231], v[96:99]
    s_add_u32 m0, s52, 142720
    ds_read_b64_tr_b16 a[244:245], v242 offset:17416
    ds_read_b64_tr_b16 a[246:247], v242 offset:17928
    v_mfma_f32_16x16x32_bf16 v[100:103], a[248:251], a[232:235], v[100:103]
    s_add_u32 s46, s46, 262144
    v_accvgpr_write_b32 a121, 0
    v_accvgpr_write_b32 a122, 0
    v_mfma_f32_16x16x32_bf16 v[104:107], a[248:251], a[236:239], v[104:107]
    s_waitcnt lgkmcnt(8)
    buffer_load_dwordx4 v239, s[16:19], s47 offen offset:640 lds
    v_mfma_f32_16x16x32_bf16 v[144:147], a[252:255], a[228:231], v[144:147]
    s_add_u32 m0, s52, 146816
    ds_read_b64_tr_b16 a[248:249], v243 offset:17408
    ds_read_b64_tr_b16 a[250:251], v243 offset:17920
    v_mfma_f32_16x16x32_bf16 v[148:151], a[252:255], a[232:235], v[148:151]
    v_accvgpr_write_b32 a123, 0
    v_accvgpr_write_b32 a124, 0
    v_mfma_f32_16x16x32_bf16 v[152:155], a[252:255], a[236:239], v[152:155]
    s_waitcnt lgkmcnt(8)
    buffer_load_dwordx4 v239, s[16:19], s48 offen offset:640 lds
    v_mfma_f32_16x16x32_bf16 v[108:111], v[216:219], a[228:231], v[108:111]
    s_add_u32 m0, s52, 150912
    ds_read_b64_tr_b16 a[252:253], v243 offset:17416
    ds_read_b64_tr_b16 a[254:255], v243 offset:17928
    v_mfma_f32_16x16x32_bf16 v[112:115], v[216:219], a[232:235], v[112:115]
    v_accvgpr_write_b32 a125, 0
    v_accvgpr_write_b32 a126, 0
    v_mfma_f32_16x16x32_bf16 v[116:119], v[216:219], a[236:239], v[116:119]
    s_waitcnt lgkmcnt(8)
    buffer_load_dwordx4 v239, s[16:19], s49 offen offset:640 lds
    v_mfma_f32_16x16x32_bf16 v[156:159], v[220:223], a[228:231], v[156:159]
    v_accvgpr_write_b32 a127, 0
    v_accvgpr_write_b32 a128, 0
    v_mfma_f32_16x16x32_bf16 v[160:163], v[220:223], a[232:235], v[160:163]
    v_accvgpr_write_b32 a129, 0
    v_accvgpr_write_b32 a130, 0
    v_mfma_f32_16x16x32_bf16 v[164:167], v[220:223], a[236:239], v[164:167]
    s_waitcnt lgkmcnt(6)
    v_accvgpr_write_b32 a131, 0
    v_accvgpr_write_b32 a132, 0
    v_mfma_f32_16x16x32_bf16 v[120:123], a[240:243], a[228:231], v[120:123]
    v_accvgpr_write_b32 a133, 0
    v_accvgpr_write_b32 a134, 0
    v_mfma_f32_16x16x32_bf16 v[124:127], a[240:243], a[232:235], v[124:127]
    s_waitcnt vmcnt(11)
    s_barrier
    ds_read_b128 v[192:195], v244
    v_mfma_f32_16x16x32_bf16 v[128:131], a[240:243], a[236:239], v[128:131]
    s_waitcnt lgkmcnt(5)
    ds_read_b64_tr_b16 v[216:217], v242 offset:24576
    ds_read_b64_tr_b16 v[218:219], v242 offset:25088
    v_mfma_f32_16x16x32_bf16 v[168:171], a[244:247], a[228:231], v[168:171]
    s_add_u32 m0, s51, 8192
    ds_read_b128 v[196:199], v244 offset:2048
    ds_read_b128 v[200:203], v244 offset:4096
    v_mfma_f32_16x16x32_bf16 v[172:175], a[244:247], a[232:235], v[172:175]
    buffer_load_dwordx4 v240, s[12:15], s46 offen lds
    v_mfma_f32_16x16x32_bf16 v[176:179], a[244:247], a[236:239], v[176:179]
    s_waitcnt lgkmcnt(7)
    buffer_load_dwordx4 v241, s[12:15], s46 offen offset:2048 lds
    v_mfma_f32_16x16x32_bf16 v[132:135], a[248:251], a[228:231], v[132:135]
    s_add_u32 m0, s51, 9088
    ds_read_b64_tr_b16 v[220:221], v242 offset:24584
    ds_read_b64_tr_b16 v[222:223], v242 offset:25096
    v_mfma_f32_16x16x32_bf16 v[136:139], a[248:251], a[232:235], v[136:139]
    ds_read_b64_tr_b16 a[240:241], v243 offset:24576
    ds_read_b64_tr_b16 a[242:243], v243 offset:25088
    v_mfma_f32_16x16x32_bf16 v[140:143], a[248:251], a[236:239], v[140:143]
    s_waitcnt lgkmcnt(9)
    buffer_load_dwordx4 v240, s[12:15], s46 offen offset:128 lds
    v_mfma_f32_16x16x32_bf16 v[180:183], a[252:255], a[228:231], v[180:183]
    ds_read_b64_tr_b16 a[244:245], v243 offset:24584
    ds_read_b64_tr_b16 a[246:247], v243 offset:25096
    v_mfma_f32_16x16x32_bf16 v[184:187], a[252:255], a[232:235], v[184:187]
    ds_read_b64_tr_b16 a[248:249], v242 offset:25600
    ds_read_b64_tr_b16 a[250:251], v242 offset:26112
    v_mfma_f32_16x16x32_bf16 v[188:191], a[252:255], a[236:239], v[188:191]
    s_waitcnt lgkmcnt(10)
    buffer_load_dwordx4 v241, s[12:15], s46 offen offset:2176 lds
    v_mfma_f32_16x16x32_bf16 v[96:99], v[216:219], v[192:195], v[96:99]
    s_waitcnt lgkmcnt(9)
    ds_read_b64_tr_b16 a[252:253], v242 offset:25608
    ds_read_b64_tr_b16 a[254:255], v242 offset:26120
    v_mfma_f32_16x16x32_bf16 v[100:103], v[216:219], v[196:199], v[100:103]
    s_waitcnt lgkmcnt(10)
    ds_read_b128 a[216:219], v245
    ds_read_b128 a[220:223], v245 offset:2048
    v_mfma_f32_16x16x32_bf16 v[104:107], v[216:219], v[200:203], v[104:107]
    s_waitcnt lgkmcnt(10)
    ds_read_b128 a[224:227], v245 offset:4096
    ds_read_b64_tr_b16 v[216:217], v243 offset:25600
    v_mfma_f32_16x16x32_bf16 v[144:147], v[220:223], v[192:195], v[144:147]
    s_add_u32 s46, s46, 262144
    ds_read_b64_tr_b16 v[218:219], v243 offset:26112
    v_accvgpr_write_b32 a135, 0
    v_mfma_f32_16x16x32_bf16 v[148:151], v[220:223], v[196:199], v[148:151]
    v_accvgpr_write_b32 a136, 0
    v_accvgpr_write_b32 a137, 0
    v_mfma_f32_16x16x32_bf16 v[152:155], v[220:223], v[200:203], v[152:155]
    s_waitcnt lgkmcnt(11)
    ds_read_b64_tr_b16 v[220:221], v243 offset:25608
    ds_read_b64_tr_b16 v[222:223], v243 offset:26120
    v_mfma_f32_16x16x32_bf16 v[108:111], a[240:243], v[192:195], v[108:111]
    v_accvgpr_write_b32 a138, 0
    v_accvgpr_write_b32 a139, 0
    v_mfma_f32_16x16x32_bf16 v[112:115], a[240:243], v[196:199], v[112:115]
    v_accvgpr_write_b32 a140, 0
    v_accvgpr_write_b32 a141, 0
    v_mfma_f32_16x16x32_bf16 v[116:119], a[240:243], v[200:203], v[116:119]
    s_waitcnt lgkmcnt(11)
    v_accvgpr_write_b32 a142, 0
    v_accvgpr_write_b32 a143, 0
    v_mfma_f32_16x16x32_bf16 v[156:159], a[244:247], v[192:195], v[156:159]
    v_accvgpr_write_b32 a144, 0
    v_accvgpr_write_b32 a145, 0
    v_mfma_f32_16x16x32_bf16 v[160:163], a[244:247], v[196:199], v[160:163]
    v_accvgpr_write_b32 a146, 0
    v_accvgpr_write_b32 a147, 0
    v_mfma_f32_16x16x32_bf16 v[164:167], a[244:247], v[200:203], v[164:167]
    s_waitcnt lgkmcnt(9)
    v_accvgpr_write_b32 a148, 0
    v_accvgpr_write_b32 a149, 0
    v_mfma_f32_16x16x32_bf16 v[120:123], a[248:251], v[192:195], v[120:123]
    v_accvgpr_write_b32 a150, 0
    v_accvgpr_write_b32 a151, 0
    v_mfma_f32_16x16x32_bf16 v[124:127], a[248:251], v[196:199], v[124:127]
    s_waitcnt vmcnt(11) lgkmcnt(4)
    s_barrier
    ds_read_b64_tr_b16 a[240:241], v242 offset:32768
    v_mfma_f32_16x16x32_bf16 v[128:131], a[248:251], v[200:203], v[128:131]
    s_add_u32 m0, s51, 16384
    ds_read_b64_tr_b16 a[242:243], v242 offset:33280
    ds_read_b64_tr_b16 a[244:245], v242 offset:32776
    v_mfma_f32_16x16x32_bf16 v[168:171], a[252:255], v[192:195], v[168:171]
    buffer_load_dwordx4 v240, s[12:15], s46 offen lds
    v_mfma_f32_16x16x32_bf16 v[172:175], a[252:255], v[196:199], v[172:175]
    ds_read_b64_tr_b16 a[246:247], v242 offset:33288
    ds_read_b64_tr_b16 a[248:249], v243 offset:32768
    v_mfma_f32_16x16x32_bf16 v[176:179], a[252:255], v[200:203], v[176:179]
    s_waitcnt lgkmcnt(7)
    buffer_load_dwordx4 v241, s[12:15], s46 offen offset:2048 lds
    v_mfma_f32_16x16x32_bf16 v[132:135], v[216:219], v[192:195], v[132:135]
    s_add_u32 m0, s51, 17280
    ds_read_b64_tr_b16 a[250:251], v243 offset:33280
    ds_read_b64_tr_b16 a[252:253], v243 offset:32776
    v_mfma_f32_16x16x32_bf16 v[136:139], v[216:219], v[196:199], v[136:139]
    ds_read_b64_tr_b16 a[254:255], v243 offset:33288
    v_accvgpr_write_b32 a152, 0
    v_mfma_f32_16x16x32_bf16 v[140:143], v[216:219], v[200:203], v[140:143]
    s_waitcnt lgkmcnt(8)
    buffer_load_dwordx4 v240, s[12:15], s46 offen offset:128 lds
    v_mfma_f32_16x16x32_bf16 v[180:183], v[220:223], v[192:195], v[180:183]
    ds_read_b64_tr_b16 v[216:217], v242 offset:33792
    ds_read_b64_tr_b16 v[218:219], v242 offset:34304
    v_mfma_f32_16x16x32_bf16 v[184:187], v[220:223], v[196:199], v[184:187]
    v_accvgpr_write_b32 a153, 0
    v_accvgpr_write_b32 a154, 0
    v_mfma_f32_16x16x32_bf16 v[188:191], v[220:223], v[200:203], v[188:191]
    s_waitcnt lgkmcnt(8)
    buffer_load_dwordx4 v241, s[12:15], s46 offen offset:2176 lds
    v_mfma_f32_16x16x32_bf16 v[96:99], a[240:243], a[216:219], v[96:99]
    s_add_u32 m0, s52, 130304
    ds_read_b64_tr_b16 v[220:221], v242 offset:33800
    ds_read_b64_tr_b16 v[222:223], v242 offset:34312
    v_mfma_f32_16x16x32_bf16 v[100:103], a[240:243], a[220:223], v[100:103]
    s_add_u32 s46, s46, 262144
    v_accvgpr_write_b32 a155, 0
    v_accvgpr_write_b32 a156, 0
    v_mfma_f32_16x16x32_bf16 v[104:107], a[240:243], a[224:227], v[104:107]
    s_waitcnt lgkmcnt(8)
    buffer_load_dwordx4 v239, s[16:19], s47 offen offset:768 lds
    v_mfma_f32_16x16x32_bf16 v[144:147], a[244:247], a[216:219], v[144:147]
    s_add_u32 m0, s52, 134400
    ds_read_b64_tr_b16 a[240:241], v243 offset:33792
    ds_read_b64_tr_b16 a[242:243], v243 offset:34304
    v_mfma_f32_16x16x32_bf16 v[148:151], a[244:247], a[220:223], v[148:151]
    v_accvgpr_write_b32 a157, 0
    v_accvgpr_write_b32 a158, 0
    v_mfma_f32_16x16x32_bf16 v[152:155], a[244:247], a[224:227], v[152:155]
    s_waitcnt lgkmcnt(8)
    buffer_load_dwordx4 v239, s[16:19], s48 offen offset:768 lds
    v_mfma_f32_16x16x32_bf16 v[108:111], a[248:251], a[216:219], v[108:111]
    s_add_u32 m0, s52, 138496
    ds_read_b64_tr_b16 a[244:245], v243 offset:33800
    ds_read_b64_tr_b16 a[246:247], v243 offset:34312
    v_mfma_f32_16x16x32_bf16 v[112:115], a[248:251], a[220:223], v[112:115]
    v_accvgpr_write_b32 a159, 0
    v_accvgpr_write_b32 a160, 0
    v_mfma_f32_16x16x32_bf16 v[116:119], a[248:251], a[224:227], v[116:119]
    s_waitcnt lgkmcnt(8)
    buffer_load_dwordx4 v239, s[16:19], s49 offen offset:768 lds
    v_mfma_f32_16x16x32_bf16 v[156:159], a[252:255], a[216:219], v[156:159]
    v_accvgpr_write_b32 a161, 0
    v_accvgpr_write_b32 a162, 0
    v_mfma_f32_16x16x32_bf16 v[160:163], a[252:255], a[220:223], v[160:163]
    v_accvgpr_write_b32 a163, 0
    v_accvgpr_write_b32 a164, 0
    v_mfma_f32_16x16x32_bf16 v[164:167], a[252:255], a[224:227], v[164:167]
    s_waitcnt lgkmcnt(6)
    v_accvgpr_write_b32 a165, 0
    v_accvgpr_write_b32 a166, 0
    v_mfma_f32_16x16x32_bf16 v[120:123], v[216:219], a[216:219], v[120:123]
    v_accvgpr_write_b32 a167, 0
    v_accvgpr_write_b32 a168, 0
    v_mfma_f32_16x16x32_bf16 v[124:127], v[216:219], a[220:223], v[124:127]
    s_waitcnt vmcnt(11)
    s_barrier
    ds_read_b128 a[228:231], v244 offset:12288
    v_mfma_f32_16x16x32_bf16 v[128:131], v[216:219], a[224:227], v[128:131]
    s_waitcnt lgkmcnt(5)
    ds_read_b64_tr_b16 a[248:249], v242
    ds_read_b64_tr_b16 a[250:251], v242 offset:512
    v_mfma_f32_16x16x32_bf16 v[168:171], v[220:223], a[216:219], v[168:171]
    s_add_u32 m0, s51, 24576
    ds_read_b128 a[232:235], v244 offset:14336
    ds_read_b128 a[236:239], v244 offset:16384
    v_mfma_f32_16x16x32_bf16 v[172:175], v[220:223], a[220:223], v[172:175]
    buffer_load_dwordx4 v240, s[12:15], s46 offen lds
    v_mfma_f32_16x16x32_bf16 v[176:179], v[220:223], a[224:227], v[176:179]
    s_waitcnt lgkmcnt(7)
    buffer_load_dwordx4 v241, s[12:15], s46 offen offset:2048 lds
    v_mfma_f32_16x16x32_bf16 v[132:135], a[240:243], a[216:219], v[132:135]
    s_add_u32 m0, s51, 25472
    ds_read_b64_tr_b16 a[252:253], v242 offset:8
    ds_read_b64_tr_b16 a[254:255], v242 offset:520
    v_mfma_f32_16x16x32_bf16 v[136:139], a[240:243], a[220:223], v[136:139]
    ds_read_b64_tr_b16 v[216:217], v243
    ds_read_b64_tr_b16 v[218:219], v243 offset:512
    v_mfma_f32_16x16x32_bf16 v[140:143], a[240:243], a[224:227], v[140:143]
    s_waitcnt lgkmcnt(9)
    buffer_load_dwordx4 v240, s[12:15], s46 offen offset:128 lds
    v_mfma_f32_16x16x32_bf16 v[180:183], a[244:247], a[216:219], v[180:183]
    ds_read_b64_tr_b16 v[220:221], v243 offset:8
    ds_read_b64_tr_b16 v[222:223], v243 offset:520
    v_mfma_f32_16x16x32_bf16 v[184:187], a[244:247], a[220:223], v[184:187]
    ds_read_b64_tr_b16 a[240:241], v242 offset:1024
    ds_read_b64_tr_b16 a[242:243], v242 offset:1536
    v_mfma_f32_16x16x32_bf16 v[188:191], a[244:247], a[224:227], v[188:191]
    s_waitcnt lgkmcnt(10)
    buffer_load_dwordx4 v241, s[12:15], s46 offen offset:2176 lds
    v_mfma_f32_16x16x32_bf16 v[96:99], a[248:251], a[228:231], v[96:99]
    s_waitcnt lgkmcnt(9)
    ds_read_b64_tr_b16 a[244:245], v242 offset:1032
    ds_read_b64_tr_b16 a[246:247], v242 offset:1544
    v_mfma_f32_16x16x32_bf16 v[100:103], a[248:251], a[232:235], v[100:103]
    s_waitcnt lgkmcnt(10)
    ds_read_b128 v[192:195], v245 offset:12288
    ds_read_b128 v[196:199], v245 offset:14336
    v_mfma_f32_16x16x32_bf16 v[104:107], a[248:251], a[236:239], v[104:107]
    s_waitcnt lgkmcnt(10)
    ds_read_b128 v[200:203], v245 offset:16384
    ds_read_b64_tr_b16 a[248:249], v243 offset:1024
    v_mfma_f32_16x16x32_bf16 v[144:147], a[252:255], a[228:231], v[144:147]
    s_add_u32 s46, s46, 262144
    ds_read_b64_tr_b16 a[250:251], v243 offset:1536
    v_accvgpr_write_b32 a169, 0
    v_mfma_f32_16x16x32_bf16 v[148:151], a[252:255], a[232:235], v[148:151]
    v_accvgpr_write_b32 a170, 0
    v_accvgpr_write_b32 a171, 0
    v_mfma_f32_16x16x32_bf16 v[152:155], a[252:255], a[236:239], v[152:155]
    s_waitcnt lgkmcnt(11)
    ds_read_b64_tr_b16 a[252:253], v243 offset:1032
    ds_read_b64_tr_b16 a[254:255], v243 offset:1544
    v_mfma_f32_16x16x32_bf16 v[108:111], v[216:219], a[228:231], v[108:111]
    v_accvgpr_write_b32 a172, 0
    v_accvgpr_write_b32 a173, 0
    v_mfma_f32_16x16x32_bf16 v[112:115], v[216:219], a[232:235], v[112:115]
    v_accvgpr_write_b32 a174, 0
    v_accvgpr_write_b32 a175, 0
    v_mfma_f32_16x16x32_bf16 v[116:119], v[216:219], a[236:239], v[116:119]
    s_waitcnt lgkmcnt(11)
    v_accvgpr_write_b32 a176, 0
    v_accvgpr_write_b32 a177, 0
    v_mfma_f32_16x16x32_bf16 v[156:159], v[220:223], a[228:231], v[156:159]
    v_accvgpr_write_b32 a178, 0
    v_accvgpr_write_b32 a179, 0
    v_mfma_f32_16x16x32_bf16 v[160:163], v[220:223], a[232:235], v[160:163]
    v_accvgpr_write_b32 a180, 0
    v_accvgpr_write_b32 a181, 0
    v_mfma_f32_16x16x32_bf16 v[164:167], v[220:223], a[236:239], v[164:167]
    s_waitcnt lgkmcnt(9)
    v_accvgpr_write_b32 a182, 0
    v_accvgpr_write_b32 a183, 0
    v_mfma_f32_16x16x32_bf16 v[120:123], a[240:243], a[228:231], v[120:123]
    v_accvgpr_write_b32 a184, 0
    v_accvgpr_write_b32 a185, 0
    v_mfma_f32_16x16x32_bf16 v[124:127], a[240:243], a[232:235], v[124:127]
    s_waitcnt vmcnt(11) lgkmcnt(4)
    s_barrier
    ds_read_b64_tr_b16 v[216:217], v242 offset:8192
    v_mfma_f32_16x16x32_bf16 v[128:131], a[240:243], a[236:239], v[128:131]
    s_add_u32 m0, s51, 32768
    ds_read_b64_tr_b16 v[218:219], v242 offset:8704
    ds_read_b64_tr_b16 v[220:221], v242 offset:8200
    v_mfma_f32_16x16x32_bf16 v[168:171], a[244:247], a[228:231], v[168:171]
    buffer_load_dwordx4 v240, s[12:15], s46 offen lds
    v_mfma_f32_16x16x32_bf16 v[172:175], a[244:247], a[232:235], v[172:175]
    ds_read_b64_tr_b16 v[222:223], v242 offset:8712
    ds_read_b64_tr_b16 a[240:241], v243 offset:8192
    v_mfma_f32_16x16x32_bf16 v[176:179], a[244:247], a[236:239], v[176:179]
    s_waitcnt lgkmcnt(7)
    buffer_load_dwordx4 v241, s[12:15], s46 offen offset:2048 lds
    v_mfma_f32_16x16x32_bf16 v[132:135], a[248:251], a[228:231], v[132:135]
    s_add_u32 m0, s51, 33664
    ds_read_b64_tr_b16 a[242:243], v243 offset:8704
    ds_read_b64_tr_b16 a[244:245], v243 offset:8200
    v_mfma_f32_16x16x32_bf16 v[136:139], a[248:251], a[232:235], v[136:139]
    ds_read_b64_tr_b16 a[246:247], v243 offset:8712
    v_accvgpr_write_b32 a186, 0
    v_mfma_f32_16x16x32_bf16 v[140:143], a[248:251], a[236:239], v[140:143]
    s_waitcnt lgkmcnt(8)
    buffer_load_dwordx4 v240, s[12:15], s46 offen offset:128 lds
    v_mfma_f32_16x16x32_bf16 v[180:183], a[252:255], a[228:231], v[180:183]
    ds_read_b64_tr_b16 a[248:249], v242 offset:9216
    ds_read_b64_tr_b16 a[250:251], v242 offset:9728
    v_mfma_f32_16x16x32_bf16 v[184:187], a[252:255], a[232:235], v[184:187]
    v_accvgpr_write_b32 a187, 0
    v_accvgpr_write_b32 a188, 0
    v_mfma_f32_16x16x32_bf16 v[188:191], a[252:255], a[236:239], v[188:191]
    s_waitcnt lgkmcnt(8)
    buffer_load_dwordx4 v241, s[12:15], s46 offen offset:2176 lds
    v_mfma_f32_16x16x32_bf16 v[96:99], v[216:219], v[192:195], v[96:99]
    s_add_u32 m0, s52, 142464
    ds_read_b64_tr_b16 a[252:253], v242 offset:9224
    ds_read_b64_tr_b16 a[254:255], v242 offset:9736
    v_mfma_f32_16x16x32_bf16 v[100:103], v[216:219], v[196:199], v[100:103]
    s_add_u32 s46, s46, 262144
    v_accvgpr_write_b32 a189, 0
    v_accvgpr_write_b32 a190, 0
    v_mfma_f32_16x16x32_bf16 v[104:107], v[216:219], v[200:203], v[104:107]
    s_waitcnt lgkmcnt(8)
    buffer_load_dwordx4 v239, s[16:19], s47 offen offset:896 lds
    v_mfma_f32_16x16x32_bf16 v[144:147], v[220:223], v[192:195], v[144:147]
    s_add_u32 m0, s52, 146560
    ds_read_b64_tr_b16 v[216:217], v243 offset:9216
    ds_read_b64_tr_b16 v[218:219], v243 offset:9728
    v_mfma_f32_16x16x32_bf16 v[148:151], v[220:223], v[196:199], v[148:151]
    v_accvgpr_write_b32 a191, 0
    v_accvgpr_write_b32 a192, 0
    v_mfma_f32_16x16x32_bf16 v[152:155], v[220:223], v[200:203], v[152:155]
    s_waitcnt lgkmcnt(8)
    buffer_load_dwordx4 v239, s[16:19], s48 offen offset:896 lds
    v_mfma_f32_16x16x32_bf16 v[108:111], a[240:243], v[192:195], v[108:111]
    s_add_u32 m0, s52, 150656
    ds_read_b64_tr_b16 v[220:221], v243 offset:9224
    ds_read_b64_tr_b16 v[222:223], v243 offset:9736
    v_mfma_f32_16x16x32_bf16 v[112:115], a[240:243], v[196:199], v[112:115]
    v_accvgpr_write_b32 a193, 0
    v_accvgpr_write_b32 a194, 0
    v_mfma_f32_16x16x32_bf16 v[116:119], a[240:243], v[200:203], v[116:119]
    s_waitcnt lgkmcnt(8)
    buffer_load_dwordx4 v239, s[16:19], s49 offen offset:896 lds
    v_mfma_f32_16x16x32_bf16 v[156:159], a[244:247], v[192:195], v[156:159]
    v_accvgpr_write_b32 a195, 0
    v_accvgpr_write_b32 a196, 0
    v_mfma_f32_16x16x32_bf16 v[160:163], a[244:247], v[196:199], v[160:163]
    v_accvgpr_write_b32 a197, 0
    v_accvgpr_write_b32 a198, 0
    v_mfma_f32_16x16x32_bf16 v[164:167], a[244:247], v[200:203], v[164:167]
    s_waitcnt lgkmcnt(6)
    v_accvgpr_write_b32 a199, 0
    v_accvgpr_write_b32 a200, 0
    v_mfma_f32_16x16x32_bf16 v[120:123], a[248:251], v[192:195], v[120:123]
    v_accvgpr_write_b32 a201, 0
    v_accvgpr_write_b32 a202, 0
    v_mfma_f32_16x16x32_bf16 v[124:127], a[248:251], v[196:199], v[124:127]
    s_waitcnt vmcnt(11)
    s_barrier
    ds_read_b128 a[216:219], v244
    v_mfma_f32_16x16x32_bf16 v[128:131], a[248:251], v[200:203], v[128:131]
    s_waitcnt lgkmcnt(5)
    ds_read_b64_tr_b16 a[240:241], v242 offset:16384
    ds_read_b64_tr_b16 a[242:243], v242 offset:16896
    v_mfma_f32_16x16x32_bf16 v[168:171], a[252:255], v[192:195], v[168:171]
    s_add_u32 m0, s51, 0
    ds_read_b128 a[220:223], v244 offset:2048
    ds_read_b128 a[224:227], v244 offset:4096
    v_mfma_f32_16x16x32_bf16 v[172:175], a[252:255], v[196:199], v[172:175]
    buffer_load_dwordx4 v240, s[12:15], s46 offen lds
    v_mfma_f32_16x16x32_bf16 v[176:179], a[252:255], v[200:203], v[176:179]
    s_waitcnt lgkmcnt(7)
    buffer_load_dwordx4 v241, s[12:15], s46 offen offset:2048 lds
    v_mfma_f32_16x16x32_bf16 v[132:135], v[216:219], v[192:195], v[132:135]
    s_add_u32 m0, s51, 896
    ds_read_b64_tr_b16 a[244:245], v242 offset:16392
    ds_read_b64_tr_b16 a[246:247], v242 offset:16904
    v_mfma_f32_16x16x32_bf16 v[136:139], v[216:219], v[196:199], v[136:139]
    ds_read_b64_tr_b16 a[248:249], v243 offset:16384
    ds_read_b64_tr_b16 a[250:251], v243 offset:16896
    v_mfma_f32_16x16x32_bf16 v[140:143], v[216:219], v[200:203], v[140:143]
    s_waitcnt lgkmcnt(9)
    buffer_load_dwordx4 v240, s[12:15], s46 offen offset:128 lds
    v_mfma_f32_16x16x32_bf16 v[180:183], v[220:223], v[192:195], v[180:183]
    ds_read_b64_tr_b16 a[252:253], v243 offset:16392
    ds_read_b64_tr_b16 a[254:255], v243 offset:16904
    v_mfma_f32_16x16x32_bf16 v[184:187], v[220:223], v[196:199], v[184:187]
    ds_read_b64_tr_b16 v[216:217], v242 offset:17408
    ds_read_b64_tr_b16 v[218:219], v242 offset:17920
    v_mfma_f32_16x16x32_bf16 v[188:191], v[220:223], v[200:203], v[188:191]
    s_waitcnt lgkmcnt(10)
    buffer_load_dwordx4 v241, s[12:15], s46 offen offset:2176 lds
    v_mfma_f32_16x16x32_bf16 v[96:99], a[240:243], a[216:219], v[96:99]
    s_waitcnt lgkmcnt(9)
    ds_read_b64_tr_b16 v[220:221], v242 offset:17416
    ds_read_b64_tr_b16 v[222:223], v242 offset:17928
    v_mfma_f32_16x16x32_bf16 v[100:103], a[240:243], a[220:223], v[100:103]
    s_waitcnt lgkmcnt(10)
    ds_read_b128 a[228:231], v245
    ds_read_b128 a[232:235], v245 offset:2048
    v_mfma_f32_16x16x32_bf16 v[104:107], a[240:243], a[224:227], v[104:107]
    s_waitcnt lgkmcnt(10)
    ds_read_b128 a[236:239], v245 offset:4096
    ds_read_b64_tr_b16 a[240:241], v243 offset:17408
    v_mfma_f32_16x16x32_bf16 v[144:147], a[244:247], a[216:219], v[144:147]
    s_add_u32 s46, s46, 262144
    ds_read_b64_tr_b16 a[242:243], v243 offset:17920
    v_accvgpr_write_b32 a203, 0
    v_mfma_f32_16x16x32_bf16 v[148:151], a[244:247], a[220:223], v[148:151]
    v_accvgpr_write_b32 a204, 0
    v_accvgpr_write_b32 a205, 0
    v_mfma_f32_16x16x32_bf16 v[152:155], a[244:247], a[224:227], v[152:155]
    s_waitcnt lgkmcnt(11)
    ds_read_b64_tr_b16 a[244:245], v243 offset:17416
    ds_read_b64_tr_b16 a[246:247], v243 offset:17928
    v_mfma_f32_16x16x32_bf16 v[108:111], a[248:251], a[216:219], v[108:111]
    v_accvgpr_write_b32 a206, 0
    v_accvgpr_write_b32 a207, 0
    v_mfma_f32_16x16x32_bf16 v[112:115], a[248:251], a[220:223], v[112:115]
    v_accvgpr_write_b32 a208, 0
    v_accvgpr_write_b32 a209, 0
    v_mfma_f32_16x16x32_bf16 v[116:119], a[248:251], a[224:227], v[116:119]
    s_waitcnt lgkmcnt(11)
    v_accvgpr_write_b32 a210, 0
    v_accvgpr_write_b32 a211, 0
    v_mfma_f32_16x16x32_bf16 v[156:159], a[252:255], a[216:219], v[156:159]
    v_accvgpr_write_b32 a212, 0
    v_accvgpr_write_b32 a213, 0
    v_mfma_f32_16x16x32_bf16 v[160:163], a[252:255], a[220:223], v[160:163]
    v_accvgpr_write_b32 a214, 0
    v_accvgpr_write_b32 a215, 0
    v_mfma_f32_16x16x32_bf16 v[164:167], a[252:255], a[224:227], v[164:167]
    s_waitcnt lgkmcnt(9)
    v_mfma_f32_16x16x32_bf16 v[120:123], v[216:219], a[216:219], v[120:123]
    v_mfma_f32_16x16x32_bf16 v[124:127], v[216:219], a[220:223], v[124:127]
    s_waitcnt vmcnt(11) lgkmcnt(4)
    s_barrier
    ds_read_b64_tr_b16 a[248:249], v242 offset:24576
    v_mfma_f32_16x16x32_bf16 v[128:131], v[216:219], a[224:227], v[128:131]
    s_add_u32 m0, s51, 8192
    ds_read_b64_tr_b16 a[250:251], v242 offset:25088
    ds_read_b64_tr_b16 a[252:253], v242 offset:24584
    v_mfma_f32_16x16x32_bf16 v[168:171], v[220:223], a[216:219], v[168:171]
    buffer_load_dwordx4 v240, s[12:15], s46 offen lds
    v_mfma_f32_16x16x32_bf16 v[172:175], v[220:223], a[220:223], v[172:175]
    ds_read_b64_tr_b16 a[254:255], v242 offset:25096
    ds_read_b64_tr_b16 v[216:217], v243 offset:24576
    v_mfma_f32_16x16x32_bf16 v[176:179], v[220:223], a[224:227], v[176:179]
    s_waitcnt lgkmcnt(7)
    buffer_load_dwordx4 v241, s[12:15], s46 offen offset:2048 lds
    v_mfma_f32_16x16x32_bf16 v[132:135], a[240:243], a[216:219], v[132:135]
    s_add_u32 m0, s51, 9088
    ds_read_b64_tr_b16 v[218:219], v243 offset:25088
    ds_read_b64_tr_b16 v[220:221], v243 offset:24584
    v_mfma_f32_16x16x32_bf16 v[136:139], a[240:243], a[220:223], v[136:139]
    ds_read_b64_tr_b16 v[222:223], v243 offset:25096
    v_mfma_f32_16x16x32_bf16 v[140:143], a[240:243], a[224:227], v[140:143]
    s_waitcnt lgkmcnt(8)
    buffer_load_dwordx4 v240, s[12:15], s46 offen offset:128 lds
    v_mfma_f32_16x16x32_bf16 v[180:183], a[244:247], a[216:219], v[180:183]
    ds_read_b64_tr_b16 a[240:241], v242 offset:25600
    ds_read_b64_tr_b16 a[242:243], v242 offset:26112
    v_mfma_f32_16x16x32_bf16 v[184:187], a[244:247], a[220:223], v[184:187]
    v_mfma_f32_16x16x32_bf16 v[188:191], a[244:247], a[224:227], v[188:191]
    s_waitcnt lgkmcnt(8)
    buffer_load_dwordx4 v241, s[12:15], s46 offen offset:2176 lds
    v_mfma_f32_16x16x32_bf16 v[96:99], a[248:251], a[228:231], v[96:99]
    s_add_u32 m0, s52, 130048
    ds_read_b64_tr_b16 a[244:245], v242 offset:25608
    ds_read_b64_tr_b16 a[246:247], v242 offset:26120
    v_mfma_f32_16x16x32_bf16 v[100:103], a[248:251], a[232:235], v[100:103]
    s_add_u32 s46, s46, 262144
    v_mfma_f32_16x16x32_bf16 v[104:107], a[248:251], a[236:239], v[104:107]
    s_waitcnt lgkmcnt(8)
    buffer_load_dwordx4 v239, s[16:19], s47 offen offset:1024 lds
    v_mfma_f32_16x16x32_bf16 v[144:147], a[252:255], a[228:231], v[144:147]
    s_add_u32 m0, s52, 134144
    ds_read_b64_tr_b16 a[248:249], v243 offset:25600
    ds_read_b64_tr_b16 a[250:251], v243 offset:26112
    v_mfma_f32_16x16x32_bf16 v[148:151], a[252:255], a[232:235], v[148:151]
    v_mfma_f32_16x16x32_bf16 v[152:155], a[252:255], a[236:239], v[152:155]
    s_waitcnt lgkmcnt(8)
    buffer_load_dwordx4 v239, s[16:19], s48 offen offset:1024 lds
    v_mfma_f32_16x16x32_bf16 v[108:111], v[216:219], a[228:231], v[108:111]
    s_add_u32 m0, s52, 138240
    ds_read_b64_tr_b16 a[252:253], v243 offset:25608
    ds_read_b64_tr_b16 a[254:255], v243 offset:26120
    v_mfma_f32_16x16x32_bf16 v[112:115], v[216:219], a[232:235], v[112:115]
    v_mfma_f32_16x16x32_bf16 v[116:119], v[216:219], a[236:239], v[116:119]
    s_waitcnt lgkmcnt(8)
    buffer_load_dwordx4 v239, s[16:19], s49 offen offset:1024 lds
    v_mfma_f32_16x16x32_bf16 v[156:159], v[220:223], a[228:231], v[156:159]
    v_mfma_f32_16x16x32_bf16 v[160:163], v[220:223], a[232:235], v[160:163]
    v_mfma_f32_16x16x32_bf16 v[164:167], v[220:223], a[236:239], v[164:167]
    s_waitcnt lgkmcnt(6)
    v_mfma_f32_16x16x32_bf16 v[120:123], a[240:243], a[228:231], v[120:123]
    v_mfma_f32_16x16x32_bf16 v[124:127], a[240:243], a[232:235], v[124:127]
    s_waitcnt vmcnt(11)
    s_barrier
    ds_read_b128 v[192:195], v244 offset:12288
    v_mfma_f32_16x16x32_bf16 v[128:131], a[240:243], a[236:239], v[128:131]
    s_waitcnt lgkmcnt(5)
    ds_read_b64_tr_b16 v[216:217], v242 offset:32768
    ds_read_b64_tr_b16 v[218:219], v242 offset:33280
    v_mfma_f32_16x16x32_bf16 v[168:171], a[244:247], a[228:231], v[168:171]
    s_add_u32 m0, s51, 16384
    ds_read_b128 v[196:199], v244 offset:14336
    ds_read_b128 v[200:203], v244 offset:16384
    v_mfma_f32_16x16x32_bf16 v[172:175], a[244:247], a[232:235], v[172:175]
    buffer_load_dwordx4 v240, s[12:15], s46 offen lds
    v_mfma_f32_16x16x32_bf16 v[176:179], a[244:247], a[236:239], v[176:179]
    s_waitcnt lgkmcnt(7)
    buffer_load_dwordx4 v241, s[12:15], s46 offen offset:2048 lds
    v_mfma_f32_16x16x32_bf16 v[132:135], a[248:251], a[228:231], v[132:135]
    s_add_u32 m0, s51, 17280
    ds_read_b64_tr_b16 v[220:221], v242 offset:32776
    ds_read_b64_tr_b16 v[222:223], v242 offset:33288
    v_mfma_f32_16x16x32_bf16 v[136:139], a[248:251], a[232:235], v[136:139]
    ds_read_b64_tr_b16 a[240:241], v243 offset:32768
    ds_read_b64_tr_b16 a[242:243], v243 offset:33280
    v_mfma_f32_16x16x32_bf16 v[140:143], a[248:251], a[236:239], v[140:143]
    s_waitcnt lgkmcnt(9)
    buffer_load_dwordx4 v240, s[12:15], s46 offen offset:128 lds
    v_mfma_f32_16x16x32_bf16 v[180:183], a[252:255], a[228:231], v[180:183]
    ds_read_b64_tr_b16 a[244:245], v243 offset:32776
    ds_read_b64_tr_b16 a[246:247], v243 offset:33288
    v_mfma_f32_16x16x32_bf16 v[184:187], a[252:255], a[232:235], v[184:187]
    ds_read_b64_tr_b16 a[248:249], v242 offset:33792
    ds_read_b64_tr_b16 a[250:251], v242 offset:34304
    v_mfma_f32_16x16x32_bf16 v[188:191], a[252:255], a[236:239], v[188:191]
    s_waitcnt lgkmcnt(10)
    buffer_load_dwordx4 v241, s[12:15], s46 offen offset:2176 lds
    v_mfma_f32_16x16x32_bf16 v[96:99], v[216:219], v[192:195], v[96:99]
    s_waitcnt lgkmcnt(9)
    ds_read_b64_tr_b16 a[252:253], v242 offset:33800
    ds_read_b64_tr_b16 a[254:255], v242 offset:34312
    v_mfma_f32_16x16x32_bf16 v[100:103], v[216:219], v[196:199], v[100:103]
    s_waitcnt lgkmcnt(10)
    ds_read_b128 a[216:219], v245 offset:12288
    ds_read_b128 a[220:223], v245 offset:14336
    v_mfma_f32_16x16x32_bf16 v[104:107], v[216:219], v[200:203], v[104:107]
    s_waitcnt lgkmcnt(10)
    ds_read_b128 a[224:227], v245 offset:16384
    ds_read_b64_tr_b16 v[216:217], v243 offset:33792
    v_mfma_f32_16x16x32_bf16 v[144:147], v[220:223], v[192:195], v[144:147]
    s_sub_u32 s46, s46, 4455936
    ds_read_b64_tr_b16 v[218:219], v243 offset:34304
    v_mov_b32 v224, 0
    v_mfma_f32_16x16x32_bf16 v[148:151], v[220:223], v[196:199], v[148:151]
    v_mov_b32 v225, 0
    v_mov_b32 v226, 0
    v_mfma_f32_16x16x32_bf16 v[152:155], v[220:223], v[200:203], v[152:155]
    s_waitcnt lgkmcnt(11)
    ds_read_b64_tr_b16 v[220:221], v243 offset:33800
    ds_read_b64_tr_b16 v[222:223], v243 offset:34312
    v_mfma_f32_16x16x32_bf16 v[108:111], a[240:243], v[192:195], v[108:111]
    v_mfma_f32_16x16x32_bf16 v[112:115], a[240:243], v[196:199], v[112:115]
    v_mfma_f32_16x16x32_bf16 v[116:119], a[240:243], v[200:203], v[116:119]
    s_waitcnt lgkmcnt(11)
    v_mfma_f32_16x16x32_bf16 v[156:159], a[244:247], v[192:195], v[156:159]
    v_mfma_f32_16x16x32_bf16 v[160:163], a[244:247], v[196:199], v[160:163]
    v_mfma_f32_16x16x32_bf16 v[164:167], a[244:247], v[200:203], v[164:167]
    s_waitcnt lgkmcnt(9)
    v_mfma_f32_16x16x32_bf16 v[120:123], a[248:251], v[192:195], v[120:123]
    v_mfma_f32_16x16x32_bf16 v[124:127], a[248:251], v[196:199], v[124:127]
    s_waitcnt vmcnt(11) lgkmcnt(4)
    s_barrier
    ds_read_b64_tr_b16 a[240:241], v242
    v_mfma_f32_16x16x32_bf16 v[128:131], a[248:251], v[200:203], v[128:131]
    s_add_u32 m0, s51, 24576
    ds_read_b64_tr_b16 a[242:243], v242 offset:512
    ds_read_b64_tr_b16 a[244:245], v242 offset:8
    v_mfma_f32_16x16x32_bf16 v[168:171], a[252:255], v[192:195], v[168:171]
    buffer_load_dwordx4 v238, s[4:7], s44 offen nt lds
    v_mfma_f32_16x16x32_bf16 v[172:175], a[252:255], v[196:199], v[172:175]
    ds_read_b64_tr_b16 a[246:247], v242 offset:520
    ds_read_b64_tr_b16 a[248:249], v243
    v_mfma_f32_16x16x32_bf16 v[176:179], a[252:255], v[200:203], v[176:179]
    s_waitcnt lgkmcnt(7)
    buffer_load_dwordx4 v238, s[4:7], s44 offen offset:2048 nt lds
    v_mfma_f32_16x16x32_bf16 v[132:135], v[216:219], v[192:195], v[132:135]
    s_add_u32 m0, s51, 25472
    ds_read_b64_tr_b16 a[250:251], v243 offset:512
    ds_read_b64_tr_b16 a[252:253], v243 offset:8
    v_mfma_f32_16x16x32_bf16 v[136:139], v[216:219], v[196:199], v[136:139]
    ds_read_b64_tr_b16 a[254:255], v243 offset:520
    v_mfma_f32_16x16x32_bf16 v[140:143], v[216:219], v[200:203], v[140:143]
    s_waitcnt lgkmcnt(8)
    buffer_load_dwordx4 v238, s[4:7], s44 offen offset:128 nt lds
    v_mfma_f32_16x16x32_bf16 v[180:183], v[220:223], v[192:195], v[180:183]
    ds_read_b64_tr_b16 v[216:217], v242 offset:1024
    ds_read_b64_tr_b16 v[218:219], v242 offset:1536
    v_mfma_f32_16x16x32_bf16 v[184:187], v[220:223], v[196:199], v[184:187]
    v_mfma_f32_16x16x32_bf16 v[188:191], v[220:223], v[200:203], v[188:191]
    s_waitcnt lgkmcnt(8)
    buffer_load_dwordx4 v238, s[4:7], s44 offen offset:2176 nt lds
    v_mfma_f32_16x16x32_bf16 v[96:99], a[240:243], a[216:219], v[96:99]
    s_add_u32 s44, s44, 8192
    ds_read_b64_tr_b16 v[220:221], v242 offset:1032
    ds_read_b64_tr_b16 v[222:223], v242 offset:1544
    v_mfma_f32_16x16x32_bf16 v[100:103], a[240:243], a[220:223], v[100:103]
    v_mfma_f32_16x16x32_bf16 v[104:107], a[240:243], a[224:227], v[104:107]
    s_waitcnt lgkmcnt(8)
    ds_read_b64_tr_b16 a[240:241], v243 offset:1024
    ds_read_b64_tr_b16 a[242:243], v243 offset:1536
    v_mfma_f32_16x16x32_bf16 v[144:147], a[244:247], a[216:219], v[144:147]
    v_mfma_f32_16x16x32_bf16 v[148:151], a[244:247], a[220:223], v[148:151]
    v_mfma_f32_16x16x32_bf16 v[152:155], a[244:247], a[224:227], v[152:155]
    s_waitcnt lgkmcnt(8)
    ds_read_b64_tr_b16 a[244:245], v243 offset:1032
    ds_read_b64_tr_b16 a[246:247], v243 offset:1544
    v_mfma_f32_16x16x32_bf16 v[108:111], a[248:251], a[216:219], v[108:111]
    v_mfma_f32_16x16x32_bf16 v[112:115], a[248:251], a[220:223], v[112:115]
    v_mfma_f32_16x16x32_bf16 v[116:119], a[248:251], a[224:227], v[116:119]
    s_waitcnt lgkmcnt(8)
    v_mfma_f32_16x16x32_bf16 v[156:159], a[252:255], a[216:219], v[156:159]
    v_mfma_f32_16x16x32_bf16 v[160:163], a[252:255], a[220:223], v[160:163]
    v_mfma_f32_16x16x32_bf16 v[164:167], a[252:255], a[224:227], v[164:167]
    s_waitcnt lgkmcnt(6)
    v_mfma_f32_16x16x32_bf16 v[120:123], v[216:219], a[216:219], v[120:123]
    v_mfma_f32_16x16x32_bf16 v[124:127], v[216:219], a[220:223], v[124:127]
    s_waitcnt vmcnt(8)
    s_barrier
    ds_read_b128 a[228:231], v244
    v_mfma_f32_16x16x32_bf16 v[128:131], v[216:219], a[224:227], v[128:131]
    s_waitcnt lgkmcnt(5)
    ds_read_b64_tr_b16 a[248:249], v242 offset:8192
    ds_read_b64_tr_b16 a[250:251], v242 offset:8704
    v_mfma_f32_16x16x32_bf16 v[168:171], v[220:223], a[216:219], v[168:171]
    s_add_u32 m0, s51, 32768
    ds_read_b128 a[232:235], v244 offset:2048
    ds_read_b128 a[236:239], v244 offset:4096
    v_mfma_f32_16x16x32_bf16 v[172:175], v[220:223], a[220:223], v[172:175]
    buffer_load_dwordx4 v238, s[4:7], s44 offen nt lds
    v_mfma_f32_16x16x32_bf16 v[176:179], v[220:223], a[224:227], v[176:179]
    s_waitcnt lgkmcnt(7)
    buffer_load_dwordx4 v238, s[4:7], s44 offen offset:2048 nt lds
    v_mfma_f32_16x16x32_bf16 v[132:135], a[240:243], a[216:219], v[132:135]
    s_add_u32 m0, s51, 33664
    ds_read_b64_tr_b16 a[252:253], v242 offset:8200
    ds_read_b64_tr_b16 a[254:255], v242 offset:8712
    v_mfma_f32_16x16x32_bf16 v[136:139], a[240:243], a[220:223], v[136:139]
    ds_read_b64_tr_b16 v[216:217], v243 offset:8192
    ds_read_b64_tr_b16 v[218:219], v243 offset:8704
    v_mfma_f32_16x16x32_bf16 v[140:143], a[240:243], a[224:227], v[140:143]
    s_waitcnt lgkmcnt(9)
    buffer_load_dwordx4 v238, s[4:7], s44 offen offset:128 nt lds
    v_mfma_f32_16x16x32_bf16 v[180:183], a[244:247], a[216:219], v[180:183]
    ds_read_b64_tr_b16 v[220:221], v243 offset:8200
    ds_read_b64_tr_b16 v[222:223], v243 offset:8712
    v_mfma_f32_16x16x32_bf16 v[184:187], a[244:247], a[220:223], v[184:187]
    ds_read_b64_tr_b16 a[240:241], v242 offset:9216
    ds_read_b64_tr_b16 a[242:243], v242 offset:9728
    v_mfma_f32_16x16x32_bf16 v[188:191], a[244:247], a[224:227], v[188:191]
    s_waitcnt lgkmcnt(10)
    buffer_load_dwordx4 v238, s[4:7], s44 offen offset:2176 nt lds
    v_mfma_f32_16x16x32_bf16 v[96:99], a[248:251], a[228:231], v[96:99]
    s_waitcnt lgkmcnt(9)
    ds_read_b64_tr_b16 a[244:245], v242 offset:9224
    ds_read_b64_tr_b16 a[246:247], v242 offset:9736
    v_mfma_f32_16x16x32_bf16 v[100:103], a[248:251], a[232:235], v[100:103]
    s_waitcnt lgkmcnt(10)
    ds_read_b128 v[192:195], v245
    ds_read_b128 v[196:199], v245 offset:2048
    v_mfma_f32_16x16x32_bf16 v[104:107], a[248:251], a[236:239], v[104:107]
    s_waitcnt lgkmcnt(10)
    ds_read_b128 v[200:203], v245 offset:4096
    ds_read_b64_tr_b16 a[248:249], v243 offset:9216
    v_mfma_f32_16x16x32_bf16 v[144:147], a[252:255], a[228:231], v[144:147]
    s_add_u32 s44, s44, 8192
    ds_read_b64_tr_b16 a[250:251], v243 offset:9728
    v_mfma_f32_16x16x32_bf16 v[148:151], a[252:255], a[232:235], v[148:151]
    v_mfma_f32_16x16x32_bf16 v[152:155], a[252:255], a[236:239], v[152:155]
    s_waitcnt lgkmcnt(11)
    ds_read_b64_tr_b16 a[252:253], v243 offset:9224
    ds_read_b64_tr_b16 a[254:255], v243 offset:9736
    v_mfma_f32_16x16x32_bf16 v[108:111], v[216:219], a[228:231], v[108:111]
    v_mfma_f32_16x16x32_bf16 v[112:115], v[216:219], a[232:235], v[112:115]
    v_mfma_f32_16x16x32_bf16 v[116:119], v[216:219], a[236:239], v[116:119]
    s_waitcnt lgkmcnt(11)
    v_mfma_f32_16x16x32_bf16 v[156:159], v[220:223], a[228:231], v[156:159]
    v_mfma_f32_16x16x32_bf16 v[160:163], v[220:223], a[232:235], v[160:163]
    v_mfma_f32_16x16x32_bf16 v[164:167], v[220:223], a[236:239], v[164:167]
    s_waitcnt lgkmcnt(9)
    v_mfma_f32_16x16x32_bf16 v[120:123], a[240:243], a[228:231], v[120:123]
    v_mfma_f32_16x16x32_bf16 v[124:127], a[240:243], a[232:235], v[124:127]
    s_waitcnt vmcnt(8) lgkmcnt(4)
    s_barrier
    ds_read_b64_tr_b16 v[216:217], v242 offset:16384
    v_mfma_f32_16x16x32_bf16 v[128:131], a[240:243], a[236:239], v[128:131]
    s_add_u32 m0, s51, 0
    ds_read_b64_tr_b16 v[218:219], v242 offset:16896
    ds_read_b64_tr_b16 v[220:221], v242 offset:16392
    v_mfma_f32_16x16x32_bf16 v[168:171], a[244:247], a[228:231], v[168:171]
    buffer_load_dwordx4 v238, s[8:11], s45 offen nt lds
    v_mfma_f32_16x16x32_bf16 v[172:175], a[244:247], a[232:235], v[172:175]
    ds_read_b64_tr_b16 v[222:223], v242 offset:16904
    ds_read_b64_tr_b16 a[240:241], v243 offset:16384
    v_mfma_f32_16x16x32_bf16 v[176:179], a[244:247], a[236:239], v[176:179]
    s_waitcnt lgkmcnt(7)
    buffer_load_dwordx4 v238, s[8:11], s45 offen offset:2048 nt lds
    v_mfma_f32_16x16x32_bf16 v[132:135], a[248:251], a[228:231], v[132:135]
    s_add_u32 m0, s51, 896
    ds_read_b64_tr_b16 a[242:243], v243 offset:16896
    ds_read_b64_tr_b16 a[244:245], v243 offset:16392
    v_mfma_f32_16x16x32_bf16 v[136:139], a[248:251], a[232:235], v[136:139]
    ds_read_b64_tr_b16 a[246:247], v243 offset:16904
    v_mfma_f32_16x16x32_bf16 v[140:143], a[248:251], a[236:239], v[140:143]
    s_waitcnt lgkmcnt(8)
    buffer_load_dwordx4 v238, s[8:11], s45 offen offset:128 nt lds
    v_mfma_f32_16x16x32_bf16 v[180:183], a[252:255], a[228:231], v[180:183]
    ds_read_b64_tr_b16 a[248:249], v242 offset:17408
    ds_read_b64_tr_b16 a[250:251], v242 offset:17920
    v_mfma_f32_16x16x32_bf16 v[184:187], a[252:255], a[232:235], v[184:187]
    v_mfma_f32_16x16x32_bf16 v[188:191], a[252:255], a[236:239], v[188:191]
    s_waitcnt lgkmcnt(8)
    buffer_load_dwordx4 v238, s[8:11], s45 offen offset:2176 nt lds
    v_mfma_f32_16x16x32_bf16 v[96:99], v[216:219], v[192:195], v[96:99]
    s_add_u32 s45, s45, 8192
    ds_read_b64_tr_b16 a[252:253], v242 offset:17416
    ds_read_b64_tr_b16 a[254:255], v242 offset:17928
    v_mfma_f32_16x16x32_bf16 v[100:103], v[216:219], v[196:199], v[100:103]
    v_mfma_f32_16x16x32_bf16 v[104:107], v[216:219], v[200:203], v[104:107]
    s_waitcnt lgkmcnt(8)
    ds_read_b64_tr_b16 v[216:217], v243 offset:17408
    ds_read_b64_tr_b16 v[218:219], v243 offset:17920
    v_mfma_f32_16x16x32_bf16 v[144:147], v[220:223], v[192:195], v[144:147]
    v_mul_f32 v96, s70, v96
    v_mul_f32 v97, s70, v97
    v_mfma_f32_16x16x32_bf16 v[148:151], v[220:223], v[196:199], v[148:151]
    v_mul_f32 v98, s70, v98
    v_mul_f32 v99, s70, v99
    v_mfma_f32_16x16x32_bf16 v[152:155], v[220:223], v[200:203], v[152:155]
    s_waitcnt lgkmcnt(8)
    ds_read_b64_tr_b16 v[220:221], v243 offset:17416
    ds_read_b64_tr_b16 v[222:223], v243 offset:17928
    v_mfma_f32_16x16x32_bf16 v[108:111], a[240:243], v[192:195], v[108:111]
    v_cvt_pk_bf16_f32 v96, v96, v97
    v_mul_f32 v100, s70, v100
    v_mfma_f32_16x16x32_bf16 v[112:115], a[240:243], v[196:199], v[112:115]
    v_mul_f32 v101, s70, v101
    v_mul_f32 v144, s70, v144
    v_mfma_f32_16x16x32_bf16 v[116:119], a[240:243], v[200:203], v[116:119]
    s_waitcnt lgkmcnt(8)
    v_mul_f32 v145, s70, v145
    v_mul_f32 v146, s70, v146
    v_mfma_f32_16x16x32_bf16 v[156:159], a[244:247], v[192:195], v[156:159]
    v_mul_f32 v147, s70, v147
    v_cvt_pk_bf16_f32 v97, v98, v99
    v_mfma_f32_16x16x32_bf16 v[160:163], a[244:247], v[196:199], v[160:163]
    v_mul_f32 v102, s70, v102
    v_mul_f32 v103, s70, v103
    v_mfma_f32_16x16x32_bf16 v[164:167], a[244:247], v[200:203], v[164:167]
    s_waitcnt lgkmcnt(6)
    v_cvt_pk_bf16_f32 v100, v100, v101
    v_mul_f32 v104, s70, v104
    v_mfma_f32_16x16x32_bf16 v[120:123], a[248:251], v[192:195], v[120:123]
    v_mul_f32 v105, s70, v105
    v_cvt_pk_bf16_f32 v98, v144, v145
    v_mfma_f32_16x16x32_bf16 v[124:127], a[248:251], v[196:199], v[124:127]
    s_waitcnt vmcnt(8)
    s_barrier
    ds_read_b128 a[240:243], v230 offset:25600
    v_mfma_f32_16x16x32_bf16 v[128:131], a[248:251], v[200:203], v[128:131]
    s_waitcnt lgkmcnt(5)
    ds_read_b128 a[248:251], v230 offset:24576
    v_cvt_pk_bf16_f32 v99, v146, v147
    v_mfma_f32_16x16x32_bf16 v[168:171], a[252:255], v[192:195], v[168:171]
    s_add_u32 m0, s51, 8192
    ds_read_b128 a[244:247], v230 offset:29696
    v_mul_f32 v148, s70, v148
    v_mfma_f32_16x16x32_bf16 v[172:175], a[252:255], v[196:199], v[172:175]
    buffer_load_dwordx4 v238, s[4:7], s44 offen nt lds
    v_mfma_f32_16x16x32_bf16 v[176:179], a[252:255], v[200:203], v[176:179]
    s_waitcnt lgkmcnt(5)
    ds_read_b128 a[252:255], v230 offset:28672
    v_mul_f32 v149, s70, v149
    v_mfma_f32_16x16x32_bf16 v[132:135], v[216:219], v[192:195], v[132:135]
    buffer_load_dwordx4 v238, s[4:7], s44 offen offset:2048 nt lds
    s_add_u32 m0, s51, 9088
    v_mfma_f32_16x16x32_bf16 v[136:139], v[216:219], v[196:199], v[136:139]
    v_mul_f32 v150, s70, v150
    v_mul_f32 v151, s70, v151
    v_mfma_f32_16x16x32_bf16 v[140:143], v[216:219], v[200:203], v[140:143]
    s_waitcnt lgkmcnt(4)
    ds_read_b128 v[216:219], v231 offset:24576
    v_cvt_pk_bf16_f32 v101, v102, v103
    v_mfma_f32_16x16x32_bf16 v[180:183], v[220:223], v[192:195], v[180:183]
    buffer_load_dwordx4 v238, s[4:7], s44 offen offset:128 nt lds
    v_mfma_f32_16x16x32_bf16 v[184:187], v[220:223], v[196:199], v[184:187]
    v_mul_f32 v106, s70, v106
    v_mul_f32 v107, s70, v107
    v_mfma_f32_16x16x32_bf16 v[188:191], v[220:223], v[200:203], v[188:191]
    s_waitcnt lgkmcnt(3)
    ds_read_b128 v[220:223], v231 offset:28672
    v_cvt_pk_bf16_f32 v104, v104, v105
    v_cvt_pk_bf16_f32 v102, v148, v149
    v_cvt_pk_bf16_f32 v103, v150, v151
    v_mfma_f32_16x16x32_bf16 v[144:147], a[248:251], v[96:99], 0
    buffer_load_dwordx4 v238, s[4:7], s44 offen offset:2176 nt lds
    s_add_u32 s44, s44, 8192
    v_mul_f32 v152, s70, v152
    v_mul_f32 v153, s70, v153
    v_mul_f32 v154, s70, v154
    v_mul_f32 v155, s70, v155
    v_cvt_pk_bf16_f32 v105, v106, v107
    v_cvt_pk_bf16_f32 v106, v152, v153
    v_cvt_pk_bf16_f32 v107, v154, v155
    v_mfma_f32_16x16x32_bf16 v[148:151], a[248:251], v[100:103], 0
    v_mul_f32 v108, s70, v108
    v_mul_f32 v109, s70, v109
    v_mfma_f32_16x16x32_bf16 v[152:155], a[248:251], v[104:107], 0
    s_waitcnt lgkmcnt(2)
    ds_read_b128 a[248:251], v231 offset:25600
    v_mul_f32 v110, s70, v110
    v_mul_f32 v111, s70, v111
    v_mul_f32 v156, s70, v156
    v_mul_f32 v157, s70, v157
    v_mul_f32 v158, s70, v158
    v_mul_f32 v159, s70, v159
    v_cvt_pk_bf16_f32 v108, v108, v109
    v_cvt_pk_bf16_f32 v109, v110, v111
    v_cvt_pk_bf16_f32 v110, v156, v157
    v_cvt_pk_bf16_f32 v111, v158, v159
    v_mfma_f32_16x16x32_bf16 v[156:159], a[252:255], v[96:99], 0
    v_mul_f32 v112, s70, v112
    v_mul_f32 v113, s70, v113
    v_mul_f32 v114, s70, v114
    v_mul_f32 v115, s70, v115
    v_mul_f32 v160, s70, v160
    v_mul_f32 v161, s70, v161
    v_mul_f32 v162, s70, v162
    v_mul_f32 v163, s70, v163
    v_cvt_pk_bf16_f32 v112, v112, v113
    v_cvt_pk_bf16_f32 v113, v114, v115
    v_cvt_pk_bf16_f32 v114, v160, v161
    v_cvt_pk_bf16_f32 v115, v162, v163
    v_mfma_f32_16x16x32_bf16 v[160:163], a[252:255], v[100:103], 0
    v_mul_f32 v116, s70, v116
    v_mul_f32 v117, s70, v117
    v_mul_f32 v118, s70, v118
    v_mul_f32 v119, s70, v119
    v_mul_f32 v164, s70, v164
    v_mul_f32 v165, s70, v165
    v_mul_f32 v166, s70, v166
    v_mul_f32 v167, s70, v167
    v_cvt_pk_bf16_f32 v116, v116, v117
    v_cvt_pk_bf16_f32 v117, v118, v119
    v_cvt_pk_bf16_f32 v118, v164, v165
    v_cvt_pk_bf16_f32 v119, v166, v167
    v_mfma_f32_16x16x32_bf16 v[164:167], a[252:255], v[104:107], 0
    s_waitcnt lgkmcnt(2)
    ds_read_b128 a[252:255], v231 offset:29696
    v_mul_f32 v120, s70, v120
    v_mfma_f32_16x16x32_bf16 v[144:147], v[216:219], v[108:111], v[144:147]
    v_mul_f32 v121, s70, v121
    v_mul_f32 v122, s70, v122
    v_mfma_f32_16x16x32_bf16 v[148:151], v[216:219], v[112:115], v[148:151]
    v_mul_f32 v123, s70, v123
    v_cvt_pk_bf16_f32 v120, v120, v121
    v_mfma_f32_16x16x32_bf16 v[152:155], v[216:219], v[116:119], v[152:155]
    s_waitcnt lgkmcnt(2)
    v_mul_f32 v124, s70, v124
    v_mul_f32 v125, s70, v125
    v_mfma_f32_16x16x32_bf16 v[156:159], v[220:223], v[108:111], v[156:159]
    v_mul_f32 v168, s70, v168
    v_mul_f32 v169, s70, v169
    v_mfma_f32_16x16x32_bf16 v[160:163], v[220:223], v[112:115], v[160:163]
    v_mul_f32 v170, s70, v170
    v_mul_f32 v171, s70, v171
    v_cvt_pk_bf16_f32 v121, v122, v123
    v_cvt_pk_bf16_f32 v122, v168, v169
    v_cvt_pk_bf16_f32 v123, v170, v171
    v_mfma_f32_16x16x32_bf16 v[164:167], v[220:223], v[116:119], v[164:167]
    v_mul_f32 v126, s70, v126
    v_mul_f32 v127, s70, v127
    v_mul_f32 v172, s70, v172
    v_mul_f32 v173, s70, v173
    v_mul_f32 v174, s70, v174
    v_mul_f32 v175, s70, v175
    v_cvt_pk_bf16_f32 v124, v124, v125
    v_cvt_pk_bf16_f32 v125, v126, v127
    v_cvt_pk_bf16_f32 v126, v172, v173
    v_cvt_pk_bf16_f32 v127, v174, v175
    v_mfma_f32_16x16x32_bf16 v[144:147], a[240:243], v[120:123], v[144:147]
    v_mul_f32 v128, s70, v128
    v_mul_f32 v129, s70, v129
    v_mul_f32 v130, s70, v130
    v_mul_f32 v131, s70, v131
    v_mul_f32 v176, s70, v176
    v_mul_f32 v177, s70, v177
    v_mul_f32 v178, s70, v178
    v_mul_f32 v179, s70, v179
    v_cvt_pk_bf16_f32 v128, v128, v129
    v_cvt_pk_bf16_f32 v129, v130, v131
    v_cvt_pk_bf16_f32 v130, v176, v177
    v_cvt_pk_bf16_f32 v131, v178, v179
    v_mfma_f32_16x16x32_bf16 v[148:151], a[240:243], v[124:127], v[148:151]
    v_mul_f32 v132, s70, v132
    v_mul_f32 v133, s70, v133
    v_mfma_f32_16x16x32_bf16 v[152:155], a[240:243], v[128:131], v[152:155]
    v_mul_f32 v134, s70, v134
    v_mul_f32 v135, s70, v135
    v_mfma_f32_16x16x32_bf16 v[156:159], a[244:247], v[120:123], v[156:159]
    v_cvt_pk_bf16_f32 v132, v132, v133
    v_mul_f32 v136, s70, v136
    v_mfma_f32_16x16x32_bf16 v[160:163], a[244:247], v[124:127], v[160:163]
    s_waitcnt vmcnt(8) lgkmcnt(0)
    s_cbranch_vccnz L_af19
L_afr19:
    s_barrier
    ds_read_b128 v[216:219], v230 offset:32768
    v_mul_f32 v180, s70, v180
    v_mul_f32 v181, s70, v181
    v_mul_f32 v182, s70, v182
    v_mul_f32 v183, s70, v183
    v_cvt_pk_bf16_f32 v133, v134, v135
    v_cvt_pk_bf16_f32 v134, v180, v181
    v_cvt_pk_bf16_f32 v135, v182, v183
    v_mfma_f32_16x16x32_bf16 v[164:167], a[244:247], v[128:131], v[164:167]
    s_add_u32 m0, s51, 16384
    ds_read_b128 v[220:223], v231 offset:32768
    v_mul_f32 v137, s70, v137
    v_mul_f32 v138, s70, v138
    v_mul_f32 v139, s70, v139
    v_mul_f32 v184, s70, v184
    v_mul_f32 v185, s70, v185
    v_mul_f32 v186, s70, v186
    v_mul_f32 v187, s70, v187
    v_cvt_pk_bf16_f32 v136, v136, v137
    v_cvt_pk_bf16_f32 v137, v138, v139
    v_cvt_pk_bf16_f32 v138, v184, v185
    v_cvt_pk_bf16_f32 v139, v186, v187
    v_mfma_f32_16x16x32_bf16 v[144:147], a[248:251], v[132:135], v[144:147]
    ds_read_b128 a[240:243], v230 offset:33792
    v_mul_f32 v140, s70, v140
    v_mul_f32 v141, s70, v141
    v_mul_f32 v142, s70, v142
    v_mul_f32 v143, s70, v143
    v_mul_f32 v188, s70, v188
    v_mul_f32 v189, s70, v189
    v_mul_f32 v190, s70, v190
    v_mul_f32 v191, s70, v191
    v_cvt_pk_bf16_f32 v140, v140, v141
    v_cvt_pk_bf16_f32 v141, v142, v143
    v_cvt_pk_bf16_f32 v142, v188, v189
    v_cvt_pk_bf16_f32 v143, v190, v191
    v_mfma_f32_16x16x32_bf16 v[148:151], a[248:251], v[136:139], v[148:151]
    buffer_load_dwordx4 v238, s[8:11], s45 offen nt lds
    v_mfma_f32_16x16x32_bf16 v[152:155], a[248:251], v[140:143], v[152:155]
    ds_read_b128 a[244:247], v231 offset:33792
    v_max3_f32 v248, v144, v145, v146
    v_mfma_f32_16x16x32_bf16 v[156:159], a[252:255], v[132:135], v[156:159]
    buffer_load_dwordx4 v238, s[8:11], s45 offen offset:2048 nt lds
    s_add_u32 m0, s51, 17280
    v_mfma_f32_16x16x32_bf16 v[160:163], a[252:255], v[136:139], v[160:163]
    ds_read_b128 a[248:251], v230 offset:36864
    v_max3_f32 v249, v148, v149, v150
    v_mfma_f32_16x16x32_bf16 v[164:167], a[252:255], v[140:143], v[164:167]
    s_waitcnt lgkmcnt(4)
    buffer_load_dwordx4 v238, s[8:11], s45 offen offset:128 nt lds
    v_mfma_f32_16x16x32_bf16 v[168:171], v[216:219], v[96:99], 0
    ds_read_b128 a[252:255], v231 offset:36864
    v_max3_f32 v248, v248, v147, v156
    v_mfma_f32_16x16x32_bf16 v[172:175], v[216:219], v[100:103], 0
    v_max3_f32 v248, v248, v157, v158
    v_max3_f32 v249, v249, v151, v160
    v_mfma_f32_16x16x32_bf16 v[176:179], v[216:219], v[104:107], 0
    s_waitcnt lgkmcnt(4)
    buffer_load_dwordx4 v238, s[8:11], s45 offen offset:2176 nt lds
    v_mfma_f32_16x16x32_bf16 v[168:171], v[220:223], v[108:111], v[168:171]
    s_add_u32 m0, s51, 24576
    ds_read_b128 v[216:219], v230 offset:37888
    v_max_f32 v248, v248, v159
    v_mfma_f32_16x16x32_bf16 v[172:175], v[220:223], v[112:115], v[172:175]
    s_add_u32 s45, s45, 8192
    v_mov_b32 v247, v248
    v_max3_f32 v249, v249, v161, v162
    v_mfma_f32_16x16x32_bf16 v[176:179], v[220:223], v[116:119], v[176:179]
    s_waitcnt lgkmcnt(4)
    buffer_load_dwordx4 v238, s[4:7], s44 offen nt lds
    v_mfma_f32_16x16x32_bf16 v[168:171], a[240:243], v[120:123], v[168:171]
    ds_read_b128 v[220:223], v231 offset:37888
    v_max_f32 v249, v249, v163
    v_mfma_f32_16x16x32_bf16 v[172:175], a[240:243], v[124:127], v[172:175]
    v_permlane32_swap_b32 v247, v248
    v_mfma_f32_16x16x32_bf16 v[176:179], a[240:243], v[128:131], v[176:179]
    s_waitcnt lgkmcnt(4)
    buffer_load_dwordx4 v238, s[4:7], s44 offen offset:2048 nt lds
    v_mfma_f32_16x16x32_bf16 v[168:171], a[244:247], v[132:135], v[168:171]
    s_add_u32 m0, s51, 25472
    v_max_f32 v248, v248, v247
    v_max3_f32 v250, v152, v153, v154
    v_mfma_f32_16x16x32_bf16 v[172:175], a[244:247], v[136:139], v[172:175]
    v_mov_b32 v247, v248
    v_max3_f32 v250, v250, v155, v164
    v_mfma_f32_16x16x32_bf16 v[176:179], a[244:247], v[140:143], v[176:179]
    s_waitcnt lgkmcnt(3)
    buffer_load_dwordx4 v238, s[4:7], s44 offen offset:128 nt lds
    v_mfma_f32_16x16x32_bf16 v[180:183], a[248:251], v[96:99], 0
    v_permlane16_swap_b32 v247, v248
    v_mfma_f32_16x16x32_bf16 v[184:187], a[248:251], v[100:103], 0
    v_max_f32 v248, v248, v247
    v_max3_f32 v250, v250, v165, v166
    v_mfma_f32_16x16x32_bf16 v[188:191], a[248:251], v[104:107], 0
    s_waitcnt lgkmcnt(2)
    buffer_load_dwordx4 v238, s[4:7], s44 offen offset:2176 nt lds
    v_mfma_f32_16x16x32_bf16 v[180:183], a[252:255], v[108:111], v[180:183]
    s_add_u32 s44, s44, 8192
    v_mov_b32 v247, v249
    v_sub_f32 v204, 0, v248
    v_mfma_f32_16x16x32_bf16 v[184:187], a[252:255], v[112:115], v[184:187]
    s_waitcnt vmcnt(12) lgkmcnt(0)
    s_cbranch_vccnz L_af20
L_afr20:
    s_barrier
    ds_read_b64_tr_b16 a[240:241], v232
    v_mfma_f32_16x16x32_bf16 v[188:191], a[252:255], v[116:119], v[188:191]
    s_add_u32 m0, s51, 32768
    ds_read_b64_tr_b16 a[242:243], v232 offset:4096
    v_sub_f32 v205, 0, v248
    v_mfma_f32_16x16x32_bf16 v[180:183], v[216:219], v[120:123], v[180:183]
    ds_read_b64_tr_b16 a[244:245], v233
    v_add_f32 v144, v204, v144
    v_mfma_f32_16x16x32_bf16 v[184:187], v[216:219], v[124:127], v[184:187]
    ds_read_b64_tr_b16 a[246:247], v233 offset:4096
    v_sub_f32 v206, 0, v248
    v_mfma_f32_16x16x32_bf16 v[188:191], v[216:219], v[128:131], v[188:191]
    ds_read_b64_tr_b16 a[248:249], v234
    v_add_f32 v145, v205, v145
    v_mfma_f32_16x16x32_bf16 v[180:183], v[220:223], v[132:135], v[180:183]
    ds_read_b64_tr_b16 a[250:251], v234 offset:4096
    v_add_f32 v146, v206, v146
    v_mfma_f32_16x16x32_bf16 v[184:187], v[220:223], v[136:139], v[184:187]
    buffer_load_dwordx4 v238, s[8:11], s45 offen nt lds
    v_sub_f32 v207, 0, v248
    v_exp_f32 v144, v144
    v_exp_f32 v145, v145
    v_exp_f32 v146, v146
    v_add_f32 v147, v207, v147
    v_exp_f32 v147, v147
    v_add_f32 v156, v204, v156
    v_exp_f32 v156, v156
    v_add_f32 v157, v205, v157
    v_exp_f32 v157, v157
    v_add_f32 v158, v206, v158
    v_exp_f32 v158, v158
    v_add_f32 v159, v207, v159
    v_exp_f32 v159, v159
    v_cvt_pk_bf16_f32 v192, v144, v145
    v_cvt_pk_bf16_f32 v193, v146, v147
    v_cvt_pk_bf16_f32 v194, v156, v157
    v_cvt_pk_bf16_f32 v195, v158, v159
    v_mfma_f32_16x16x32_bf16 v[188:191], v[220:223], v[140:143], v[188:191]
    s_waitcnt lgkmcnt(4)
    ds_read_b64_tr_b16 a[252:253], v235
    v_max_f32 v250, v250, v167
    v_permlane32_swap_b32 v247, v249
    v_max_f32 v249, v249, v247
    v_mov_b32 v247, v249
    s_nop 1
    v_permlane16_swap_b32 v247, v249
    v_max_f32 v249, v249, v247
    v_sub_f32 v208, 0, v249
    v_sub_f32 v209, 0, v249
    v_sub_f32 v210, 0, v249
    v_sub_f32 v211, 0, v249
    v_add_f32 v148, v208, v148
    v_exp_f32 v148, v148
    v_add_f32 v149, v209, v149
    v_exp_f32 v149, v149
    v_add_f32 v150, v210, v150
    v_exp_f32 v150, v150
    v_add_f32 v151, v211, v151
    v_exp_f32 v151, v151
    v_add_f32 v160, v208, v160
    v_exp_f32 v160, v160
    v_add_f32 v161, v209, v161
    v_exp_f32 v161, v161
    v_add_f32 v162, v210, v162
    v_exp_f32 v162, v162
    v_add_f32 v163, v211, v163
    v_exp_f32 v163, v163
    v_cvt_pk_bf16_f32 v196, v148, v149
    v_cvt_pk_bf16_f32 v197, v150, v151
    v_cvt_pk_bf16_f32 v198, v160, v161
    v_cvt_pk_bf16_f32 v199, v162, v163
    v_mfma_f32_16x16x32_bf16 v[0:3], a[240:243], v[192:195], 0
    ds_read_b64_tr_b16 a[254:255], v235 offset:4096
    v_mov_b32 v247, v250
    s_nop 1
    v_permlane32_swap_b32 v247, v250
    v_max_f32 v250, v250, v247
    v_mov_b32 v247, v250
    s_nop 1
    v_permlane16_swap_b32 v247, v250
    v_max_f32 v250, v250, v247
    v_sub_f32 v212, 0, v250
    v_sub_f32 v213, 0, v250
    v_sub_f32 v214, 0, v250
    v_sub_f32 v215, 0, v250
    v_add_f32 v152, v212, v152
    v_exp_f32 v152, v152
    v_add_f32 v153, v213, v153
    v_exp_f32 v153, v153
    v_add_f32 v154, v214, v154
    v_exp_f32 v154, v154
    v_add_f32 v155, v215, v155
    v_exp_f32 v155, v155
    v_add_f32 v164, v212, v164
    v_exp_f32 v164, v164
    v_add_f32 v165, v213, v165
    v_exp_f32 v165, v165
    v_add_f32 v166, v214, v166
    v_exp_f32 v166, v166
    v_add_f32 v167, v215, v167
    v_exp_f32 v167, v167
    v_cvt_pk_bf16_f32 v200, v152, v153
    v_cvt_pk_bf16_f32 v201, v154, v155
    v_cvt_pk_bf16_f32 v202, v164, v165
    v_cvt_pk_bf16_f32 v203, v166, v167
    v_mfma_f32_16x16x32_bf16 v[4:7], a[240:243], v[196:199], 0
    buffer_load_dwordx4 v238, s[8:11], s45 offen offset:2048 nt lds
    s_add_u32 m0, s51, 33664
    v_mfma_f32_16x16x32_bf16 v[8:11], a[240:243], v[200:203], 0
    s_waitcnt lgkmcnt(4)
    ds_read_b64_tr_b16 v[216:217], v232 offset:1024
    v_add_f32 v224, v224, v144
    v_mfma_f32_16x16x32_bf16 v[12:15], a[244:247], v[192:195], 0
    ds_read_b64_tr_b16 v[218:219], v232 offset:5120
    v_add_f32 v224, v224, v145
    v_mfma_f32_16x16x32_bf16 v[16:19], a[244:247], v[196:199], 0
    buffer_load_dwordx4 v238, s[8:11], s45 offen offset:128 nt lds
    v_mfma_f32_16x16x32_bf16 v[20:23], a[244:247], v[200:203], 0
    s_waitcnt lgkmcnt(4)
    ds_read_b64_tr_b16 v[220:221], v233 offset:1024
    v_add_f32 v224, v224, v146
    v_mfma_f32_16x16x32_bf16 v[24:27], a[248:251], v[192:195], 0
    ds_read_b64_tr_b16 v[222:223], v233 offset:5120
    v_add_f32 v224, v224, v147
    v_mfma_f32_16x16x32_bf16 v[28:31], a[248:251], v[196:199], 0
    buffer_load_dwordx4 v238, s[8:11], s45 offen offset:2176 nt lds
    s_add_u32 s45, s45, 8192
    v_mfma_f32_16x16x32_bf16 v[32:35], a[248:251], v[200:203], 0
    s_waitcnt lgkmcnt(4)
    ds_read_b64_tr_b16 a[240:241], v234 offset:1024
    v_add_f32 v225, v225, v148
    v_mfma_f32_16x16x32_bf16 v[36:39], a[252:255], v[192:195], 0
    ds_read_b64_tr_b16 a[242:243], v234 offset:5120
    v_add_f32 v225, v225, v149
    v_mfma_f32_16x16x32_bf16 v[40:43], a[252:255], v[196:199], 0
    ds_read_b64_tr_b16 a[244:245], v235 offset:1024
    v_add_f32 v225, v225, v150
    v_mfma_f32_16x16x32_bf16 v[44:47], a[252:255], v[200:203], 0
    s_waitcnt lgkmcnt(5)
    ds_read_b64_tr_b16 a[246:247], v235 offset:5120
    v_add_f32 v225, v225, v151
    v_mfma_f32_16x16x32_bf16 v[48:51], v[216:219], v[192:195], 0
    v_add_f32 v226, v226, v152
    v_add_f32 v224, v224, v156
    v_mfma_f32_16x16x32_bf16 v[52:55], v[216:219], v[196:199], 0
    v_add_f32 v226, v226, v153
    v_add_f32 v224, v224, v157
    v_mfma_f32_16x16x32_bf16 v[56:59], v[216:219], v[200:203], 0
    s_waitcnt lgkmcnt(4)
    v_add_f32 v226, v226, v154
    v_add_f32 v168, v204, v168
    v_mfma_f32_16x16x32_bf16 v[60:63], v[220:223], v[192:195], 0
    v_add_f32 v226, v226, v155
    v_add_f32 v224, v224, v158
    v_mfma_f32_16x16x32_bf16 v[64:67], v[220:223], v[196:199], 0
    s_waitcnt vmcnt(12) lgkmcnt(0)
    s_cbranch_vccnz L_af21
L_afr21:
    s_barrier
    ds_read_b128 a[248:251], v230 offset:8192
    v_mfma_f32_16x16x32_bf16 v[68:71], v[220:223], v[200:203], 0
    s_add_u32 m0, s51, 0
    ds_read_b128 a[252:255], v231 offset:8192
    v_add_f32 v169, v205, v169
    v_mfma_f32_16x16x32_bf16 v[72:75], a[240:243], v[192:195], 0
    ds_read_b128 v[216:219], v230 offset:9216
    v_add_f32 v224, v224, v159
    v_mfma_f32_16x16x32_bf16 v[76:79], a[240:243], v[196:199], 0
    buffer_load_dwordx4 v238, s[4:7], s44 offen nt lds
    v_mfma_f32_16x16x32_bf16 v[80:83], a[240:243], v[200:203], 0
    ds_read_b128 v[220:223], v231 offset:9216
    v_add_f32 v170, v206, v170
    v_mfma_f32_16x16x32_bf16 v[84:87], a[244:247], v[192:195], 0
    buffer_load_dwordx4 v238, s[4:7], s44 offen offset:2048 nt lds
    s_add_u32 m0, s51, 896
    v_mfma_f32_16x16x32_bf16 v[88:91], a[244:247], v[196:199], 0
    ds_read_b128 a[240:243], v230 offset:12288
    v_add_f32 v225, v225, v160
    v_mfma_f32_16x16x32_bf16 v[92:95], a[244:247], v[200:203], 0
    s_waitcnt lgkmcnt(4)
    v_exp_f32 v168, v168
    v_mfma_f32_16x16x32_bf16 v[144:147], a[248:251], v[96:99], v[204:207]
    v_exp_f32 v169, v169
    v_mfma_f32_16x16x32_bf16 v[148:151], a[248:251], v[100:103], v[208:211]
    buffer_load_dwordx4 v238, s[4:7], s44 offen offset:128 nt lds
    v_mfma_f32_16x16x32_bf16 v[152:155], a[248:251], v[104:107], v[212:215]
    s_waitcnt lgkmcnt(3)
    v_exp_f32 v170, v170
    v_mfma_f32_16x16x32_bf16 v[144:147], a[252:255], v[108:111], v[144:147]
    ds_read_b128 a[244:247], v231 offset:12288
    v_add_f32 v171, v207, v171
    v_mfma_f32_16x16x32_bf16 v[148:151], a[252:255], v[112:115], v[148:151]
    v_exp_f32 v171, v171
    v_mfma_f32_16x16x32_bf16 v[152:155], a[252:255], v[116:119], v[152:155]
    s_waitcnt lgkmcnt(3)
    buffer_load_dwordx4 v238, s[4:7], s44 offen offset:2176 nt lds
    v_mfma_f32_16x16x32_bf16 v[144:147], v[216:219], v[120:123], v[144:147]
    s_add_u32 s44, s44, 8192
    ds_read_b128 a[248:251], v230 offset:13312
    v_add_f32 v225, v225, v161
    v_mfma_f32_16x16x32_bf16 v[148:151], v[216:219], v[124:127], v[148:151]
    ds_read_b128 a[252:255], v231 offset:13312
    v_add_f32 v224, v224, v168
    v_mfma_f32_16x16x32_bf16 v[152:155], v[216:219], v[128:131], v[152:155]
    s_waitcnt lgkmcnt(4)
    v_add_f32 v172, v208, v172
    v_add_f32 v224, v224, v169
    v_mfma_f32_16x16x32_bf16 v[144:147], v[220:223], v[132:135], v[144:147]
    v_exp_f32 v172, v172
    v_mfma_f32_16x16x32_bf16 v[148:151], v[220:223], v[136:139], v[148:151]
    v_add_f32 v225, v225, v162
    v_add_f32 v224, v224, v170
    v_mfma_f32_16x16x32_bf16 v[152:155], v[220:223], v[140:143], v[152:155]
    s_waitcnt lgkmcnt(3)
    v_add_f32 v173, v209, v173
    v_add_f32 v225, v225, v163
    v_mfma_f32_16x16x32_bf16 v[156:159], a[240:243], v[96:99], v[204:207]
    v_exp_f32 v173, v173
    v_mfma_f32_16x16x32_bf16 v[160:163], a[240:243], v[100:103], v[208:211]
    v_add_f32 v174, v210, v174
    v_add_f32 v224, v224, v171
    v_add_f32 v226, v226, v164
    v_add_f32 v226, v226, v165
    v_add_f32 v226, v226, v166
    v_add_f32 v226, v226, v167
    v_mfma_f32_16x16x32_bf16 v[164:167], a[240:243], v[104:107], v[212:215]
    s_waitcnt lgkmcnt(2)
    v_exp_f32 v174, v174
    v_mfma_f32_16x16x32_bf16 v[156:159], a[244:247], v[108:111], v[156:159]
    v_add_f32 v225, v225, v172
    v_add_f32 v175, v211, v175
    v_mfma_f32_16x16x32_bf16 v[160:163], a[244:247], v[112:115], v[160:163]
    s_waitcnt vmcnt(12) lgkmcnt(0)
    s_cbranch_vccnz L_af22
L_afr22:
    s_barrier
    ds_read_b64_tr_b16 v[216:217], v232 offset:16384
    v_mfma_f32_16x16x32_bf16 v[164:167], a[244:247], v[116:119], v[164:167]
    s_add_u32 m0, s51, 8192
    v_exp_f32 v175, v175
    v_mfma_f32_16x16x32_bf16 v[156:159], a[248:251], v[120:123], v[156:159]
    ds_read_b64_tr_b16 v[218:219], v232 offset:20480
    v_add_f32 v176, v212, v176
    v_mfma_f32_16x16x32_bf16 v[160:163], a[248:251], v[124:127], v[160:163]
    v_exp_f32 v176, v176
    v_mfma_f32_16x16x32_bf16 v[164:167], a[248:251], v[128:131], v[164:167]
    ds_read_b64_tr_b16 v[220:221], v233 offset:16384
    v_add_f32 v225, v225, v173
    v_mfma_f32_16x16x32_bf16 v[156:159], a[252:255], v[132:135], v[156:159]
    ds_read_b64_tr_b16 v[222:223], v233 offset:20480
    v_add_f32 v225, v225, v174
    v_mfma_f32_16x16x32_bf16 v[160:163], a[252:255], v[136:139], v[160:163]
    ds_read_b64_tr_b16 a[240:241], v234 offset:16384
    v_add_f32 v177, v213, v177
    v_add_f32 v180, v204, v180
    v_exp_f32 v180, v180
    v_add_f32 v181, v205, v181
    v_exp_f32 v181, v181
    v_add_f32 v182, v206, v182
    v_exp_f32 v182, v182
    v_add_f32 v183, v207, v183
    v_exp_f32 v183, v183
    v_cvt_pk_bf16_f32 v192, v168, v169
    v_cvt_pk_bf16_f32 v193, v170, v171
    v_cvt_pk_bf16_f32 v194, v180, v181
    v_cvt_pk_bf16_f32 v195, v182, v183
    v_mfma_f32_16x16x32_bf16 v[164:167], a[252:255], v[140:143], v[164:167]
    s_waitcnt lgkmcnt(3)
    v_exp_f32 v177, v177
    v_add_f32 v184, v208, v184
    v_exp_f32 v184, v184
    v_add_f32 v185, v209, v185
    v_exp_f32 v185, v185
    v_add_f32 v186, v210, v186
    v_exp_f32 v186, v186
    v_add_f32 v187, v211, v187
    v_exp_f32 v187, v187
    v_cvt_pk_bf16_f32 v196, v172, v173
    v_cvt_pk_bf16_f32 v197, v174, v175
    v_cvt_pk_bf16_f32 v198, v184, v185
    v_cvt_pk_bf16_f32 v199, v186, v187
    v_mfma_f32_16x16x32_bf16 v[0:3], v[216:219], v[192:195], v[0:3]
    ds_read_b64_tr_b16 a[242:243], v234 offset:20480
    v_add_f32 v178, v214, v178
    v_exp_f32 v178, v178
    v_add_f32 v179, v215, v179
    v_exp_f32 v179, v179
    v_add_f32 v188, v212, v188
    v_exp_f32 v188, v188
    v_add_f32 v189, v213, v189
    v_exp_f32 v189, v189
    v_add_f32 v190, v214, v190
    v_exp_f32 v190, v190
    v_add_f32 v191, v215, v191
    v_exp_f32 v191, v191
    v_cvt_pk_bf16_f32 v200, v176, v177
    v_cvt_pk_bf16_f32 v201, v178, v179
    v_cvt_pk_bf16_f32 v202, v188, v189
    v_cvt_pk_bf16_f32 v203, v190, v191
    v_mfma_f32_16x16x32_bf16 v[4:7], v[216:219], v[196:199], v[4:7]
    ds_read_b64_tr_b16 a[244:245], v235 offset:16384
    v_add_f32 v225, v225, v175
    v_mfma_f32_16x16x32_bf16 v[8:11], v[216:219], v[200:203], v[8:11]
    s_waitcnt lgkmcnt(3)
    ds_read_b64_tr_b16 a[246:247], v235 offset:20480
    v_add_f32 v226, v226, v176
    v_mfma_f32_16x16x32_bf16 v[12:15], v[220:223], v[192:195], v[12:15]
    ds_read_b64_tr_b16 a[248:249], v232 offset:17408
    v_add_f32 v226, v226, v177
    v_mfma_f32_16x16x32_bf16 v[16:19], v[220:223], v[196:199], v[16:19]
    ds_read_b64_tr_b16 a[250:251], v232 offset:21504
    v_add_f32 v226, v226, v178
    v_mfma_f32_16x16x32_bf16 v[20:23], v[220:223], v[200:203], v[20:23]
    s_waitcnt lgkmcnt(4)
    buffer_load_dwordx4 v238, s[8:11], s45 offen nt lds
    v_mfma_f32_16x16x32_bf16 v[24:27], a[240:243], v[192:195], v[24:27]
    ds_read_b64_tr_b16 a[252:253], v233 offset:17408
    v_add_f32 v226, v226, v179
    v_mfma_f32_16x16x32_bf16 v[28:31], a[240:243], v[196:199], v[28:31]
    ds_read_b64_tr_b16 a[254:255], v233 offset:21504
    v_add_f32 v224, v224, v180
    v_mfma_f32_16x16x32_bf16 v[32:35], a[240:243], v[200:203], v[32:35]
    s_waitcnt lgkmcnt(4)
    buffer_load_dwordx4 v238, s[8:11], s45 offen offset:2048 nt lds
    v_mfma_f32_16x16x32_bf16 v[36:39], a[244:247], v[192:195], v[36:39]
    s_add_u32 m0, s51, 9088
    ds_read_b64_tr_b16 v[216:217], v234 offset:17408
    v_add_f32 v224, v224, v181
    v_mfma_f32_16x16x32_bf16 v[40:43], a[244:247], v[196:199], v[40:43]
    ds_read_b64_tr_b16 v[218:219], v234 offset:21504
    v_add_f32 v224, v224, v182
    v_mfma_f32_16x16x32_bf16 v[44:47], a[244:247], v[200:203], v[44:47]
    s_waitcnt lgkmcnt(4)
    buffer_load_dwordx4 v238, s[8:11], s45 offen offset:128 nt lds
    v_mfma_f32_16x16x32_bf16 v[48:51], a[248:251], v[192:195], v[48:51]
    ds_read_b64_tr_b16 v[220:221], v235 offset:17408
    v_add_f32 v224, v224, v183
    ds_read_b64_tr_b16 v[222:223], v235 offset:21504
    v_mfma_f32_16x16x32_bf16 v[52:55], a[248:251], v[196:199], v[52:55]
    buffer_load_dwordx4 v238, s[8:11], s45 offen offset:2176 nt lds
    s_add_u32 s45, s45, 8192
    v_mfma_f32_16x16x32_bf16 v[56:59], a[248:251], v[200:203], v[56:59]
    s_waitcnt lgkmcnt(4)
    v_add_f32 v225, v225, v184
    v_add_f32 v226, v226, v188
    v_mfma_f32_16x16x32_bf16 v[60:63], a[252:255], v[192:195], v[60:63]
    v_add_f32 v225, v225, v185
    v_add_f32 v226, v226, v189
    v_mfma_f32_16x16x32_bf16 v[64:67], a[252:255], v[196:199], v[64:67]
    s_waitcnt vmcnt(12) lgkmcnt(0)
    s_cbranch_vccnz L_af23
L_afr23:
    s_barrier
    v_add_f32 v225, v225, v186
    v_mfma_f32_16x16x32_bf16 v[68:71], a[252:255], v[200:203], v[68:71]
    s_add_u32 m0, s51, 16384
    ds_read_b128 a[240:243], v230 offset:24576
    v_add_f32 v225, v225, v187
    v_mfma_f32_16x16x32_bf16 v[72:75], v[216:219], v[192:195], v[72:75]
    ds_read_b128 a[244:247], v231 offset:24576
    v_add_f32 v226, v226, v190
    v_mfma_f32_16x16x32_bf16 v[76:79], v[216:219], v[196:199], v[76:79]
    v_exp_f32 v144, v144
    v_mfma_f32_16x16x32_bf16 v[80:83], v[216:219], v[200:203], v[80:83]
    v_exp_f32 v145, v145
    v_mfma_f32_16x16x32_bf16 v[84:87], v[220:223], v[192:195], v[84:87]
    ds_read_b128 a[248:251], v230 offset:25600
    v_add_f32 v226, v226, v191
    v_mfma_f32_16x16x32_bf16 v[88:91], v[220:223], v[196:199], v[88:91]
    v_exp_f32 v146, v146
    v_mfma_f32_16x16x32_bf16 v[92:95], v[220:223], v[200:203], v[92:95]
    s_waitcnt lgkmcnt(2)
    v_exp_f32 v147, v147
    v_mfma_f32_16x16x32_bf16 v[168:171], a[240:243], v[96:99], v[204:207]
    ds_read_b128 a[252:255], v231 offset:25600
    v_add_f32 v224, v224, v144
    v_mfma_f32_16x16x32_bf16 v[172:175], a[240:243], v[100:103], v[208:211]
    v_exp_f32 v148, v148
    v_mfma_f32_16x16x32_bf16 v[176:179], a[240:243], v[104:107], v[212:215]
    s_waitcnt lgkmcnt(2)
    ds_read_b128 v[216:219], v230 offset:28672
    v_add_f32 v224, v224, v145
    v_mfma_f32_16x16x32_bf16 v[168:171], a[244:247], v[108:111], v[168:171]
    ds_read_b128 v[220:223], v231 offset:28672
    v_add_f32 v224, v224, v146
    v_mfma_f32_16x16x32_bf16 v[172:175], a[244:247], v[112:115], v[172:175]
    v_exp_f32 v149, v149
    v_mfma_f32_16x16x32_bf16 v[176:179], a[244:247], v[116:119], v[176:179]
    s_waitcnt lgkmcnt(3)
    buffer_load_dwordx4 v238, s[4:7], s44 offen nt lds
    v_mfma_f32_16x16x32_bf16 v[168:171], a[248:251], v[120:123], v[168:171]
    v_exp_f32 v150, v150
    v_mfma_f32_16x16x32_bf16 v[172:175], a[248:251], v[124:127], v[172:175]
    ds_read_b128 a[240:243], v230 offset:29696
    v_add_f32 v224, v224, v147
    v_mfma_f32_16x16x32_bf16 v[176:179], a[248:251], v[128:131], v[176:179]
    s_waitcnt lgkmcnt(3)
    ds_read_b128 a[244:247], v231 offset:29696
    v_add_f32 v225, v225, v148
    v_mfma_f32_16x16x32_bf16 v[168:171], a[252:255], v[132:135], v[168:171]
    v_exp_f32 v151, v151
    v_mfma_f32_16x16x32_bf16 v[172:175], a[252:255], v[136:139], v[172:175]
    buffer_load_dwordx4 v238, s[4:7], s44 offen offset:2048 nt lds
    s_add_u32 m0, s51, 17280
    v_mfma_f32_16x16x32_bf16 v[176:179], a[252:255], v[140:143], v[176:179]
    s_waitcnt lgkmcnt(3)
    v_exp_f32 v152, v152
    v_mfma_f32_16x16x32_bf16 v[180:183], v[216:219], v[96:99], v[204:207]
    v_add_f32 v225, v225, v149
    v_add_f32 v226, v226, v152
    v_mfma_f32_16x16x32_bf16 v[184:187], v[216:219], v[100:103], v[208:211]
    v_exp_f32 v153, v153
    v_mfma_f32_16x16x32_bf16 v[188:191], v[216:219], v[104:107], v[212:215]
    s_waitcnt lgkmcnt(2)
    buffer_load_dwordx4 v238, s[4:7], s44 offen offset:128 nt lds
    v_mfma_f32_16x16x32_bf16 v[180:183], v[220:223], v[108:111], v[180:183]
    v_add_f32 v225, v225, v150
    v_add_f32 v226, v226, v153
    v_mfma_f32_16x16x32_bf16 v[184:187], v[220:223], v[112:115], v[184:187]
    s_waitcnt vmcnt(11) lgkmcnt(0)
    s_cbranch_vccnz L_af24
L_afr24:
    s_barrier
    v_add_f32 v225, v225, v151
    v_mfma_f32_16x16x32_bf16 v[188:191], v[220:223], v[116:119], v[188:191]
    v_exp_f32 v154, v154
    v_mfma_f32_16x16x32_bf16 v[180:183], a[240:243], v[120:123], v[180:183]
    v_exp_f32 v155, v155
    v_mfma_f32_16x16x32_bf16 v[184:187], a[240:243], v[124:127], v[184:187]
    buffer_load_dwordx4 v238, s[4:7], s44 offen offset:2176 nt lds
    s_add_u32 m0, s51, 24576
    v_mfma_f32_16x16x32_bf16 v[188:191], a[240:243], v[128:131], v[188:191]
    s_add_u32 s44, s44, 8192
    v_exp_f32 v156, v156
    v_mfma_f32_16x16x32_bf16 v[180:183], a[244:247], v[132:135], v[180:183]
    v_exp_f32 v157, v157
    v_mfma_f32_16x16x32_bf16 v[184:187], a[244:247], v[136:139], v[184:187]
    ds_read_b64_tr_b16 a[248:249], v232 offset:32768
    v_add_f32 v226, v226, v154
    ds_read_b64_tr_b16 a[250:251], v232 offset:36864
    v_exp_f32 v158, v158
    v_exp_f32 v159, v159
    v_cvt_pk_bf16_f32 v192, v144, v145
    v_cvt_pk_bf16_f32 v193, v146, v147
    v_cvt_pk_bf16_f32 v194, v156, v157
    v_cvt_pk_bf16_f32 v195, v158, v159
    v_mfma_f32_16x16x32_bf16 v[188:191], a[244:247], v[140:143], v[188:191]
    s_waitcnt lgkmcnt(0)
    ds_read_b64_tr_b16 a[252:253], v233 offset:32768
    v_add_f32 v226, v226, v155
    v_exp_f32 v160, v160
    v_exp_f32 v161, v161
    v_exp_f32 v162, v162
    v_exp_f32 v163, v163
    v_cvt_pk_bf16_f32 v196, v148, v149
    v_cvt_pk_bf16_f32 v197, v150, v151
    v_cvt_pk_bf16_f32 v198, v160, v161
    v_cvt_pk_bf16_f32 v199, v162, v163
    v_mfma_f32_16x16x32_bf16 v[0:3], a[248:251], v[192:195], v[0:3]
    ds_read_b64_tr_b16 a[254:255], v233 offset:36864
    v_add_f32 v224, v224, v156
    v_exp_f32 v164, v164
    v_exp_f32 v165, v165
    v_exp_f32 v166, v166
    v_exp_f32 v167, v167
    v_cvt_pk_bf16_f32 v200, v152, v153
    v_cvt_pk_bf16_f32 v201, v154, v155
    v_cvt_pk_bf16_f32 v202, v164, v165
    v_cvt_pk_bf16_f32 v203, v166, v167
    v_mfma_f32_16x16x32_bf16 v[4:7], a[248:251], v[196:199], v[4:7]
    ds_read_b64_tr_b16 v[216:217], v234 offset:32768
    v_add_f32 v224, v224, v157
    v_mfma_f32_16x16x32_bf16 v[8:11], a[248:251], v[200:203], v[8:11]
    s_waitcnt lgkmcnt(1)
    ds_read_b64_tr_b16 v[218:219], v234 offset:36864
    v_add_f32 v224, v224, v158
    v_mfma_f32_16x16x32_bf16 v[12:15], a[252:255], v[192:195], v[12:15]
    ds_read_b64_tr_b16 v[220:221], v235 offset:32768
    v_add_f32 v224, v224, v159
    v_mfma_f32_16x16x32_bf16 v[16:19], a[252:255], v[196:199], v[16:19]
    ds_read_b64_tr_b16 v[222:223], v235 offset:36864
    v_add_f32 v225, v225, v160
    v_mfma_f32_16x16x32_bf16 v[20:23], a[252:255], v[200:203], v[20:23]
    s_waitcnt lgkmcnt(2)
    ds_read_b64_tr_b16 a[240:241], v232 offset:33792
    v_add_f32 v225, v225, v161
    v_mfma_f32_16x16x32_bf16 v[24:27], v[216:219], v[192:195], v[24:27]
    ds_read_b64_tr_b16 a[242:243], v232 offset:37888
    v_add_f32 v225, v225, v162
    v_mfma_f32_16x16x32_bf16 v[28:31], v[216:219], v[196:199], v[28:31]
    buffer_load_dwordx4 v238, s[8:11], s45 offen nt lds
    v_mfma_f32_16x16x32_bf16 v[32:35], v[216:219], v[200:203], v[32:35]
    s_waitcnt lgkmcnt(2)
    ds_read_b64_tr_b16 a[244:245], v233 offset:33792
    v_add_f32 v225, v225, v163
    v_mfma_f32_16x16x32_bf16 v[36:39], v[220:223], v[192:195], v[36:39]
    ds_read_b64_tr_b16 a[246:247], v233 offset:37888
    v_add_f32 v226, v226, v164
    v_mfma_f32_16x16x32_bf16 v[40:43], v[220:223], v[196:199], v[40:43]
    buffer_load_dwordx4 v238, s[8:11], s45 offen offset:2048 nt lds
    s_add_u32 m0, s51, 25472
    v_mfma_f32_16x16x32_bf16 v[44:47], v[220:223], v[200:203], v[44:47]
    s_waitcnt lgkmcnt(2)
    ds_read_b64_tr_b16 a[248:249], v234 offset:33792
    v_add_f32 v226, v226, v165
    v_mfma_f32_16x16x32_bf16 v[48:51], a[240:243], v[192:195], v[48:51]
    ds_read_b64_tr_b16 a[250:251], v234 offset:37888
    v_add_f32 v226, v226, v166
    ds_read_b64_tr_b16 a[252:253], v235 offset:33792
    ds_read_b64_tr_b16 a[254:255], v235 offset:37888
    v_mfma_f32_16x16x32_bf16 v[52:55], a[240:243], v[196:199], v[52:55]
    buffer_load_dwordx4 v238, s[8:11], s45 offen offset:128 nt lds
    v_mfma_f32_16x16x32_bf16 v[56:59], a[240:243], v[200:203], v[56:59]
    s_waitcnt lgkmcnt(4)
    buffer_load_dwordx4 v238, s[8:11], s45 offen offset:2176 nt lds
    v_mfma_f32_16x16x32_bf16 v[60:63], a[244:247], v[192:195], v[60:63]
    s_or_b32 s3, s65, s53
    s_cbranch_scc1 L_nocnt
    s_and_b32 s3, s55, 0xfc
    s_add_u32 s3, s3, 64
    s_mov_b64 exec, 1
    s_nop 0
    buffer_atomic_add v252, off, s[32:35], s3 sc1
    s_mov_b64 exec, -1
L_nocnt:
    v_add_f32 v226, v226, v167
    s_add_u32 s45, s45, 8192
    v_mfma_f32_16x16x32_bf16 v[64:67], a[244:247], v[196:199], v[64:67]
    s_waitcnt vmcnt(12) lgkmcnt(0)
    s_cbranch_vccnz L_af25
L_afr25:
    s_barrier
    ds_read_b128 v[216:219], v230
    v_mfma_f32_16x16x32_bf16 v[68:71], a[244:247], v[200:203], v[68:71]
    s_add_u32 m0, s51, 32768
    v_exp_f32 v168, v168
    v_mfma_f32_16x16x32_bf16 v[72:75], a[248:251], v[192:195], v[72:75]
    v_exp_f32 v169, v169
    v_mfma_f32_16x16x32_bf16 v[76:79], a[248:251], v[196:199], v[76:79]
    v_exp_f32 v170, v170
    v_mfma_f32_16x16x32_bf16 v[80:83], a[248:251], v[200:203], v[80:83]
    ds_read_b128 v[220:223], v231
    v_add_f32 v224, v224, v168
    v_mfma_f32_16x16x32_bf16 v[84:87], a[252:255], v[192:195], v[84:87]
    v_exp_f32 v171, v171
    v_mfma_f32_16x16x32_bf16 v[88:91], a[252:255], v[196:199], v[88:91]
    v_exp_f32 v172, v172
    v_mfma_f32_16x16x32_bf16 v[92:95], a[252:255], v[200:203], v[92:95]
    s_waitcnt lgkmcnt(1)
    ds_read_b128 a[240:243], v230 offset:1024
    v_add_f32 v224, v224, v169
    v_mfma_f32_16x16x32_bf16 v[144:147], v[216:219], v[96:99], v[204:207]
    ds_read_b128 a[244:247], v231 offset:1024
    v_add_f32 v224, v224, v170
    v_mfma_f32_16x16x32_bf16 v[148:151], v[216:219], v[100:103], v[208:211]
    v_exp_f32 v173, v173
    v_mfma_f32_16x16x32_bf16 v[152:155], v[216:219], v[104:107], v[212:215]
    s_waitcnt lgkmcnt(2)
    buffer_load_dwordx4 v238, s[4:7], s44 offen nt lds
    v_mfma_f32_16x16x32_bf16 v[144:147], v[220:223], v[108:111], v[144:147]
    v_exp_f32 v174, v174
    v_mfma_f32_16x16x32_bf16 v[148:151], v[220:223], v[112:115], v[148:151]
    ds_read_b128 a[248:251], v230 offset:4096
    v_add_f32 v224, v224, v171
    v_mfma_f32_16x16x32_bf16 v[152:155], v[220:223], v[116:119], v[152:155]
    s_waitcnt lgkmcnt(2)
    ds_read_b128 a[252:255], v231 offset:4096
    v_add_f32 v225, v225, v172
    v_mfma_f32_16x16x32_bf16 v[144:147], a[240:243], v[120:123], v[144:147]
    v_exp_f32 v175, v175
    v_mfma_f32_16x16x32_bf16 v[148:151], a[240:243], v[124:127], v[148:151]
    buffer_load_dwordx4 v238, s[4:7], s44 offen offset:2048 nt lds
    s_add_u32 m0, s51, 33664
    v_mfma_f32_16x16x32_bf16 v[152:155], a[240:243], v[128:131], v[152:155]
    s_waitcnt lgkmcnt(2)
    v_exp_f32 v176, v176
    v_mfma_f32_16x16x32_bf16 v[144:147], a[244:247], v[132:135], v[144:147]
    ds_read_b128 v[216:219], v230 offset:5120
    v_add_f32 v225, v225, v173
    v_mfma_f32_16x16x32_bf16 v[148:151], a[244:247], v[136:139], v[148:151]
    ds_read_b128 v[220:223], v231 offset:5120
    v_add_f32 v225, v225, v174
    v_mfma_f32_16x16x32_bf16 v[152:155], a[244:247], v[140:143], v[152:155]
    s_waitcnt lgkmcnt(3)
    v_exp_f32 v177, v177
    v_mfma_f32_16x16x32_bf16 v[156:159], a[248:251], v[96:99], v[204:207]
    buffer_load_dwordx4 v238, s[4:7], s44 offen offset:128 nt lds
    v_mfma_f32_16x16x32_bf16 v[160:163], a[248:251], v[100:103], v[208:211]
    v_exp_f32 v178, v178
    v_mfma_f32_16x16x32_bf16 v[164:167], a[248:251], v[104:107], v[212:215]
    s_waitcnt lgkmcnt(2)
    v_exp_f32 v179, v179
    v_mfma_f32_16x16x32_bf16 v[156:159], a[252:255], v[108:111], v[156:159]
    v_add_f32 v225, v225, v175
    v_add_f32 v226, v226, v176
    v_mfma_f32_16x16x32_bf16 v[160:163], a[252:255], v[112:115], v[160:163]
    s_waitcnt vmcnt(11) lgkmcnt(0)
    s_cbranch_vccnz L_af26
L_afr26:
    s_barrier
    v_add_f32 v226, v226, v177
    v_mfma_f32_16x16x32_bf16 v[164:167], a[252:255], v[116:119], v[164:167]
    buffer_load_dwordx4 v238, s[4:7], s44 offen offset:2176 nt lds
    s_add_u32 m0, s51, 0
    v_mfma_f32_16x16x32_bf16 v[156:159], v[216:219], v[120:123], v[156:159]
    s_add_u32 s44, s44, 8192
    v_exp_f32 v180, v180
    v_mfma_f32_16x16x32_bf16 v[160:163], v[216:219], v[124:127], v[160:163]
    v_exp_f32 v181, v181
    v_mfma_f32_16x16x32_bf16 v[164:167], v[216:219], v[128:131], v[164:167]
    ds_read_b64_tr_b16 a[240:241], v232 offset:8192
    v_add_f32 v226, v226, v178
    v_mfma_f32_16x16x32_bf16 v[156:159], v[220:223], v[132:135], v[156:159]
    ds_read_b64_tr_b16 a[242:243], v232 offset:12288
    v_add_f32 v226, v226, v179
    v_mfma_f32_16x16x32_bf16 v[160:163], v[220:223], v[136:139], v[160:163]
    v_exp_f32 v182, v182
    v_exp_f32 v183, v183
    v_cvt_pk_bf16_f32 v192, v168, v169
    v_cvt_pk_bf16_f32 v193, v170, v171
    v_cvt_pk_bf16_f32 v194, v180, v181
    v_cvt_pk_bf16_f32 v195, v182, v183
    v_mfma_f32_16x16x32_bf16 v[164:167], v[220:223], v[140:143], v[164:167]
    s_waitcnt lgkmcnt(0)
    ds_read_b64_tr_b16 a[244:245], v233 offset:8192
    v_add_f32 v224, v224, v180
    v_exp_f32 v184, v184
    v_exp_f32 v185, v185
    v_exp_f32 v186, v186
    v_exp_f32 v187, v187
    v_cvt_pk_bf16_f32 v196, v172, v173
    v_cvt_pk_bf16_f32 v197, v174, v175
    v_cvt_pk_bf16_f32 v198, v184, v185
    v_cvt_pk_bf16_f32 v199, v186, v187
    v_mfma_f32_16x16x32_bf16 v[0:3], a[240:243], v[192:195], v[0:3]
    ds_read_b64_tr_b16 a[246:247], v233 offset:12288
    v_add_f32 v224, v224, v181
    v_exp_f32 v188, v188
    v_exp_f32 v189, v189
    v_exp_f32 v190, v190
    v_exp_f32 v191, v191
    v_cvt_pk_bf16_f32 v200, v176, v177
    v_cvt_pk_bf16_f32 v201, v178, v179
    v_cvt_pk_bf16_f32 v202, v188, v189
    v_cvt_pk_bf16_f32 v203, v190, v191
    v_mfma_f32_16x16x32_bf16 v[4:7], a[240:243], v[196:199], v[4:7]
    ds_read_b64_tr_b16 a[248:249], v234 offset:8192
    v_add_f32 v224, v224, v182
    v_mfma_f32_16x16x32_bf16 v[8:11], a[240:243], v[200:203], v[8:11]
    s_waitcnt lgkmcnt(1)
    ds_read_b64_tr_b16 a[250:251], v234 offset:12288
    v_add_f32 v224, v224, v183
    v_mfma_f32_16x16x32_bf16 v[12:15], a[244:247], v[192:195], v[12:15]
    ds_read_b64_tr_b16 a[252:253], v235 offset:8192
    v_add_f32 v225, v225, v184
    v_mfma_f32_16x16x32_bf16 v[16:19], a[244:247], v[196:199], v[16:19]
    ds_read_b64_tr_b16 a[254:255], v235 offset:12288
    v_add_f32 v225, v225, v185
    v_mfma_f32_16x16x32_bf16 v[20:23], a[244:247], v[200:203], v[20:23]
    s_waitcnt lgkmcnt(2)
    ds_read_b64_tr_b16 v[216:217], v232 offset:9216
    v_add_f32 v225, v225, v186
    v_mfma_f32_16x16x32_bf16 v[24:27], a[248:251], v[192:195], v[24:27]
    buffer_load_dwordx4 v238, s[8:11], s45 offen nt lds
    v_mfma_f32_16x16x32_bf16 v[28:31], a[248:251], v[196:199], v[28:31]
    ds_read_b64_tr_b16 v[218:219], v232 offset:13312
    v_add_f32 v225, v225, v187
    v_mfma_f32_16x16x32_bf16 v[32:35], a[248:251], v[200:203], v[32:35]
    s_waitcnt lgkmcnt(2)
    ds_read_b64_tr_b16 v[220:221], v233 offset:9216
    v_add_f32 v226, v226, v188
    v_mfma_f32_16x16x32_bf16 v[36:39], a[252:255], v[192:195], v[36:39]
    buffer_load_dwordx4 v238, s[8:11], s45 offen offset:2048 nt lds
    s_add_u32 m0, s51, 896
    v_mfma_f32_16x16x32_bf16 v[40:43], a[252:255], v[196:199], v[40:43]
    ds_read_b64_tr_b16 v[222:223], v233 offset:13312
    v_add_f32 v226, v226, v189
    v_mfma_f32_16x16x32_bf16 v[44:47], a[252:255], v[200:203], v[44:47]
    s_waitcnt lgkmcnt(2)
    ds_read_b64_tr_b16 a[240:241], v234 offset:9216
    v_add_f32 v226, v226, v190
    v_mfma_f32_16x16x32_bf16 v[48:51], v[216:219], v[192:195], v[48:51]
    buffer_load_dwordx4 v238, s[8:11], s45 offen offset:128 nt lds
    ds_read_b64_tr_b16 a[242:243], v234 offset:13312
    ds_read_b64_tr_b16 a[244:245], v235 offset:9216
    ds_read_b64_tr_b16 a[246:247], v235 offset:13312
    v_mfma_f32_16x16x32_bf16 v[52:55], v[216:219], v[196:199], v[52:55]
    buffer_load_dwordx4 v238, s[8:11], s45 offen offset:2176 nt lds
    s_add_u32 s45, s45, 8192
    v_mfma_f32_16x16x32_bf16 v[56:59], v[216:219], v[200:203], v[56:59]
    s_waitcnt lgkmcnt(4)
    v_add_f32 v226, v226, v191
    v_mfma_f32_16x16x32_bf16 v[60:63], v[220:223], v[192:195], v[60:63]
    v_exp_f32 v144, v144
    v_mfma_f32_16x16x32_bf16 v[64:67], v[220:223], v[196:199], v[64:67]
    s_waitcnt vmcnt(12) lgkmcnt(0)
    s_cbranch_vccnz L_af27
L_afr27:
    s_barrier
    ds_read_b128 a[248:251], v230 offset:16384
    v_mfma_f32_16x16x32_bf16 v[68:71], v[220:223], v[200:203], v[68:71]
    s_add_u32 m0, s51, 8192
    v_exp_f32 v145, v145
    v_mfma_f32_16x16x32_bf16 v[72:75], a[240:243], v[192:195], v[72:75]
    v_exp_f32 v146, v146
    v_mfma_f32_16x16x32_bf16 v[76:79], a[240:243], v[196:199], v[76:79]
    ds_read_b128 a[252:255], v231 offset:16384
    v_add_f32 v224, v224, v144
    v_mfma_f32_16x16x32_bf16 v[80:83], a[240:243], v[200:203], v[80:83]
    v_exp_f32 v147, v147
    v_mfma_f32_16x16x32_bf16 v[84:87], a[244:247], v[192:195], v[84:87]
    v_exp_f32 v148, v148
    v_mfma_f32_16x16x32_bf16 v[88:91], a[244:247], v[196:199], v[88:91]
    ds_read_b128 v[216:219], v230 offset:17408
    v_add_f32 v224, v224, v145
    v_mfma_f32_16x16x32_bf16 v[92:95], a[244:247], v[200:203], v[92:95]
    s_waitcnt lgkmcnt(2)
    ds_read_b128 v[220:223], v231 offset:17408
    v_add_f32 v224, v224, v146
    v_mfma_f32_16x16x32_bf16 v[168:171], a[248:251], v[96:99], v[204:207]
    v_exp_f32 v149, v149
    v_mfma_f32_16x16x32_bf16 v[172:175], a[248:251], v[100:103], v[208:211]
    buffer_load_dwordx4 v238, s[4:7], s44 offen nt lds
    v_mfma_f32_16x16x32_bf16 v[176:179], a[248:251], v[104:107], v[212:215]
    s_waitcnt lgkmcnt(2)
    v_exp_f32 v150, v150
    v_mfma_f32_16x16x32_bf16 v[168:171], a[252:255], v[108:111], v[168:171]
    ds_read_b128 a[240:243], v230 offset:20480
    v_add_f32 v224, v224, v147
    v_mfma_f32_16x16x32_bf16 v[172:175], a[252:255], v[112:115], v[172:175]
    ds_read_b128 a[244:247], v231 offset:20480
    v_add_f32 v225, v225, v148
    v_mfma_f32_16x16x32_bf16 v[176:179], a[252:255], v[116:119], v[176:179]
    s_waitcnt lgkmcnt(3)
    v_exp_f32 v151, v151
    v_mfma_f32_16x16x32_bf16 v[168:171], v[216:219], v[120:123], v[168:171]
    buffer_load_dwordx4 v238, s[4:7], s44 offen offset:2048 nt lds
    s_add_u32 m0, s51, 9088
    v_mfma_f32_16x16x32_bf16 v[172:175], v[216:219], v[124:127], v[172:175]
    v_exp_f32 v152, v152
    v_mfma_f32_16x16x32_bf16 v[176:179], v[216:219], v[128:131], v[176:179]
    s_waitcnt lgkmcnt(2)
    ds_read_b128 a[248:251], v230 offset:21504
    v_add_f32 v225, v225, v149
    v_mfma_f32_16x16x32_bf16 v[168:171], v[220:223], v[132:135], v[168:171]
    ds_read_b128 a[252:255], v231 offset:21504
    v_add_f32 v225, v225, v150
    v_mfma_f32_16x16x32_bf16 v[172:175], v[220:223], v[136:139], v[172:175]
    v_exp_f32 v153, v153
    v_mfma_f32_16x16x32_bf16 v[176:179], v[220:223], v[140:143], v[176:179]
    s_waitcnt lgkmcnt(3)
    buffer_load_dwordx4 v238, s[4:7], s44 offen offset:128 nt lds
    v_mfma_f32_16x16x32_bf16 v[180:183], a[240:243], v[96:99], v[204:207]
    v_exp_f32 v154, v154
    v_mfma_f32_16x16x32_bf16 v[184:187], a[240:243], v[100:103], v[208:211]
    v_exp_f32 v155, v155
    v_mfma_f32_16x16x32_bf16 v[188:191], a[240:243], v[104:107], v[212:215]
    s_waitcnt lgkmcnt(2)
    v_add_f32 v225, v225, v151
    v_add_f32 v226, v226, v152
    v_mfma_f32_16x16x32_bf16 v[180:183], a[244:247], v[108:111], v[180:183]
    buffer_load_dwordx4 v238, s[4:7], s44 offen offset:2176 nt lds
    s_add_u32 s44, s44, 8192
    v_mfma_f32_16x16x32_bf16 v[184:187], a[244:247], v[112:115], v[184:187]
    s_waitcnt vmcnt(12) lgkmcnt(0)
    s_cbranch_vccnz L_af28
L_afr28:
    s_barrier
    v_add_f32 v226, v226, v153
    v_mfma_f32_16x16x32_bf16 v[188:191], a[244:247], v[116:119], v[188:191]
    s_add_u32 m0, s51, 16384
    v_exp_f32 v156, v156
    v_mfma_f32_16x16x32_bf16 v[180:183], a[248:251], v[120:123], v[180:183]
    v_exp_f32 v157, v157
    v_mfma_f32_16x16x32_bf16 v[184:187], a[248:251], v[124:127], v[184:187]
    ds_read_b64_tr_b16 v[216:217], v232 offset:24576
    v_add_f32 v226, v226, v154
    v_mfma_f32_16x16x32_bf16 v[188:191], a[248:251], v[128:131], v[188:191]
    ds_read_b64_tr_b16 v[218:219], v232 offset:28672
    v_add_f32 v226, v226, v155
    v_mfma_f32_16x16x32_bf16 v[180:183], a[252:255], v[132:135], v[180:183]
    v_exp_f32 v158, v158
    v_mfma_f32_16x16x32_bf16 v[184:187], a[252:255], v[136:139], v[184:187]
    v_exp_f32 v159, v159
    v_cvt_pk_bf16_f32 v192, v144, v145
    v_cvt_pk_bf16_f32 v193, v146, v147
    v_cvt_pk_bf16_f32 v194, v156, v157
    v_cvt_pk_bf16_f32 v195, v158, v159
    v_mfma_f32_16x16x32_bf16 v[188:191], a[252:255], v[140:143], v[188:191]
    s_waitcnt lgkmcnt(0)
    ds_read_b64_tr_b16 v[220:221], v233 offset:24576
    v_add_f32 v224, v224, v156
    v_exp_f32 v160, v160
    v_exp_f32 v161, v161
    v_exp_f32 v162, v162
    v_exp_f32 v163, v163
    v_cvt_pk_bf16_f32 v196, v148, v149
    v_cvt_pk_bf16_f32 v197, v150, v151
    v_cvt_pk_bf16_f32 v198, v160, v161
    v_cvt_pk_bf16_f32 v199, v162, v163
    v_mfma_f32_16x16x32_bf16 v[0:3], v[216:219], v[192:195], v[0:3]
    ds_read_b64_tr_b16 v[222:223], v233 offset:28672
    v_add_f32 v224, v224, v157
    v_exp_f32 v164, v164
    v_exp_f32 v165, v165
    v_exp_f32 v166, v166
    v_exp_f32 v167, v167
    v_cvt_pk_bf16_f32 v200, v152, v153
    v_cvt_pk_bf16_f32 v201, v154, v155
    v_cvt_pk_bf16_f32 v202, v164, v165
    v_cvt_pk_bf16_f32 v203, v166, v167
    v_mfma_f32_16x16x32_bf16 v[4:7], v[216:219], v[196:199], v[4:7]
    ds_read_b64_tr_b16 a[240:241], v234 offset:24576
    v_add_f32 v224, v224, v158
    v_mfma_f32_16x16x32_bf16 v[8:11], v[216:219], v[200:203], v[8:11]
    s_waitcnt lgkmcnt(1)
    ds_read_b64_tr_b16 a[242:243], v234 offset:28672
    v_add_f32 v224, v224, v159
    v_mfma_f32_16x16x32_bf16 v[12:15], v[220:223], v[192:195], v[12:15]
    ds_read_b64_tr_b16 a[244:245], v235 offset:24576
    v_add_f32 v225, v225, v160
    v_mfma_f32_16x16x32_bf16 v[16:19], v[220:223], v[196:199], v[16:19]
    ds_read_b64_tr_b16 a[246:247], v235 offset:28672
    v_add_f32 v225, v225, v161
    v_mfma_f32_16x16x32_bf16 v[20:23], v[220:223], v[200:203], v[20:23]
    s_waitcnt lgkmcnt(2)
    ds_read_b64_tr_b16 a[248:249], v232 offset:25600
    v_add_f32 v225, v225, v162
    v_mfma_f32_16x16x32_bf16 v[24:27], a[240:243], v[192:195], v[24:27]
    buffer_load_dwordx4 v238, s[8:11], s45 offen nt lds
    v_mfma_f32_16x16x32_bf16 v[28:31], a[240:243], v[196:199], v[28:31]
    ds_read_b64_tr_b16 a[250:251], v232 offset:29696
    v_add_f32 v225, v225, v163
    v_mfma_f32_16x16x32_bf16 v[32:35], a[240:243], v[200:203], v[32:35]
    s_waitcnt lgkmcnt(2)
    ds_read_b64_tr_b16 a[252:253], v233 offset:25600
    v_add_f32 v226, v226, v164
    v_mfma_f32_16x16x32_bf16 v[36:39], a[244:247], v[192:195], v[36:39]
    buffer_load_dwordx4 v238, s[8:11], s45 offen offset:2048 nt lds
    s_add_u32 m0, s51, 17280
    v_mfma_f32_16x16x32_bf16 v[40:43], a[244:247], v[196:199], v[40:43]
    ds_read_b64_tr_b16 a[254:255], v233 offset:29696
    v_add_f32 v226, v226, v165
    v_mfma_f32_16x16x32_bf16 v[44:47], a[244:247], v[200:203], v[44:47]
    s_waitcnt lgkmcnt(2)
    ds_read_b64_tr_b16 v[216:217], v234 offset:25600
    v_add_f32 v226, v226, v166
    v_mfma_f32_16x16x32_bf16 v[48:51], a[248:251], v[192:195], v[48:51]
    buffer_load_dwordx4 v238, s[8:11], s45 offen offset:128 nt lds
    ds_read_b64_tr_b16 v[218:219], v234 offset:29696
    ds_read_b64_tr_b16 v[220:221], v235 offset:25600
    ds_read_b64_tr_b16 v[222:223], v235 offset:29696
    v_mfma_f32_16x16x32_bf16 v[52:55], a[248:251], v[196:199], v[52:55]
    buffer_load_dwordx4 v238, s[8:11], s45 offen offset:2176 nt lds
    s_add_u32 s45, s45, 8192
    v_mfma_f32_16x16x32_bf16 v[56:59], a[248:251], v[200:203], v[56:59]
    s_waitcnt lgkmcnt(4)
    v_add_f32 v226, v226, v167
    v_mfma_f32_16x16x32_bf16 v[60:63], a[252:255], v[192:195], v[60:63]
    v_exp_f32 v168, v168
    v_mfma_f32_16x16x32_bf16 v[64:67], a[252:255], v[196:199], v[64:67]
    s_waitcnt vmcnt(12) lgkmcnt(0)
    s_cbranch_vccnz L_af29
L_afr29:
    s_barrier
    ds_read_b128 a[240:243], v230 offset:32768
    v_mfma_f32_16x16x32_bf16 v[68:71], a[252:255], v[200:203], v[68:71]
    s_add_u32 m0, s51, 24576
    v_exp_f32 v169, v169
    v_mfma_f32_16x16x32_bf16 v[72:75], v[216:219], v[192:195], v[72:75]
    v_exp_f32 v170, v170
    v_mfma_f32_16x16x32_bf16 v[76:79], v[216:219], v[196:199], v[76:79]
    ds_read_b128 a[244:247], v231 offset:32768
    v_add_f32 v224, v224, v168
    v_mfma_f32_16x16x32_bf16 v[80:83], v[216:219], v[200:203], v[80:83]
    v_exp_f32 v171, v171
    v_mfma_f32_16x16x32_bf16 v[84:87], v[220:223], v[192:195], v[84:87]
    v_exp_f32 v172, v172
    v_mfma_f32_16x16x32_bf16 v[88:91], v[220:223], v[196:199], v[88:91]
    ds_read_b128 a[248:251], v230 offset:33792
    v_add_f32 v224, v224, v169
    v_mfma_f32_16x16x32_bf16 v[92:95], v[220:223], v[200:203], v[92:95]
    s_waitcnt lgkmcnt(2)
    ds_read_b128 a[252:255], v231 offset:33792
    v_add_f32 v224, v224, v170
    v_mfma_f32_16x16x32_bf16 v[144:147], a[240:243], v[96:99], v[204:207]
    v_exp_f32 v173, v173
    v_mfma_f32_16x16x32_bf16 v[148:151], a[240:243], v[100:103], v[208:211]
    buffer_load_dwordx4 v238, s[4:7], s44 offen nt lds
    v_mfma_f32_16x16x32_bf16 v[152:155], a[240:243], v[104:107], v[212:215]
    s_waitcnt lgkmcnt(2)
    v_exp_f32 v174, v174
    v_mfma_f32_16x16x32_bf16 v[144:147], a[244:247], v[108:111], v[144:147]
    ds_read_b128 v[216:219], v230 offset:36864
    v_add_f32 v224, v224, v171
    v_mfma_f32_16x16x32_bf16 v[148:151], a[244:247], v[112:115], v[148:151]
    ds_read_b128 v[220:223], v231 offset:36864
    v_add_f32 v225, v225, v172
    v_mfma_f32_16x16x32_bf16 v[152:155], a[244:247], v[116:119], v[152:155]
    s_waitcnt lgkmcnt(3)
    v_exp_f32 v175, v175
    v_mfma_f32_16x16x32_bf16 v[144:147], a[248:251], v[120:123], v[144:147]
    buffer_load_dwordx4 v238, s[4:7], s44 offen offset:2048 nt lds
    s_add_u32 m0, s51, 25472
    v_mfma_f32_16x16x32_bf16 v[148:151], a[248:251], v[124:127], v[148:151]
    v_exp_f32 v176, v176
    v_mfma_f32_16x16x32_bf16 v[152:155], a[248:251], v[128:131], v[152:155]
    s_waitcnt lgkmcnt(2)
    ds_read_b128 a[240:243], v230 offset:37888
    v_add_f32 v225, v225, v173
    v_mfma_f32_16x16x32_bf16 v[144:147], a[252:255], v[132:135], v[144:147]
    ds_read_b128 a[244:247], v231 offset:37888
    v_add_f32 v225, v225, v174
    v_mfma_f32_16x16x32_bf16 v[148:151], a[252:255], v[136:139], v[148:151]
    v_exp_f32 v177, v177
    v_mfma_f32_16x16x32_bf16 v[152:155], a[252:255], v[140:143], v[152:155]
    s_waitcnt lgkmcnt(3)
    buffer_load_dwordx4 v238, s[4:7], s44 offen offset:128 nt lds
    v_mfma_f32_16x16x32_bf16 v[156:159], v[216:219], v[96:99], v[204:207]
    v_exp_f32 v178, v178
    v_mfma_f32_16x16x32_bf16 v[160:163], v[216:219], v[100:103], v[208:211]
    v_exp_f32 v179, v179
    v_mfma_f32_16x16x32_bf16 v[164:167], v[216:219], v[104:107], v[212:215]
    s_waitcnt lgkmcnt(2)
    v_add_f32 v225, v225, v175
    v_add_f32 v226, v226, v176
    v_mfma_f32_16x16x32_bf16 v[156:159], v[220:223], v[108:111], v[156:159]
    buffer_load_dwordx4 v238, s[4:7], s44 offen offset:2176 nt lds
    s_add_u32 s44, s44, 8192
    v_mfma_f32_16x16x32_bf16 v[160:163], v[220:223], v[112:115], v[160:163]
    s_waitcnt vmcnt(12) lgkmcnt(0)
    s_cbranch_vccnz L_af30
L_afr30:
    s_barrier
    v_add_f32 v226, v226, v177
    v_mfma_f32_16x16x32_bf16 v[164:167], v[220:223], v[116:119], v[164:167]
    s_add_u32 m0, s51, 32768
    v_exp_f32 v180, v180
    v_mfma_f32_16x16x32_bf16 v[156:159], a[240:243], v[120:123], v[156:159]
    s_add_u32 s95, s95, 294912
    v_exp_f32 v181, v181
    v_mfma_f32_16x16x32_bf16 v[160:163], a[240:243], v[124:127], v[160:163]
    ds_read_b64_tr_b16 a[248:249], v232
    v_add_f32 v226, v226, v178
    v_mfma_f32_16x16x32_bf16 v[164:167], a[240:243], v[128:131], v[164:167]
    ds_read_b64_tr_b16 a[250:251], v232 offset:4096
    v_add_f32 v226, v226, v179
    v_mfma_f32_16x16x32_bf16 v[156:159], a[244:247], v[132:135], v[156:159]
    v_exp_f32 v182, v182
    v_mfma_f32_16x16x32_bf16 v[160:163], a[244:247], v[136:139], v[160:163]
    v_exp_f32 v183, v183
    v_cvt_pk_bf16_f32 v192, v168, v169
    v_cvt_pk_bf16_f32 v193, v170, v171
    v_cvt_pk_bf16_f32 v194, v180, v181
    v_cvt_pk_bf16_f32 v195, v182, v183
    v_mfma_f32_16x16x32_bf16 v[164:167], a[244:247], v[140:143], v[164:167]
    s_waitcnt lgkmcnt(0)
    ds_read_b64_tr_b16 a[252:253], v233
    v_add_f32 v224, v224, v180
    v_exp_f32 v184, v184
    v_exp_f32 v185, v185
    v_exp_f32 v186, v186
    v_exp_f32 v187, v187
    v_cvt_pk_bf16_f32 v196, v172, v173
    v_cvt_pk_bf16_f32 v197, v174, v175
    v_cvt_pk_bf16_f32 v198, v184, v185
    v_cvt_pk_bf16_f32 v199, v186, v187
    v_mfma_f32_16x16x32_bf16 v[0:3], a[248:251], v[192:195], v[0:3]
    ds_read_b64_tr_b16 a[254:255], v233 offset:4096
    v_add_f32 v224, v224, v181
    v_exp_f32 v188, v188
    v_exp_f32 v189, v189
    v_exp_f32 v190, v190
    v_exp_f32 v191, v191
    v_cvt_pk_bf16_f32 v200, v176, v177
    v_cvt_pk_bf16_f32 v201, v178, v179
    v_cvt_pk_bf16_f32 v202, v188, v189
    v_cvt_pk_bf16_f32 v203, v190, v191
    v_mfma_f32_16x16x32_bf16 v[4:7], a[248:251], v[196:199], v[4:7]
    ds_read_b64_tr_b16 v[216:217], v234
    v_add_f32 v224, v224, v182
    v_mfma_f32_16x16x32_bf16 v[8:11], a[248:251], v[200:203], v[8:11]
    s_waitcnt lgkmcnt(1)
    ds_read_b64_tr_b16 v[218:219], v234 offset:4096
    v_add_f32 v224, v224, v183
    v_mfma_f32_16x16x32_bf16 v[12:15], a[252:255], v[192:195], v[12:15]
    ds_read_b64_tr_b16 v[220:221], v235
    v_add_f32 v225, v225, v184
    v_mfma_f32_16x16x32_bf16 v[16:19], a[252:255], v[196:199], v[16:19]
    ds_read_b64_tr_b16 v[222:223], v235 offset:4096
    v_add_f32 v225, v225, v185
    v_mfma_f32_16x16x32_bf16 v[20:23], a[252:255], v[200:203], v[20:23]
    s_waitcnt lgkmcnt(2)
    ds_read_b64_tr_b16 a[240:241], v232 offset:1024
    v_add_f32 v225, v225, v186
    v_mfma_f32_16x16x32_bf16 v[24:27], v[216:219], v[192:195], v[24:27]
    buffer_load_dwordx4 v238, s[8:11], s45 offen nt lds
    v_mfma_f32_16x16x32_bf16 v[28:31], v[216:219], v[196:199], v[28:31]
    ds_read_b64_tr_b16 a[242:243], v232 offset:5120
    v_add_f32 v225, v225, v187
    v_mfma_f32_16x16x32_bf16 v[32:35], v[216:219], v[200:203], v[32:35]
    s_waitcnt lgkmcnt(2)
    ds_read_b64_tr_b16 a[244:245], v233 offset:1024
    v_add_f32 v226, v226, v188
    v_mfma_f32_16x16x32_bf16 v[36:39], v[220:223], v[192:195], v[36:39]
    buffer_load_dwordx4 v238, s[8:11], s45 offen offset:2048 nt lds
    s_add_u32 m0, s51, 33664
    v_mfma_f32_16x16x32_bf16 v[40:43], v[220:223], v[196:199], v[40:43]
    ds_read_b64_tr_b16 a[246:247], v233 offset:5120
    v_add_f32 v226, v226, v189
    v_mfma_f32_16x16x32_bf16 v[44:47], v[220:223], v[200:203], v[44:47]
    s_waitcnt lgkmcnt(2)
    ds_read_b64_tr_b16 a[248:249], v234 offset:1024
    v_add_f32 v226, v226, v190
    v_mfma_f32_16x16x32_bf16 v[48:51], a[240:243], v[192:195], v[48:51]
    buffer_load_dwordx4 v238, s[8:11], s45 offen offset:128 nt lds
    ds_read_b64_tr_b16 a[250:251], v234 offset:5120
    ds_read_b64_tr_b16 a[252:253], v235 offset:1024
    ds_read_b64_tr_b16 a[254:255], v235 offset:5120
    v_mfma_f32_16x16x32_bf16 v[52:55], a[240:243], v[196:199], v[52:55]
    buffer_load_dwordx4 v238, s[8:11], s45 offen offset:2176 nt lds
    s_add_u32 s45, s45, 8192
    v_mfma_f32_16x16x32_bf16 v[56:59], a[240:243], v[200:203], v[56:59]
    s_waitcnt lgkmcnt(4)
    v_add_f32 v226, v226, v191
    v_mfma_f32_16x16x32_bf16 v[60:63], a[244:247], v[192:195], v[60:63]
    v_exp_f32 v144, v144
    v_mfma_f32_16x16x32_bf16 v[64:67], a[244:247], v[196:199], v[64:67]
    s_waitcnt vmcnt(12) lgkmcnt(0)
    s_cbranch_vccnz L_af31
L_afr31:
    s_barrier
    ds_read_b128 v[216:219], v230 offset:8192
    v_mfma_f32_16x16x32_bf16 v[68:71], a[244:247], v[200:203], v[68:71]
    s_add_u32 m0, s51, 0
    v_exp_f32 v145, v145
    v_mfma_f32_16x16x32_bf16 v[72:75], a[248:251], v[192:195], v[72:75]
    v_exp_f32 v146, v146
    v_mfma_f32_16x16x32_bf16 v[76:79], a[248:251], v[196:199], v[76:79]
    ds_read_b128 v[220:223], v231 offset:8192
    v_add_f32 v224, v224, v144
    v_mfma_f32_16x16x32_bf16 v[80:83], a[248:251], v[200:203], v[80:83]
    v_exp_f32 v147, v147
    v_mfma_f32_16x16x32_bf16 v[84:87], a[252:255], v[192:195], v[84:87]
    v_exp_f32 v148, v148
    v_mfma_f32_16x16x32_bf16 v[88:91], a[252:255], v[196:199], v[88:91]
    ds_read_b128 a[240:243], v230 offset:9216
    v_add_f32 v224, v224, v145
    v_mfma_f32_16x16x32_bf16 v[92:95], a[252:255], v[200:203], v[92:95]
    s_waitcnt lgkmcnt(2)
    ds_read_b128 a[244:247], v231 offset:9216
    v_add_f32 v224, v224, v146
    v_mfma_f32_16x16x32_bf16 v[168:171], v[216:219], v[96:99], v[204:207]
    v_exp_f32 v149, v149
    v_mfma_f32_16x16x32_bf16 v[172:175], v[216:219], v[100:103], v[208:211]
    buffer_load_dwordx4 v238, s[4:7], s44 offen nt lds
    v_mfma_f32_16x16x32_bf16 v[176:179], v[216:219], v[104:107], v[212:215]
    s_waitcnt lgkmcnt(2)
    v_exp_f32 v150, v150
    v_mfma_f32_16x16x32_bf16 v[168:171], v[220:223], v[108:111], v[168:171]
    ds_read_b128 a[248:251], v230 offset:12288
    v_add_f32 v224, v224, v147
    v_mfma_f32_16x16x32_bf16 v[172:175], v[220:223], v[112:115], v[172:175]
    ds_read_b128 a[252:255], v231 offset:12288
    v_add_f32 v225, v225, v148
    v_mfma_f32_16x16x32_bf16 v[176:179], v[220:223], v[116:119], v[176:179]
    s_waitcnt lgkmcnt(3)
    v_exp_f32 v151, v151
    v_mfma_f32_16x16x32_bf16 v[168:171], a[240:243], v[120:123], v[168:171]
    buffer_load_dwordx4 v238, s[4:7], s44 offen offset:2048 nt lds
    s_add_u32 m0, s51, 896
    v_mfma_f32_16x16x32_bf16 v[172:175], a[240:243], v[124:127], v[172:175]
    v_exp_f32 v152, v152
    v_mfma_f32_16x16x32_bf16 v[176:179], a[240:243], v[128:131], v[176:179]
    s_waitcnt lgkmcnt(2)
    ds_read_b128 v[216:219], v230 offset:13312
    v_add_f32 v225, v225, v149
    v_mfma_f32_16x16x32_bf16 v[168:171], a[244:247], v[132:135], v[168:171]
    ds_read_b128 v[220:223], v231 offset:13312
    v_add_f32 v225, v225, v150
    v_mfma_f32_16x16x32_bf16 v[172:175], a[244:247], v[136:139], v[172:175]
    v_exp_f32 v153, v153
    v_mfma_f32_16x16x32_bf16 v[176:179], a[244:247], v[140:143], v[176:179]
    s_waitcnt lgkmcnt(3)
    buffer_load_dwordx4 v238, s[4:7], s44 offen offset:128 nt lds
    v_mfma_f32_16x16x32_bf16 v[180:183], a[248:251], v[96:99], v[204:207]
    v_exp_f32 v154, v154
    v_mfma_f32_16x16x32_bf16 v[184:187], a[248:251], v[100:103], v[208:211]
    v_exp_f32 v155, v155
    v_mfma_f32_16x16x32_bf16 v[188:191], a[248:251], v[104:107], v[212:215]
    s_waitcnt lgkmcnt(2)
    v_add_f32 v225, v225, v151
    v_add_f32 v226, v226, v152
    v_mfma_f32_16x16x32_bf16 v[180:183], a[252:255], v[108:111], v[180:183]
    buffer_load_dwordx4 v238, s[4:7], s44 offen offset:2176 nt lds
    s_add_u32 s44, s44, 8192
    v_mfma_f32_16x16x32_bf16 v[184:187], a[252:255], v[112:115], v[184:187]
    s_waitcnt vmcnt(12) lgkmcnt(0)
    s_cbranch_vccnz L_af32
L_afr32:
    s_barrier
    v_add_f32 v226, v226, v153
    v_mfma_f32_16x16x32_bf16 v[188:191], a[252:255], v[116:119], v[188:191]
    s_add_u32 m0, s51, 8192
    v_exp_f32 v156, v156
    v_mfma_f32_16x16x32_bf16 v[180:183], v[216:219], v[120:123], v[180:183]
    v_exp_f32 v157, v157
    v_mfma_f32_16x16x32_bf16 v[184:187], v[216:219], v[124:127], v[184:187]
    ds_read_b64_tr_b16 a[240:241], v232 offset:16384
    v_add_f32 v226, v226, v154
    v_mfma_f32_16x16x32_bf16 v[188:191], v[216:219], v[128:131], v[188:191]
    ds_read_b64_tr_b16 a[242:243], v232 offset:20480
    v_add_f32 v226, v226, v155
    v_mfma_f32_16x16x32_bf16 v[180:183], v[220:223], v[132:135], v[180:183]
    v_exp_f32 v158, v158
    v_mfma_f32_16x16x32_bf16 v[184:187], v[220:223], v[136:139], v[184:187]
    v_exp_f32 v159, v159
    v_cvt_pk_bf16_f32 v192, v144, v145
    v_cvt_pk_bf16_f32 v193, v146, v147
    v_cvt_pk_bf16_f32 v194, v156, v157
    v_cvt_pk_bf16_f32 v195, v158, v159
    v_mfma_f32_16x16x32_bf16 v[188:191], v[220:223], v[140:143], v[188:191]
    s_waitcnt lgkmcnt(0)
    ds_read_b64_tr_b16 a[244:245], v233 offset:16384
    v_add_f32 v224, v224, v156
    v_exp_f32 v160, v160
    v_exp_f32 v161, v161
    v_exp_f32 v162, v162
    v_exp_f32 v163, v163
    v_cvt_pk_bf16_f32 v196, v148, v149
    v_cvt_pk_bf16_f32 v197, v150, v151
    v_cvt_pk_bf16_f32 v198, v160, v161
    v_cvt_pk_bf16_f32 v199, v162, v163
    v_mfma_f32_16x16x32_bf16 v[0:3], a[240:243], v[192:195], v[0:3]
    ds_read_b64_tr_b16 a[246:247], v233 offset:20480
    v_add_f32 v224, v224, v157
    v_exp_f32 v164, v164
    v_exp_f32 v165, v165
    v_exp_f32 v166, v166
    v_exp_f32 v167, v167
    v_cvt_pk_bf16_f32 v200, v152, v153
    v_cvt_pk_bf16_f32 v201, v154, v155
    v_cvt_pk_bf16_f32 v202, v164, v165
    v_cvt_pk_bf16_f32 v203, v166, v167
    v_mfma_f32_16x16x32_bf16 v[4:7], a[240:243], v[196:199], v[4:7]
    ds_read_b64_tr_b16 a[248:249], v234 offset:16384
    v_add_f32 v224, v224, v158
    v_mfma_f32_16x16x32_bf16 v[8:11], a[240:243], v[200:203], v[8:11]
    s_waitcnt lgkmcnt(1)
    ds_read_b64_tr_b16 a[250:251], v234 offset:20480
    v_add_f32 v224, v224, v159
    v_mfma_f32_16x16x32_bf16 v[12:15], a[244:247], v[192:195], v[12:15]
    ds_read_b64_tr_b16 a[252:253], v235 offset:16384
    v_add_f32 v225, v225, v160
    v_mfma_f32_16x16x32_bf16 v[16:19], a[244:247], v[196:199], v[16:19]
    ds_read_b64_tr_b16 a[254:255], v235 offset:20480
    v_add_f32 v225, v225, v161
    v_mfma_f32_16x16x32_bf16 v[20:23], a[244:247], v[200:203], v[20:23]
    s_waitcnt lgkmcnt(2)
    ds_read_b64_tr_b16 v[216:217], v232 offset:17408
    v_add_f32 v225, v225, v162
    v_mfma_f32_16x16x32_bf16 v[24:27], a[248:251], v[192:195], v[24:27]
    buffer_load_dwordx4 v238, s[8:11], s45 offen nt lds
    v_mfma_f32_16x16x32_bf16 v[28:31], a[248:251], v[196:199], v[28:31]
    ds_read_b64_tr_b16 v[218:219], v232 offset:21504
    v_add_f32 v225, v225, v163
    v_mfma_f32_16x16x32_bf16 v[32:35], a[248:251], v[200:203], v[32:35]
    s_waitcnt lgkmcnt(2)
    ds_read_b64_tr_b16 v[220:221], v233 offset:17408
    v_add_f32 v226, v226, v164
    v_mfma_f32_16x16x32_bf16 v[36:39], a[252:255], v[192:195], v[36:39]
    buffer_load_dwordx4 v238, s[8:11], s45 offen offset:2048 nt lds
    s_add_u32 m0, s51, 9088
    v_mfma_f32_16x16x32_bf16 v[40:43], a[252:255], v[196:199], v[40:43]
    ds_read_b64_tr_b16 v[222:223], v233 offset:21504
    v_add_f32 v226, v226, v165
    v_mfma_f32_16x16x32_bf16 v[44:47], a[252:255], v[200:203], v[44:47]
    s_waitcnt lgkmcnt(2)
    ds_read_b64_tr_b16 a[240:241], v234 offset:17408
    v_add_f32 v226, v226, v166
    v_mfma_f32_16x16x32_bf16 v[48:51], v[216:219], v[192:195], v[48:51]
    buffer_load_dwordx4 v238, s[8:11], s45 offen offset:128 nt lds
    ds_read_b64_tr_b16 a[242:243], v234 offset:21504
    ds_read_b64_tr_b16 a[244:245], v235 offset:17408
    ds_read_b64_tr_b16 a[246:247], v235 offset:21504
    v_mfma_f32_16x16x32_bf16 v[52:55], v[216:219], v[196:199], v[52:55]
    buffer_load_dwordx4 v238, s[8:11], s45 offen offset:2176 nt lds
    s_add_u32 s45, s45, 8192
    v_mfma_f32_16x16x32_bf16 v[56:59], v[216:219], v[200:203], v[56:59]
    s_waitcnt lgkmcnt(4)
    v_add_f32 v226, v226, v167
    v_mfma_f32_16x16x32_bf16 v[60:63], v[220:223], v[192:195], v[60:63]
    v_exp_f32 v168, v168
    v_mfma_f32_16x16x32_bf16 v[64:67], v[220:223], v[196:199], v[64:67]
    s_waitcnt vmcnt(12) lgkmcnt(0)
    s_cbranch_vccnz L_af33
L_afr33:
    s_barrier
    ds_read_b128 a[248:251], v230 offset:24576
    v_mfma_f32_16x16x32_bf16 v[68:71], v[220:223], v[200:203], v[68:71]
    s_add_u32 m0, s51, 16384
    v_exp_f32 v169, v169
    v_mfma_f32_16x16x32_bf16 v[72:75], a[240:243], v[192:195], v[72:75]
    v_exp_f32 v170, v170
    v_mfma_f32_16x16x32_bf16 v[76:79], a[240:243], v[196:199], v[76:79]
    ds_read_b128 a[252:255], v231 offset:24576
    v_add_f32 v224, v224, v168
    v_mfma_f32_16x16x32_bf16 v[80:83], a[240:243], v[200:203], v[80:83]
    v_exp_f32 v171, v171
    v_mfma_f32_16x16x32_bf16 v[84:87], a[244:247], v[192:195], v[84:87]
    v_exp_f32 v172, v172
    v_mfma_f32_16x16x32_bf16 v[88:91], a[244:247], v[196:199], v[88:91]
    ds_read_b128 v[216:219], v230 offset:25600
    v_add_f32 v224, v224, v169
    v_mfma_f32_16x16x32_bf16 v[92:95], a[244:247], v[200:203], v[92:95]
    s_waitcnt lgkmcnt(2)
    ds_read_b128 v[220:223], v231 offset:25600
    v_add_f32 v224, v224, v170
    v_mfma_f32_16x16x32_bf16 v[144:147], a[248:251], v[96:99], v[204:207]
    v_exp_f32 v173, v173
    v_mfma_f32_16x16x32_bf16 v[148:151], a[248:251], v[100:103], v[208:211]
    buffer_load_dwordx4 v238, s[4:7], s44 offen nt lds
    v_mfma_f32_16x16x32_bf16 v[152:155], a[248:251], v[104:107], v[212:215]
    s_waitcnt lgkmcnt(2)
    v_exp_f32 v174, v174
    v_mfma_f32_16x16x32_bf16 v[144:147], a[252:255], v[108:111], v[144:147]
    ds_read_b128 a[240:243], v230 offset:28672
    v_add_f32 v224, v224, v171
    v_mfma_f32_16x16x32_bf16 v[148:151], a[252:255], v[112:115], v[148:151]
    ds_read_b128 a[244:247], v231 offset:28672
    v_add_f32 v225, v225, v172
    v_mfma_f32_16x16x32_bf16 v[152:155], a[252:255], v[116:119], v[152:155]
    s_waitcnt lgkmcnt(3)
    v_exp_f32 v175, v175
    v_mfma_f32_16x16x32_bf16 v[144:147], v[216:219], v[120:123], v[144:147]
    buffer_load_dwordx4 v238, s[4:7], s44 offen offset:2048 nt lds
    s_add_u32 m0, s51, 17280
    v_mfma_f32_16x16x32_bf16 v[148:151], v[216:219], v[124:127], v[148:151]
    v_exp_f32 v176, v176
    v_mfma_f32_16x16x32_bf16 v[152:155], v[216:219], v[128:131], v[152:155]
    s_waitcnt lgkmcnt(2)
    ds_read_b128 a[248:251], v230 offset:29696
    v_add_f32 v225, v225, v173
    v_mfma_f32_16x16x32_bf16 v[144:147], v[220:223], v[132:135], v[144:147]
    ds_read_b128 a[252:255], v231 offset:29696
    v_add_f32 v225, v225, v174
    v_mfma_f32_16x16x32_bf16 v[148:151], v[220:223], v[136:139], v[148:151]
    v_exp_f32 v177, v177
    v_mfma_f32_16x16x32_bf16 v[152:155], v[220:223], v[140:143], v[152:155]
    s_waitcnt lgkmcnt(3)
    buffer_load_dwordx4 v238, s[4:7], s44 offen offset:128 nt lds
    v_mfma_f32_16x16x32_bf16 v[156:159], a[240:243], v[96:99], v[204:207]
    v_exp_f32 v178, v178
    v_mfma_f32_16x16x32_bf16 v[160:163], a[240:243], v[100:103], v[208:211]
    v_exp_f32 v179, v179
    v_mfma_f32_16x16x32_bf16 v[164:167], a[240:243], v[104:107], v[212:215]
    s_waitcnt lgkmcnt(2)
    v_add_f32 v225, v225, v175
    v_add_f32 v226, v226, v176
    v_mfma_f32_16x16x32_bf16 v[156:159], a[244:247], v[108:111], v[156:159]
    buffer_load_dwordx4 v238, s[4:7], s44 offen offset:2176 nt lds
    s_add_u32 s44, s44, 8192
    v_mfma_f32_16x16x32_bf16 v[160:163], a[244:247], v[112:115], v[160:163]
    s_waitcnt vmcnt(12) lgkmcnt(0)
    s_cbranch_vccnz L_af34
L_afr34:
    s_barrier
    v_add_f32 v226, v226, v177
    v_mfma_f32_16x16x32_bf16 v[164:167], a[244:247], v[116:119], v[164:167]
    s_add_u32 m0, s51, 24576
    v_exp_f32 v180, v180
    v_mfma_f32_16x16x32_bf16 v[156:159], a[248:251], v[120:123], v[156:159]
    v_exp_f32 v181, v181
    v_mfma_f32_16x16x32_bf16 v[160:163], a[248:251], v[124:127], v[160:163]
    ds_read_b64_tr_b16 v[216:217], v232 offset:32768
    v_add_f32 v226, v226, v178
    v_mfma_f32_16x16x32_bf16 v[164:167], a[248:251], v[128:131], v[164:167]
    ds_read_b64_tr_b16 v[218:219], v232 offset:36864
    v_add_f32 v226, v226, v179
    v_mfma_f32_16x16x32_bf16 v[156:159], a[252:255], v[132:135], v[156:159]
    v_exp_f32 v182, v182
    v_mfma_f32_16x16x32_bf16 v[160:163], a[252:255], v[136:139], v[160:163]
    v_exp_f32 v183, v183
    v_cvt_pk_bf16_f32 v192, v168, v169
    v_cvt_pk_bf16_f32 v193, v170, v171
    v_cvt_pk_bf16_f32 v194, v180, v181
    v_cvt_pk_bf16_f32 v195, v182, v183
    v_mfma_f32_16x16x32_bf16 v[164:167], a[252:255], v[140:143], v[164:167]
    s_waitcnt lgkmcnt(0)
    ds_read_b64_tr_b16 v[220:221], v233 offset:32768
    v_add_f32 v224, v224, v180
    v_exp_f32 v184, v184
    v_exp_f32 v185, v185
    v_exp_f32 v186, v186
    v_exp_f32 v187, v187
    v_cvt_pk_bf16_f32 v196, v172, v173
    v_cvt_pk_bf16_f32 v197, v174, v175
    v_cvt_pk_bf16_f32 v198, v184, v185
    v_cvt_pk_bf16_f32 v199, v186, v187
    v_mfma_f32_16x16x32_bf16 v[0:3], v[216:219], v[192:195], v[0:3]
    ds_read_b64_tr_b16 v[222:223], v233 offset:36864
    v_add_f32 v224, v224, v181
    v_exp_f32 v188, v188
    v_exp_f32 v189, v189
    v_exp_f32 v190, v190
    v_exp_f32 v191, v191
    v_cvt_pk_bf16_f32 v200, v176, v177
    v_cvt_pk_bf16_f32 v201, v178, v179
    v_cvt_pk_bf16_f32 v202, v188, v189
    v_cvt_pk_bf16_f32 v203, v190, v191
    v_mfma_f32_16x16x32_bf16 v[4:7], v[216:219], v[196:199], v[4:7]
    ds_read_b64_tr_b16 a[240:241], v234 offset:32768
    v_add_f32 v224, v224, v182
    v_mfma_f32_16x16x32_bf16 v[8:11], v[216:219], v[200:203], v[8:11]
    s_waitcnt lgkmcnt(1)
    ds_read_b64_tr_b16 a[242:243], v234 offset:36864
    v_add_f32 v224, v224, v183
    v_mfma_f32_16x16x32_bf16 v[12:15], v[220:223], v[192:195], v[12:15]
    ds_read_b64_tr_b16 a[244:245], v235 offset:32768
    v_add_f32 v225, v225, v184
    v_mfma_f32_16x16x32_bf16 v[16:19], v[220:223], v[196:199], v[16:19]
    ds_read_b64_tr_b16 a[246:247], v235 offset:36864
    v_add_f32 v225, v225, v185
    v_mfma_f32_16x16x32_bf16 v[20:23], v[220:223], v[200:203], v[20:23]
    s_waitcnt lgkmcnt(2)
    ds_read_b64_tr_b16 a[248:249], v232 offset:33792
    v_add_f32 v225, v225, v186
    v_mfma_f32_16x16x32_bf16 v[24:27], a[240:243], v[192:195], v[24:27]
    buffer_load_dwordx4 v238, s[8:11], s45 offen nt lds
    v_mfma_f32_16x16x32_bf16 v[28:31], a[240:243], v[196:199], v[28:31]
    ds_read_b64_tr_b16 a[250:251], v232 offset:37888
    v_add_f32 v225, v225, v187
    v_mfma_f32_16x16x32_bf16 v[32:35], a[240:243], v[200:203], v[32:35]
    s_waitcnt lgkmcnt(2)
    ds_read_b64_tr_b16 a[252:253], v233 offset:33792
    v_add_f32 v226, v226, v188
    v_mfma_f32_16x16x32_bf16 v[36:39], a[244:247], v[192:195], v[36:39]
    buffer_load_dwordx4 v238, s[8:11], s45 offen offset:2048 nt lds
    s_add_u32 m0, s51, 25472
    v_mfma_f32_16x16x32_bf16 v[40:43], a[244:247], v[196:199], v[40:43]
    ds_read_b64_tr_b16 a[254:255], v233 offset:37888
    v_add_f32 v226, v226, v189
    v_mfma_f32_16x16x32_bf16 v[44:47], a[244:247], v[200:203], v[44:47]
    s_waitcnt lgkmcnt(2)
    ds_read_b64_tr_b16 v[216:217], v234 offset:33792
    v_add_f32 v226, v226, v190
    v_mfma_f32_16x16x32_bf16 v[48:51], a[248:251], v[192:195], v[48:51]
    buffer_load_dwordx4 v238, s[8:11], s45 offen offset:128 nt lds
    ds_read_b64_tr_b16 v[218:219], v234 offset:37888
    ds_read_b64_tr_b16 v[220:221], v235 offset:33792
    ds_read_b64_tr_b16 v[222:223], v235 offset:37888
    v_mfma_f32_16x16x32_bf16 v[52:55], a[248:251], v[196:199], v[52:55]
    buffer_load_dwordx4 v238, s[8:11], s45 offen offset:2176 nt lds
    s_add_u32 s45, s45, 8192
    v_mfma_f32_16x16x32_bf16 v[56:59], a[248:251], v[200:203], v[56:59]
    s_waitcnt lgkmcnt(4)
    v_add_f32 v226, v226, v191
    v_mfma_f32_16x16x32_bf16 v[60:63], a[252:255], v[192:195], v[60:63]
    v_exp_f32 v144, v144
    v_mfma_f32_16x16x32_bf16 v[64:67], a[252:255], v[196:199], v[64:67]
    s_waitcnt vmcnt(12) lgkmcnt(0)
    s_cbranch_vccnz L_af35
L_afr35:
    s_barrier
    ds_read_b128 a[240:243], v230
    v_mfma_f32_16x16x32_bf16 v[68:71], a[252:255], v[200:203], v[68:71]
    s_add_u32 m0, s51, 32768
    v_exp_f32 v145, v145
    v_mfma_f32_16x16x32_bf16 v[72:75], v[216:219], v[192:195], v[72:75]
    v_exp_f32 v146, v146
    v_mfma_f32_16x16x32_bf16 v[76:79], v[216:219], v[196:199], v[76:79]
    ds_read_b128 a[244:247], v231
    v_add_f32 v224, v224, v144
    v_mfma_f32_16x16x32_bf16 v[80:83], v[216:219], v[200:203], v[80:83]
    v_exp_f32 v147, v147
    v_mfma_f32_16x16x32_bf16 v[84:87], v[220:223], v[192:195], v[84:87]
    v_exp_f32 v148, v148
    v_mfma_f32_16x16x32_bf16 v[88:91], v[220:223], v[196:199], v[88:91]
    ds_read_b128 a[248:251], v230 offset:1024
    v_add_f32 v224, v224, v145
    v_mfma_f32_16x16x32_bf16 v[92:95], v[220:223], v[200:203], v[92:95]
    s_waitcnt lgkmcnt(2)
    ds_read_b128 a[252:255], v231 offset:1024
    v_add_f32 v224, v224, v146
    v_mfma_f32_16x16x32_bf16 v[168:171], a[240:243], v[96:99], v[204:207]
    v_exp_f32 v149, v149
    v_mfma_f32_16x16x32_bf16 v[172:175], a[240:243], v[100:103], v[208:211]
    buffer_load_dwordx4 v238, s[4:7], s44 offen nt lds
    v_mfma_f32_16x16x32_bf16 v[176:179], a[240:243], v[104:107], v[212:215]
    s_waitcnt lgkmcnt(2)
    v_exp_f32 v150, v150
    v_mfma_f32_16x16x32_bf16 v[168:171], a[244:247], v[108:111], v[168:171]
    ds_read_b128 v[216:219], v230 offset:4096
    v_add_f32 v224, v224, v147
    v_mfma_f32_16x16x32_bf16 v[172:175], a[244:247], v[112:115], v[172:175]
    ds_read_b128 v[220:223], v231 offset:4096
    v_add_f32 v225, v225, v148
    v_mfma_f32_16x16x32_bf16 v[176:179], a[244:247], v[116:119], v[176:179]
    s_waitcnt lgkmcnt(3)
    v_exp_f32 v151, v151
    v_mfma_f32_16x16x32_bf16 v[168:171], a[248:251], v[120:123], v[168:171]
    buffer_load_dwordx4 v238, s[4:7], s44 offen offset:2048 nt lds
    s_add_u32 m0, s51, 33664
    v_mfma_f32_16x16x32_bf16 v[172:175], a[248:251], v[124:127], v[172:175]
    v_exp_f32 v152, v152
    v_mfma_f32_16x16x32_bf16 v[176:179], a[248:251], v[128:131], v[176:179]
    s_waitcnt lgkmcnt(2)
    ds_read_b128 a[240:243], v230 offset:5120
    v_add_f32 v225, v225, v149
    v_mfma_f32_16x16x32_bf16 v[168:171], a[252:255], v[132:135], v[168:171]
    ds_read_b128 a[244:247], v231 offset:5120
    v_add_f32 v225, v225, v150
    v_mfma_f32_16x16x32_bf16 v[172:175], a[252:255], v[136:139], v[172:175]
    v_exp_f32 v153, v153
    v_mfma_f32_16x16x32_bf16 v[176:179], a[252:255], v[140:143], v[176:179]
    s_waitcnt lgkmcnt(3)
    buffer_load_dwordx4 v238, s[4:7], s44 offen offset:128 nt lds
    v_mfma_f32_16x16x32_bf16 v[180:183], v[216:219], v[96:99], v[204:207]
    v_exp_f32 v154, v154
    v_mfma_f32_16x16x32_bf16 v[184:187], v[216:219], v[100:103], v[208:211]
    v_exp_f32 v155, v155
    v_mfma_f32_16x16x32_bf16 v[188:191], v[216:219], v[104:107], v[212:215]
    s_waitcnt lgkmcnt(2)
    v_add_f32 v225, v225, v151
    v_add_f32 v226, v226, v152
    v_mfma_f32_16x16x32_bf16 v[180:183], v[220:223], v[108:111], v[180:183]
    buffer_load_dwordx4 v238, s[4:7], s44 offen offset:2176 nt lds
    s_add_u32 s44, s44, 8192
    v_mfma_f32_16x16x32_bf16 v[184:187], v[220:223], v[112:115], v[184:187]
    s_waitcnt vmcnt(12) lgkmcnt(0)
    s_cbranch_vccnz L_af36
L_afr36:
    s_barrier
    v_add_f32 v226, v226, v153
    v_mfma_f32_16x16x32_bf16 v[188:191], v[220:223], v[116:119], v[188:191]
    s_add_u32 m0, s51, 0
    v_exp_f32 v156, v156
    v_mfma_f32_16x16x32_bf16 v[180:183], a[240:243], v[120:123], v[180:183]
    v_exp_f32 v157, v157
    v_mfma_f32_16x16x32_bf16 v[184:187], a[240:243], v[124:127], v[184:187]
    ds_read_b64_tr_b16 a[248:249], v232 offset:8192
    v_add_f32 v226, v226, v154
    v_mfma_f32_16x16x32_bf16 v[188:191], a[240:243], v[128:131], v[188:191]
    ds_read_b64_tr_b16 a[250:251], v232 offset:12288
    v_add_f32 v226, v226, v155
    v_mfma_f32_16x16x32_bf16 v[180:183], a[244:247], v[132:135], v[180:183]
    v_exp_f32 v158, v158
    v_mfma_f32_16x16x32_bf16 v[184:187], a[244:247], v[136:139], v[184:187]
    v_exp_f32 v159, v159
    v_cvt_pk_bf16_f32 v192, v144, v145
    v_cvt_pk_bf16_f32 v193, v146, v147
    v_cvt_pk_bf16_f32 v194, v156, v157
    v_cvt_pk_bf16_f32 v195, v158, v159
    v_mfma_f32_16x16x32_bf16 v[188:191], a[244:247], v[140:143], v[188:191]
    s_waitcnt lgkmcnt(0)
    ds_read_b64_tr_b16 a[252:253], v233 offset:8192
    v_add_f32 v224, v224, v156
    v_exp_f32 v160, v160
    v_exp_f32 v161, v161
    v_exp_f32 v162, v162
    v_exp_f32 v163, v163
    v_cvt_pk_bf16_f32 v196, v148, v149
    v_cvt_pk_bf16_f32 v197, v150, v151
    v_cvt_pk_bf16_f32 v198, v160, v161
    v_cvt_pk_bf16_f32 v199, v162, v163
    v_mfma_f32_16x16x32_bf16 v[0:3], a[248:251], v[192:195], v[0:3]
    ds_read_b64_tr_b16 a[254:255], v233 offset:12288
    v_add_f32 v224, v224, v157
    v_exp_f32 v164, v164
    v_exp_f32 v165, v165
    v_exp_f32 v166, v166
    v_exp_f32 v167, v167
    v_cvt_pk_bf16_f32 v200, v152, v153
    v_cvt_pk_bf16_f32 v201, v154, v155
    v_cvt_pk_bf16_f32 v202, v164, v165
    v_cvt_pk_bf16_f32 v203, v166, v167
    v_mfma_f32_16x16x32_bf16 v[4:7], a[248:251], v[196:199], v[4:7]
    ds_read_b64_tr_b16 v[216:217], v234 offset:8192
    v_add_f32 v224, v224, v158
    v_mfma_f32_16x16x32_bf16 v[8:11], a[248:251], v[200:203], v[8:11]
    s_waitcnt lgkmcnt(1)
    ds_read_b64_tr_b16 v[218:219], v234 offset:12288
    v_add_f32 v224, v224, v159
    v_mfma_f32_16x16x32_bf16 v[12:15], a[252:255], v[192:195], v[12:15]
    ds_read_b64_tr_b16 v[220:221], v235 offset:8192
    v_add_f32 v225, v225, v160
    v_mfma_f32_16x16x32_bf16 v[16:19], a[252:255], v[196:199], v[16:19]
    ds_read_b64_tr_b16 v[222:223], v235 offset:12288
    v_add_f32 v225, v225, v161
    v_mfma_f32_16x16x32_bf16 v[20:23], a[252:255], v[200:203], v[20:23]
    s_waitcnt lgkmcnt(2)
    ds_read_b64_tr_b16 a[240:241], v232 offset:9216
    v_add_f32 v225, v225, v162
    v_mfma_f32_16x16x32_bf16 v[24:27], v[216:219], v[192:195], v[24:27]
    buffer_load_dwordx4 v238, s[8:11], s45 offen nt lds
    v_mfma_f32_16x16x32_bf16 v[28:31], v[216:219], v[196:199], v[28:31]
    ds_read_b64_tr_b16 a[242:243], v232 offset:13312
    v_add_f32 v225, v225, v163
    v_mfma_f32_16x16x32_bf16 v[32:35], v[216:219], v[200:203], v[32:35]
    s_waitcnt lgkmcnt(2)
    ds_read_b64_tr_b16 a[244:245], v233 offset:9216
    v_add_f32 v226, v226, v164
    v_mfma_f32_16x16x32_bf16 v[36:39], v[220:223], v[192:195], v[36:39]
    buffer_load_dwordx4 v238, s[8:11], s45 offen offset:2048 nt lds
    s_add_u32 m0, s51, 896
    v_mfma_f32_16x16x32_bf16 v[40:43], v[220:223], v[196:199], v[40:43]
    ds_read_b64_tr_b16 a[246:247], v233 offset:13312
    v_add_f32 v226, v226, v165
    v_mfma_f32_16x16x32_bf16 v[44:47], v[220:223], v[200:203], v[44:47]
    s_waitcnt lgkmcnt(2)
    ds_read_b64_tr_b16 a[248:249], v234 offset:9216
    v_add_f32 v226, v226, v166
    v_mfma_f32_16x16x32_bf16 v[48:51], a[240:243], v[192:195], v[48:51]
    buffer_load_dwordx4 v238, s[8:11], s45 offen offset:128 nt lds
    ds_read_b64_tr_b16 a[250:251], v234 offset:13312
    ds_read_b64_tr_b16 a[252:253], v235 offset:9216
    ds_read_b64_tr_b16 a[254:255], v235 offset:13312
    v_mfma_f32_16x16x32_bf16 v[52:55], a[240:243], v[196:199], v[52:55]
    buffer_load_dwordx4 v238, s[8:11], s45 offen offset:2176 nt lds
    s_add_u32 s45, s45, 8192
    v_mfma_f32_16x16x32_bf16 v[56:59], a[240:243], v[200:203], v[56:59]
    s_waitcnt lgkmcnt(4)
    v_add_f32 v226, v226, v167
    v_mfma_f32_16x16x32_bf16 v[60:63], a[244:247], v[192:195], v[60:63]
    v_exp_f32 v168, v168
    v_mfma_f32_16x16x32_bf16 v[64:67], a[244:247], v[196:199], v[64:67]
    s_waitcnt vmcnt(12) lgkmcnt(0)
    s_cbranch_vccnz L_af37
L_afr37:
    s_barrier
    ds_read_b128 v[216:219], v230 offset:16384
    v_mfma_f32_16x16x32_bf16 v[68:71], a[244:247], v[200:203], v[68:71]
    s_add_u32 m0, s51, 8192
    v_exp_f32 v169, v169
    v_mfma_f32_16x16x32_bf16 v[72:75], a[248:251], v[192:195], v[72:75]
    v_exp_f32 v170, v170
    v_mfma_f32_16x16x32_bf16 v[76:79], a[248:251], v[196:199], v[76:79]
    ds_read_b128 v[220:223], v231 offset:16384
    v_add_f32 v224, v224, v168
    v_mfma_f32_16x16x32_bf16 v[80:83], a[248:251], v[200:203], v[80:83]
    v_exp_f32 v171, v171
    v_mfma_f32_16x16x32_bf16 v[84:87], a[252:255], v[192:195], v[84:87]
    v_exp_f32 v172, v172
    v_mfma_f32_16x16x32_bf16 v[88:91], a[252:255], v[196:199], v[88:91]
    ds_read_b128 a[240:243], v230 offset:17408
    v_add_f32 v224, v224, v169
    v_mfma_f32_16x16x32_bf16 v[92:95], a[252:255], v[200:203], v[92:95]
    s_waitcnt lgkmcnt(2)
    ds_read_b128 a[244:247], v231 offset:17408
    v_add_f32 v224, v224, v170
    v_mfma_f32_16x16x32_bf16 v[144:147], v[216:219], v[96:99], v[204:207]
    v_exp_f32 v173, v173
    v_mfma_f32_16x16x32_bf16 v[148:151], v[216:219], v[100:103], v[208:211]
    buffer_load_dwordx4 v238, s[4:7], s44 offen nt lds
    v_mfma_f32_16x16x32_bf16 v[152:155], v[216:219], v[104:107], v[212:215]
    s_waitcnt lgkmcnt(2)
    v_exp_f32 v174, v174
    v_mfma_f32_16x16x32_bf16 v[144:147], v[220:223], v[108:111], v[144:147]
    ds_read_b128 a[248:251], v230 offset:20480
    v_add_f32 v224, v224, v171
    v_mfma_f32_16x16x32_bf16 v[148:151], v[220:223], v[112:115], v[148:151]
    ds_read_b128 a[252:255], v231 offset:20480
    v_add_f32 v225, v225, v172
    v_mfma_f32_16x16x32_bf16 v[152:155], v[220:223], v[116:119], v[152:155]
    s_waitcnt lgkmcnt(3)
    v_exp_f32 v175, v175
    v_mfma_f32_16x16x32_bf16 v[144:147], a[240:243], v[120:123], v[144:147]
    buffer_load_dwordx4 v238, s[4:7], s44 offen offset:2048 nt lds
    s_add_u32 m0, s51, 9088
    v_mfma_f32_16x16x32_bf16 v[148:151], a[240:243], v[124:127], v[148:151]
    v_exp_f32 v176, v176
    v_mfma_f32_16x16x32_bf16 v[152:155], a[240:243], v[128:131], v[152:155]
    s_waitcnt lgkmcnt(2)
    ds_read_b128 v[216:219], v230 offset:21504
    v_add_f32 v225, v225, v173
    v_mfma_f32_16x16x32_bf16 v[144:147], a[244:247], v[132:135], v[144:147]
    ds_read_b128 v[220:223], v231 offset:21504
    v_add_f32 v225, v225, v174
    v_mfma_f32_16x16x32_bf16 v[148:151], a[244:247], v[136:139], v[148:151]
    v_exp_f32 v177, v177
    v_mfma_f32_16x16x32_bf16 v[152:155], a[244:247], v[140:143], v[152:155]
    s_waitcnt lgkmcnt(3)
    buffer_load_dwordx4 v238, s[4:7], s44 offen offset:128 nt lds
    v_mfma_f32_16x16x32_bf16 v[156:159], a[248:251], v[96:99], v[204:207]
    v_exp_f32 v178, v178
    v_mfma_f32_16x16x32_bf16 v[160:163], a[248:251], v[100:103], v[208:211]
    v_exp_f32 v179, v179
    v_mfma_f32_16x16x32_bf16 v[164:167], a[248:251], v[104:107], v[212:215]
    s_waitcnt lgkmcnt(2)
    v_add_f32 v225, v225, v175
    v_add_f32 v226, v226, v176
    v_mfma_f32_16x16x32_bf16 v[156:159], a[252:255], v[108:111], v[156:159]
    buffer_load_dwordx4 v238, s[4:7], s44 offen offset:2176 nt lds
    s_add_u32 s44, s44, 8192
    v_mfma_f32_16x16x32_bf16 v[160:163], a[252:255], v[112:115], v[160:163]
    s_waitcnt vmcnt(12) lgkmcnt(0)
    s_cbranch_vccnz L_af38
L_afr38:
    s_barrier
    v_add_f32 v226, v226, v177
    v_mfma_f32_16x16x32_bf16 v[164:167], a[252:255], v[116:119], v[164:167]
    s_add_u32 m0, s51, 16384
    v_exp_f32 v180, v180
    v_mfma_f32_16x16x32_bf16 v[156:159], v[216:219], v[120:123], v[156:159]
    v_exp_f32 v181, v181
    v_mfma_f32_16x16x32_bf16 v[160:163], v[216:219], v[124:127], v[160:163]
    ds_read_b64_tr_b16 a[240:241], v232 offset:24576
    v_add_f32 v226, v226, v178
    v_mfma_f32_16x16x32_bf16 v[164:167], v[216:219], v[128:131], v[164:167]
    ds_read_b64_tr_b16 a[242:243], v232 offset:28672
    v_add_f32 v226, v226, v179
    v_mfma_f32_16x16x32_bf16 v[156:159], v[220:223], v[132:135], v[156:159]
    v_exp_f32 v182, v182
    v_mfma_f32_16x16x32_bf16 v[160:163], v[220:223], v[136:139], v[160:163]
    v_exp_f32 v183, v183
    v_cvt_pk_bf16_f32 v192, v168, v169
    v_cvt_pk_bf16_f32 v193, v170, v171
    v_cvt_pk_bf16_f32 v194, v180, v181
    v_cvt_pk_bf16_f32 v195, v182, v183
    v_mfma_f32_16x16x32_bf16 v[164:167], v[220:223], v[140:143], v[164:167]
    s_waitcnt lgkmcnt(0)
    ds_read_b64_tr_b16 a[244:245], v233 offset:24576
    v_add_f32 v224, v224, v180
    v_exp_f32 v184, v184
    v_exp_f32 v185, v185
    v_exp_f32 v186, v186
    v_exp_f32 v187, v187
    v_cvt_pk_bf16_f32 v196, v172, v173
    v_cvt_pk_bf16_f32 v197, v174, v175
    v_cvt_pk_bf16_f32 v198, v184, v185
    v_cvt_pk_bf16_f32 v199, v186, v187
    v_mfma_f32_16x16x32_bf16 v[0:3], a[240:243], v[192:195], v[0:3]
    ds_read_b64_tr_b16 a[246:247], v233 offset:28672
    v_add_f32 v224, v224, v181
    v_exp_f32 v188, v188
    v_exp_f32 v189, v189
    v_exp_f32 v190, v190
    v_exp_f32 v191, v191
    v_cvt_pk_bf16_f32 v200, v176, v177
    v_cvt_pk_bf16_f32 v201, v178, v179
    v_cvt_pk_bf16_f32 v202, v188, v189
    v_cvt_pk_bf16_f32 v203, v190, v191
    v_mfma_f32_16x16x32_bf16 v[4:7], a[240:243], v[196:199], v[4:7]
    ds_read_b64_tr_b16 a[248:249], v234 offset:24576
    v_add_f32 v224, v224, v182
    v_mfma_f32_16x16x32_bf16 v[8:11], a[240:243], v[200:203], v[8:11]
    s_waitcnt lgkmcnt(1)
    ds_read_b64_tr_b16 a[250:251], v234 offset:28672
    v_add_f32 v224, v224, v183
    v_mfma_f32_16x16x32_bf16 v[12:15], a[244:247], v[192:195], v[12:15]
    ds_read_b64_tr_b16 a[252:253], v235 offset:24576
    v_add_f32 v225, v225, v184
    v_mfma_f32_16x16x32_bf16 v[16:19], a[244:247], v[196:199], v[16:19]
    ds_read_b64_tr_b16 a[254:255], v235 offset:28672
    v_add_f32 v225, v225, v185
    v_mfma_f32_16x16x32_bf16 v[20:23], a[244:247], v[200:203], v[20:23]
    s_waitcnt lgkmcnt(2)
    ds_read_b64_tr_b16 v[216:217], v232 offset:25600
    v_add_f32 v225, v225, v186
    v_mfma_f32_16x16x32_bf16 v[24:27], a[248:251], v[192:195], v[24:27]
    buffer_load_dwordx4 v238, s[8:11], s45 offen nt lds
    v_mfma_f32_16x16x32_bf16 v[28:31], a[248:251], v[196:199], v[28:31]
    ds_read_b64_tr_b16 v[218:219], v232 offset:29696
    v_add_f32 v225, v225, v187
    v_mfma_f32_16x16x32_bf16 v[32:35], a[248:251], v[200:203], v[32:35]
    s_waitcnt lgkmcnt(2)
    ds_read_b64_tr_b16 v[220:221], v233 offset:25600
    v_add_f32 v226, v226, v188
    v_mfma_f32_16x16x32_bf16 v[36:39], a[252:255], v[192:195], v[36:39]
    buffer_load_dwordx4 v238, s[8:11], s45 offen offset:2048 nt lds
    s_add_u32 m0, s51, 17280
    v_mfma_f32_16x16x32_bf16 v[40:43], a[252:255], v[196:199], v[40:43]
    ds_read_b64_tr_b16 v[222:223], v233 offset:29696
    v_add_f32 v226, v226, v189
    v_mfma_f32_16x16x32_bf16 v[44:47], a[252:255], v[200:203], v[44:47]
    s_waitcnt lgkmcnt(2)
    ds_read_b64_tr_b16 a[240:241], v234 offset:25600
    v_add_f32 v226, v226, v190
    v_mfma_f32_16x16x32_bf16 v[48:51], v[216:219], v[192:195], v[48:51]
    buffer_load_dwordx4 v238, s[8:11], s45 offen offset:128 nt lds
    ds_read_b64_tr_b16 a[242:243], v234 offset:29696
    ds_read_b64_tr_b16 a[244:245], v235 offset:25600
    ds_read_b64_tr_b16 a[246:247], v235 offset:29696
    v_mfma_f32_16x16x32_bf16 v[52:55], v[216:219], v[196:199], v[52:55]
    buffer_load_dwordx4 v238, s[8:11], s45 offen offset:2176 nt lds
    s_add_u32 s45, s45, 8192
    v_mfma_f32_16x16x32_bf16 v[56:59], v[216:219], v[200:203], v[56:59]
    s_waitcnt lgkmcnt(4)
    v_add_f32 v226, v226, v191
    v_mfma_f32_16x16x32_bf16 v[60:63], v[220:223], v[192:195], v[60:63]
    v_exp_f32 v144, v144
    v_mfma_f32_16x16x32_bf16 v[64:67], v[220:223], v[196:199], v[64:67]
    s_waitcnt vmcnt(12) lgkmcnt(0)
    s_cbranch_vccnz L_af39
L_afr39:
    s_barrier
    ds_read_b128 a[248:251], v230 offset:32768
    v_mfma_f32_16x16x32_bf16 v[68:71], v[220:223], v[200:203], v[68:71]
    s_add_u32 m0, s51, 24576
    v_exp_f32 v145, v145
    v_mfma_f32_16x16x32_bf16 v[72:75], a[240:243], v[192:195], v[72:75]
    v_exp_f32 v146, v146
    v_mfma_f32_16x16x32_bf16 v[76:79], a[240:243], v[196:199], v[76:79]
    ds_read_b128 a[252:255], v231 offset:32768
    v_add_f32 v224, v224, v144
    v_mfma_f32_16x16x32_bf16 v[80:83], a[240:243], v[200:203], v[80:83]
    v_exp_f32 v147, v147
    v_mfma_f32_16x16x32_bf16 v[84:87], a[244:247], v[192:195], v[84:87]
    v_exp_f32 v148, v148
    v_mfma_f32_16x16x32_bf16 v[88:91], a[244:247], v[196:199], v[88:91]
    ds_read_b128 v[216:219], v230 offset:33792
    v_add_f32 v224, v224, v145
    v_mfma_f32_16x16x32_bf16 v[92:95], a[244:247], v[200:203], v[92:95]
    s_waitcnt lgkmcnt(2)
    ds_read_b128 v[220:223], v231 offset:33792
    v_add_f32 v224, v224, v146
    v_mfma_f32_16x16x32_bf16 v[168:171], a[248:251], v[96:99], v[204:207]
    v_exp_f32 v149, v149
    v_mfma_f32_16x16x32_bf16 v[172:175], a[248:251], v[100:103], v[208:211]
    buffer_load_dwordx4 v238, s[4:7], s44 offen nt lds
    v_mfma_f32_16x16x32_bf16 v[176:179], a[248:251], v[104:107], v[212:215]
    s_waitcnt lgkmcnt(2)
    v_exp_f32 v150, v150
    v_mfma_f32_16x16x32_bf16 v[168:171], a[252:255], v[108:111], v[168:171]
    ds_read_b128 a[240:243], v230 offset:36864
    v_add_f32 v224, v224, v147
    v_mfma_f32_16x16x32_bf16 v[172:175], a[252:255], v[112:115], v[172:175]
    ds_read_b128 a[244:247], v231 offset:36864
    v_add_f32 v225, v225, v148
    v_mfma_f32_16x16x32_bf16 v[176:179], a[252:255], v[116:119], v[176:179]
    s_waitcnt lgkmcnt(3)
    v_exp_f32 v151, v151
    v_mfma_f32_16x16x32_bf16 v[168:171], v[216:219], v[120:123], v[168:171]
    buffer_load_dwordx4 v238, s[4:7], s44 offen offset:2048 nt lds
    s_add_u32 m0, s51, 25472
    v_mfma_f32_16x16x32_bf16 v[172:175], v[216:219], v[124:127], v[172:175]
    v_exp_f32 v152, v152
    v_mfma_f32_16x16x32_bf16 v[176:179], v[216:219], v[128:131], v[176:179]
    s_waitcnt lgkmcnt(2)
    ds_read_b128 a[248:251], v230 offset:37888
    v_add_f32 v225, v225, v149
    v_mfma_f32_16x16x32_bf16 v[168:171], v[220:223], v[132:135], v[168:171]
    ds_read_b128 a[252:255], v231 offset:37888
    v_add_f32 v225, v225, v150
    v_mfma_f32_16x16x32_bf16 v[172:175], v[220:223], v[136:139], v[172:175]
    v_exp_f32 v153, v153
    v_mfma_f32_16x16x32_bf16 v[176:179], v[220:223], v[140:143], v[176:179]
    s_waitcnt lgkmcnt(3)
    buffer_load_dwordx4 v238, s[4:7], s44 offen offset:128 nt lds
    v_mfma_f32_16x16x32_bf16 v[180:183], a[240:243], v[96:99], v[204:207]
    v_exp_f32 v154, v154
    v_mfma_f32_16x16x32_bf16 v[184:187], a[240:243], v[100:103], v[208:211]
    v_exp_f32 v155, v155
    v_mfma_f32_16x16x32_bf16 v[188:191], a[240:243], v[104:107], v[212:215]
    s_waitcnt lgkmcnt(2)
    v_add_f32 v225, v225, v151
    v_add_f32 v226, v226, v152
    v_mfma_f32_16x16x32_bf16 v[180:183], a[244:247], v[108:111], v[180:183]
    buffer_load_dwordx4 v238, s[4:7], s44 offen offset:2176 nt lds
    s_add_u32 s44, s44, 8192
    v_mfma_f32_16x16x32_bf16 v[184:187], a[244:247], v[112:115], v[184:187]
    s_waitcnt vmcnt(12) lgkmcnt(0)
    s_cbranch_vccnz L_af40
L_afr40:
    s_barrier
    v_add_f32 v226, v226, v153
    v_mfma_f32_16x16x32_bf16 v[188:191], a[244:247], v[116:119], v[188:191]
    s_add_u32 m0, s51, 32768
    v_exp_f32 v156, v156
    v_mfma_f32_16x16x32_bf16 v[180:183], a[248:251], v[120:123], v[180:183]
    v_exp_f32 v157, v157
    v_mfma_f32_16x16x32_bf16 v[184:187], a[248:251], v[124:127], v[184:187]
    ds_read_b64_tr_b16 v[216:217], v232
    v_add_f32 v226, v226, v154
    v_mfma_f32_16x16x32_bf16 v[188:191], a[248:251], v[128:131], v[188:191]
    ds_read_b64_tr_b16 v[218:219], v232 offset:4096
    v_add_f32 v226, v226, v155
    v_mfma_f32_16x16x32_bf16 v[180:183], a[252:255], v[132:135], v[180:183]
    v_exp_f32 v158, v158
    v_mfma_f32_16x16x32_bf16 v[184:187], a[252:255], v[136:139], v[184:187]
    v_exp_f32 v159, v159
    v_cvt_pk_bf16_f32 v192, v144, v145
    v_cvt_pk_bf16_f32 v193, v146, v147
    v_cvt_pk_bf16_f32 v194, v156, v157
    v_cvt_pk_bf16_f32 v195, v158, v159
    v_mfma_f32_16x16x32_bf16 v[188:191], a[252:255], v[140:143], v[188:191]
    s_waitcnt lgkmcnt(0)
    ds_read_b64_tr_b16 v[220:221], v233
    v_add_f32 v224, v224, v156
    v_exp_f32 v160, v160
    v_exp_f32 v161, v161
    v_exp_f32 v162, v162
    v_exp_f32 v163, v163
    v_cvt_pk_bf16_f32 v196, v148, v149
    v_cvt_pk_bf16_f32 v197, v150, v151
    v_cvt_pk_bf16_f32 v198, v160, v161
    v_cvt_pk_bf16_f32 v199, v162, v163
    v_mfma_f32_16x16x32_bf16 v[0:3], v[216:219], v[192:195], v[0:3]
    ds_read_b64_tr_b16 v[222:223], v233 offset:4096
    v_add_f32 v224, v224, v157
    v_exp_f32 v164, v164
    v_exp_f32 v165, v165
    v_exp_f32 v166, v166
    v_exp_f32 v167, v167
    v_cvt_pk_bf16_f32 v200, v152, v153
    v_cvt_pk_bf16_f32 v201, v154, v155
    v_cvt_pk_bf16_f32 v202, v164, v165
    v_cvt_pk_bf16_f32 v203, v166, v167
    v_mfma_f32_16x16x32_bf16 v[4:7], v[216:219], v[196:199], v[4:7]
    ds_read_b64_tr_b16 a[240:241], v234
    v_add_f32 v224, v224, v158
    v_mfma_f32_16x16x32_bf16 v[8:11], v[216:219], v[200:203], v[8:11]
    s_waitcnt lgkmcnt(1)
    ds_read_b64_tr_b16 a[242:243], v234 offset:4096
    v_add_f32 v224, v224, v159
    v_mfma_f32_16x16x32_bf16 v[12:15], v[220:223], v[192:195], v[12:15]
    ds_read_b64_tr_b16 a[244:245], v235
    v_add_f32 v225, v225, v160
    v_mfma_f32_16x16x32_bf16 v[16:19], v[220:223], v[196:199], v[16:19]
    ds_read_b64_tr_b16 a[246:247], v235 offset:4096
    v_add_f32 v225, v225, v161
    v_mfma_f32_16x16x32_bf16 v[20:23], v[220:223], v[200:203], v[20:23]
    s_waitcnt lgkmcnt(2)
    ds_read_b64_tr_b16 a[248:249], v232 offset:1024
    v_add_f32 v225, v225, v162
    v_mfma_f32_16x16x32_bf16 v[24:27], a[240:243], v[192:195], v[24:27]
    buffer_load_dwordx4 v238, s[8:11], s45 offen nt lds
    v_mfma_f32_16x16x32_bf16 v[28:31], a[240:243], v[196:199], v[28:31]
    ds_read_b64_tr_b16 a[250:251], v232 offset:5120
    v_add_f32 v225, v225, v163
    v_mfma_f32_16x16x32_bf16 v[32:35], a[240:243], v[200:203], v[32:35]
    s_waitcnt lgkmcnt(2)
    ds_read_b64_tr_b16 a[252:253], v233 offset:1024
    v_add_f32 v226, v226, v164
    v_mfma_f32_16x16x32_bf16 v[36:39], a[244:247], v[192:195], v[36:39]
    buffer_load_dwordx4 v238, s[8:11], s45 offen offset:2048 nt lds
    s_add_u32 m0, s51, 33664
    v_mfma_f32_16x16x32_bf16 v[40:43], a[244:247], v[196:199], v[40:43]
    ds_read_b64_tr_b16 a[254:255], v233 offset:5120
    v_add_f32 v226, v226, v165
    v_mfma_f32_16x16x32_bf16 v[44:47], a[244:247], v[200:203], v[44:47]
    s_waitcnt lgkmcnt(2)
    ds_read_b64_tr_b16 v[216:217], v234 offset:1024
    v_add_f32 v226, v226, v166
    v_mfma_f32_16x16x32_bf16 v[48:51], a[248:251], v[192:195], v[48:51]
    buffer_load_dwordx4 v238, s[8:11], s45 offen offset:128 nt lds
    ds_read_b64_tr_b16 v[218:219], v234 offset:5120
    ds_read_b64_tr_b16 v[220:221], v235 offset:1024
    ds_read_b64_tr_b16 v[222:223], v235 offset:5120
    v_mfma_f32_16x16x32_bf16 v[52:55], a[248:251], v[196:199], v[52:55]
    buffer_load_dwordx4 v238, s[8:11], s45 offen offset:2176 nt lds
    s_add_u32 s45, s45, 8192
    v_mfma_f32_16x16x32_bf16 v[56:59], a[248:251], v[200:203], v[56:59]
    s_waitcnt lgkmcnt(4)
    v_add_f32 v226, v226, v167
    v_mfma_f32_16x16x32_bf16 v[60:63], a[252:255], v[192:195], v[60:63]
    v_exp_f32 v168, v168
    v_mfma_f32_16x16x32_bf16 v[64:67], a[252:255], v[196:199], v[64:67]
    s_waitcnt vmcnt(12) lgkmcnt(0)
    s_cbranch_vccnz L_af41
L_afr41:
    s_barrier
    ds_read_b128 a[240:243], v230 offset:8192
    v_mfma_f32_16x16x32_bf16 v[68:71], a[252:255], v[200:203], v[68:71]
    s_add_u32 m0, s51, 0
    v_exp_f32 v169, v169
    v_mfma_f32_16x16x32_bf16 v[72:75], v[216:219], v[192:195], v[72:75]
    v_exp_f32 v170, v170
    v_mfma_f32_16x16x32_bf16 v[76:79], v[216:219], v[196:199], v[76:79]
    ds_read_b128 a[244:247], v231 offset:8192
    v_add_f32 v224, v224, v168
    v_mfma_f32_16x16x32_bf16 v[80:83], v[216:219], v[200:203], v[80:83]
    v_exp_f32 v171, v171
    v_mfma_f32_16x16x32_bf16 v[84:87], v[220:223], v[192:195], v[84:87]
    v_exp_f32 v172, v172
    v_mfma_f32_16x16x32_bf16 v[88:91], v[220:223], v[196:199], v[88:91]
    ds_read_b128 a[248:251], v230 offset:9216
    v_add_f32 v224, v224, v169
    v_mfma_f32_16x16x32_bf16 v[92:95], v[220:223], v[200:203], v[92:95]
    s_waitcnt lgkmcnt(2)
    ds_read_b128 a[252:255], v231 offset:9216
    v_add_f32 v224, v224, v170
    v_mfma_f32_16x16x32_bf16 v[144:147], a[240:243], v[96:99], v[204:207]
    v_exp_f32 v173, v173
    v_mfma_f32_16x16x32_bf16 v[148:151], a[240:243], v[100:103], v[208:211]
    buffer_load_dwordx4 v238, s[4:7], s44 offen nt lds
    v_mfma_f32_16x16x32_bf16 v[152:155], a[240:243], v[104:107], v[212:215]
    s_waitcnt lgkmcnt(2)
    v_exp_f32 v174, v174
    v_mfma_f32_16x16x32_bf16 v[144:147], a[244:247], v[108:111], v[144:147]
    ds_read_b128 v[216:219], v230 offset:12288
    v_add_f32 v224, v224, v171
    v_mfma_f32_16x16x32_bf16 v[148:151], a[244:247], v[112:115], v[148:151]
    ds_read_b128 v[220:223], v231 offset:12288
    v_add_f32 v225, v225, v172
    v_mfma_f32_16x16x32_bf16 v[152:155], a[244:247], v[116:119], v[152:155]
    s_waitcnt lgkmcnt(3)
    v_exp_f32 v175, v175
    v_mfma_f32_16x16x32_bf16 v[144:147], a[248:251], v[120:123], v[144:147]
    buffer_load_dwordx4 v238, s[4:7], s44 offen offset:2048 nt lds
    s_add_u32 m0, s51, 896
    v_mfma_f32_16x16x32_bf16 v[148:151], a[248:251], v[124:127], v[148:151]
    v_exp_f32 v176, v176
    v_mfma_f32_16x16x32_bf16 v[152:155], a[248:251], v[128:131], v[152:155]
    s_waitcnt lgkmcnt(2)
    ds_read_b128 a[240:243], v230 offset:13312
    v_add_f32 v225, v225, v173
    v_mfma_f32_16x16x32_bf16 v[144:147], a[252:255], v[132:135], v[144:147]
    ds_read_b128 a[244:247], v231 offset:13312
    v_add_f32 v225, v225, v174
    v_mfma_f32_16x16x32_bf16 v[148:151], a[252:255], v[136:139], v[148:151]
    v_exp_f32 v177, v177
    v_mfma_f32_16x16x32_bf16 v[152:155], a[252:255], v[140:143], v[152:155]
    s_waitcnt lgkmcnt(3)
    buffer_load_dwordx4 v238, s[4:7], s44 offen offset:128 nt lds
    v_mfma_f32_16x16x32_bf16 v[156:159], v[216:219], v[96:99], v[204:207]
    v_exp_f32 v178, v178
    v_mfma_f32_16x16x32_bf16 v[160:163], v[216:219], v[100:103], v[208:211]
    v_exp_f32 v179, v179
    v_mfma_f32_16x16x32_bf16 v[164:167], v[216:219], v[104:107], v[212:215]
    s_waitcnt lgkmcnt(2)
    v_add_f32 v225, v225, v175
    v_add_f32 v226, v226, v176
    v_mfma_f32_16x16x32_bf16 v[156:159], v[220:223], v[108:111], v[156:159]
    buffer_load_dwordx4 v238, s[4:7], s44 offen offset:2176 nt lds
    s_add_u32 s44, s44, 8192
    v_mfma_f32_16x16x32_bf16 v[160:163], v[220:223], v[112:115], v[160:163]
    s_waitcnt vmcnt(12) lgkmcnt(0)
    s_cbranch_vccnz L_af42
L_afr42:
    s_barrier
    v_add_f32 v226, v226, v177
    v_mfma_f32_16x16x32_bf16 v[164:167], v[220:223], v[116:119], v[164:167]
    s_add_u32 m0, s51, 8192
    v_exp_f32 v180, v180
    v_mfma_f32_16x16x32_bf16 v[156:159], a[240:243], v[120:123], v[156:159]
    v_exp_f32 v181, v181
    v_mfma_f32_16x16x32_bf16 v[160:163], a[240:243], v[124:127], v[160:163]
    ds_read_b64_tr_b16 a[248:249], v232 offset:16384
    v_add_f32 v226, v226, v178
    v_mfma_f32_16x16x32_bf16 v[164:167], a[240:243], v[128:131], v[164:167]
    ds_read_b64_tr_b16 a[250:251], v232 offset:20480
    v_add_f32 v226, v226, v179
    v_mfma_f32_16x16x32_bf16 v[156:159], a[244:247], v[132:135], v[156:159]
    v_exp_f32 v182, v182
    v_mfma_f32_16x16x32_bf16 v[160:163], a[244:247], v[136:139], v[160:163]
    v_exp_f32 v183, v183
    v_cvt_pk_bf16_f32 v192, v168, v169
    v_cvt_pk_bf16_f32 v193, v170, v171
    v_cvt_pk_bf16_f32 v194, v180, v181
    v_cvt_pk_bf16_f32 v195, v182, v183
    v_mfma_f32_16x16x32_bf16 v[164:167], a[244:247], v[140:143], v[164:167]
    s_waitcnt lgkmcnt(0)
    ds_read_b64_tr_b16 a[252:253], v233 offset:16384
    v_add_f32 v224, v224, v180
    v_exp_f32 v184, v184
    v_exp_f32 v185, v185
    v_exp_f32 v186, v186
    v_exp_f32 v187, v187
    v_cvt_pk_bf16_f32 v196, v172, v173
    v_cvt_pk_bf16_f32 v197, v174, v175
    v_cvt_pk_bf16_f32 v198, v184, v185
    v_cvt_pk_bf16_f32 v199, v186, v187
    v_mfma_f32_16x16x32_bf16 v[0:3], a[248:251], v[192:195], v[0:3]
    ds_read_b64_tr_b16 a[254:255], v233 offset:20480
    v_add_f32 v224, v224, v181
    v_exp_f32 v188, v188
    v_exp_f32 v189, v189
    v_exp_f32 v190, v190
    v_exp_f32 v191, v191
    v_cvt_pk_bf16_f32 v200, v176, v177
    v_cvt_pk_bf16_f32 v201, v178, v179
    v_cvt_pk_bf16_f32 v202, v188, v189
    v_cvt_pk_bf16_f32 v203, v190, v191
    v_mfma_f32_16x16x32_bf16 v[4:7], a[248:251], v[196:199], v[4:7]
    ds_read_b64_tr_b16 v[216:217], v234 offset:16384
    v_add_f32 v224, v224, v182
    v_mfma_f32_16x16x32_bf16 v[8:11], a[248:251], v[200:203], v[8:11]
    s_waitcnt lgkmcnt(1)
    ds_read_b64_tr_b16 v[218:219], v234 offset:20480
    v_add_f32 v224, v224, v183
    v_mfma_f32_16x16x32_bf16 v[12:15], a[252:255], v[192:195], v[12:15]
    ds_read_b64_tr_b16 v[220:221], v235 offset:16384
    v_add_f32 v225, v225, v184
    v_mfma_f32_16x16x32_bf16 v[16:19], a[252:255], v[196:199], v[16:19]
    ds_read_b64_tr_b16 v[222:223], v235 offset:20480
    v_add_f32 v225, v225, v185
    v_mfma_f32_16x16x32_bf16 v[20:23], a[252:255], v[200:203], v[20:23]
    s_waitcnt lgkmcnt(2)
    ds_read_b64_tr_b16 a[240:241], v232 offset:17408
    v_add_f32 v225, v225, v186
    v_mfma_f32_16x16x32_bf16 v[24:27], v[216:219], v[192:195], v[24:27]
    buffer_load_dwordx4 v238, s[8:11], s45 offen nt lds
    v_mfma_f32_16x16x32_bf16 v[28:31], v[216:219], v[196:199], v[28:31]
    ds_read_b64_tr_b16 a[242:243], v232 offset:21504
    v_add_f32 v225, v225, v187
    v_mfma_f32_16x16x32_bf16 v[32:35], v[216:219], v[200:203], v[32:35]
    s_waitcnt lgkmcnt(2)
    ds_read_b64_tr_b16 a[244:245], v233 offset:17408
    v_add_f32 v226, v226, v188
    v_mfma_f32_16x16x32_bf16 v[36:39], v[220:223], v[192:195], v[36:39]
    buffer_load_dwordx4 v238, s[8:11], s45 offen offset:2048 nt lds
    s_add_u32 m0, s51, 9088
    v_mfma_f32_16x16x32_bf16 v[40:43], v[220:223], v[196:199], v[40:43]
    ds_read_b64_tr_b16 a[246:247], v233 offset:21504
    v_add_f32 v226, v226, v189
    v_mfma_f32_16x16x32_bf16 v[44:47], v[220:223], v[200:203], v[44:47]
    s_waitcnt lgkmcnt(2)
    ds_read_b64_tr_b16 a[248:249], v234 offset:17408
    v_add_f32 v226, v226, v190
    v_mfma_f32_16x16x32_bf16 v[48:51], a[240:243], v[192:195], v[48:51]
    buffer_load_dwordx4 v238, s[8:11], s45 offen offset:128 nt lds
    ds_read_b64_tr_b16 a[250:251], v234 offset:21504
    ds_read_b64_tr_b16 a[252:253], v235 offset:17408
    ds_read_b64_tr_b16 a[254:255], v235 offset:21504
    v_mfma_f32_16x16x32_bf16 v[52:55], a[240:243], v[196:199], v[52:55]
    buffer_load_dwordx4 v238, s[8:11], s45 offen offset:2176 nt lds
    s_add_u32 s45, s45, 8192
    v_mfma_f32_16x16x32_bf16 v[56:59], a[240:243], v[200:203], v[56:59]
    s_waitcnt lgkmcnt(4)
    v_add_f32 v226, v226, v191
    v_mfma_f32_16x16x32_bf16 v[60:63], a[244:247], v[192:195], v[60:63]
    v_exp_f32 v144, v144
    v_mfma_f32_16x16x32_bf16 v[64:67], a[244:247], v[196:199], v[64:67]
    s_waitcnt vmcnt(12) lgkmcnt(0)
    s_cbranch_vccnz L_af43
L_afr43:
    s_barrier
    ds_read_b128 v[216:219], v230 offset:24576
    v_mfma_f32_16x16x32_bf16 v[68:71], a[244:247], v[200:203], v[68:71]
    s_add_u32 m0, s51, 16384
    v_exp_f32 v145, v145
    v_mfma_f32_16x16x32_bf16 v[72:75], a[248:251], v[192:195], v[72:75]
    v_exp_f32 v146, v146
    v_mfma_f32_16x16x32_bf16 v[76:79], a[248:251], v[196:199], v[76:79]
    ds_read_b128 v[220:223], v231 offset:24576
    v_add_f32 v224, v224, v144
    v_mfma_f32_16x16x32_bf16 v[80:83], a[248:251], v[200:203], v[80:83]
    v_exp_f32 v147, v147
    v_mfma_f32_16x16x32_bf16 v[84:87], a[252:255], v[192:195], v[84:87]
    v_exp_f32 v148, v148
    v_mfma_f32_16x16x32_bf16 v[88:91], a[252:255], v[196:199], v[88:91]
    ds_read_b128 a[240:243], v230 offset:25600
    v_add_f32 v224, v224, v145
    v_mfma_f32_16x16x32_bf16 v[92:95], a[252:255], v[200:203], v[92:95]
    s_waitcnt lgkmcnt(2)
    ds_read_b128 a[244:247], v231 offset:25600
    v_add_f32 v224, v224, v146
    v_mfma_f32_16x16x32_bf16 v[168:171], v[216:219], v[96:99], v[204:207]
    v_exp_f32 v149, v149
    v_mfma_f32_16x16x32_bf16 v[172:175], v[216:219], v[100:103], v[208:211]
    buffer_load_dwordx4 v238, s[4:7], s44 offen nt lds
    v_mfma_f32_16x16x32_bf16 v[176:179], v[216:219], v[104:107], v[212:215]
    s_waitcnt lgkmcnt(2)
    v_exp_f32 v150, v150
    v_mfma_f32_16x16x32_bf16 v[168:171], v[220:223], v[108:111], v[168:171]
    ds_read_b128 a[248:251], v230 offset:28672
    v_add_f32 v224, v224, v147
    v_mfma_f32_16x16x32_bf16 v[172:175], v[220:223], v[112:115], v[172:175]
    ds_read_b128 a[252:255], v231 offset:28672
    v_add_f32 v225, v225, v148
    v_mfma_f32_16x16x32_bf16 v[176:179], v[220:223], v[116:119], v[176:179]
    s_waitcnt lgkmcnt(3)
    v_exp_f32 v151, v151
    v_mfma_f32_16x16x32_bf16 v[168:171], a[240:243], v[120:123], v[168:171]
    buffer_load_dwordx4 v238, s[4:7], s44 offen offset:2048 nt lds
    s_add_u32 m0, s51, 17280
    v_mfma_f32_16x16x32_bf16 v[172:175], a[240:243], v[124:127], v[172:175]
    v_exp_f32 v152, v152
    v_mfma_f32_16x16x32_bf16 v[176:179], a[240:243], v[128:131], v[176:179]
    s_waitcnt lgkmcnt(2)
    ds_read_b128 v[216:219], v230 offset:29696
    v_add_f32 v225, v225, v149
    v_mfma_f32_16x16x32_bf16 v[168:171], a[244:247], v[132:135], v[168:171]
    ds_read_b128 v[220:223], v231 offset:29696
    v_add_f32 v225, v225, v150
    v_mfma_f32_16x16x32_bf16 v[172:175], a[244:247], v[136:139], v[172:175]
    v_exp_f32 v153, v153
    v_mfma_f32_16x16x32_bf16 v[176:179], a[244:247], v[140:143], v[176:179]
    s_waitcnt lgkmcnt(3)
    buffer_load_dwordx4 v238, s[4:7], s44 offen offset:128 nt lds
    v_mfma_f32_16x16x32_bf16 v[180:183], a[248:251], v[96:99], v[204:207]
    v_exp_f32 v154, v154
    v_mfma_f32_16x16x32_bf16 v[184:187], a[248:251], v[100:103], v[208:211]
    v_exp_f32 v155, v155
    v_mfma_f32_16x16x32_bf16 v[188:191], a[248:251], v[104:107], v[212:215]
    s_waitcnt lgkmcnt(2)
    v_add_f32 v225, v225, v151
    v_add_f32 v226, v226, v152
    v_mfma_f32_16x16x32_bf16 v[180:183], a[252:255], v[108:111], v[180:183]
    buffer_load_dwordx4 v238, s[4:7], s44 offen offset:2176 nt lds
    s_add_u32 s44, s44, 8192
    v_mfma_f32_16x16x32_bf16 v[184:187], a[252:255], v[112:115], v[184:187]
    s_waitcnt vmcnt(12) lgkmcnt(0)
    s_cbranch_vccnz L_af44
L_afr44:
    s_barrier
    v_add_f32 v226, v226, v153
    v_mfma_f32_16x16x32_bf16 v[188:191], a[252:255], v[116:119], v[188:191]
    s_add_u32 m0, s51, 24576
    v_exp_f32 v156, v156
    v_mfma_f32_16x16x32_bf16 v[180:183], v[216:219], v[120:123], v[180:183]
    s_add_u32 s44, s44, s68
    v_exp_f32 v157, v157
    v_mfma_f32_16x16x32_bf16 v[184:187], v[216:219], v[124:127], v[184:187]
    ds_read_b64_tr_b16 a[240:241], v232 offset:32768
    v_add_f32 v226, v226, v154
    v_mfma_f32_16x16x32_bf16 v[188:191], v[216:219], v[128:131], v[188:191]
    ds_read_b64_tr_b16 a[242:243], v232 offset:36864
    v_add_f32 v226, v226, v155
    v_mfma_f32_16x16x32_bf16 v[180:183], v[220:223], v[132:135], v[180:183]
    v_exp_f32 v158, v158
    v_mfma_f32_16x16x32_bf16 v[184:187], v[220:223], v[136:139], v[184:187]
    v_exp_f32 v159, v159
    v_cvt_pk_bf16_f32 v192, v144, v145
    v_cvt_pk_bf16_f32 v193, v146, v147
    v_cvt_pk_bf16_f32 v194, v156, v157
    v_cvt_pk_bf16_f32 v195, v158, v159
    v_mfma_f32_16x16x32_bf16 v[188:191], v[220:223], v[140:143], v[188:191]
    s_waitcnt lgkmcnt(0)
    ds_read_b64_tr_b16 a[244:245], v233 offset:32768
    v_add_f32 v224, v224, v156
    v_exp_f32 v160, v160
    v_exp_f32 v161, v161
    v_exp_f32 v162, v162
    v_exp_f32 v163, v163
    v_cvt_pk_bf16_f32 v196, v148, v149
    v_cvt_pk_bf16_f32 v197, v150, v151
    v_cvt_pk_bf16_f32 v198, v160, v161
    v_cvt_pk_bf16_f32 v199, v162, v163
    v_mfma_f32_16x16x32_bf16 v[0:3], a[240:243], v[192:195], v[0:3]
    ds_read_b64_tr_b16 a[246:247], v233 offset:36864
    v_add_f32 v224, v224, v157
    v_exp_f32 v164, v164
    v_exp_f32 v165, v165
    v_exp_f32 v166, v166
    v_exp_f32 v167, v167
    v_cvt_pk_bf16_f32 v200, v152, v153
    v_cvt_pk_bf16_f32 v201, v154, v155
    v_cvt_pk_bf16_f32 v202, v164, v165
    v_cvt_pk_bf16_f32 v203, v166, v167
    v_mfma_f32_16x16x32_bf16 v[4:7], a[240:243], v[196:199], v[4:7]
    ds_read_b64_tr_b16 a[248:249], v234 offset:32768
    v_add_f32 v224, v224, v158
    v_mfma_f32_16x16x32_bf16 v[8:11], a[240:243], v[200:203], v[8:11]
    s_waitcnt lgkmcnt(1)
    ds_read_b64_tr_b16 a[250:251], v234 offset:36864
    v_add_f32 v224, v224, v159
    v_mfma_f32_16x16x32_bf16 v[12:15], a[244:247], v[192:195], v[12:15]
    ds_read_b64_tr_b16 a[252:253], v235 offset:32768
    v_add_f32 v225, v225, v160
    v_mfma_f32_16x16x32_bf16 v[16:19], a[244:247], v[196:199], v[16:19]
    ds_read_b64_tr_b16 a[254:255], v235 offset:36864
    v_add_f32 v225, v225, v161
    v_mfma_f32_16x16x32_bf16 v[20:23], a[244:247], v[200:203], v[20:23]
    s_waitcnt lgkmcnt(2)
    ds_read_b64_tr_b16 v[216:217], v232 offset:33792
    v_add_f32 v225, v225, v162
    v_mfma_f32_16x16x32_bf16 v[24:27], a[248:251], v[192:195], v[24:27]
    buffer_load_dwordx4 v238, s[8:11], s45 offen nt lds
    v_mfma_f32_16x16x32_bf16 v[28:31], a[248:251], v[196:199], v[28:31]
    ds_read_b64_tr_b16 v[218:219], v232 offset:37888
    v_add_f32 v225, v225, v163
    v_mfma_f32_16x16x32_bf16 v[32:35], a[248:251], v[200:203], v[32:35]
    s_waitcnt lgkmcnt(2)
    ds_read_b64_tr_b16 v[220:221], v233 offset:33792
    v_add_f32 v226, v226, v164
    v_mfma_f32_16x16x32_bf16 v[36:39], a[252:255], v[192:195], v[36:39]
    buffer_load_dwordx4 v238, s[8:11], s45 offen offset:2048 nt lds
    s_add_u32 m0, s51, 25472
    v_mfma_f32_16x16x32_bf16 v[40:43], a[252:255], v[196:199], v[40:43]
    ds_read_b64_tr_b16 v[222:223], v233 offset:37888
    v_add_f32 v226, v226, v165
    v_mfma_f32_16x16x32_bf16 v[44:47], a[252:255], v[200:203], v[44:47]
    s_waitcnt lgkmcnt(2)
    ds_read_b64_tr_b16 a[240:241], v234 offset:33792
    v_add_f32 v226, v226, v166
    v_mfma_f32_16x16x32_bf16 v[48:51], v[216:219], v[192:195], v[48:51]
    buffer_load_dwordx4 v238, s[8:11], s45 offen offset:128 nt lds
    ds_read_b64_tr_b16 a[242:243], v234 offset:37888
    ds_read_b64_tr_b16 a[244:245], v235 offset:33792
    ds_read_b64_tr_b16 a[246:247], v235 offset:37888
    v_mfma_f32_16x16x32_bf16 v[52:55], v[216:219], v[196:199], v[52:55]
    buffer_load_dwordx4 v238, s[8:11], s45 offen offset:2176 nt lds
    s_add_u32 m0, s52, 131072
    v_mfma_f32_16x16x32_bf16 v[56:59], v[216:219], v[200:203], v[56:59]
    s_waitcnt lgkmcnt(4)
    v_add_f32 v226, v226, v167
    s_add_u32 s45, s45, 8192
    v_mfma_f32_16x16x32_bf16 v[60:63], v[220:223], v[192:195], v[60:63]
    buffer_load_dwordx4 v239, s[16:19], s47 offen lds
    s_add_u32 m0, s52, 135168
    v_mfma_f32_16x16x32_bf16 v[64:67], v[220:223], v[196:199], v[64:67]
    s_waitcnt vmcnt(13) lgkmcnt(0)
    s_cbranch_vccnz L_af45
L_afr45:
    s_barrier
    ds_read_b128 a[248:251], v230
    v_mfma_f32_16x16x32_bf16 v[68:71], v[220:223], v[200:203], v[68:71]
    buffer_load_dwordx4 v239, s[16:19], s48 offen lds
    s_add_u32 m0, s52, 139264
    v_mfma_f32_16x16x32_bf16 v[72:75], a[240:243], v[192:195], v[72:75]
    v_exp_f32 v168, v168
    v_mfma_f32_16x16x32_bf16 v[76:79], a[240:243], v[196:199], v[76:79]
    v_exp_f32 v169, v169
    v_mfma_f32_16x16x32_bf16 v[80:83], a[240:243], v[200:203], v[80:83]
    buffer_load_dwordx4 v239, s[16:19], s49 offen lds
    s_add_u32 m0, s51, 32768
    v_mfma_f32_16x16x32_bf16 v[84:87], a[244:247], v[192:195], v[84:87]
    v_exp_f32 v170, v170
    v_mfma_f32_16x16x32_bf16 v[88:91], a[244:247], v[196:199], v[88:91]
    ds_read_b128 a[252:255], v231
    v_add_f32 v224, v224, v168
    v_mfma_f32_16x16x32_bf16 v[92:95], a[244:247], v[200:203], v[92:95]
    s_waitcnt lgkmcnt(1)
    v_exp_f32 v171, v171
    v_mfma_f32_16x16x32_bf16 v[144:147], a[248:251], v[96:99], v[204:207]
    v_exp_f32 v172, v172
    v_mfma_f32_16x16x32_bf16 v[148:151], a[248:251], v[100:103], v[208:211]
    ds_read_b128 v[216:219], v230 offset:1024
    v_add_f32 v224, v224, v169
    v_mfma_f32_16x16x32_bf16 v[152:155], a[248:251], v[104:107], v[212:215]
    s_waitcnt lgkmcnt(1)
    ds_read_b128 v[220:223], v231 offset:1024
    v_add_f32 v224, v224, v170
    v_mfma_f32_16x16x32_bf16 v[144:147], a[252:255], v[108:111], v[144:147]
    v_exp_f32 v173, v173
    v_mfma_f32_16x16x32_bf16 v[148:151], a[252:255], v[112:115], v[148:151]
    buffer_load_dwordx4 v238, s[8:11], s45 offen nt lds
    v_mfma_f32_16x16x32_bf16 v[152:155], a[252:255], v[116:119], v[152:155]
    s_waitcnt lgkmcnt(1)
    v_exp_f32 v174, v174
    v_mfma_f32_16x16x32_bf16 v[144:147], v[216:219], v[120:123], v[144:147]
    ds_read_b128 a[240:243], v230 offset:4096
    v_add_f32 v224, v224, v171
    v_mfma_f32_16x16x32_bf16 v[148:151], v[216:219], v[124:127], v[148:151]
    ds_read_b128 a[244:247], v231 offset:4096
    v_add_f32 v225, v225, v172
    v_mfma_f32_16x16x32_bf16 v[152:155], v[216:219], v[128:131], v[152:155]
    s_waitcnt lgkmcnt(2)
    v_exp_f32 v175, v175
    v_mfma_f32_16x16x32_bf16 v[144:147], v[220:223], v[132:135], v[144:147]
    buffer_load_dwordx4 v238, s[8:11], s45 offen offset:2048 nt lds
    s_add_u32 m0, s51, 33664
    v_mfma_f32_16x16x32_bf16 v[148:151], v[220:223], v[136:139], v[148:151]
    v_exp_f32 v176, v176
    v_mfma_f32_16x16x32_bf16 v[152:155], v[220:223], v[140:143], v[152:155]
    s_waitcnt lgkmcnt(1)
    ds_read_b128 a[248:251], v230 offset:5120
    v_add_f32 v225, v225, v173
    v_mfma_f32_16x16x32_bf16 v[156:159], a[240:243], v[96:99], v[204:207]
    ds_read_b128 a[252:255], v231 offset:5120
    v_add_f32 v225, v225, v174
    v_mfma_f32_16x16x32_bf16 v[160:163], a[240:243], v[100:103], v[208:211]
    v_exp_f32 v177, v177
    v_mfma_f32_16x16x32_bf16 v[164:167], a[240:243], v[104:107], v[212:215]
    s_waitcnt lgkmcnt(2)
    buffer_load_dwordx4 v238, s[8:11], s45 offen offset:128 nt lds
    v_mfma_f32_16x16x32_bf16 v[156:159], a[244:247], v[108:111], v[156:159]
    v_exp_f32 v178, v178
    v_mfma_f32_16x16x32_bf16 v[160:163], a[244:247], v[112:115], v[160:163]
    s_waitcnt vmcnt(14) lgkmcnt(0)
    s_cbranch_vccnz L_af46
L_afr46:
    s_barrier
    v_add_f32 v225, v225, v175
    v_mfma_f32_16x16x32_bf16 v[164:167], a[244:247], v[116:119], v[164:167]
    v_exp_f32 v179, v179
    v_mfma_f32_16x16x32_bf16 v[156:159], a[248:251], v[120:123], v[156:159]
    ds_read_b64_tr_b16 v[216:217], v232 offset:8192
    v_add_f32 v226, v226, v176
    v_mfma_f32_16x16x32_bf16 v[160:163], a[248:251], v[124:127], v[160:163]
    buffer_load_dwordx4 v238, s[8:11], s45 offen offset:2176 nt lds
    s_add_u32 m0, s52, 143232
    v_mfma_f32_16x16x32_bf16 v[164:167], a[248:251], v[128:131], v[164:167]
    s_add_u32 s45, s45, 8192
    v_exp_f32 v180, v180
    v_mfma_f32_16x16x32_bf16 v[156:159], a[252:255], v[132:135], v[156:159]
    s_add_u32 s45, s45, s68
    ds_read_b64_tr_b16 v[218:219], v232 offset:12288
    v_add_f32 v226, v226, v177
    v_mfma_f32_16x16x32_bf16 v[160:163], a[252:255], v[136:139], v[160:163]
    v_exp_f32 v181, v181
    v_exp_f32 v182, v182
    v_exp_f32 v183, v183
    v_cvt_pk_bf16_f32 v192, v168, v169
    v_cvt_pk_bf16_f32 v193, v170, v171
    v_cvt_pk_bf16_f32 v194, v180, v181
    v_cvt_pk_bf16_f32 v195, v182, v183
    v_mfma_f32_16x16x32_bf16 v[164:167], a[252:255], v[140:143], v[164:167]
    s_waitcnt lgkmcnt(0)
    ds_read_b64_tr_b16 v[220:221], v233 offset:8192
    v_add_f32 v226, v226, v178
    v_exp_f32 v184, v184
    v_exp_f32 v185, v185
    v_exp_f32 v186, v186
    v_exp_f32 v187, v187
    v_cvt_pk_bf16_f32 v196, v172, v173
    v_cvt_pk_bf16_f32 v197, v174, v175
    v_cvt_pk_bf16_f32 v198, v184, v185
    v_cvt_pk_bf16_f32 v199, v186, v187
    v_mfma_f32_16x16x32_bf16 v[0:3], v[216:219], v[192:195], v[0:3]
    buffer_load_dwordx4 v239, s[16:19], s47 offen offset:128 lds
    s_add_u32 m0, s52, 147328
    v_exp_f32 v188, v188
    v_exp_f32 v189, v189
    v_exp_f32 v190, v190
    v_exp_f32 v191, v191
    v_cvt_pk_bf16_f32 v200, v176, v177
    v_cvt_pk_bf16_f32 v201, v178, v179
    v_cvt_pk_bf16_f32 v202, v188, v189
    v_cvt_pk_bf16_f32 v203, v190, v191
    v_mfma_f32_16x16x32_bf16 v[4:7], v[216:219], v[196:199], v[4:7]
    ds_read_b64_tr_b16 v[222:223], v233 offset:12288
    v_add_f32 v226, v226, v179
    v_mfma_f32_16x16x32_bf16 v[8:11], v[216:219], v[200:203], v[8:11]
    s_waitcnt lgkmcnt(0)
    ds_read_b64_tr_b16 a[240:241], v234 offset:8192
    v_add_f32 v224, v224, v180
    v_mfma_f32_16x16x32_bf16 v[12:15], v[220:223], v[192:195], v[12:15]
    buffer_load_dwordx4 v239, s[16:19], s48 offen offset:128 lds
    s_add_u32 m0, s52, 151424
    v_mfma_f32_16x16x32_bf16 v[16:19], v[220:223], v[196:199], v[16:19]
    ds_read_b64_tr_b16 a[242:243], v234 offset:12288
    v_add_f32 v224, v224, v181
    v_mfma_f32_16x16x32_bf16 v[20:23], v[220:223], v[200:203], v[20:23]
    s_waitcnt lgkmcnt(0)
    ds_read_b64_tr_b16 a[244:245], v235 offset:8192
    v_add_f32 v224, v224, v182
    v_mfma_f32_16x16x32_bf16 v[24:27], a[240:243], v[192:195], v[24:27]
    buffer_load_dwordx4 v239, s[16:19], s49 offen offset:128 lds
    s_add_u32 m0, s51, 0
    v_mfma_f32_16x16x32_bf16 v[28:31], a[240:243], v[196:199], v[28:31]
    ds_read_b64_tr_b16 a[246:247], v235 offset:12288
    v_add_f32 v224, v224, v183
    v_mfma_f32_16x16x32_bf16 v[32:35], a[240:243], v[200:203], v[32:35]
    s_waitcnt lgkmcnt(0)
    ds_read_b64_tr_b16 a[248:249], v232 offset:9216
    v_add_f32 v225, v225, v184
    v_mfma_f32_16x16x32_bf16 v[36:39], a[244:247], v[192:195], v[36:39]
    ds_read_b64_tr_b16 a[250:251], v232 offset:13312
    v_add_f32 v225, v225, v185
    v_mfma_f32_16x16x32_bf16 v[40:43], a[244:247], v[196:199], v[40:43]
    ds_read_b64_tr_b16 a[252:253], v233 offset:9216
    v_add_f32 v225, v225, v186
    v_mfma_f32_16x16x32_bf16 v[44:47], a[244:247], v[200:203], v[44:47]
    s_waitcnt lgkmcnt(1)
    buffer_load_dwordx4 v240, s[12:15], s46 offen lds
    v_mfma_f32_16x16x32_bf16 v[48:51], a[248:251], v[192:195], v[48:51]
    ds_read_b64_tr_b16 a[254:255], v233 offset:13312
    v_add_f32 v225, v225, v187
    ds_read_b64_tr_b16 v[216:217], v234 offset:9216
    ds_read_b64_tr_b16 v[218:219], v234 offset:13312
    ds_read_b64_tr_b16 v[220:221], v235 offset:9216
    ds_read_b64_tr_b16 v[222:223], v235 offset:13312
    v_mfma_f32_16x16x32_bf16 v[52:55], a[248:251], v[196:199], v[52:55]
    buffer_load_dwordx4 v241, s[12:15], s46 offen offset:2048 lds
    s_add_u32 m0, s51, 896
    v_mfma_f32_16x16x32_bf16 v[56:59], a[248:251], v[200:203], v[56:59]
    s_waitcnt lgkmcnt(4)
    buffer_load_dwordx4 v240, s[12:15], s46 offen offset:128 lds
    v_mfma_f32_16x16x32_bf16 v[60:63], a[252:255], v[192:195], v[60:63]
    v_add_f32 v226, v226, v188
    v_mfma_f32_16x16x32_bf16 v[64:67], a[252:255], v[196:199], v[64:67]
    s_waitcnt vmcnt(17) lgkmcnt(0)
    s_cbranch_vccnz L_af47
L_afr47:
    s_barrier
    v_add_f32 v226, v226, v189
    v_mfma_f32_16x16x32_bf16 v[68:71], a[252:255], v[200:203], v[68:71]
    ds_read_b128 a[240:243], v230 offset:16384
    v_add_f32 v226, v226, v190
    v_mfma_f32_16x16x32_bf16 v[72:75], v[216:219], v[192:195], v[72:75]
    ds_read_b128 a[244:247], v231 offset:16384
    v_add_f32 v226, v226, v191
    v_mfma_f32_16x16x32_bf16 v[76:79], v[216:219], v[196:199], v[76:79]
    buffer_load_dwordx4 v241, s[12:15], s46 offen offset:2176 lds
    s_add_u32 s46, s46, 262144
    v_mfma_f32_16x16x32_bf16 v[80:83], v[216:219], v[200:203], v[80:83]
    s_add_u32 m0, s51, 8192
    v_exp_f32 v144, v144
    v_mfma_f32_16x16x32_bf16 v[84:87], v[220:223], v[192:195], v[84:87]
    v_exp_f32 v145, v145
    v_mfma_f32_16x16x32_bf16 v[88:91], v[220:223], v[196:199], v[88:91]
    v_exp_f32 v146, v146
    v_mfma_f32_16x16x32_bf16 v[92:95], v[220:223], v[200:203], v[92:95]
    s_waitcnt lgkmcnt(1)
    v_exp_f32 v147, v147
    v_mfma_f32_16x16x32_bf16 v[168:171], a[240:243], v[96:99], v[204:207]
    ds_read_b128 a[248:251], v230 offset:17408
    v_add_f32 v224, v224, v144
    v_mfma_f32_16x16x32_bf16 v[172:175], a[240:243], v[100:103], v[208:211]
    v_exp_f32 v148, v148
    v_mfma_f32_16x16x32_bf16 v[176:179], a[240:243], v[104:107], v[212:215]
    s_waitcnt lgkmcnt(1)
    ds_read_b128 a[252:255], v231 offset:17408
    v_add_f32 v224, v224, v145
    v_mfma_f32_16x16x32_bf16 v[168:171], a[244:247], v[108:111], v[168:171]
    ds_read_b128 v[216:219], v230 offset:20480
    v_add_f32 v224, v224, v146
    v_mfma_f32_16x16x32_bf16 v[172:175], a[244:247], v[112:115], v[172:175]
    v_exp_f32 v149, v149
    v_mfma_f32_16x16x32_bf16 v[176:179], a[244:247], v[116:119], v[176:179]
    s_waitcnt lgkmcnt(2)
    buffer_load_dwordx4 v240, s[12:15], s46 offen lds
    v_mfma_f32_16x16x32_bf16 v[168:171], a[248:251], v[120:123], v[168:171]
    v_exp_f32 v150, v150
    v_mfma_f32_16x16x32_bf16 v[172:175], a[248:251], v[124:127], v[172:175]
    ds_read_b128 v[220:223], v231 offset:20480
    v_add_f32 v224, v224, v147
    v_mfma_f32_16x16x32_bf16 v[176:179], a[248:251], v[128:131], v[176:179]
    s_waitcnt lgkmcnt(2)
    ds_read_b128 a[240:243], v230 offset:21504
    v_add_f32 v225, v225, v148
    v_mfma_f32_16x16x32_bf16 v[168:171], a[252:255], v[132:135], v[168:171]
    v_exp_f32 v151, v151
    v_mfma_f32_16x16x32_bf16 v[172:175], a[252:255], v[136:139], v[172:175]
    buffer_load_dwordx4 v241, s[12:15], s46 offen offset:2048 lds
    s_add_u32 m0, s51, 9088
    v_mfma_f32_16x16x32_bf16 v[176:179], a[252:255], v[140:143], v[176:179]
    s_waitcnt lgkmcnt(2)
    v_exp_f32 v152, v152
    v_mfma_f32_16x16x32_bf16 v[180:183], v[216:219], v[96:99], v[204:207]
    ds_read_b128 a[244:247], v231 offset:21504
    v_add_f32 v225, v225, v149
    v_mfma_f32_16x16x32_bf16 v[184:187], v[216:219], v[100:103], v[208:211]
    v_exp_f32 v153, v153
    v_mfma_f32_16x16x32_bf16 v[188:191], v[216:219], v[104:107], v[212:215]
    s_waitcnt lgkmcnt(2)
    buffer_load_dwordx4 v240, s[12:15], s46 offen offset:128 lds
    v_mfma_f32_16x16x32_bf16 v[180:183], v[220:223], v[108:111], v[180:183]
    v_add_f32 v225, v225, v150
    v_add_f32 v226, v226, v152
    v_mfma_f32_16x16x32_bf16 v[184:187], v[220:223], v[112:115], v[184:187]
    s_waitcnt vmcnt(17) lgkmcnt(0)
    s_cbranch_vccnz L_af48
L_afr48:
    s_barrier
    v_add_f32 v225, v225, v151
    v_mfma_f32_16x16x32_bf16 v[188:191], v[220:223], v[116:119], v[188:191]
    v_exp_f32 v154, v154
    v_mfma_f32_16x16x32_bf16 v[180:183], a[240:243], v[120:123], v[180:183]
    v_exp_f32 v155, v155
    v_mfma_f32_16x16x32_bf16 v[184:187], a[240:243], v[124:127], v[184:187]
    buffer_load_dwordx4 v241, s[12:15], s46 offen offset:2176 lds
    s_add_u32 s46, s46, 262144
    v_mfma_f32_16x16x32_bf16 v[188:191], a[240:243], v[128:131], v[188:191]
    s_add_u32 m0, s51, 16384
    v_exp_f32 v156, v156
    v_mfma_f32_16x16x32_bf16 v[180:183], a[244:247], v[132:135], v[180:183]
    ds_read_b64_tr_b16 a[248:249], v232 offset:24576
    v_add_f32 v226, v226, v153
    v_mfma_f32_16x16x32_bf16 v[184:187], a[244:247], v[136:139], v[184:187]
    v_exp_f32 v157, v157
    ds_read_b64_tr_b16 a[250:251], v232 offset:28672
    v_exp_f32 v158, v158
    v_exp_f32 v159, v159
    v_cvt_pk_bf16_f32 v192, v144, v145
    v_cvt_pk_bf16_f32 v193, v146, v147
    v_cvt_pk_bf16_f32 v194, v156, v157
    v_cvt_pk_bf16_f32 v195, v158, v159
    v_mfma_f32_16x16x32_bf16 v[188:191], a[244:247], v[140:143], v[188:191]
    s_waitcnt lgkmcnt(0)
    ds_read_b64_tr_b16 a[252:253], v233 offset:24576
    v_add_f32 v226, v226, v154
    v_exp_f32 v160, v160
    v_exp_f32 v161, v161
    v_exp_f32 v162, v162
    v_exp_f32 v163, v163
    v_cvt_pk_bf16_f32 v196, v148, v149
    v_cvt_pk_bf16_f32 v197, v150, v151
    v_cvt_pk_bf16_f32 v198, v160, v161
    v_cvt_pk_bf16_f32 v199, v162, v163
    v_mfma_f32_16x16x32_bf16 v[0:3], a[248:251], v[192:195], v[0:3]
    buffer_load_dword v251, v227, s[12:15], s94 offen
    s_cmp_lt_u32 s53, 2
    s_cselect_b32 s54, 512, 0
    s_add_u32 s94, s94, s54
    v_exp_f32 v164, v164
    v_exp_f32 v165, v165
    v_exp_f32 v166, v166
    v_exp_f32 v167, v167
    v_cvt_pk_bf16_f32 v200, v152, v153
    v_cvt_pk_bf16_f32 v201, v154, v155
    v_cvt_pk_bf16_f32 v202, v164, v165
    v_cvt_pk_bf16_f32 v203, v166, v167
    v_mfma_f32_16x16x32_bf16 v[4:7], a[248:251], v[196:199], v[4:7]
    ds_read_b64_tr_b16 a[254:255], v233 offset:28672
    v_add_f32 v226, v226, v155
    v_mfma_f32_16x16x32_bf16 v[8:11], a[248:251], v[200:203], v[8:11]
    s_waitcnt lgkmcnt(0)
    ds_read_b64_tr_b16 v[216:217], v234 offset:24576
    v_add_f32 v224, v224, v156
    v_mfma_f32_16x16x32_bf16 v[12:15], a[252:255], v[192:195], v[12:15]
    ds_read_b64_tr_b16 v[218:219], v234 offset:28672
    v_add_f32 v224, v224, v157
    v_mfma_f32_16x16x32_bf16 v[16:19], a[252:255], v[196:199], v[16:19]
    ds_read_b64_tr_b16 v[220:221], v235 offset:24576
    v_add_f32 v224, v224, v158
    v_mfma_f32_16x16x32_bf16 v[20:23], a[252:255], v[200:203], v[20:23]
    s_waitcnt lgkmcnt(1)
    ds_read_b64_tr_b16 v[222:223], v235 offset:28672
    v_add_f32 v224, v224, v159
    v_mfma_f32_16x16x32_bf16 v[24:27], v[216:219], v[192:195], v[24:27]
    ds_read_b64_tr_b16 a[240:241], v232 offset:25600
    v_add_f32 v225, v225, v160
    v_mfma_f32_16x16x32_bf16 v[28:31], v[216:219], v[196:199], v[28:31]
    ds_read_b64_tr_b16 a[242:243], v232 offset:29696
    v_add_f32 v225, v225, v161
    v_mfma_f32_16x16x32_bf16 v[32:35], v[216:219], v[200:203], v[32:35]
    s_waitcnt lgkmcnt(2)
    ds_read_b64_tr_b16 a[244:245], v233 offset:25600
    v_add_f32 v225, v225, v162
    v_mfma_f32_16x16x32_bf16 v[36:39], v[220:223], v[192:195], v[36:39]
    buffer_load_dwordx4 v240, s[12:15], s46 offen lds
    v_mfma_f32_16x16x32_bf16 v[40:43], v[220:223], v[196:199], v[40:43]
    ds_read_b64_tr_b16 a[246:247], v233 offset:29696
    v_add_f32 v225, v225, v163
    v_mfma_f32_16x16x32_bf16 v[44:47], v[220:223], v[200:203], v[44:47]
    s_waitcnt lgkmcnt(2)
    ds_read_b64_tr_b16 a[248:249], v234 offset:25600
    v_add_f32 v226, v226, v164
    v_mfma_f32_16x16x32_bf16 v[48:51], a[240:243], v[192:195], v[48:51]
    buffer_load_dwordx4 v241, s[12:15], s46 offen offset:2048 lds
    s_add_u32 m0, s51, 17280
    ds_read_b64_tr_b16 a[250:251], v234 offset:29696
    ds_read_b64_tr_b16 a[252:253], v235 offset:25600
    ds_read_b64_tr_b16 a[254:255], v235 offset:29696
    v_mfma_f32_16x16x32_bf16 v[52:55], a[240:243], v[196:199], v[52:55]
    buffer_load_dwordx4 v240, s[12:15], s46 offen offset:128 lds
    v_mfma_f32_16x16x32_bf16 v[56:59], a[240:243], v[200:203], v[56:59]
    s_waitcnt lgkmcnt(4)
    v_add_f32 v226, v226, v165
    v_mfma_f32_16x16x32_bf16 v[60:63], a[244:247], v[192:195], v[60:63]
    v_add_f32 v226, v226, v166
    v_mfma_f32_16x16x32_bf16 v[64:67], a[244:247], v[196:199], v[64:67]
    s_waitcnt vmcnt(15) lgkmcnt(0)
    s_cbranch_vccnz L_af49
L_afr49:
    s_barrier
    v_add_f32 v226, v226, v167
    v_mfma_f32_16x16x32_bf16 v[68:71], a[244:247], v[200:203], v[68:71]
    buffer_load_dwordx4 v241, s[12:15], s46 offen offset:2176 lds
    s_add_u32 s46, s46, 262144
    v_mfma_f32_16x16x32_bf16 v[72:75], a[248:251], v[192:195], v[72:75]
    s_add_u32 m0, s51, 24576
    ds_read_b64_tr_b16 v[216:217], v232 offset:32768
    ds_read_b64_tr_b16 v[218:219], v232 offset:36864
    v_mfma_f32_16x16x32_bf16 v[76:79], a[248:251], v[196:199], v[76:79]
    v_exp_f32 v168, v168
    v_mfma_f32_16x16x32_bf16 v[80:83], a[248:251], v[200:203], v[80:83]
    v_exp_f32 v169, v169
    v_mfma_f32_16x16x32_bf16 v[84:87], a[252:255], v[192:195], v[84:87]
    v_exp_f32 v170, v170
    v_mfma_f32_16x16x32_bf16 v[88:91], a[252:255], v[196:199], v[88:91]
    ds_read_b64_tr_b16 v[220:221], v233 offset:32768
    v_add_f32 v224, v224, v168
    v_exp_f32 v171, v171
    v_exp_f32 v180, v180
    v_exp_f32 v181, v181
    v_exp_f32 v182, v182
    v_exp_f32 v183, v183
    v_cvt_pk_bf16_f32 v192, v168, v169
    v_cvt_pk_bf16_f32 v193, v170, v171
    v_cvt_pk_bf16_f32 v194, v180, v181
    v_cvt_pk_bf16_f32 v195, v182, v183
    v_mfma_f32_16x16x32_bf16 v[92:95], a[252:255], v[200:203], v[92:95]
    s_waitcnt lgkmcnt(1)
    ds_read_b64_tr_b16 v[222:223], v233 offset:36864
    v_add_f32 v224, v224, v169
    v_exp_f32 v172, v172
    v_exp_f32 v173, v173
    v_exp_f32 v174, v174
    v_exp_f32 v175, v175
    v_exp_f32 v184, v184
    v_exp_f32 v185, v185
    v_exp_f32 v186, v186
    v_exp_f32 v187, v187
    v_cvt_pk_bf16_f32 v196, v172, v173
    v_cvt_pk_bf16_f32 v197, v174, v175
    v_cvt_pk_bf16_f32 v198, v184, v185
    v_cvt_pk_bf16_f32 v199, v186, v187
    v_mfma_f32_16x16x32_bf16 v[0:3], v[216:219], v[192:195], v[0:3]
    ds_read_b64_tr_b16 a[240:241], v234 offset:32768
    v_add_f32 v224, v224, v170
    v_exp_f32 v176, v176
    v_exp_f32 v177, v177
    v_exp_f32 v178, v178
    v_exp_f32 v179, v179
    v_exp_f32 v188, v188
    v_exp_f32 v189, v189
    v_exp_f32 v190, v190
    v_exp_f32 v191, v191
    v_cvt_pk_bf16_f32 v200, v176, v177
    v_cvt_pk_bf16_f32 v201, v178, v179
    v_cvt_pk_bf16_f32 v202, v188, v189
    v_cvt_pk_bf16_f32 v203, v190, v191
    v_mfma_f32_16x16x32_bf16 v[4:7], v[216:219], v[196:199], v[4:7]
    ds_read_b64_tr_b16 a[242:243], v234 offset:36864
    v_add_f32 v224, v224, v171
    v_mfma_f32_16x16x32_bf16 v[8:11], v[216:219], v[200:203], v[8:11]
    s_waitcnt lgkmcnt(2)
    buffer_load_dwordx4 v240, s[12:15], s46 offen lds
    v_mfma_f32_16x16x32_bf16 v[12:15], v[220:223], v[192:195], v[12:15]
    ds_read_b64_tr_b16 a[244:245], v235 offset:32768
    v_add_f32 v225, v225, v172
    v_mfma_f32_16x16x32_bf16 v[16:19], v[220:223], v[196:199], v[16:19]
    ds_read_b64_tr_b16 a[246:247], v235 offset:36864
    v_add_f32 v225, v225, v173
    v_mfma_f32_16x16x32_bf16 v[20:23], v[220:223], v[200:203], v[20:23]
    s_waitcnt lgkmcnt(2)
    buffer_load_dwordx4 v241, s[12:15], s46 offen offset:2048 lds
    v_mfma_f32_16x16x32_bf16 v[24:27], a[240:243], v[192:195], v[24:27]
    s_add_u32 m0, s51, 25472
    ds_read_b64_tr_b16 a[248:249], v232 offset:33792
    v_add_f32 v225, v225, v174
    v_mfma_f32_16x16x32_bf16 v[28:31], a[240:243], v[196:199], v[28:31]
    ds_read_b64_tr_b16 a[250:251], v232 offset:37888
    v_add_f32 v225, v225, v175
    v_mfma_f32_16x16x32_bf16 v[32:35], a[240:243], v[200:203], v[32:35]
    s_waitcnt lgkmcnt(2)
    buffer_load_dwordx4 v240, s[12:15], s46 offen offset:128 lds
    v_mfma_f32_16x16x32_bf16 v[36:39], a[244:247], v[192:195], v[36:39]
    ds_read_b64_tr_b16 a[252:253], v233 offset:33792
    v_add_f32 v226, v226, v176
    v_mfma_f32_16x16x32_bf16 v[40:43], a[244:247], v[196:199], v[40:43]
    ds_read_b64_tr_b16 a[254:255], v233 offset:37888
    v_add_f32 v226, v226, v177
    v_mfma_f32_16x16x32_bf16 v[44:47], a[244:247], v[200:203], v[44:47]
    s_waitcnt lgkmcnt(2)
    buffer_load_dwordx4 v241, s[12:15], s46 offen offset:2176 lds
    v_mfma_f32_16x16x32_bf16 v[48:51], a[248:251], v[192:195], v[48:51]
    s_add_u32 s46, s46, 262144
    ds_read_b64_tr_b16 v[216:217], v234 offset:33792
    v_add_f32 v226, v226, v178
    v_mfma_f32_16x16x32_bf16 v[52:55], a[248:251], v[196:199], v[52:55]
    s_waitcnt vmcnt(13)
    s_barrier
    ds_read_b64_tr_b16 v[218:219], v234 offset:37888
    v_mfma_f32_16x16x32_bf16 v[56:59], a[248:251], v[200:203], v[56:59]
    s_waitcnt lgkmcnt(2)
    ds_read_b64_tr_b16 v[220:221], v235 offset:33792
    v_add_f32 v226, v226, v179
    v_mfma_f32_16x16x32_bf16 v[60:63], a[252:255], v[192:195], v[60:63]
    ds_read_b64_tr_b16 v[222:223], v235 offset:37888
    v_add_f32 v224, v224, v180
    v_mfma_f32_16x16x32_bf16 v[64:67], a[252:255], v[196:199], v[64:67]
    ds_read_b64_tr_b16 a[240:241], v242
    v_add_f32 v224, v224, v181
    v_mfma_f32_16x16x32_bf16 v[68:71], a[252:255], v[200:203], v[68:71]
    s_waitcnt lgkmcnt(3)
    ds_read_b64_tr_b16 a[242:243], v242 offset:512
    v_add_f32 v224, v224, v182
    v_mfma_f32_16x16x32_bf16 v[72:75], v[216:219], v[192:195], v[72:75]
    ds_read_b128 a[216:219], v244
    v_add_f32 v224, v224, v183
    v_mfma_f32_16x16x32_bf16 v[76:79], v[216:219], v[196:199], v[76:79]
    ds_read_b128 a[220:223], v244 offset:2048
    v_add_f32 v225, v225, v184
    v_mfma_f32_16x16x32_bf16 v[80:83], v[216:219], v[200:203], v[80:83]
    s_waitcnt lgkmcnt(4)
    ds_read_b128 a[224:227], v244 offset:4096
    v_add_f32 v225, v225, v185
    v_add_f32 v225, v225, v186
    v_add_f32 v225, v225, v187
    v_add_f32 v226, v226, v188
    v_add_f32 v226, v226, v189
    v_add_f32 v226, v226, v190
    v_add_f32 v226, v226, v191
    v_add_f32 v247, v224, v225
    v_add_f32 v247, v247, v226
    v_cmp_nle_f32 s[98:99], v247, s50
    v_mfma_f32_16x16x32_bf16 v[84:87], v[220:223], v[192:195], v[84:87]
    ds_read_b64_tr_b16 a[244:245], v242 offset:8
    ds_read_b64_tr_b16 a[246:247], v242 offset:520
    v_mfma_f32_16x16x32_bf16 v[88:91], v[220:223], v[196:199], v[88:91]
    ds_read_b64_tr_b16 a[248:249], v243
    ds_read_b64_tr_b16 a[250:251], v243 offset:512
    v_mfma_f32_16x16x32_bf16 v[92:95], v[220:223], v[200:203], v[92:95]
    ds_read_b128 a[228:231], v245
    ds_read_b128 a[232:235], v245 offset:2048
    ds_read_b128 a[236:239], v245 offset:4096
    s_mov_b32 s53, 1
    s_cmp_lg_u64 s[98:99], 0
    s_cbranch_scc1 L_slow0
L_ret0:
L_loop:
    s_waitcnt lgkmcnt(9)
    ds_read_b64_tr_b16 a[252:253], v243 offset:8
    ds_read_b64_tr_b16 a[254:255], v243 offset:520
    v_mfma_f32_16x16x32_bf16 v[96:99], a[240:243], a[216:219], 0
    s_waitcnt lgkmcnt(10)
    ds_read_b64_tr_b16 v[216:217], v242 offset:1024
    ds_read_b64_tr_b16 v[218:219], v242 offset:1536
    v_mfma_f32_16x16x32_bf16 v[100:103], a[240:243], a[220:223], 0
    s_waitcnt lgkmcnt(11)
    ds_read_b64_tr_b16 v[220:221], v242 offset:1032
    ds_read_b64_tr_b16 v[222:223], v242 offset:1544
    v_mfma_f32_16x16x32_bf16 v[104:107], a[240:243], a[224:227], 0
    s_waitcnt lgkmcnt(11)
    ds_read_b64_tr_b16 a[240:241], v243 offset:1024
    ds_read_b64_tr_b16 a[242:243], v243 offset:1536
    v_mfma_f32_16x16x32_bf16 v[144:147], a[244:247], a[216:219], 0
    v_mov_b32 v247, v224
    v_mfma_f32_16x16x32_bf16 v[148:151], a[244:247], a[220:223], 0
    v_mfma_f32_16x16x32_bf16 v[152:155], a[244:247], a[224:227], 0
    s_waitcnt lgkmcnt(11)
    ds_read_b64_tr_b16 a[244:245], v243 offset:1032
    ds_read_b64_tr_b16 a[246:247], v243 offset:1544
    v_mfma_f32_16x16x32_bf16 v[108:111], a[248:251], a[216:219], 0
    v_permlane32_swap_b32 v247, v224
    v_mfma_f32_16x16x32_bf16 v[112:115], a[248:251], a[220:223], 0
    v_add_f32 v224, v224, v247
    v_mfma_f32_16x16x32_bf16 v[116:119], a[248:251], a[224:227], 0
    s_waitcnt lgkmcnt(8)
    v_mov_b32 v247, v224
    v_mfma_f32_16x16x32_bf16 v[156:159], a[252:255], a[216:219], 0
    v_mfma_f32_16x16x32_bf16 v[160:163], a[252:255], a[220:223], 0
    v_permlane16_swap_b32 v247, v224
    v_mfma_f32_16x16x32_bf16 v[164:167], a[252:255], a[224:227], 0
    s_waitcnt lgkmcnt(6)
    v_add_f32 v224, v224, v247
    v_mfma_f32_16x16x32_bf16 v[120:123], v[216:219], a[216:219], 0
    v_rcp_f32 v248, v224
    v_mfma_f32_16x16x32_bf16 v[124:127], v[216:219], a[220:223], 0
    s_waitcnt vmcnt(9)
    s_barrier
    ds_read_b64_tr_b16 a[248:249], v242 offset:8192
    v_mfma_f32_16x16x32_bf16 v[128:131], v[216:219], a[224:227], 0
    s_waitcnt lgkmcnt(5)
    ds_read_b64_tr_b16 a[250:251], v242 offset:8704
    ds_read_b64_tr_b16 a[252:253], v242 offset:8200
    v_mfma_f32_16x16x32_bf16 v[168:171], v[220:223], a[216:219], 0
    s_add_u32 m0, s51, 32768
    ds_read_b64_tr_b16 a[254:255], v242 offset:8712
    ds_read_b64_tr_b16 v[216:217], v243 offset:8192
    v_mfma_f32_16x16x32_bf16 v[172:175], v[220:223], a[220:223], 0
    buffer_load_dwordx4 v240, s[12:15], s46 offen lds
    v_mfma_f32_16x16x32_bf16 v[176:179], v[220:223], a[224:227], 0
    s_waitcnt lgkmcnt(7)
    buffer_load_dwordx4 v241, s[12:15], s46 offen offset:2048 lds
    v_mfma_f32_16x16x32_bf16 v[132:135], a[240:243], a[216:219], 0
    s_add_u32 m0, s51, 33664
    ds_read_b64_tr_b16 v[218:219], v243 offset:8704
    ds_read_b64_tr_b16 v[220:221], v243 offset:8200
    v_mfma_f32_16x16x32_bf16 v[136:139], a[240:243], a[220:223], 0
    ds_read_b64_tr_b16 v[222:223], v243 offset:8712
    v_mul_f32 v0, v248, v0
    v_mfma_f32_16x16x32_bf16 v[140:143], a[240:243], a[224:227], 0
    s_waitcnt lgkmcnt(8)
    buffer_load_dwordx4 v240, s[12:15], s46 offen offset:128 lds
    v_mfma_f32_16x16x32_bf16 v[180:183], a[244:247], a[216:219], 0
    ds_read_b64_tr_b16 a[240:241], v242 offset:9216
    ds_read_b64_tr_b16 a[242:243], v242 offset:9728
    v_mfma_f32_16x16x32_bf16 v[184:187], a[244:247], a[220:223], 0
    v_mul_f32 v1, v248, v1
    v_mul_f32 v2, v248, v2
    v_mfma_f32_16x16x32_bf16 v[188:191], a[244:247], a[224:227], 0
    s_waitcnt lgkmcnt(8)
    buffer_load_dwordx4 v241, s[12:15], s46 offen offset:2176 lds
    v_mfma_f32_16x16x32_bf16 v[96:99], a[248:251], a[228:231], v[96:99]
    s_add_u32 m0, s52, 130816
    ds_read_b64_tr_b16 a[244:245], v242 offset:9224
    ds_read_b64_tr_b16 a[246:247], v242 offset:9736
    v_mfma_f32_16x16x32_bf16 v[100:103], a[248:251], a[232:235], v[100:103]
    s_add_u32 s46, s46, 262144
    v_mul_f32 v3, v248, v3
    v_mul_f32 v12, v248, v12
    v_mfma_f32_16x16x32_bf16 v[104:107], a[248:251], a[236:239], v[104:107]
    s_waitcnt lgkmcnt(8)
    buffer_load_dwordx4 v239, s[16:19], s47 offen offset:256 lds
    v_mfma_f32_16x16x32_bf16 v[144:147], a[252:255], a[228:231], v[144:147]
    s_add_u32 m0, s52, 134912
    ds_read_b64_tr_b16 a[248:249], v243 offset:9216
    ds_read_b64_tr_b16 a[250:251], v243 offset:9728
    v_mfma_f32_16x16x32_bf16 v[148:151], a[252:255], a[232:235], v[148:151]
    v_mul_f32 v13, v248, v13
    v_mul_f32 v14, v248, v14
    v_mfma_f32_16x16x32_bf16 v[152:155], a[252:255], a[236:239], v[152:155]
    s_waitcnt lgkmcnt(8)
    buffer_load_dwordx4 v239, s[16:19], s48 offen offset:256 lds
    v_mfma_f32_16x16x32_bf16 v[108:111], v[216:219], a[228:231], v[108:111]
    s_add_u32 m0, s52, 139008
    ds_read_b64_tr_b16 a[252:253], v243 offset:9224
    ds_read_b64_tr_b16 a[254:255], v243 offset:9736
    v_mfma_f32_16x16x32_bf16 v[112:115], v[216:219], a[232:235], v[112:115]
    v_mul_f32 v15, v248, v15
    v_cvt_pk_bf16_f32 v0, v0, v1
    v_mfma_f32_16x16x32_bf16 v[116:119], v[216:219], a[236:239], v[116:119]
    s_waitcnt lgkmcnt(8)
    buffer_load_dwordx4 v239, s[16:19], s49 offen offset:256 lds
    v_mfma_f32_16x16x32_bf16 v[156:159], v[220:223], a[228:231], v[156:159]
    v_mov_b32 v247, v225
    v_cvt_pk_bf16_f32 v1, v2, v3
    v_mfma_f32_16x16x32_bf16 v[160:163], v[220:223], a[232:235], v[160:163]
    v_permlane32_swap_b32 v247, v225
    v_mfma_f32_16x16x32_bf16 v[164:167], v[220:223], a[236:239], v[164:167]
    s_waitcnt lgkmcnt(6)
    v_add_f32 v225, v225, v247
    v_cvt_pk_bf16_f32 v2, v12, v13
    v_mfma_f32_16x16x32_bf16 v[120:123], a[240:243], a[228:231], v[120:123]
    v_mov_b32 v247, v225
    v_cvt_pk_bf16_f32 v3, v14, v15
    v_mfma_f32_16x16x32_bf16 v[124:127], a[240:243], a[232:235], v[124:127]
    s_waitcnt vmcnt(7)
    s_barrier
    ds_read_b128 v[192:195], v244 offset:12288
    v_mfma_f32_16x16x32_bf16 v[128:131], a[240:243], a[236:239], v[128:131]
    s_waitcnt lgkmcnt(5)
    ds_read_b64_tr_b16 v[216:217], v242 offset:16384
    ds_read_b64_tr_b16 v[218:219], v242 offset:16896
    v_mfma_f32_16x16x32_bf16 v[168:171], a[244:247], a[228:231], v[168:171]
    s_add_u32 m0, s51, 0
    ds_read_b128 v[196:199], v244 offset:14336
    ds_read_b128 v[200:203], v244 offset:16384
    v_mfma_f32_16x16x32_bf16 v[172:175], a[244:247], a[232:235], v[172:175]
    s_add_u32 s56, s56, 294912
    buffer_load_dwordx4 v240, s[12:15], s46 offen lds
    v_mfma_f32_16x16x32_bf16 v[176:179], a[244:247], a[236:239], v[176:179]
    s_waitcnt lgkmcnt(7)
    ds_read_b64_tr_b16 v[220:221], v242 offset:16392
    ds_read_b64_tr_b16 v[222:223], v242 offset:16904
    v_mfma_f32_16x16x32_bf16 v[132:135], a[248:251], a[228:231], v[132:135]
    s_add_u32 s57, s57, 294912
    buffer_load_dwordx4 v241, s[12:15], s46 offen offset:2048 lds
    v_mfma_f32_16x16x32_bf16 v[136:139], a[248:251], a[232:235], v[136:139]
    s_add_u32 m0, s51, 896
    ds_read_b64_tr_b16 a[240:241], v243 offset:16384
    ds_read_b64_tr_b16 a[242:243], v243 offset:16896
    v_mfma_f32_16x16x32_bf16 v[140:143], a[248:251], a[236:239], v[140:143]
    s_waitcnt lgkmcnt(9)
    buffer_load_dwordx4 v240, s[12:15], s46 offen offset:128 lds
    v_mfma_f32_16x16x32_bf16 v[180:183], a[252:255], a[228:231], v[180:183]
    s_add_u32 s58, s58, 294912
    ds_read_b64_tr_b16 a[244:245], v243 offset:16392
    ds_read_b64_tr_b16 a[246:247], v243 offset:16904
    v_mfma_f32_16x16x32_bf16 v[184:187], a[252:255], a[232:235], v[184:187]
    s_add_u32 s59, s59, 294912
    ds_read_b64_tr_b16 a[248:249], v242 offset:17408
    ds_read_b64_tr_b16 a[250:251], v242 offset:17920
    v_mfma_f32_16x16x32_bf16 v[188:191], a[252:255], a[236:239], v[188:191]
    s_waitcnt lgkmcnt(10)
    buffer_load_dwordx4 v241, s[12:15], s46 offen offset:2176 lds
    v_mfma_f32_16x16x32_bf16 v[96:99], v[216:219], v[192:195], v[96:99]
    s_waitcnt lgkmcnt(9)
    ds_read_b64_tr_b16 a[252:253], v242 offset:17416
    ds_read_b64_tr_b16 a[254:255], v242 offset:17928
    v_mfma_f32_16x16x32_bf16 v[100:103], v[216:219], v[196:199], v[100:103]
    s_waitcnt lgkmcnt(10)
    v_permlane16_swap_b32 v247, v225
    v_mfma_f32_16x16x32_bf16 v[104:107], v[216:219], v[200:203], v[104:107]
    s_waitcnt lgkmcnt(8)
    buffer_load_dword v251, v228, s[20:23], s95 offen
    v_mfma_f32_16x16x32_bf16 v[144:147], v[220:223], v[192:195], v[144:147]
    s_add_u32 s46, s46, 262144
    ds_read_b128 a[216:219], v245 offset:12288
    v_add_f32 v225, v225, v247
    v_mfma_f32_16x16x32_bf16 v[148:151], v[220:223], v[196:199], v[148:151]
    s_add_u32 s60, s60, 294912
    ds_read_b128 a[220:223], v245 offset:14336
    ds_read_b128 a[224:227], v245 offset:16384
    v_mfma_f32_16x16x32_bf16 v[152:155], v[220:223], v[200:203], v[152:155]
    s_waitcnt lgkmcnt(9)
    ds_read_b64_tr_b16 v[216:217], v243 offset:17408
    ds_read_b64_tr_b16 v[218:219], v243 offset:17920
    v_mfma_f32_16x16x32_bf16 v[108:111], a[240:243], v[192:195], v[108:111]
    s_add_u32 s61, s61, 294912
    v_rcp_f32 v249, v225
    v_mfma_f32_16x16x32_bf16 v[112:115], a[240:243], v[196:199], v[112:115]
    s_add_u32 s62, s62, 294912
    ds_read_b64_tr_b16 v[220:221], v243 offset:17416
    v_mul_f32 v4, v249, v4
    v_mfma_f32_16x16x32_bf16 v[116:119], a[240:243], v[200:203], v[116:119]
    s_waitcnt lgkmcnt(10)
    ds_read_b64_tr_b16 v[222:223], v243 offset:17928
    v_mul_f32 v5, v249, v5
    v_mfma_f32_16x16x32_bf16 v[156:159], a[244:247], v[192:195], v[156:159]
    s_add_u32 s63, s63, 294912
    v_mul_f32 v6, v249, v6
    v_mul_f32 v7, v249, v7
    v_mfma_f32_16x16x32_bf16 v[160:163], a[244:247], v[196:199], v[160:163]
    s_add_u32 s64, s64, 294912
    v_mul_f32 v16, v249, v16
    v_mul_f32 v17, v249, v17
    v_mfma_f32_16x16x32_bf16 v[164:167], a[244:247], v[200:203], v[164:167]
    s_waitcnt lgkmcnt(9)
    v_mul_f32 v18, v249, v18
    v_mul_f32 v19, v249, v19
    v_mfma_f32_16x16x32_bf16 v[120:123], a[248:251], v[192:195], v[120:123]
    v_cvt_pk_bf16_f32 v4, v4, v5
    v_mov_b32 v247, v226
    v_mfma_f32_16x16x32_bf16 v[124:127], a[248:251], v[196:199], v[124:127]
    s_waitcnt vmcnt(12) lgkmcnt(4)
    s_barrier
    ds_read_b64_tr_b16 a[240:241], v242 offset:24576
    v_mfma_f32_16x16x32_bf16 v[128:131], a[248:251], v[200:203], v[128:131]
    s_add_u32 m0, s51, 8192
    ds_read_b64_tr_b16 a[242:243], v242 offset:25088
    ds_read_b64_tr_b16 a[244:245], v242 offset:24584
    v_mfma_f32_16x16x32_bf16 v[168:171], a[252:255], v[192:195], v[168:171]
    buffer_load_dwordx4 v240, s[12:15], s46 offen lds
    v_mfma_f32_16x16x32_bf16 v[172:175], a[252:255], v[196:199], v[172:175]
    ds_read_b64_tr_b16 a[246:247], v242 offset:25096
    ds_read_b64_tr_b16 a[248:249], v243 offset:24576
    v_mfma_f32_16x16x32_bf16 v[176:179], a[252:255], v[200:203], v[176:179]
    s_waitcnt lgkmcnt(7)
    buffer_load_dwordx4 v241, s[12:15], s46 offen offset:2048 lds
    v_mfma_f32_16x16x32_bf16 v[132:135], v[216:219], v[192:195], v[132:135]
    s_add_u32 m0, s51, 9088
    ds_read_b64_tr_b16 a[250:251], v243 offset:25088
    ds_read_b64_tr_b16 a[252:253], v243 offset:24584
    v_mfma_f32_16x16x32_bf16 v[136:139], v[216:219], v[196:199], v[136:139]
    ds_read_b64_tr_b16 a[254:255], v243 offset:25096
    v_cvt_pk_bf16_f32 v5, v6, v7
    v_mfma_f32_16x16x32_bf16 v[140:143], v[216:219], v[200:203], v[140:143]
    s_waitcnt lgkmcnt(8)
    buffer_load_dwordx4 v240, s[12:15], s46 offen offset:128 lds
    v_mfma_f32_16x16x32_bf16 v[180:183], v[220:223], v[192:195], v[180:183]
    ds_read_b64_tr_b16 v[216:217], v242 offset:25600
    ds_read_b64_tr_b16 v[218:219], v242 offset:26112
    v_mfma_f32_16x16x32_bf16 v[184:187], v[220:223], v[196:199], v[184:187]
    v_permlane32_swap_b32 v247, v226
    v_mfma_f32_16x16x32_bf16 v[188:191], v[220:223], v[200:203], v[188:191]
    s_waitcnt lgkmcnt(8)
    buffer_load_dwordx4 v241, s[12:15], s46 offen offset:2176 lds
    v_mfma_f32_16x16x32_bf16 v[96:99], a[240:243], a[216:219], v[96:99]
    s_add_u32 m0, s52, 142976
    ds_read_b64_tr_b16 v[220:221], v242 offset:25608
    ds_read_b64_tr_b16 v[222:223], v242 offset:26120
    v_mfma_f32_16x16x32_bf16 v[100:103], a[240:243], a[220:223], v[100:103]
    s_add_u32 s46, s46, 262144
    v_add_f32 v226, v226, v247
    v_cvt_pk_bf16_f32 v6, v16, v17
    v_mfma_f32_16x16x32_bf16 v[104:107], a[240:243], a[224:227], v[104:107]
    s_waitcnt lgkmcnt(8)
    buffer_load_dwordx4 v239, s[16:19], s47 offen offset:384 lds
    v_mfma_f32_16x16x32_bf16 v[144:147], a[244:247], a[216:219], v[144:147]
    s_add_u32 m0, s52, 147072
    ds_read_b64_tr_b16 a[240:241], v243 offset:25600
    v_mov_b32 v247, v226
    v_mfma_f32_16x16x32_bf16 v[148:151], a[244:247], a[220:223], v[148:151]
    ds_read_b64_tr_b16 a[242:243], v243 offset:26112
    v_cvt_pk_bf16_f32 v7, v18, v19
    v_mfma_f32_16x16x32_bf16 v[152:155], a[244:247], a[224:227], v[152:155]
    s_waitcnt lgkmcnt(8)
    buffer_load_dwordx4 v239, s[16:19], s48 offen offset:384 lds
    v_mfma_f32_16x16x32_bf16 v[108:111], a[248:251], a[216:219], v[108:111]
    s_add_u32 m0, s52, 151168
    v_permlane16_swap_b32 v247, v226
    v_mfma_f32_16x16x32_bf16 v[112:115], a[248:251], a[220:223], v[112:115]
    ds_read_b64_tr_b16 a[244:245], v243 offset:25608
    v_add_f32 v226, v226, v247
    v_mfma_f32_16x16x32_bf16 v[116:119], a[248:251], a[224:227], v[116:119]
    s_waitcnt lgkmcnt(7)
    buffer_load_dwordx4 v239, s[16:19], s49 offen offset:384 lds
    v_mfma_f32_16x16x32_bf16 v[156:159], a[252:255], a[216:219], v[156:159]
    v_rcp_f32 v250, v226
    v_mfma_f32_16x16x32_bf16 v[160:163], a[252:255], a[220:223], v[160:163]
    ds_read_b64_tr_b16 a[246:247], v243 offset:26120
    v_mul_f32 v8, v250, v8
    v_mfma_f32_16x16x32_bf16 v[164:167], a[252:255], a[224:227], v[164:167]
    s_waitcnt lgkmcnt(6)
    v_mul_f32 v9, v250, v9
    v_mul_f32 v10, v250, v10
    v_mfma_f32_16x16x32_bf16 v[120:123], v[216:219], a[216:219], v[120:123]
    v_mul_f32 v11, v250, v11
    v_mul_f32 v20, v250, v20
    v_mfma_f32_16x16x32_bf16 v[124:127], v[216:219], a[220:223], v[124:127]
    s_waitcnt vmcnt(12)
    s_barrier
    ds_read_b128 a[228:231], v244
    v_mfma_f32_16x16x32_bf16 v[128:131], v[216:219], a[224:227], v[128:131]
    s_waitcnt lgkmcnt(5)
    ds_read_b64_tr_b16 a[248:249], v242 offset:32768
    ds_read_b64_tr_b16 a[250:251], v242 offset:33280
    v_mfma_f32_16x16x32_bf16 v[168:171], v[220:223], a[216:219], v[168:171]
    s_add_u32 m0, s51, 16384
    ds_read_b128 a[232:235], v244 offset:2048
    ds_read_b128 a[236:239], v244 offset:4096
    v_mfma_f32_16x16x32_bf16 v[172:175], v[220:223], a[220:223], v[172:175]
    buffer_load_dwordx4 v240, s[12:15], s46 offen lds
    v_mfma_f32_16x16x32_bf16 v[176:179], v[220:223], a[224:227], v[176:179]
    s_waitcnt lgkmcnt(7)
    ds_read_b64_tr_b16 a[252:253], v242 offset:32776
    ds_read_b64_tr_b16 a[254:255], v242 offset:33288
    v_mfma_f32_16x16x32_bf16 v[132:135], a[240:243], a[216:219], v[132:135]
    buffer_load_dwordx4 v241, s[12:15], s46 offen offset:2048 lds
    s_add_u32 m0, s51, 17280
    v_mfma_f32_16x16x32_bf16 v[136:139], a[240:243], a[220:223], v[136:139]
    ds_read_b64_tr_b16 v[216:217], v243 offset:32768
    ds_read_b64_tr_b16 v[218:219], v243 offset:33280
    v_mfma_f32_16x16x32_bf16 v[140:143], a[240:243], a[224:227], v[140:143]
    s_waitcnt lgkmcnt(9)
    buffer_load_dwordx4 v240, s[12:15], s46 offen offset:128 lds
    v_mfma_f32_16x16x32_bf16 v[180:183], a[244:247], a[216:219], v[180:183]
    ds_read_b64_tr_b16 v[220:221], v243 offset:32776
    v_mul_f32 v21, v250, v21
    v_mfma_f32_16x16x32_bf16 v[184:187], a[244:247], a[220:223], v[184:187]
    ds_read_b64_tr_b16 v[222:223], v243 offset:33288
    v_mul_f32 v22, v250, v22
    v_mfma_f32_16x16x32_bf16 v[188:191], a[244:247], a[224:227], v[188:191]
    s_waitcnt lgkmcnt(8)
    buffer_load_dwordx4 v241, s[12:15], s46 offen offset:2176 lds
    v_mfma_f32_16x16x32_bf16 v[96:99], a[248:251], a[228:231], v[96:99]
    s_waitcnt lgkmcnt(7)
    ds_read_b64_tr_b16 a[240:241], v242 offset:33792
    ds_read_b64_tr_b16 a[242:243], v242 offset:34304
    v_mfma_f32_16x16x32_bf16 v[100:103], a[248:251], a[232:235], v[100:103]
    s_waitcnt lgkmcnt(8)
    ds_read_b64_tr_b16 a[244:245], v242 offset:33800
    v_mul_f32 v23, v250, v23
    v_mfma_f32_16x16x32_bf16 v[104:107], a[248:251], a[236:239], v[104:107]
    s_waitcnt lgkmcnt(7)
    ds_read_b64_tr_b16 a[246:247], v242 offset:34312
    v_cvt_pk_bf16_f32 v8, v8, v9
    v_mfma_f32_16x16x32_bf16 v[144:147], a[252:255], a[228:231], v[144:147]
    s_add_u32 s46, s46, 262144
    ds_read_b128 v[192:195], v245
    v_cvt_pk_bf16_f32 v9, v10, v11
    v_mfma_f32_16x16x32_bf16 v[148:151], a[252:255], a[232:235], v[148:151]
    ds_read_b128 v[196:199], v245 offset:2048
    ds_read_b128 v[200:203], v245 offset:4096
    v_mfma_f32_16x16x32_bf16 v[152:155], a[252:255], a[236:239], v[152:155]
    s_waitcnt lgkmcnt(9)
    ds_read_b64_tr_b16 a[248:249], v243 offset:33792
    ds_read_b64_tr_b16 a[250:251], v243 offset:34304
    v_mfma_f32_16x16x32_bf16 v[108:111], v[216:219], a[228:231], v[108:111]
    ds_read_b64_tr_b16 a[252:253], v243 offset:33800
    v_cvt_pk_bf16_f32 v10, v20, v21
    v_mfma_f32_16x16x32_bf16 v[112:115], v[216:219], a[232:235], v[112:115]
    ds_read_b64_tr_b16 a[254:255], v243 offset:34312
    v_cvt_pk_bf16_f32 v11, v22, v23
    v_mfma_f32_16x16x32_bf16 v[116:119], v[216:219], a[236:239], v[116:119]
    s_waitcnt lgkmcnt(11)
    v_mul_f32 v24, v248, v24
    v_mul_f32 v25, v248, v25
    v_mfma_f32_16x16x32_bf16 v[156:159], v[220:223], a[228:231], v[156:159]
    v_mul_f32 v26, v248, v26
    v_mul_f32 v27, v248, v27
    v_mfma_f32_16x16x32_bf16 v[160:163], v[220:223], a[232:235], v[160:163]
    v_mul_f32 v36, v248, v36
    v_mul_f32 v37, v248, v37
    v_mfma_f32_16x16x32_bf16 v[164:167], v[220:223], a[236:239], v[164:167]
    s_waitcnt lgkmcnt(9)
    v_mul_f32 v38, v248, v38
    v_mul_f32 v39, v248, v39
    v_mfma_f32_16x16x32_bf16 v[120:123], a[240:243], a[228:231], v[120:123]
    v_cvt_pk_bf16_f32 v24, v24, v25
    v_mul_f32 v28, v249, v28
    v_mfma_f32_16x16x32_bf16 v[124:127], a[240:243], a[232:235], v[124:127]
    s_waitcnt vmcnt(12) lgkmcnt(4)
    s_barrier
    ds_read_b64_tr_b16 v[216:217], v242
    v_mfma_f32_16x16x32_bf16 v[128:131], a[240:243], a[236:239], v[128:131]
    s_add_u32 m0, s51, 24576
    ds_read_b64_tr_b16 v[218:219], v242 offset:512
    ds_read_b64_tr_b16 v[220:221], v242 offset:8
    v_mfma_f32_16x16x32_bf16 v[168:171], a[244:247], a[228:231], v[168:171]
    buffer_load_dwordx4 v240, s[12:15], s46 offen lds
    v_mfma_f32_16x16x32_bf16 v[172:175], a[244:247], a[232:235], v[172:175]
    ds_read_b64_tr_b16 v[222:223], v242 offset:520
    ds_read_b64_tr_b16 a[240:241], v243
    v_mfma_f32_16x16x32_bf16 v[176:179], a[244:247], a[236:239], v[176:179]
    s_waitcnt lgkmcnt(7)
    buffer_load_dwordx4 v241, s[12:15], s46 offen offset:2048 lds
    v_mfma_f32_16x16x32_bf16 v[132:135], a[248:251], a[228:231], v[132:135]
    s_add_u32 m0, s51, 25472
    ds_read_b64_tr_b16 a[242:243], v243 offset:512
    ds_read_b64_tr_b16 a[244:245], v243 offset:8
    v_mfma_f32_16x16x32_bf16 v[136:139], a[248:251], a[232:235], v[136:139]
    ds_read_b64_tr_b16 a[246:247], v243 offset:520
    v_cvt_pk_bf16_f32 v25, v26, v27
    v_mfma_f32_16x16x32_bf16 v[140:143], a[248:251], a[236:239], v[140:143]
    s_waitcnt lgkmcnt(8)
    buffer_load_dwordx4 v240, s[12:15], s46 offen offset:128 lds
    v_mfma_f32_16x16x32_bf16 v[180:183], a[252:255], a[228:231], v[180:183]
    ds_read_b64_tr_b16 a[248:249], v242 offset:1024
    ds_read_b64_tr_b16 a[250:251], v242 offset:1536
    v_mfma_f32_16x16x32_bf16 v[184:187], a[252:255], a[232:235], v[184:187]
    v_cvt_pk_bf16_f32 v26, v36, v37
    v_cvt_pk_bf16_f32 v27, v38, v39
    v_mfma_f32_16x16x32_bf16 v[188:191], a[252:255], a[236:239], v[188:191]
    s_waitcnt lgkmcnt(8)
    buffer_load_dwordx4 v241, s[12:15], s46 offen offset:2176 lds
    v_mfma_f32_16x16x32_bf16 v[96:99], v[216:219], v[192:195], v[96:99]
    s_add_u32 m0, s52, 130560
    ds_read_b64_tr_b16 a[252:253], v242 offset:1032
    ds_read_b64_tr_b16 a[254:255], v242 offset:1544
    v_mfma_f32_16x16x32_bf16 v[100:103], v[216:219], v[196:199], v[100:103]
    s_add_u32 s46, s46, 262144
    v_mul_f32 v29, v249, v29
    v_mul_f32 v30, v249, v30
    v_mfma_f32_16x16x32_bf16 v[104:107], v[216:219], v[200:203], v[104:107]
    s_waitcnt lgkmcnt(8)
    buffer_load_dwordx4 v239, s[16:19], s47 offen offset:512 lds
    v_mfma_f32_16x16x32_bf16 v[144:147], v[220:223], v[192:195], v[144:147]
    s_add_u32 m0, s52, 134656
    ds_read_b64_tr_b16 v[216:217], v243 offset:1024
    ds_read_b64_tr_b16 v[218:219], v243 offset:1536
    v_mfma_f32_16x16x32_bf16 v[148:151], v[220:223], v[196:199], v[148:151]
    v_mul_f32 v31, v249, v31
    v_mul_f32 v40, v249, v40
    v_mfma_f32_16x16x32_bf16 v[152:155], v[220:223], v[200:203], v[152:155]
    s_waitcnt lgkmcnt(8)
    buffer_load_dwordx4 v239, s[16:19], s48 offen offset:512 lds
    v_mfma_f32_16x16x32_bf16 v[108:111], a[240:243], v[192:195], v[108:111]
    s_add_u32 m0, s52, 138752
    ds_read_b64_tr_b16 v[220:221], v243 offset:1032
    ds_read_b64_tr_b16 v[222:223], v243 offset:1544
    v_mfma_f32_16x16x32_bf16 v[112:115], a[240:243], v[196:199], v[112:115]
    v_mul_f32 v41, v249, v41
    v_mul_f32 v42, v249, v42
    v_mfma_f32_16x16x32_bf16 v[116:119], a[240:243], v[200:203], v[116:119]
    s_waitcnt lgkmcnt(8)
    buffer_load_dwordx4 v239, s[16:19], s49 offen offset:512 lds
    v_mfma_f32_16x16x32_bf16 v[156:159], a[244:247], v[192:195], v[156:159]
    v_mul_f32 v43, v249, v43
    v_cvt_pk_bf16_f32 v28, v28, v29
    v_mfma_f32_16x16x32_bf16 v[160:163], a[244:247], v[196:199], v[160:163]
    v_cvt_pk_bf16_f32 v29, v30, v31
    v_mul_f32 v32, v250, v32
    v_mfma_f32_16x16x32_bf16 v[164:167], a[244:247], v[200:203], v[164:167]
    s_waitcnt lgkmcnt(6)
    v_cvt_pk_bf16_f32 v30, v40, v41
    v_cvt_pk_bf16_f32 v31, v42, v43
    v_mfma_f32_16x16x32_bf16 v[120:123], a[248:251], v[192:195], v[120:123]
    v_mul_f32 v33, v250, v33
    v_mul_f32 v34, v250, v34
    v_mfma_f32_16x16x32_bf16 v[124:127], a[248:251], v[196:199], v[124:127]
    s_waitcnt vmcnt(11)
    s_barrier
    ds_read_b128 a[216:219], v244 offset:12288
    v_mfma_f32_16x16x32_bf16 v[128:131], a[248:251], v[200:203], v[128:131]
    s_waitcnt lgkmcnt(5)
    ds_read_b64_tr_b16 a[240:241], v242 offset:8192
    ds_read_b64_tr_b16 a[242:243], v242 offset:8704
    v_mfma_f32_16x16x32_bf16 v[168:171], a[252:255], v[192:195], v[168:171]
    s_add_u32 m0, s51, 32768
    ds_read_b128 a[220:223], v244 offset:14336
    ds_read_b128 a[224:227], v244 offset:16384
    v_mfma_f32_16x16x32_bf16 v[172:175], a[252:255], v[196:199], v[172:175]
    buffer_load_dwordx4 v240, s[12:15], s46 offen lds
    v_mfma_f32_16x16x32_bf16 v[176:179], a[252:255], v[200:203], v[176:179]
    s_waitcnt lgkmcnt(7)
    ds_read_b64_tr_b16 a[244:245], v242 offset:8200
    ds_read_b64_tr_b16 a[246:247], v242 offset:8712
    v_mfma_f32_16x16x32_bf16 v[132:135], v[216:219], v[192:195], v[132:135]
    buffer_load_dwordx4 v241, s[12:15], s46 offen offset:2048 lds
    s_add_u32 m0, s51, 33664
    v_mfma_f32_16x16x32_bf16 v[136:139], v[216:219], v[196:199], v[136:139]
    ds_read_b64_tr_b16 a[248:249], v243 offset:8192
    ds_read_b64_tr_b16 a[250:251], v243 offset:8704
    v_mfma_f32_16x16x32_bf16 v[140:143], v[216:219], v[200:203], v[140:143]
    s_waitcnt lgkmcnt(9)
    buffer_load_dwordx4 v240, s[12:15], s46 offen offset:128 lds
    v_mfma_f32_16x16x32_bf16 v[180:183], v[220:223], v[192:195], v[180:183]
    ds_read_b64_tr_b16 a[252:253], v243 offset:8200
    ds_read_b64_tr_b16 a[254:255], v243 offset:8712
    v_mfma_f32_16x16x32_bf16 v[184:187], v[220:223], v[196:199], v[184:187]
    ds_read_b64_tr_b16 v[216:217], v242 offset:9216
    ds_read_b64_tr_b16 v[218:219], v242 offset:9728
    v_mfma_f32_16x16x32_bf16 v[188:191], v[220:223], v[200:203], v[188:191]
    s_waitcnt lgkmcnt(10)
    buffer_load_dwordx4 v241, s[12:15], s46 offen offset:2176 lds
    v_mfma_f32_16x16x32_bf16 v[96:99], a[240:243], a[216:219], v[96:99]
    s_waitcnt lgkmcnt(9)
    ds_read_b64_tr_b16 v[220:221], v242 offset:9224
    ds_read_b64_tr_b16 v[222:223], v242 offset:9736
    v_mfma_f32_16x16x32_bf16 v[100:103], a[240:243], a[220:223], v[100:103]
    s_waitcnt lgkmcnt(10)
    ds_read_b128 a[228:231], v245 offset:12288
    ds_read_b128 a[232:235], v245 offset:14336
    v_mfma_f32_16x16x32_bf16 v[104:107], a[240:243], a[224:227], v[104:107]
    s_waitcnt lgkmcnt(10)
    ds_read_b128 a[236:239], v245 offset:16384
    ds_read_b64_tr_b16 a[240:241], v243 offset:9216
    v_mfma_f32_16x16x32_bf16 v[144:147], a[244:247], a[216:219], v[144:147]
    s_add_u32 s46, s46, 262144
    ds_read_b64_tr_b16 a[242:243], v243 offset:9728
    v_mul_f32 v35, v250, v35
    v_mfma_f32_16x16x32_bf16 v[148:151], a[244:247], a[220:223], v[148:151]
    v_mul_f32 v44, v250, v44
    v_mul_f32 v45, v250, v45
    v_mfma_f32_16x16x32_bf16 v[152:155], a[244:247], a[224:227], v[152:155]
    s_waitcnt lgkmcnt(11)
    ds_read_b64_tr_b16 a[244:245], v243 offset:9224
    ds_read_b64_tr_b16 a[246:247], v243 offset:9736
    v_mfma_f32_16x16x32_bf16 v[108:111], a[248:251], a[216:219], v[108:111]
    v_mul_f32 v46, v250, v46
    v_mul_f32 v47, v250, v47
    v_mfma_f32_16x16x32_bf16 v[112:115], a[248:251], a[220:223], v[112:115]
    v_cvt_pk_bf16_f32 v32, v32, v33
    v_mul_f32 v48, v248, v48
    v_mfma_f32_16x16x32_bf16 v[116:119], a[248:251], a[224:227], v[116:119]
    s_waitcnt lgkmcnt(11)
    v_cvt_pk_bf16_f32 v33, v34, v35
    v_mul_f32 v49, v248, v49
    v_mfma_f32_16x16x32_bf16 v[156:159], a[252:255], a[216:219], v[156:159]
    v_cvt_pk_bf16_f32 v34, v44, v45
    v_cvt_pk_bf16_f32 v35, v46, v47
    v_mfma_f32_16x16x32_bf16 v[160:163], a[252:255], a[220:223], v[160:163]
    v_mul_f32 v50, v248, v50
    v_mul_f32 v51, v248, v51
    v_mfma_f32_16x16x32_bf16 v[164:167], a[252:255], a[224:227], v[164:167]
    s_waitcnt lgkmcnt(9)
    v_mul_f32 v60, v248, v60
    v_mul_f32 v61, v248, v61
    v_mfma_f32_16x16x32_bf16 v[120:123], v[216:219], a[216:219], v[120:123]
    v_mul_f32 v62, v248, v62
    v_mul_f32 v63, v248, v63
    v_mfma_f32_16x16x32_bf16 v[124:127], v[216:219], a[220:223], v[124:127]
    s_waitcnt vmcnt(11) lgkmcnt(4)
    s_barrier
    ds_read_b64_tr_b16 a[248:249], v242 offset:16384
    v_mfma_f32_16x16x32_bf16 v[128:131], v[216:219], a[224:227], v[128:131]
    s_add_u32 m0, s51, 0
    ds_read_b64_tr_b16 a[250:251], v242 offset:16896
    ds_read_b64_tr_b16 a[252:253], v242 offset:16392
    v_mfma_f32_16x16x32_bf16 v[168:171], v[220:223], a[216:219], v[168:171]
    buffer_load_dwordx4 v240, s[12:15], s46 offen lds
    v_mfma_f32_16x16x32_bf16 v[172:175], v[220:223], a[220:223], v[172:175]
    ds_read_b64_tr_b16 a[254:255], v242 offset:16904
    ds_read_b64_tr_b16 v[216:217], v243 offset:16384
    v_mfma_f32_16x16x32_bf16 v[176:179], v[220:223], a[224:227], v[176:179]
    s_waitcnt lgkmcnt(7)
    buffer_load_dwordx4 v241, s[12:15], s46 offen offset:2048 lds
    v_mfma_f32_16x16x32_bf16 v[132:135], a[240:243], a[216:219], v[132:135]
    s_add_u32 m0, s51, 896
    ds_read_b64_tr_b16 v[218:219], v243 offset:16896
    ds_read_b64_tr_b16 v[220:221], v243 offset:16392
    v_mfma_f32_16x16x32_bf16 v[136:139], a[240:243], a[220:223], v[136:139]
    ds_read_b64_tr_b16 v[222:223], v243 offset:16904
    v_cvt_pk_bf16_f32 v48, v48, v49
    v_mfma_f32_16x16x32_bf16 v[140:143], a[240:243], a[224:227], v[140:143]
    s_waitcnt lgkmcnt(8)
    buffer_load_dwordx4 v240, s[12:15], s46 offen offset:128 lds
    v_mfma_f32_16x16x32_bf16 v[180:183], a[244:247], a[216:219], v[180:183]
    ds_read_b64_tr_b16 a[240:241], v242 offset:17408
    ds_read_b64_tr_b16 a[242:243], v242 offset:17920
    v_mfma_f32_16x16x32_bf16 v[184:187], a[244:247], a[220:223], v[184:187]
    v_cvt_pk_bf16_f32 v49, v50, v51
    v_mul_f32 v52, v249, v52
    v_mfma_f32_16x16x32_bf16 v[188:191], a[244:247], a[224:227], v[188:191]
    s_waitcnt lgkmcnt(8)
    buffer_load_dwordx4 v241, s[12:15], s46 offen offset:2176 lds
    v_mfma_f32_16x16x32_bf16 v[96:99], a[248:251], a[228:231], v[96:99]
    s_add_u32 m0, s52, 142720
    ds_read_b64_tr_b16 a[244:245], v242 offset:17416
    ds_read_b64_tr_b16 a[246:247], v242 offset:17928
    v_mfma_f32_16x16x32_bf16 v[100:103], a[248:251], a[232:235], v[100:103]
    s_add_u32 s46, s46, 262144
    v_cvt_pk_bf16_f32 v50, v60, v61
    v_cvt_pk_bf16_f32 v51, v62, v63
    v_mfma_f32_16x16x32_bf16 v[104:107], a[248:251], a[236:239], v[104:107]
    s_waitcnt lgkmcnt(8)
    buffer_load_dwordx4 v239, s[16:19], s47 offen offset:640 lds
    v_mfma_f32_16x16x32_bf16 v[144:147], a[252:255], a[228:231], v[144:147]
    s_add_u32 m0, s52, 146816
    ds_read_b64_tr_b16 a[248:249], v243 offset:17408
    ds_read_b64_tr_b16 a[250:251], v243 offset:17920
    v_mfma_f32_16x16x32_bf16 v[148:151], a[252:255], a[232:235], v[148:151]
    v_mul_f32 v53, v249, v53
    v_mul_f32 v54, v249, v54
    v_mfma_f32_16x16x32_bf16 v[152:155], a[252:255], a[236:239], v[152:155]
    s_waitcnt lgkmcnt(8)
    buffer_load_dwordx4 v239, s[16:19], s48 offen offset:640 lds
    v_mfma_f32_16x16x32_bf16 v[108:111], v[216:219], a[228:231], v[108:111]
    s_add_u32 m0, s52, 150912
    ds_read_b64_tr_b16 a[252:253], v243 offset:17416
    ds_read_b64_tr_b16 a[254:255], v243 offset:17928
    v_mfma_f32_16x16x32_bf16 v[112:115], v[216:219], a[232:235], v[112:115]
    v_mul_f32 v55, v249, v55
    v_mul_f32 v64, v249, v64
    v_mfma_f32_16x16x32_bf16 v[116:119], v[216:219], a[236:239], v[116:119]
    s_waitcnt lgkmcnt(8)
    buffer_load_dwordx4 v239, s[16:19], s49 offen offset:640 lds
    v_mfma_f32_16x16x32_bf16 v[156:159], v[220:223], a[228:231], v[156:159]
    v_mul_f32 v65, v249, v65
    v_mul_f32 v66, v249, v66
    v_mfma_f32_16x16x32_bf16 v[160:163], v[220:223], a[232:235], v[160:163]
    v_mul_f32 v67, v249, v67
    v_cvt_pk_bf16_f32 v52, v52, v53
    v_mfma_f32_16x16x32_bf16 v[164:167], v[220:223], a[236:239], v[164:167]
    s_waitcnt lgkmcnt(6)
    v_cvt_pk_bf16_f32 v53, v54, v55
    v_mul_f32 v56, v250, v56
    v_mfma_f32_16x16x32_bf16 v[120:123], a[240:243], a[228:231], v[120:123]
    v_cvt_pk_bf16_f32 v54, v64, v65
    v_cvt_pk_bf16_f32 v55, v66, v67
    v_mfma_f32_16x16x32_bf16 v[124:127], a[240:243], a[232:235], v[124:127]
    s_waitcnt vmcnt(11)
    s_barrier
    ds_read_b128 v[192:195], v244
    v_mfma_f32_16x16x32_bf16 v[128:131], a[240:243], a[236:239], v[128:131]
    s_waitcnt lgkmcnt(5)
    ds_read_b64_tr_b16 v[216:217], v242 offset:24576
    ds_read_b64_tr_b16 v[218:219], v242 offset:25088
    v_mfma_f32_16x16x32_bf16 v[168:171], a[244:247], a[228:231], v[168:171]
    s_add_u32 m0, s51, 8192
    ds_read_b128 v[196:199], v244 offset:2048
    ds_read_b128 v[200:203], v244 offset:4096
    v_mfma_f32_16x16x32_bf16 v[172:175], a[244:247], a[232:235], v[172:175]
    buffer_load_dwordx4 v240, s[12:15], s46 offen lds
    v_mfma_f32_16x16x32_bf16 v[176:179], a[244:247], a[236:239], v[176:179]
    s_waitcnt lgkmcnt(7)
    ds_read_b64_tr_b16 v[220:221], v242 offset:24584
    ds_read_b64_tr_b16 v[222:223], v242 offset:25096
    v_mfma_f32_16x16x32_bf16 v[132:135], a[248:251], a[228:231], v[132:135]
    buffer_load_dwordx4 v241, s[12:15], s46 offen offset:2048 lds
    s_add_u32 m0, s51, 9088
    v_mfma_f32_16x16x32_bf16 v[136:139], a[248:251], a[232:235], v[136:139]
    ds_read_b64_tr_b16 a[240:241], v243 offset:24576
    ds_read_b64_tr_b16 a[242:243], v243 offset:25088
    v_mfma_f32_16x16x32_bf16 v[140:143], a[248:251], a[236:239], v[140:143]
    s_waitcnt lgkmcnt(9)
    buffer_load_dwordx4 v240, s[12:15], s46 offen offset:128 lds
    v_mfma_f32_16x16x32_bf16 v[180:183], a[252:255], a[228:231], v[180:183]
    ds_read_b64_tr_b16 a[244:245], v243 offset:24584
    ds_read_b64_tr_b16 a[246:247], v243 offset:25096
    v_mfma_f32_16x16x32_bf16 v[184:187], a[252:255], a[232:235], v[184:187]
    ds_read_b64_tr_b16 a[248:249], v242 offset:25600
    ds_read_b64_tr_b16 a[250:251], v242 offset:26112
    v_mfma_f32_16x16x32_bf16 v[188:191], a[252:255], a[236:239], v[188:191]
    s_waitcnt lgkmcnt(10)
    buffer_load_dwordx4 v241, s[12:15], s46 offen offset:2176 lds
    v_mfma_f32_16x16x32_bf16 v[96:99], v[216:219], v[192:195], v[96:99]
    s_waitcnt lgkmcnt(9)
    ds_read_b64_tr_b16 a[252:253], v242 offset:25608
    ds_read_b64_tr_b16 a[254:255], v242 offset:26120
    v_mfma_f32_16x16x32_bf16 v[100:103], v[216:219], v[196:199], v[100:103]
    s_waitcnt lgkmcnt(10)
    ds_read_b128 a[216:219], v245
    ds_read_b128 a[220:223], v245 offset:2048
    v_mfma_f32_16x16x32_bf16 v[104:107], v[216:219], v[200:203], v[104:107]
    s_waitcnt lgkmcnt(10)
    ds_read_b128 a[224:227], v245 offset:4096
    ds_read_b64_tr_b16 v[216:217], v243 offset:25600
    v_mfma_f32_16x16x32_bf16 v[144:147], v[220:223], v[192:195], v[144:147]
    s_add_u32 s46, s46, 262144
    ds_read_b64_tr_b16 v[218:219], v243 offset:26112
    v_mul_f32 v57, v250, v57
    v_mfma_f32_16x16x32_bf16 v[148:151], v[220:223], v[196:199], v[148:151]
    v_mul_f32 v58, v250, v58
    v_mul_f32 v59, v250, v59
    v_mfma_f32_16x16x32_bf16 v[152:155], v[220:223], v[200:203], v[152:155]
    s_waitcnt lgkmcnt(11)
    ds_read_b64_tr_b16 v[220:221], v243 offset:25608
    ds_read_b64_tr_b16 v[222:223], v243 offset:26120
    v_mfma_f32_16x16x32_bf16 v[108:111], a[240:243], v[192:195], v[108:111]
    v_mul_f32 v68, v250, v68
    v_mul_f32 v69, v250, v69
    v_mfma_f32_16x16x32_bf16 v[112:115], a[240:243], v[196:199], v[112:115]
    v_mul_f32 v70, v250, v70
    v_mul_f32 v71, v250, v71
    v_mfma_f32_16x16x32_bf16 v[116:119], a[240:243], v[200:203], v[116:119]
    s_waitcnt lgkmcnt(11)
    v_cvt_pk_bf16_f32 v56, v56, v57
    v_mul_f32 v72, v248, v72
    v_mfma_f32_16x16x32_bf16 v[156:159], a[244:247], v[192:195], v[156:159]
    v_cvt_pk_bf16_f32 v57, v58, v59
    v_mul_f32 v73, v248, v73
    v_mfma_f32_16x16x32_bf16 v[160:163], a[244:247], v[196:199], v[160:163]
    v_cvt_pk_bf16_f32 v58, v68, v69
    v_cvt_pk_bf16_f32 v59, v70, v71
    v_mfma_f32_16x16x32_bf16 v[164:167], a[244:247], v[200:203], v[164:167]
    s_waitcnt lgkmcnt(9)
    v_mul_f32 v74, v248, v74
    v_mul_f32 v75, v248, v75
    v_mfma_f32_16x16x32_bf16 v[120:123], a[248:251], v[192:195], v[120:123]
    v_mul_f32 v84, v248, v84
    v_mul_f32 v85, v248, v85
    v_mfma_f32_16x16x32_bf16 v[124:127], a[248:251], v[196:199], v[124:127]
    s_waitcnt vmcnt(11) lgkmcnt(4)
    s_barrier
    ds_read_b64_tr_b16 a[240:241], v242 offset:32768
    v_mfma_f32_16x16x32_bf16 v[128:131], a[248:251], v[200:203], v[128:131]
    s_add_u32 m0, s51, 16384
    ds_read_b64_tr_b16 a[242:243], v242 offset:33280
    ds_read_b64_tr_b16 a[244:245], v242 offset:32776
    v_mfma_f32_16x16x32_bf16 v[168:171], a[252:255], v[192:195], v[168:171]
    buffer_load_dwordx4 v240, s[12:15], s46 offen lds
    v_mfma_f32_16x16x32_bf16 v[172:175], a[252:255], v[196:199], v[172:175]
    ds_read_b64_tr_b16 a[246:247], v242 offset:33288
    ds_read_b64_tr_b16 a[248:249], v243 offset:32768
    v_mfma_f32_16x16x32_bf16 v[176:179], a[252:255], v[200:203], v[176:179]
    s_waitcnt lgkmcnt(7)
    buffer_load_dwordx4 v241, s[12:15], s46 offen offset:2048 lds
    v_mfma_f32_16x16x32_bf16 v[132:135], v[216:219], v[192:195], v[132:135]
    s_add_u32 m0, s51, 17280
    ds_write_b128 v246, v[0:3]
    v_mfma_f32_16x16x32_bf16 v[136:139], v[216:219], v[196:199], v[136:139]
    ds_read_b64_tr_b16 a[250:251], v243 offset:33280
    ds_read_b64_tr_b16 a[252:253], v243 offset:32776
    v_mfma_f32_16x16x32_bf16 v[140:143], v[216:219], v[200:203], v[140:143]
    s_waitcnt lgkmcnt(8)
    ds_write_b128 v246, v[4:7] offset:1024
    v_mfma_f32_16x16x32_bf16 v[180:183], v[220:223], v[192:195], v[180:183]
    buffer_load_dwordx4 v240, s[12:15], s46 offen offset:128 lds
    v_mfma_f32_16x16x32_bf16 v[184:187], v[220:223], v[196:199], v[184:187]
    ds_write_b128 v246, v[8:11] offset:2048
    v_mfma_f32_16x16x32_bf16 v[188:191], v[220:223], v[200:203], v[188:191]
    s_waitcnt lgkmcnt(8)
    ds_read_b64_tr_b16 a[254:255], v243 offset:33288
    ds_read_b64_tr_b16 v[216:217], v242 offset:33792
    v_mfma_f32_16x16x32_bf16 v[96:99], a[240:243], a[216:219], v[96:99]
    buffer_load_dwordx4 v241, s[12:15], s46 offen offset:2176 lds
    s_add_u32 m0, s52, 130304
    v_mfma_f32_16x16x32_bf16 v[100:103], a[240:243], a[220:223], v[100:103]
    s_add_u32 s46, s46, 262144
    ds_read_b64_tr_b16 v[218:219], v242 offset:34304
    ds_read_b64_tr_b16 v[220:221], v242 offset:33800
    v_mfma_f32_16x16x32_bf16 v[104:107], a[240:243], a[224:227], v[104:107]
    s_waitcnt lgkmcnt(10)
    buffer_load_dwordx4 v239, s[16:19], s47 offen offset:768 lds
    v_mfma_f32_16x16x32_bf16 v[144:147], a[244:247], a[216:219], v[144:147]
    s_add_u32 m0, s52, 134400
    ds_read_b64_tr_b16 v[222:223], v242 offset:34312
    ds_read_b64_tr_b16 a[240:241], v243 offset:33792
    v_mfma_f32_16x16x32_bf16 v[148:151], a[244:247], a[220:223], v[148:151]
    ds_read_b64_tr_b16 a[242:243], v243 offset:34304
    v_mul_f32 v86, v248, v86
    v_mfma_f32_16x16x32_bf16 v[152:155], a[244:247], a[224:227], v[152:155]
    s_waitcnt lgkmcnt(10)
    buffer_load_dwordx4 v239, s[16:19], s48 offen offset:768 lds
    v_mfma_f32_16x16x32_bf16 v[108:111], a[248:251], a[216:219], v[108:111]
    s_add_u32 m0, s52, 138496
    ds_read_b64_tr_b16 a[244:245], v243 offset:33800
    ds_read_b64_tr_b16 a[246:247], v243 offset:34312
    v_mfma_f32_16x16x32_bf16 v[112:115], a[248:251], a[220:223], v[112:115]
    v_mul_f32 v87, v248, v87
    v_cvt_pk_bf16_f32 v72, v72, v73
    v_mfma_f32_16x16x32_bf16 v[116:119], a[248:251], a[224:227], v[116:119]
    s_waitcnt lgkmcnt(8)
    buffer_load_dwordx4 v239, s[16:19], s49 offen offset:768 lds
    v_mfma_f32_16x16x32_bf16 v[156:159], a[252:255], a[216:219], v[156:159]
    v_cvt_pk_bf16_f32 v73, v74, v75
    v_mul_f32 v76, v249, v76
    v_mfma_f32_16x16x32_bf16 v[160:163], a[252:255], a[220:223], v[160:163]
    v_cvt_pk_bf16_f32 v74, v84, v85
    v_cvt_pk_bf16_f32 v75, v86, v87
    v_mfma_f32_16x16x32_bf16 v[164:167], a[252:255], a[224:227], v[164:167]
    s_waitcnt lgkmcnt(6)
    v_mul_f32 v77, v249, v77
    v_mul_f32 v78, v249, v78
    v_mfma_f32_16x16x32_bf16 v[120:123], v[216:219], a[216:219], v[120:123]
    v_mul_f32 v79, v249, v79
    v_mul_f32 v88, v249, v88
    v_mfma_f32_16x16x32_bf16 v[124:127], v[216:219], a[220:223], v[124:127]
    s_waitcnt vmcnt(11)
    s_barrier
    ds_read_b128 a[228:231], v244 offset:12288
    v_mfma_f32_16x16x32_bf16 v[128:131], v[216:219], a[224:227], v[128:131]
    s_waitcnt lgkmcnt(5)
    ds_read_b64_tr_b16 a[248:249], v242
    ds_read_b64_tr_b16 a[250:251], v242 offset:512
    v_mfma_f32_16x16x32_bf16 v[168:171], v[220:223], a[216:219], v[168:171]
    s_add_u32 m0, s51, 24576
    ds_read_b128 a[232:235], v244 offset:14336
    ds_read_b128 a[236:239], v244 offset:16384
    v_mfma_f32_16x16x32_bf16 v[172:175], v[220:223], a[220:223], v[172:175]
    buffer_load_dwordx4 v240, s[12:15], s46 offen lds
    v_mfma_f32_16x16x32_bf16 v[176:179], v[220:223], a[224:227], v[176:179]
    s_waitcnt lgkmcnt(7)
    ds_read_b64_tr_b16 a[252:253], v242 offset:8
    ds_read_b64_tr_b16 a[254:255], v242 offset:520
    v_mfma_f32_16x16x32_bf16 v[132:135], a[240:243], a[216:219], v[132:135]
    buffer_load_dwordx4 v241, s[12:15], s46 offen offset:2048 lds
    s_add_u32 m0, s51, 25472
    v_mfma_f32_16x16x32_bf16 v[136:139], a[240:243], a[220:223], v[136:139]
    ds_read_b64_tr_b16 v[216:217], v243
    ds_read_b64_tr_b16 v[218:219], v243 offset:512
    v_mfma_f32_16x16x32_bf16 v[140:143], a[240:243], a[224:227], v[140:143]
    s_waitcnt lgkmcnt(9)
    buffer_load_dwordx4 v240, s[12:15], s46 offen offset:128 lds
    v_mfma_f32_16x16x32_bf16 v[180:183], a[244:247], a[216:219], v[180:183]
    ds_read_b64_tr_b16 v[220:221], v243 offset:8
    ds_read_b64_tr_b16 v[222:223], v243 offset:520
    v_mfma_f32_16x16x32_bf16 v[184:187], a[244:247], a[220:223], v[184:187]
    ds_read_b64_tr_b16 a[240:241], v242 offset:1024
    ds_read_b64_tr_b16 a[242:243], v242 offset:1536
    v_mfma_f32_16x16x32_bf16 v[188:191], a[244:247], a[224:227], v[188:191]
    s_waitcnt lgkmcnt(10)
    buffer_load_dwordx4 v241, s[12:15], s46 offen offset:2176 lds
    v_mfma_f32_16x16x32_bf16 v[96:99], a[248:251], a[228:231], v[96:99]
    s_waitcnt lgkmcnt(9)
    ds_read_b64_tr_b16 a[244:245], v242 offset:1032
    ds_read_b64_tr_b16 a[246:247], v242 offset:1544
    v_mfma_f32_16x16x32_bf16 v[100:103], a[248:251], a[232:235], v[100:103]
    s_waitcnt lgkmcnt(10)
    ds_read_b128 v[192:195], v245 offset:12288
    ds_read_b128 v[196:199], v245 offset:14336
    v_mfma_f32_16x16x32_bf16 v[104:107], a[248:251], a[236:239], v[104:107]
    s_waitcnt lgkmcnt(10)
    ds_read_b128 v[200:203], v245 offset:16384
    ds_read_b64_tr_b16 a[248:249], v243 offset:1024
    v_mfma_f32_16x16x32_bf16 v[144:147], a[252:255], a[228:231], v[144:147]
    s_add_u32 s46, s46, 262144
    ds_read_b64_tr_b16 a[250:251], v243 offset:1536
    v_mul_f32 v89, v249, v89
    v_mfma_f32_16x16x32_bf16 v[148:151], a[252:255], a[232:235], v[148:151]
    v_mul_f32 v90, v249, v90
    v_mul_f32 v91, v249, v91
    v_mfma_f32_16x16x32_bf16 v[152:155], a[252:255], a[236:239], v[152:155]
    s_waitcnt lgkmcnt(11)
    ds_read_b64_tr_b16 a[252:253], v243 offset:1032
    ds_read_b64_tr_b16 a[254:255], v243 offset:1544
    v_mfma_f32_16x16x32_bf16 v[108:111], v[216:219], a[228:231], v[108:111]
    v_cvt_pk_bf16_f32 v76, v76, v77
    v_mul_f32 v80, v250, v80
    v_mfma_f32_16x16x32_bf16 v[112:115], v[216:219], a[232:235], v[112:115]
    v_cvt_pk_bf16_f32 v77, v78, v79
    v_mul_f32 v81, v250, v81
    v_mfma_f32_16x16x32_bf16 v[116:119], v[216:219], a[236:239], v[116:119]
    s_waitcnt lgkmcnt(11)
    v_cvt_pk_bf16_f32 v78, v88, v89
    v_cvt_pk_bf16_f32 v79, v90, v91
    v_mfma_f32_16x16x32_bf16 v[156:159], v[220:223], a[228:231], v[156:159]
    v_mul_f32 v82, v250, v82
    v_mul_f32 v83, v250, v83
    v_mfma_f32_16x16x32_bf16 v[160:163], v[220:223], a[232:235], v[160:163]
    v_mul_f32 v92, v250, v92
    v_mul_f32 v93, v250, v93
    v_mfma_f32_16x16x32_bf16 v[164:167], v[220:223], a[236:239], v[164:167]
    s_waitcnt lgkmcnt(9)
    v_mul_f32 v94, v250, v94
    v_mul_f32 v95, v250, v95
    v_mfma_f32_16x16x32_bf16 v[120:123], a[240:243], a[228:231], v[120:123]
    v_cvt_pk_bf16_f32 v80, v80, v81
    v_mfma_f32_16x16x32_bf16 v[124:127], a[240:243], a[232:235], v[124:127]
    s_waitcnt vmcnt(11) lgkmcnt(4)
    s_barrier
    ds_read_b64_tr_b16 v[216:217], v242 offset:8192
    v_mfma_f32_16x16x32_bf16 v[128:131], a[240:243], a[236:239], v[128:131]
    s_add_u32 m0, s51, 32768
    ds_read_b64_tr_b16 v[218:219], v242 offset:8704
    ds_read_b64_tr_b16 v[220:221], v242 offset:8200
    v_mfma_f32_16x16x32_bf16 v[168:171], a[244:247], a[228:231], v[168:171]
    s_add_u32 s54, s56, 0
    buffer_load_dwordx4 v240, s[12:15], s46 offen lds
    v_mfma_f32_16x16x32_bf16 v[172:175], a[244:247], a[232:235], v[172:175]
    ds_read_b64_tr_b16 v[222:223], v242 offset:8712
    ds_read_b64_tr_b16 a[240:241], v243 offset:8192
    v_mfma_f32_16x16x32_bf16 v[176:179], a[244:247], a[236:239], v[176:179]
    s_waitcnt lgkmcnt(7)
    buffer_load_dwordx4 v241, s[12:15], s46 offen offset:2048 lds
    v_mfma_f32_16x16x32_bf16 v[132:135], a[248:251], a[228:231], v[132:135]
    s_add_u32 m0, s51, 33664
    ds_read_b64_tr_b16 a[242:243], v243 offset:8704
    ds_read_b64_tr_b16 a[244:245], v243 offset:8200
    v_mfma_f32_16x16x32_bf16 v[136:139], a[248:251], a[232:235], v[136:139]
    ds_read_b64_tr_b16 a[246:247], v243 offset:8712
    v_cvt_pk_bf16_f32 v81, v82, v83
    v_mfma_f32_16x16x32_bf16 v[140:143], a[248:251], a[236:239], v[140:143]
    s_waitcnt lgkmcnt(8)
    buffer_load_dwordx4 v240, s[12:15], s46 offen offset:128 lds
    v_mfma_f32_16x16x32_bf16 v[180:183], a[252:255], a[228:231], v[180:183]
    ds_read_b64_tr_b16 a[248:249], v242 offset:9216
    ds_read_b64_tr_b16 a[250:251], v242 offset:9728
    v_mfma_f32_16x16x32_bf16 v[184:187], a[252:255], a[232:235], v[184:187]
    v_cvt_pk_bf16_f32 v82, v92, v93
    v_cvt_pk_bf16_f32 v83, v94, v95
    v_mfma_f32_16x16x32_bf16 v[188:191], a[252:255], a[236:239], v[188:191]
    s_waitcnt lgkmcnt(8)
    buffer_load_dwordx4 v241, s[12:15], s46 offen offset:2176 lds
    v_mfma_f32_16x16x32_bf16 v[96:99], v[216:219], v[192:195], v[96:99]
    s_add_u32 m0, s52, 142464
    ds_read_b64_tr_b16 a[252:253], v242 offset:9224
    ds_read_b64_tr_b16 a[254:255], v242 offset:9736
    v_mfma_f32_16x16x32_bf16 v[100:103], v[216:219], v[196:199], v[100:103]
    s_add_u32 s46, s46, 262144
    v_mfma_f32_16x16x32_bf16 v[104:107], v[216:219], v[200:203], v[104:107]
    s_waitcnt lgkmcnt(8)
    buffer_load_dwordx4 v239, s[16:19], s47 offen offset:896 lds
    v_mfma_f32_16x16x32_bf16 v[144:147], v[220:223], v[192:195], v[144:147]
    s_add_u32 m0, s52, 146560
    ds_read_b64_tr_b16 v[216:217], v243 offset:9216
    ds_read_b64_tr_b16 v[218:219], v243 offset:9728
    v_mfma_f32_16x16x32_bf16 v[148:151], v[220:223], v[196:199], v[148:151]
    v_mfma_f32_16x16x32_bf16 v[152:155], v[220:223], v[200:203], v[152:155]
    s_waitcnt lgkmcnt(8)
    buffer_load_dwordx4 v239, s[16:19], s48 offen offset:896 lds
    v_mfma_f32_16x16x32_bf16 v[108:111], a[240:243], v[192:195], v[108:111]
    s_add_u32 m0, s52, 150656
    ds_read_b64_tr_b16 v[220:221], v243 offset:9224
    ds_read_b64_tr_b16 v[222:223], v243 offset:9736
    v_mfma_f32_16x16x32_bf16 v[112:115], a[240:243], v[196:199], v[112:115]
    v_mfma_f32_16x16x32_bf16 v[116:119], a[240:243], v[200:203], v[116:119]
    s_waitcnt lgkmcnt(8)
    buffer_load_dwordx4 v239, s[16:19], s49 offen offset:896 lds
    v_mfma_f32_16x16x32_bf16 v[156:159], a[244:247], v[192:195], v[156:159]
    s_add_u32 m0, s52, 155648
    v_mfma_f32_16x16x32_bf16 v[160:163], a[244:247], v[196:199], v[160:163]
    v_mfma_f32_16x16x32_bf16 v[164:167], a[244:247], v[200:203], v[164:167]
    s_waitcnt lgkmcnt(6)
    buffer_load_dwordx4 v239, s[20:23], s54 offen lds
    v_mfma_f32_16x16x32_bf16 v[120:123], a[248:251], v[192:195], v[120:123]
    s_add_u32 s54, s57, 0
    s_add_u32 m0, s52, 159744
    v_mfma_f32_16x16x32_bf16 v[124:127], a[248:251], v[196:199], v[124:127]
    s_waitcnt vmcnt(12)
    s_barrier
    ds_read_b128 a[216:219], v244
    v_mfma_f32_16x16x32_bf16 v[128:131], a[248:251], v[200:203], v[128:131]
    s_waitcnt lgkmcnt(5)
    ds_read_b64_tr_b16 a[240:241], v242 offset:16384
    ds_read_b64_tr_b16 a[242:243], v242 offset:16896
    v_mfma_f32_16x16x32_bf16 v[168:171], a[252:255], v[192:195], v[168:171]
    buffer_load_dwordx4 v239, s[20:23], s54 offen lds
    s_add_u32 m0, s51, 0
    v_mfma_f32_16x16x32_bf16 v[172:175], a[252:255], v[196:199], v[172:175]
    ds_read_b128 a[220:223], v244 offset:2048
    ds_read_b128 a[224:227], v244 offset:4096
    v_mfma_f32_16x16x32_bf16 v[176:179], a[252:255], v[200:203], v[176:179]
    s_waitcnt lgkmcnt(7)
    ds_read_b64_tr_b16 a[244:245], v242 offset:16392
    ds_read_b64_tr_b16 a[246:247], v242 offset:16904
    v_mfma_f32_16x16x32_bf16 v[132:135], v[216:219], v[192:195], v[132:135]
    buffer_load_dwordx4 v240, s[12:15], s46 offen lds
    v_mfma_f32_16x16x32_bf16 v[136:139], v[216:219], v[196:199], v[136:139]
    ds_read_b64_tr_b16 a[248:249], v243 offset:16384
    ds_read_b64_tr_b16 a[250:251], v243 offset:16896
    v_mfma_f32_16x16x32_bf16 v[140:143], v[216:219], v[200:203], v[140:143]
    s_waitcnt lgkmcnt(9)
    buffer_load_dwordx4 v241, s[12:15], s46 offen offset:2048 lds
    v_mfma_f32_16x16x32_bf16 v[180:183], v[220:223], v[192:195], v[180:183]
    s_add_u32 m0, s51, 896
    ds_read_b64_tr_b16 a[252:253], v243 offset:16392
    ds_read_b64_tr_b16 a[254:255], v243 offset:16904
    v_mfma_f32_16x16x32_bf16 v[184:187], v[220:223], v[196:199], v[184:187]
    ds_read_b64_tr_b16 v[216:217], v242 offset:17408
    ds_read_b64_tr_b16 v[218:219], v242 offset:17920
    v_mfma_f32_16x16x32_bf16 v[188:191], v[220:223], v[200:203], v[188:191]
    s_waitcnt lgkmcnt(10)
    buffer_load_dwordx4 v240, s[12:15], s46 offen offset:128 lds
    v_mfma_f32_16x16x32_bf16 v[96:99], a[240:243], a[216:219], v[96:99]
    s_waitcnt lgkmcnt(9)
    ds_read_b64_tr_b16 v[220:221], v242 offset:17416
    ds_read_b64_tr_b16 v[222:223], v242 offset:17928
    v_mfma_f32_16x16x32_bf16 v[100:103], a[240:243], a[220:223], v[100:103]
    s_waitcnt lgkmcnt(10)
    ds_read_b128 a[228:231], v245
    ds_read_b128 a[232:235], v245 offset:2048
    v_mfma_f32_16x16x32_bf16 v[104:107], a[240:243], a[224:227], v[104:107]
    s_waitcnt lgkmcnt(10)
    buffer_load_dwordx4 v241, s[12:15], s46 offen offset:2176 lds
    v_mfma_f32_16x16x32_bf16 v[144:147], a[244:247], a[216:219], v[144:147]
    s_add_u32 s46, s46, 262144
    ds_read_b128 a[236:239], v245 offset:4096
    ds_read_b64_tr_b16 a[240:241], v243 offset:17408
    v_mfma_f32_16x16x32_bf16 v[148:151], a[244:247], a[220:223], v[148:151]
    ds_read_b64_tr_b16 a[242:243], v243 offset:17920
    v_mfma_f32_16x16x32_bf16 v[152:155], a[244:247], a[224:227], v[152:155]
    s_waitcnt lgkmcnt(11)
    ds_read_b64_tr_b16 a[244:245], v243 offset:17416
    ds_read_b64_tr_b16 a[246:247], v243 offset:17928
    v_mfma_f32_16x16x32_bf16 v[108:111], a[248:251], a[216:219], v[108:111]
    v_mfma_f32_16x16x32_bf16 v[112:115], a[248:251], a[220:223], v[112:115]
    v_mfma_f32_16x16x32_bf16 v[116:119], a[248:251], a[224:227], v[116:119]
    s_waitcnt lgkmcnt(11)
    v_mfma_f32_16x16x32_bf16 v[156:159], a[252:255], a[216:219], v[156:159]
    v_mfma_f32_16x16x32_bf16 v[160:163], a[252:255], a[220:223], v[160:163]
    v_mfma_f32_16x16x32_bf16 v[164:167], a[252:255], a[224:227], v[164:167]
    s_waitcnt lgkmcnt(9)
    v_mfma_f32_16x16x32_bf16 v[120:123], v[216:219], a[216:219], v[120:123]
    v_mfma_f32_16x16x32_bf16 v[124:127], v[216:219], a[220:223], v[124:127]
    s_waitcnt vmcnt(13) lgkmcnt(4)
    s_barrier
    ds_read_b64_tr_b16 a[248:249], v242 offset:24576
    v_mfma_f32_16x16x32_bf16 v[128:131], v[216:219], a[224:227], v[128:131]
    s_add_u32 m0, s51, 8192
    ds_read_b64_tr_b16 a[250:251], v242 offset:25088
    ds_read_b64_tr_b16 a[252:253], v242 offset:24584
    v_mfma_f32_16x16x32_bf16 v[168:171], v[220:223], a[216:219], v[168:171]
    buffer_load_dwordx4 v240, s[12:15], s46 offen lds
    v_mfma_f32_16x16x32_bf16 v[172:175], v[220:223], a[220:223], v[172:175]
    ds_read_b64_tr_b16 a[254:255], v242 offset:25096
    ds_read_b64_tr_b16 v[216:217], v243 offset:24576
    v_mfma_f32_16x16x32_bf16 v[176:179], v[220:223], a[224:227], v[176:179]
    s_waitcnt lgkmcnt(7)
    buffer_load_dwordx4 v241, s[12:15], s46 offen offset:2048 lds
    v_mfma_f32_16x16x32_bf16 v[132:135], a[240:243], a[216:219], v[132:135]
    s_add_u32 m0, s51, 9088
    ds_read_b64_tr_b16 v[218:219], v243 offset:25088
    ds_read_b64_tr_b16 v[220:221], v243 offset:24584
    v_mfma_f32_16x16x32_bf16 v[136:139], a[240:243], a[220:223], v[136:139]
    ds_read_b64_tr_b16 v[222:223], v243 offset:25096
    v_mfma_f32_16x16x32_bf16 v[140:143], a[240:243], a[224:227], v[140:143]
    s_waitcnt lgkmcnt(8)
    buffer_load_dwordx4 v240, s[12:15], s46 offen offset:128 lds
    v_mfma_f32_16x16x32_bf16 v[180:183], a[244:247], a[216:219], v[180:183]
    ds_read_b64_tr_b16 a[240:241], v242 offset:25600
    ds_read_b64_tr_b16 a[242:243], v242 offset:26112
    v_mfma_f32_16x16x32_bf16 v[184:187], a[244:247], a[220:223], v[184:187]
    v_mfma_f32_16x16x32_bf16 v[188:191], a[244:247], a[224:227], v[188:191]
    s_waitcnt lgkmcnt(8)
    buffer_load_dwordx4 v241, s[12:15], s46 offen offset:2176 lds
    v_mfma_f32_16x16x32_bf16 v[96:99], a[248:251], a[228:231], v[96:99]
    s_add_u32 m0, s52, 130048
    ds_read_b64_tr_b16 a[244:245], v242 offset:25608
    ds_read_b64_tr_b16 a[246:247], v242 offset:26120
    v_mfma_f32_16x16x32_bf16 v[100:103], a[248:251], a[232:235], v[100:103]
    s_add_u32 s46, s46, 262144
    v_mfma_f32_16x16x32_bf16 v[104:107], a[248:251], a[236:239], v[104:107]
    s_waitcnt lgkmcnt(8)
    buffer_load_dwordx4 v239, s[16:19], s47 offen offset:1024 lds
    v_mfma_f32_16x16x32_bf16 v[144:147], a[252:255], a[228:231], v[144:147]
    s_add_u32 m0, s52, 134144
    ds_read_b64_tr_b16 a[248:249], v243 offset:25600
    ds_read_b64_tr_b16 a[250:251], v243 offset:26112
    v_mfma_f32_16x16x32_bf16 v[148:151], a[252:255], a[232:235], v[148:151]
    v_mfma_f32_16x16x32_bf16 v[152:155], a[252:255], a[236:239], v[152:155]
    s_waitcnt lgkmcnt(8)
    buffer_load_dwordx4 v239, s[16:19], s48 offen offset:1024 lds
    v_mfma_f32_16x16x32_bf16 v[108:111], v[216:219], a[228:231], v[108:111]
    s_add_u32 m0, s52, 138240
    ds_read_b64_tr_b16 a[252:253], v243 offset:25608
    ds_read_b64_tr_b16 a[254:255], v243 offset:26120
    v_mfma_f32_16x16x32_bf16 v[112:115], v[216:219], a[232:235], v[112:115]
    v_mfma_f32_16x16x32_bf16 v[116:119], v[216:219], a[236:239], v[116:119]
    s_waitcnt lgkmcnt(8)
    buffer_load_dwordx4 v239, s[16:19], s49 offen offset:1024 lds
    v_mfma_f32_16x16x32_bf16 v[156:159], v[220:223], a[228:231], v[156:159]
    v_mfma_f32_16x16x32_bf16 v[160:163], v[220:223], a[232:235], v[160:163]
    v_mfma_f32_16x16x32_bf16 v[164:167], v[220:223], a[236:239], v[164:167]
    s_waitcnt lgkmcnt(6)
    v_mfma_f32_16x16x32_bf16 v[120:123], a[240:243], a[228:231], v[120:123]
    v_mfma_f32_16x16x32_bf16 v[124:127], a[240:243], a[232:235], v[124:127]
    s_waitcnt vmcnt(13)
    s_barrier
    ds_read_b128 v[192:195], v244 offset:12288
    v_mfma_f32_16x16x32_bf16 v[128:131], a[240:243], a[236:239], v[128:131]
    s_waitcnt lgkmcnt(5)
    ds_read_b64_tr_b16 v[216:217], v242 offset:32768
    ds_read_b64_tr_b16 v[218:219], v242 offset:33280
    v_mfma_f32_16x16x32_bf16 v[168:171], a[244:247], a[228:231], v[168:171]
    s_add_u32 m0, s51, 16384
    ds_read_b128 v[196:199], v244 offset:14336
    ds_read_b128 v[200:203], v244 offset:16384
    v_mfma_f32_16x16x32_bf16 v[172:175], a[244:247], a[232:235], v[172:175]
    buffer_load_dwordx4 v240, s[12:15], s46 offen lds
    v_mfma_f32_16x16x32_bf16 v[176:179], a[244:247], a[236:239], v[176:179]
    s_waitcnt lgkmcnt(7)
    ds_read_b64_tr_b16 v[220:221], v242 offset:32776
    ds_read_b64_tr_b16 v[222:223], v242 offset:33288
    v_mfma_f32_16x16x32_bf16 v[132:135], a[248:251], a[228:231], v[132:135]
    buffer_load_dwordx4 v241, s[12:15], s46 offen offset:2048 lds
    s_add_u32 m0, s51, 17280
    v_mfma_f32_16x16x32_bf16 v[136:139], a[248:251], a[232:235], v[136:139]
    ds_read_b64_tr_b16 a[240:241], v243 offset:32768
    ds_read_b64_tr_b16 a[242:243], v243 offset:33280
    v_mfma_f32_16x16x32_bf16 v[140:143], a[248:251], a[236:239], v[140:143]
    s_waitcnt lgkmcnt(9)
    buffer_load_dwordx4 v240, s[12:15], s46 offen offset:128 lds
    v_mfma_f32_16x16x32_bf16 v[180:183], a[252:255], a[228:231], v[180:183]
    ds_read_b64_tr_b16 a[244:245], v243 offset:32776
    ds_read_b64_tr_b16 a[246:247], v243 offset:33288
    v_mfma_f32_16x16x32_bf16 v[184:187], a[252:255], a[232:235], v[184:187]
    ds_read_b64_tr_b16 a[248:249], v242 offset:33792
    ds_read_b64_tr_b16 a[250:251], v242 offset:34304
    v_mfma_f32_16x16x32_bf16 v[188:191], a[252:255], a[236:239], v[188:191]
    s_waitcnt lgkmcnt(10)
    buffer_load_dwordx4 v241, s[12:15], s46 offen offset:2176 lds
    v_mfma_f32_16x16x32_bf16 v[96:99], v[216:219], v[192:195], v[96:99]
    s_waitcnt lgkmcnt(9)
    ds_read_b64_tr_b16 a[252:253], v242 offset:33800
    ds_read_b64_tr_b16 a[254:255], v242 offset:34312
    v_mfma_f32_16x16x32_bf16 v[100:103], v[216:219], v[196:199], v[100:103]
    s_waitcnt lgkmcnt(10)
    ds_read_b128 a[216:219], v245 offset:12288
    ds_read_b128 a[220:223], v245 offset:14336
    v_mfma_f32_16x16x32_bf16 v[104:107], v[216:219], v[200:203], v[104:107]
    s_waitcnt lgkmcnt(10)
    ds_read_b128 a[224:227], v245 offset:16384
    ds_read_b64_tr_b16 v[216:217], v243 offset:33792
    v_mfma_f32_16x16x32_bf16 v[144:147], v[220:223], v[192:195], v[144:147]
    s_sub_u32 s46, s46, 4455936
    ds_read_b64_tr_b16 v[218:219], v243 offset:34304
    v_mov_b32 v224, 0
    v_mfma_f32_16x16x32_bf16 v[148:151], v[220:223], v[196:199], v[148:151]
    v_mov_b32 v225, 0
    v_mov_b32 v226, 0
    v_mfma_f32_16x16x32_bf16 v[152:155], v[220:223], v[200:203], v[152:155]
    s_waitcnt lgkmcnt(11)
    ds_read_b64_tr_b16 v[220:221], v243 offset:33800
    ds_read_b64_tr_b16 v[222:223], v243 offset:34312
    v_mfma_f32_16x16x32_bf16 v[108:111], a[240:243], v[192:195], v[108:111]
    v_mfma_f32_16x16x32_bf16 v[112:115], a[240:243], v[196:199], v[112:115]
    v_mfma_f32_16x16x32_bf16 v[116:119], a[240:243], v[200:203], v[116:119]
    s_waitcnt lgkmcnt(11)
    v_mfma_f32_16x16x32_bf16 v[156:159], a[244:247], v[192:195], v[156:159]
    v_mfma_f32_16x16x32_bf16 v[160:163], a[244:247], v[196:199], v[160:163]
    v_mfma_f32_16x16x32_bf16 v[164:167], a[244:247], v[200:203], v[164:167]
    s_waitcnt lgkmcnt(9)
    v_mfma_f32_16x16x32_bf16 v[120:123], a[248:251], v[192:195], v[120:123]
    v_mfma_f32_16x16x32_bf16 v[124:127], a[248:251], v[196:199], v[124:127]
    s_waitcnt vmcnt(11) lgkmcnt(4)
    s_barrier
    ds_read_b64_tr_b16 a[240:241], v242
    v_mfma_f32_16x16x32_bf16 v[128:131], a[248:251], v[200:203], v[128:131]
    s_add_u32 s54, s58, 0
    ds_read_b64_tr_b16 a[242:243], v242 offset:512
    ds_read_b64_tr_b16 a[244:245], v242 offset:8
    v_mfma_f32_16x16x32_bf16 v[168:171], a[252:255], v[192:195], v[168:171]
    s_add_u32 m0, s52, 143360
    ds_read_b64_tr_b16 a[246:247], v242 offset:520
    ds_read_b64_tr_b16 a[248:249], v243
    v_mfma_f32_16x16x32_bf16 v[172:175], a[252:255], v[196:199], v[172:175]
    buffer_load_dwordx4 v239, s[20:23], s54 offen lds
    s_add_u32 s54, s59, 0
    v_mfma_f32_16x16x32_bf16 v[176:179], a[252:255], v[200:203], v[176:179]
    s_waitcnt lgkmcnt(7)
    ds_read_b64_tr_b16 a[250:251], v243 offset:512
    ds_read_b64_tr_b16 a[252:253], v243 offset:8
    v_mfma_f32_16x16x32_bf16 v[132:135], v[216:219], v[192:195], v[132:135]
    s_add_u32 m0, s52, 147456
    ds_read_b64_tr_b16 a[254:255], v243 offset:520
    v_mfma_f32_16x16x32_bf16 v[136:139], v[216:219], v[196:199], v[136:139]
    buffer_load_dwordx4 v239, s[20:23], s54 offen lds
    s_add_u32 s54, s60, 0
    v_mfma_f32_16x16x32_bf16 v[140:143], v[216:219], v[200:203], v[140:143]
    s_waitcnt lgkmcnt(8)
    ds_read_b64_tr_b16 v[216:217], v242 offset:1024
    ds_read_b64_tr_b16 v[218:219], v242 offset:1536
    v_mfma_f32_16x16x32_bf16 v[180:183], v[220:223], v[192:195], v[180:183]
    s_add_u32 m0, s52, 151552
    v_mfma_f32_16x16x32_bf16 v[184:187], v[220:223], v[196:199], v[184:187]
    buffer_load_dwordx4 v239, s[20:23], s54 offen lds
    s_add_u32 m0, s51, 24576
    v_mfma_f32_16x16x32_bf16 v[188:191], v[220:223], v[200:203], v[188:191]
    s_waitcnt lgkmcnt(8)
    buffer_load_dwordx4 v238, s[4:7], s44 offen nt lds
    v_mfma_f32_16x16x32_bf16 v[96:99], a[240:243], a[216:219], v[96:99]
    ds_read_b64_tr_b16 v[220:221], v242 offset:1032
    ds_read_b64_tr_b16 v[222:223], v242 offset:1544
    v_mfma_f32_16x16x32_bf16 v[100:103], a[240:243], a[220:223], v[100:103]
    v_mfma_f32_16x16x32_bf16 v[104:107], a[240:243], a[224:227], v[104:107]
    s_waitcnt lgkmcnt(8)
    buffer_load_dwordx4 v238, s[4:7], s44 offen offset:2048 nt lds
    v_mfma_f32_16x16x32_bf16 v[144:147], a[244:247], a[216:219], v[144:147]
    s_add_u32 m0, s51, 25472
    ds_read_b64_tr_b16 a[240:241], v243 offset:1024
    ds_read_b64_tr_b16 a[242:243], v243 offset:1536
    v_mfma_f32_16x16x32_bf16 v[148:151], a[244:247], a[220:223], v[148:151]
    v_mfma_f32_16x16x32_bf16 v[152:155], a[244:247], a[224:227], v[152:155]
    s_waitcnt lgkmcnt(8)
    buffer_load_dwordx4 v238, s[4:7], s44 offen offset:128 nt lds
    v_mfma_f32_16x16x32_bf16 v[108:111], a[248:251], a[216:219], v[108:111]
    ds_read_b64_tr_b16 a[244:245], v243 offset:1032
    ds_read_b64_tr_b16 a[246:247], v243 offset:1544
    v_mfma_f32_16x16x32_bf16 v[112:115], a[248:251], a[220:223], v[112:115]
    v_mfma_f32_16x16x32_bf16 v[116:119], a[248:251], a[224:227], v[116:119]
    s_waitcnt lgkmcnt(8)
    buffer_load_dwordx4 v238, s[4:7], s44 offen offset:2176 nt lds
    v_mfma_f32_16x16x32_bf16 v[156:159], a[252:255], a[216:219], v[156:159]
    s_add_u32 s44, s44, 8192
    v_mfma_f32_16x16x32_bf16 v[160:163], a[252:255], a[220:223], v[160:163]
    v_mfma_f32_16x16x32_bf16 v[164:167], a[252:255], a[224:227], v[164:167]
    s_waitcnt lgkmcnt(6)
    v_mfma_f32_16x16x32_bf16 v[120:123], v[216:219], a[216:219], v[120:123]
    v_mfma_f32_16x16x32_bf16 v[124:127], v[216:219], a[220:223], v[124:127]
    s_waitcnt vmcnt(11)
    s_barrier
    ds_read_b128 a[228:231], v244
    v_mfma_f32_16x16x32_bf16 v[128:131], v[216:219], a[224:227], v[128:131]
    s_waitcnt lgkmcnt(5)
    ds_read_b64_tr_b16 a[248:249], v242 offset:8192
    ds_read_b64_tr_b16 a[250:251], v242 offset:8704
    v_mfma_f32_16x16x32_bf16 v[168:171], v[220:223], a[216:219], v[168:171]
    s_add_u32 m0, s51, 32768
    ds_read_b128 a[232:235], v244 offset:2048
    ds_read_b128 a[236:239], v244 offset:4096
    v_mfma_f32_16x16x32_bf16 v[172:175], v[220:223], a[220:223], v[172:175]
    buffer_load_dwordx4 v238, s[4:7], s44 offen nt lds
    v_mfma_f32_16x16x32_bf16 v[176:179], v[220:223], a[224:227], v[176:179]
    s_waitcnt lgkmcnt(7)
    ds_read_b64_tr_b16 a[252:253], v242 offset:8200
    ds_read_b64_tr_b16 a[254:255], v242 offset:8712
    v_mfma_f32_16x16x32_bf16 v[132:135], a[240:243], a[216:219], v[132:135]
    buffer_load_dwordx4 v238, s[4:7], s44 offen offset:2048 nt lds
    s_add_u32 m0, s51, 33664
    v_mfma_f32_16x16x32_bf16 v[136:139], a[240:243], a[220:223], v[136:139]
    ds_read_b64_tr_b16 v[216:217], v243 offset:8192
    ds_read_b64_tr_b16 v[218:219], v243 offset:8704
    v_mfma_f32_16x16x32_bf16 v[140:143], a[240:243], a[224:227], v[140:143]
    s_waitcnt lgkmcnt(9)
    buffer_load_dwordx4 v238, s[4:7], s44 offen offset:128 nt lds
    v_mfma_f32_16x16x32_bf16 v[180:183], a[244:247], a[216:219], v[180:183]
    ds_read_b64_tr_b16 v[220:221], v243 offset:8200
    ds_read_b64_tr_b16 v[222:223], v243 offset:8712
    v_mfma_f32_16x16x32_bf16 v[184:187], a[244:247], a[220:223], v[184:187]
    ds_read_b64_tr_b16 a[240:241], v242 offset:9216
    ds_read_b64_tr_b16 a[242:243], v242 offset:9728
    v_mfma_f32_16x16x32_bf16 v[188:191], a[244:247], a[224:227], v[188:191]
    s_waitcnt lgkmcnt(10)
    buffer_load_dwordx4 v238, s[4:7], s44 offen offset:2176 nt lds
    v_mfma_f32_16x16x32_bf16 v[96:99], a[248:251], a[228:231], v[96:99]
    s_waitcnt lgkmcnt(9)
    ds_read_b64_tr_b16 a[244:245], v242 offset:9224
    ds_read_b64_tr_b16 a[246:247], v242 offset:9736
    v_mfma_f32_16x16x32_bf16 v[100:103], a[248:251], a[232:235], v[100:103]
    s_waitcnt lgkmcnt(10)
    ds_read_b128 v[192:195], v245
    ds_read_b128 v[196:199], v245 offset:2048
    v_mfma_f32_16x16x32_bf16 v[104:107], a[248:251], a[236:239], v[104:107]
    s_waitcnt lgkmcnt(10)
    ds_read_b128 v[200:203], v245 offset:4096
    ds_read_b64_tr_b16 a[248:249], v243 offset:9216
    v_mfma_f32_16x16x32_bf16 v[144:147], a[252:255], a[228:231], v[144:147]
    s_add_u32 s44, s44, 8192
    ds_read_b64_tr_b16 a[250:251], v243 offset:9728
    ds_read_b128 a[216:219], v237
    v_mfma_f32_16x16x32_bf16 v[148:151], a[252:255], a[232:235], v[148:151]
    ds_read_b128 a[220:223], v237 offset:1024
    ds_read_b128 a[224:227], v237 offset:2048
    v_mfma_f32_16x16x32_bf16 v[152:155], a[252:255], a[236:239], v[152:155]
    s_waitcnt lgkmcnt(14)
    ds_read_b64_tr_b16 a[252:253], v243 offset:9224
    ds_read_b64_tr_b16 a[254:255], v243 offset:9736
    v_mfma_f32_16x16x32_bf16 v[108:111], v[216:219], a[228:231], v[108:111]
    v_mfma_f32_16x16x32_bf16 v[112:115], v[216:219], a[232:235], v[112:115]
    v_mfma_f32_16x16x32_bf16 v[116:119], v[216:219], a[236:239], v[116:119]
    s_waitcnt lgkmcnt(14)
    v_mfma_f32_16x16x32_bf16 v[156:159], v[220:223], a[228:231], v[156:159]
    v_mfma_f32_16x16x32_bf16 v[160:163], v[220:223], a[232:235], v[160:163]
    v_mfma_f32_16x16x32_bf16 v[164:167], v[220:223], a[236:239], v[164:167]
    s_waitcnt lgkmcnt(12)
    v_mfma_f32_16x16x32_bf16 v[120:123], a[240:243], a[228:231], v[120:123]
    v_mfma_f32_16x16x32_bf16 v[124:127], a[240:243], a[232:235], v[124:127]
    s_waitcnt vmcnt(11) lgkmcnt(7)
    s_barrier
    ds_read_b64_tr_b16 v[216:217], v242 offset:16384
    v_mfma_f32_16x16x32_bf16 v[128:131], a[240:243], a[236:239], v[128:131]
    s_add_u32 s54, s61, 0
    ds_read_b64_tr_b16 v[218:219], v242 offset:16896
    ds_read_b64_tr_b16 v[220:221], v242 offset:16392
    v_mfma_f32_16x16x32_bf16 v[168:171], a[244:247], a[228:231], v[168:171]
    s_add_u32 m0, s52, 131072
    ds_read_b64_tr_b16 v[222:223], v242 offset:16904
    ds_read_b64_tr_b16 a[240:241], v243 offset:16384
    v_mfma_f32_16x16x32_bf16 v[172:175], a[244:247], a[232:235], v[172:175]
    buffer_load_dwordx4 v239, s[20:23], s54 offen lds
    s_add_u32 s54, s62, 0
    v_mfma_f32_16x16x32_bf16 v[176:179], a[244:247], a[236:239], v[176:179]
    s_waitcnt lgkmcnt(10)
    ds_read_b64_tr_b16 a[242:243], v243 offset:16896
    ds_read_b64_tr_b16 a[244:245], v243 offset:16392
    v_mfma_f32_16x16x32_bf16 v[132:135], a[248:251], a[228:231], v[132:135]
    s_add_u32 m0, s52, 135168
    ds_read_b64_tr_b16 a[246:247], v243 offset:16904
    v_mfma_f32_16x16x32_bf16 v[136:139], a[248:251], a[232:235], v[136:139]
    buffer_load_dwordx4 v239, s[20:23], s54 offen lds
    s_add_u32 s54, s63, 0
    v_mfma_f32_16x16x32_bf16 v[140:143], a[248:251], a[236:239], v[140:143]
    s_waitcnt lgkmcnt(8)
    ds_read_b64_tr_b16 a[248:249], v242 offset:17408
    ds_read_b64_tr_b16 a[250:251], v242 offset:17920
    v_mfma_f32_16x16x32_bf16 v[180:183], a[252:255], a[228:231], v[180:183]
    s_add_u32 m0, s52, 139264
    ds_read_b128 a[228:231], v237 offset:3072
    v_mfma_f32_16x16x32_bf16 v[184:187], a[252:255], a[232:235], v[184:187]
    ds_read_b128 a[232:235], v237 offset:4096
    v_mfma_f32_16x16x32_bf16 v[188:191], a[252:255], a[236:239], v[188:191]
    s_waitcnt lgkmcnt(10)
    buffer_load_dwordx4 v239, s[20:23], s54 offen lds
    v_mfma_f32_16x16x32_bf16 v[96:99], v[216:219], v[192:195], v[96:99]
    s_add_u32 m0, s51, 0
    ds_read_b64_tr_b16 a[252:253], v242 offset:17416
    ds_read_b64_tr_b16 a[254:255], v242 offset:17928
    v_mfma_f32_16x16x32_bf16 v[100:103], v[216:219], v[196:199], v[100:103]
    ds_read_b128 a[236:239], v237 offset:5120
    v_mfma_f32_16x16x32_bf16 v[104:107], v[216:219], v[200:203], v[104:107]
    s_waitcnt lgkmcnt(11)
    buffer_load_dwordx4 v238, s[8:11], s45 offen nt lds
    v_mfma_f32_16x16x32_bf16 v[144:147], v[220:223], v[192:195], v[144:147]
    buffer_load_dwordx4 v238, s[8:11], s45 offen offset:2048 nt lds
    s_add_u32 m0, s51, 896
    v_mfma_f32_16x16x32_bf16 v[148:151], v[220:223], v[196:199], v[148:151]
    ds_read_b64_tr_b16 v[216:217], v243 offset:17408
    ds_read_b64_tr_b16 v[218:219], v243 offset:17920
    v_mfma_f32_16x16x32_bf16 v[152:155], v[220:223], v[200:203], v[152:155]
    s_waitcnt lgkmcnt(11)
    buffer_load_dwordx4 v238, s[8:11], s45 offen offset:128 nt lds
    v_mfma_f32_16x16x32_bf16 v[108:111], a[240:243], v[192:195], v[108:111]
    ds_read_b64_tr_b16 v[220:221], v243 offset:17416
    ds_read_b64_tr_b16 v[222:223], v243 offset:17928
    v_mfma_f32_16x16x32_bf16 v[112:115], a[240:243], v[196:199], v[112:115]
    v_mul_f32 v96, s70, v96
    v_mul_f32 v97, s70, v97
    v_mfma_f32_16x16x32_bf16 v[116:119], a[240:243], v[200:203], v[116:119]
    s_waitcnt lgkmcnt(11)
    buffer_load_dwordx4 v238, s[8:11], s45 offen offset:2176 nt lds
    v_mfma_f32_16x16x32_bf16 v[156:159], a[244:247], v[192:195], v[156:159]
    s_add_u32 s45, s45, 8192
    v_mul_f32 v98, s70, v98
    v_mul_f32 v99, s70, v99
    v_mfma_f32_16x16x32_bf16 v[160:163], a[244:247], v[196:199], v[160:163]
    v_cvt_pk_bf16_f32 v96, v96, v97
    v_mul_f32 v100, s70, v100
    v_mfma_f32_16x16x32_bf16 v[164:167], a[244:247], v[200:203], v[164:167]
    s_waitcnt lgkmcnt(9)
    v_mul_f32 v101, s70, v101
    v_mul_f32 v144, s70, v144
    v_mfma_f32_16x16x32_bf16 v[120:123], a[248:251], v[192:195], v[120:123]
    v_mul_f32 v145, s70, v145
    v_mul_f32 v146, s70, v146
    v_mfma_f32_16x16x32_bf16 v[124:127], a[248:251], v[196:199], v[124:127]
    s_waitcnt vmcnt(16)
    s_barrier
    v_mul_f32 v147, s70, v147
    v_mfma_f32_16x16x32_bf16 v[128:131], a[248:251], v[200:203], v[128:131]
    s_waitcnt lgkmcnt(5)
    ds_read_b64_tr_b16 a[248:249], v236 offset:24576
    ds_read_b64_tr_b16 a[250:251], v236 offset:26624
    v_mfma_f32_16x16x32_bf16 v[168:171], a[252:255], v[192:195], v[168:171]
    s_add_u32 m0, s51, 8192
    v_cvt_pk_bf16_f32 v97, v98, v99
    v_mul_f32 v102, s70, v102
    v_mfma_f32_16x16x32_bf16 v[172:175], a[252:255], v[196:199], v[172:175]
    buffer_load_dwordx4 v238, s[4:7], s44 offen nt lds
    v_mfma_f32_16x16x32_bf16 v[176:179], a[252:255], v[200:203], v[176:179]
    s_waitcnt lgkmcnt(4)
    ds_read_b64_tr_b16 a[252:253], v236 offset:28672
    ds_read_b64_tr_b16 a[254:255], v236 offset:30720
    v_mfma_f32_16x16x32_bf16 v[132:135], v[216:219], v[192:195], v[132:135]
    buffer_load_dwordx4 v238, s[4:7], s44 offen offset:2048 nt lds
    s_add_u32 m0, s51, 9088
    v_mfma_f32_16x16x32_bf16 v[136:139], v[216:219], v[196:199], v[136:139]
    v_mul_f32 v103, s70, v103
    v_cvt_pk_bf16_f32 v100, v100, v101
    v_mfma_f32_16x16x32_bf16 v[140:143], v[216:219], v[200:203], v[140:143]
    s_waitcnt lgkmcnt(4)
    ds_read_b64_tr_b16 v[216:217], v236 offset:12288
    ds_read_b64_tr_b16 v[218:219], v236 offset:14336
    v_mfma_f32_16x16x32_bf16 v[180:183], v[220:223], v[192:195], v[180:183]
    buffer_load_dwordx4 v238, s[4:7], s44 offen offset:128 nt lds
    v_mfma_f32_16x16x32_bf16 v[184:187], v[220:223], v[196:199], v[184:187]
    v_mul_f32 v104, s70, v104
    v_mul_f32 v105, s70, v105
    v_mfma_f32_16x16x32_bf16 v[188:191], v[220:223], v[200:203], v[188:191]
    s_waitcnt lgkmcnt(4)
    ds_read_b64_tr_b16 v[220:221], v236 offset:16384
    ds_read_b64_tr_b16 v[222:223], v236 offset:18432
    v_mfma_f32_16x16x32_bf16 a[0:3], a[248:251], a[216:219], a[0:3]
    buffer_load_dwordx4 v238, s[4:7], s44 offen offset:2176 nt lds
    s_add_u32 s44, s44, 8192
    v_mfma_f32_16x16x32_bf16 a[4:7], a[248:251], a[220:223], a[4:7]
    ds_write_b128 v246, v[24:27] offset:6144
    v_mfma_f32_16x16x32_bf16 a[8:11], a[248:251], a[224:227], a[8:11]
    ds_write_b128 v246, v[28:31] offset:7168
    v_mfma_f32_16x16x32_bf16 a[12:15], a[248:251], a[228:231], a[12:15]
    ds_write_b128 v246, v[32:35] offset:8192
    v_mfma_f32_16x16x32_bf16 a[16:19], a[248:251], a[232:235], a[16:19]
    ds_write_b128 v246, v[48:51] offset:12288
    v_mfma_f32_16x16x32_bf16 a[20:23], a[248:251], a[236:239], a[20:23]
    s_waitcnt lgkmcnt(8)
    ds_write_b128 v246, v[52:55] offset:13312
    v_mfma_f32_16x16x32_bf16 a[24:27], a[252:255], a[216:219], a[24:27]
    ds_write_b128 v246, v[56:59] offset:14336
    v_mfma_f32_16x16x32_bf16 a[28:31], a[252:255], a[220:223], a[28:31]
    ds_write_b128 v246, v[72:75] offset:18432
    v_mfma_f32_16x16x32_bf16 a[32:35], a[252:255], a[224:227], a[32:35]
    ds_write_b128 v246, v[76:79] offset:19456
    v_mfma_f32_16x16x32_bf16 a[36:39], a[252:255], a[228:231], a[36:39]
    ds_write_b128 v246, v[80:83] offset:20480
    v_mfma_f32_16x16x32_bf16 a[40:43], a[252:255], a[232:235], a[40:43]
    v_cvt_pk_bf16_f32 v98, v144, v145
    v_cvt_pk_bf16_f32 v99, v146, v147
    v_mfma_f32_16x16x32_bf16 a[44:47], a[252:255], a[236:239], a[44:47]
    s_waitcnt lgkmcnt(11)
    v_mul_f32 v148, s70, v148
    v_mul_f32 v149, s70, v149
    v_mfma_f32_16x16x32_bf16 a[48:51], v[216:219], a[216:219], a[48:51]
    v_mul_f32 v150, s70, v150
    v_mul_f32 v151, s70, v151
    v_mfma_f32_16x16x32_bf16 a[52:55], v[216:219], a[220:223], a[52:55]
    v_cvt_pk_bf16_f32 v101, v102, v103
    v_mul_f32 v106, s70, v106
    v_mfma_f32_16x16x32_bf16 a[56:59], v[216:219], a[224:227], a[56:59]
    v_mul_f32 v107, s70, v107
    v_cvt_pk_bf16_f32 v104, v104, v105
    v_mfma_f32_16x16x32_bf16 a[60:63], v[216:219], a[228:231], a[60:63]
    v_cvt_pk_bf16_f32 v102, v148, v149
    v_cvt_pk_bf16_f32 v103, v150, v151
    v_mfma_f32_16x16x32_bf16 a[64:67], v[216:219], a[232:235], a[64:67]
    v_mul_f32 v152, s70, v152
    v_mul_f32 v153, s70, v153
    v_mfma_f32_16x16x32_bf16 a[68:71], v[216:219], a[236:239], a[68:71]
    s_waitcnt vmcnt(9) lgkmcnt(9)
    s_barrier
    ds_read_b64_tr_b16 a[240:241], v236 offset:20480
    v_mfma_f32_16x16x32_bf16 a[72:75], v[220:223], a[216:219], a[72:75]
    s_add_u32 s54, s64, 0
    ds_read_b64_tr_b16 a[242:243], v236 offset:22528
    ds_read_b64_tr_b16 a[244:245], v236
    v_mfma_f32_16x16x32_bf16 a[76:79], v[220:223], a[220:223], a[76:79]
    s_add_u32 m0, s52, 155648
    ds_read_b64_tr_b16 a[246:247], v236 offset:2048
    ds_read_b64_tr_b16 a[248:249], v236 offset:4096
    v_mfma_f32_16x16x32_bf16 a[80:83], v[220:223], a[224:227], a[80:83]
    ds_read_b64_tr_b16 a[250:251], v236 offset:6144
    v_mul_f32 v154, s70, v154
    v_mfma_f32_16x16x32_bf16 a[84:87], v[220:223], a[228:231], a[84:87]
    buffer_load_dwordx4 v239, s[20:23], s54 offen lds
    s_add_u32 s54, s56, 36864
    v_mfma_f32_16x16x32_bf16 a[88:91], v[220:223], a[232:235], a[88:91]
    s_add_u32 m0, s52, 143360
    v_mul_f32 v155, s70, v155
    v_cvt_pk_bf16_f32 v105, v106, v107
    v_mfma_f32_16x16x32_bf16 a[92:95], v[220:223], a[236:239], a[92:95]
    s_waitcnt lgkmcnt(4)
    buffer_load_dwordx4 v239, s[20:23], s54 offen lds
    v_mfma_f32_16x16x32_bf16 a[96:99], a[240:243], a[216:219], a[96:99]
    s_add_u32 s54, s57, 36864
    v_mul_f32 v108, s70, v108
    v_mul_f32 v109, s70, v109
    v_mfma_f32_16x16x32_bf16 a[100:103], a[240:243], a[220:223], a[100:103]
    s_add_u32 m0, s52, 159744
    v_cvt_pk_bf16_f32 v106, v152, v153
    v_cvt_pk_bf16_f32 v107, v154, v155
    v_mfma_f32_16x16x32_bf16 a[104:107], a[240:243], a[224:227], a[104:107]
    buffer_load_dwordx4 v239, s[20:23], s54 offen lds
    s_add_u32 s54, s58, 36864
    v_mfma_f32_16x16x32_bf16 a[108:111], a[240:243], a[228:231], a[108:111]
    s_add_u32 m0, s52, 147456
    v_mul_f32 v110, s70, v110
    v_mul_f32 v111, s70, v111
    v_mfma_f32_16x16x32_bf16 a[112:115], a[240:243], a[232:235], a[112:115]
    buffer_load_dwordx4 v239, s[20:23], s54 offen lds
    s_add_u32 m0, s51, 16384
    v_mfma_f32_16x16x32_bf16 a[116:119], a[240:243], a[236:239], a[116:119]
    s_waitcnt lgkmcnt(2)
    v_cvt_pk_bf16_f32 v108, v108, v109
    v_mul_f32 v112, s70, v112
    v_mfma_f32_16x16x32_bf16 a[120:123], a[244:247], a[216:219], a[120:123]
    buffer_load_dwordx4 v238, s[8:11], s45 offen nt lds
    v_mfma_f32_16x16x32_bf16 a[124:127], a[244:247], a[220:223], a[124:127]
    v_mul_f32 v113, s70, v113
    v_mul_f32 v156, s70, v156
    v_mfma_f32_16x16x32_bf16 a[128:131], a[244:247], a[224:227], a[128:131]
    v_mul_f32 v157, s70, v157
    v_mul_f32 v158, s70, v158
    v_mfma_f32_16x16x32_bf16 a[132:135], a[244:247], a[228:231], a[132:135]
    buffer_load_dwordx4 v238, s[8:11], s45 offen offset:2048 nt lds
    s_add_u32 m0, s51, 17280
    v_mfma_f32_16x16x32_bf16 a[136:139], a[244:247], a[232:235], a[136:139]
    v_mul_f32 v159, s70, v159
    v_cvt_pk_bf16_f32 v109, v110, v111
    v_mfma_f32_16x16x32_bf16 a[140:143], a[244:247], a[236:239], a[140:143]
    s_waitcnt vmcnt(14) lgkmcnt(0)
    s_barrier
    ds_read_b64_tr_b16 a[252:253], v236 offset:8192
    v_mfma_f32_16x16x32_bf16 a[144:147], a[248:251], a[216:219], a[144:147]
    s_add_u32 s54, s59, 36864
    ds_read_b64_tr_b16 a[254:255], v236 offset:10240
    ds_read_b128 v[216:219], v230 offset:24576
    v_mfma_f32_16x16x32_bf16 a[148:151], a[248:251], a[220:223], a[148:151]
    ds_read_b128 v[220:223], v230 offset:28672
    ds_read_b128 a[240:243], v231 offset:24576
    v_mfma_f32_16x16x32_bf16 a[152:155], a[248:251], a[224:227], a[152:155]
    ds_read_b128 a[244:247], v231 offset:28672
    v_mul_f32 v114, s70, v114
    v_mfma_f32_16x16x32_bf16 a[156:159], a[248:251], a[228:231], a[156:159]
    buffer_load_dwordx4 v238, s[8:11], s45 offen offset:128 nt lds
    v_mfma_f32_16x16x32_bf16 a[160:163], a[248:251], a[232:235], a[160:163]
    buffer_load_dwordx4 v238, s[8:11], s45 offen offset:2176 nt lds
    s_add_u32 m0, s52, 151552
    v_mfma_f32_16x16x32_bf16 a[164:167], a[248:251], a[236:239], a[164:167]
    s_waitcnt lgkmcnt(4)
    ds_read_b128 a[248:251], v230 offset:25600
    v_mul_f32 v115, s70, v115
    v_mfma_f32_16x16x32_bf16 a[168:171], a[252:255], a[216:219], a[168:171]
    s_add_u32 s45, s45, 8192
    buffer_load_dwordx4 v239, s[20:23], s54 offen lds
    v_mfma_f32_16x16x32_bf16 a[172:175], a[252:255], a[220:223], a[172:175]
    s_add_u32 s54, s60, 36864
    v_cvt_pk_bf16_f32 v112, v112, v113
    v_mul_f32 v116, s70, v116
    v_mfma_f32_16x16x32_bf16 a[176:179], a[252:255], a[224:227], a[176:179]
    s_add_u32 m0, s52, 131072
    v_mul_f32 v117, s70, v117
    v_cvt_pk_bf16_f32 v110, v156, v157
    v_mfma_f32_16x16x32_bf16 a[180:183], a[252:255], a[228:231], a[180:183]
    buffer_load_dwordx4 v239, s[20:23], s54 offen lds
    s_add_u32 s54, s61, 36864
    v_mfma_f32_16x16x32_bf16 a[184:187], a[252:255], a[232:235], a[184:187]
    s_add_u32 m0, s52, 135168
    v_cvt_pk_bf16_f32 v111, v158, v159
    v_mul_f32 v160, s70, v160
    v_mfma_f32_16x16x32_bf16 a[188:191], a[252:255], a[236:239], a[188:191]
    s_waitcnt lgkmcnt(4)
    ds_read_b128 a[252:255], v230 offset:29696
    v_mul_f32 v161, s70, v161
    v_mfma_f32_16x16x32_bf16 v[144:147], v[216:219], v[96:99], 0
    buffer_load_dwordx4 v239, s[20:23], s54 offen lds
    v_mfma_f32_16x16x32_bf16 v[148:151], v[216:219], v[100:103], 0
    v_mul_f32 v162, s70, v162
    v_mul_f32 v163, s70, v163
    v_mfma_f32_16x16x32_bf16 v[152:155], v[216:219], v[104:107], 0
    s_waitcnt lgkmcnt(4)
    ds_read_b128 v[216:219], v231 offset:25600
    v_cvt_pk_bf16_f32 v113, v114, v115
    v_mfma_f32_16x16x32_bf16 v[156:159], v[220:223], v[96:99], 0
    v_mul_f32 v118, s70, v118
    v_mul_f32 v119, s70, v119
    v_cvt_pk_bf16_f32 v114, v160, v161
    v_cvt_pk_bf16_f32 v115, v162, v163
    v_mfma_f32_16x16x32_bf16 v[160:163], v[220:223], v[100:103], 0
    v_cvt_pk_bf16_f32 v116, v116, v117
    v_mul_f32 v164, s70, v164
    v_mul_f32 v165, s70, v165
    v_mul_f32 v166, s70, v166
    v_mul_f32 v167, s70, v167
    v_cvt_pk_bf16_f32 v117, v118, v119
    v_cvt_pk_bf16_f32 v118, v164, v165
    v_cvt_pk_bf16_f32 v119, v166, v167
    v_mfma_f32_16x16x32_bf16 v[164:167], v[220:223], v[104:107], 0
    s_waitcnt lgkmcnt(4)
    ds_read_b128 v[220:223], v231 offset:29696
    v_mul_f32 v120, s70, v120
    v_mfma_f32_16x16x32_bf16 v[144:147], a[240:243], v[108:111], v[144:147]
    v_mul_f32 v121, s70, v121
    v_mul_f32 v122, s70, v122
    v_mfma_f32_16x16x32_bf16 v[148:151], a[240:243], v[112:115], v[148:151]
    v_mul_f32 v123, s70, v123
    v_cvt_pk_bf16_f32 v120, v120, v121
    v_mfma_f32_16x16x32_bf16 v[152:155], a[240:243], v[116:119], v[152:155]
    s_waitcnt lgkmcnt(4)
    v_mul_f32 v124, s70, v124
    v_mul_f32 v125, s70, v125
    v_mfma_f32_16x16x32_bf16 v[156:159], a[244:247], v[108:111], v[156:159]
    v_mul_f32 v168, s70, v168
    v_mul_f32 v169, s70, v169
    v_mfma_f32_16x16x32_bf16 v[160:163], a[244:247], v[112:115], v[160:163]
    v_mul_f32 v170, s70, v170
    v_mul_f32 v171, s70, v171
    v_cvt_pk_bf16_f32 v121, v122, v123
    v_cvt_pk_bf16_f32 v122, v168, v169
    v_cvt_pk_bf16_f32 v123, v170, v171
    v_mfma_f32_16x16x32_bf16 v[164:167], a[244:247], v[116:119], v[164:167]
    s_waitcnt lgkmcnt(3)
    v_mul_f32 v126, s70, v126
    v_mul_f32 v127, s70, v127
    v_mul_f32 v172, s70, v172
    v_mul_f32 v173, s70, v173
    v_mul_f32 v174, s70, v174
    v_mul_f32 v175, s70, v175
    v_cvt_pk_bf16_f32 v124, v124, v125
    v_cvt_pk_bf16_f32 v125, v126, v127
    v_cvt_pk_bf16_f32 v126, v172, v173
    v_cvt_pk_bf16_f32 v127, v174, v175
    v_mfma_f32_16x16x32_bf16 v[144:147], a[248:251], v[120:123], v[144:147]
    v_mul_f32 v128, s70, v128
    v_mul_f32 v129, s70, v129
    v_mul_f32 v130, s70, v130
    v_mul_f32 v131, s70, v131
    v_mul_f32 v176, s70, v176
    v_mul_f32 v177, s70, v177
    v_mul_f32 v178, s70, v178
    v_mul_f32 v179, s70, v179
    v_cvt_pk_bf16_f32 v128, v128, v129
    v_cvt_pk_bf16_f32 v129, v130, v131
    v_cvt_pk_bf16_f32 v130, v176, v177
    v_cvt_pk_bf16_f32 v131, v178, v179
    v_mfma_f32_16x16x32_bf16 v[148:151], a[248:251], v[124:127], v[148:151]
    v_mul_f32 v132, s70, v132
    v_mul_f32 v133, s70, v133
    v_mfma_f32_16x16x32_bf16 v[152:155], a[248:251], v[128:131], v[152:155]
    s_waitcnt lgkmcnt(2)
    v_mul_f32 v134, s70, v134
    v_mul_f32 v135, s70, v135
    v_mfma_f32_16x16x32_bf16 v[156:159], a[252:255], v[120:123], v[156:159]
    v_cvt_pk_bf16_f32 v132, v132, v133
    v_mul_f32 v136, s70, v136
    v_mfma_f32_16x16x32_bf16 v[160:163], a[252:255], v[124:127], v[160:163]
    s_waitcnt vmcnt(8) lgkmcnt(0)
    s_barrier
    ds_read_b64_tr_b16 a[240:241], v236 offset:24576
    v_mul_f32 v180, s70, v180
    v_mul_f32 v181, s70, v181
    v_mul_f32 v182, s70, v182
    v_mul_f32 v183, s70, v183
    v_cvt_pk_bf16_f32 v133, v134, v135
    v_cvt_pk_bf16_f32 v134, v180, v181
    v_cvt_pk_bf16_f32 v135, v182, v183
    v_mfma_f32_16x16x32_bf16 v[164:167], a[252:255], v[128:131], v[164:167]
    s_add_u32 s54, s62, 36864
    ds_read_b64_tr_b16 a[242:243], v236 offset:26624
    v_mul_f32 v137, s70, v137
    v_mul_f32 v138, s70, v138
    v_mul_f32 v139, s70, v139
    v_mul_f32 v184, s70, v184
    v_mul_f32 v185, s70, v185
    v_mul_f32 v186, s70, v186
    v_mul_f32 v187, s70, v187
    v_cvt_pk_bf16_f32 v136, v136, v137
    v_cvt_pk_bf16_f32 v137, v138, v139
    v_cvt_pk_bf16_f32 v138, v184, v185
    v_cvt_pk_bf16_f32 v139, v186, v187
    v_mfma_f32_16x16x32_bf16 v[144:147], v[216:219], v[132:135], v[144:147]
    s_add_u32 m0, s52, 139264
    ds_read_b128 a[244:247], v230 offset:32768
    v_mul_f32 v140, s70, v140
    v_mul_f32 v141, s70, v141
    v_mul_f32 v142, s70, v142
    v_mul_f32 v143, s70, v143
    v_mul_f32 v188, s70, v188
    v_mul_f32 v189, s70, v189
    v_mul_f32 v190, s70, v190
    v_mul_f32 v191, s70, v191
    v_cvt_pk_bf16_f32 v140, v140, v141
    v_cvt_pk_bf16_f32 v141, v142, v143
    v_cvt_pk_bf16_f32 v142, v188, v189
    v_cvt_pk_bf16_f32 v143, v190, v191
    v_mfma_f32_16x16x32_bf16 v[148:151], v[216:219], v[136:139], v[148:151]
    ds_read_b128 a[248:251], v231 offset:32768
    v_max3_f32 v248, v144, v145, v146
    v_mfma_f32_16x16x32_bf16 v[152:155], v[216:219], v[140:143], v[152:155]
    ds_read_b128 a[252:255], v230 offset:33792
    ds_read_b64_tr_b16 v[216:217], v236 offset:12288
    v_mfma_f32_16x16x32_bf16 v[156:159], v[220:223], v[132:135], v[156:159]
    ds_read_b64_tr_b16 v[218:219], v236 offset:14336
    v_mfma_f32_16x16x32_bf16 v[160:163], v[220:223], v[136:139], v[160:163]
    buffer_load_dwordx4 v239, s[20:23], s54 offen lds
    s_add_u32 m0, s51, 24576
    v_mfma_f32_16x16x32_bf16 v[164:167], v[220:223], v[140:143], v[164:167]
    s_waitcnt lgkmcnt(5)
    ds_read_b128 v[220:223], v231 offset:33792
    v_max3_f32 v249, v148, v149, v150
    v_mfma_f32_16x16x32_bf16 a[192:195], a[240:243], a[216:219], a[192:195]
    ds_read_b128 a[216:219], v237 offset:6144
    v_max3_f32 v248, v248, v147, v156
    v_mfma_f32_16x16x32_bf16 a[196:199], a[240:243], a[220:223], a[196:199]
    ds_read_b128 a[220:223], v237 offset:7168
    v_max3_f32 v248, v248, v157, v158
    v_mfma_f32_16x16x32_bf16 a[200:203], a[240:243], a[224:227], a[200:203]
    ds_read_b128 a[224:227], v237 offset:8192
    v_max_f32 v248, v248, v159
    v_mfma_f32_16x16x32_bf16 a[204:207], a[240:243], a[228:231], a[204:207]
    ds_read_b128 a[228:231], v237 offset:9216
    v_mov_b32 v247, v248
    v_mfma_f32_16x16x32_bf16 a[208:211], a[240:243], a[232:235], a[208:211]
    ds_read_b128 a[232:235], v237 offset:10240
    v_max3_f32 v249, v249, v151, v160
    v_mfma_f32_16x16x32_bf16 a[212:215], a[240:243], a[236:239], a[212:215]
    s_waitcnt lgkmcnt(10)
    ds_read_b128 a[236:239], v237 offset:11264
    v_max3_f32 v249, v249, v161, v162
    v_mfma_f32_16x16x32_bf16 v[168:171], a[244:247], v[96:99], 0
    ds_read_b128 a[240:243], v230 offset:36864
    v_max_f32 v249, v249, v163
    v_mfma_f32_16x16x32_bf16 v[172:175], a[244:247], v[100:103], 0
    v_permlane32_swap_b32 v247, v248
    v_mfma_f32_16x16x32_bf16 v[176:179], a[244:247], v[104:107], 0
    s_waitcnt lgkmcnt(11)
    ds_read_b128 a[244:247], v231 offset:36864
    v_max_f32 v248, v248, v247
    v_mfma_f32_16x16x32_bf16 v[168:171], a[248:251], v[108:111], v[168:171]
    buffer_load_dwordx4 v238, s[4:7], s44 offen nt lds
    v_mfma_f32_16x16x32_bf16 v[172:175], a[248:251], v[112:115], v[172:175]
    v_mov_b32 v247, v248
    v_max3_f32 v250, v152, v153, v154
    v_mfma_f32_16x16x32_bf16 v[176:179], a[248:251], v[116:119], v[176:179]
    s_waitcnt lgkmcnt(11)
    ds_read_b64_tr_b16 a[248:249], v236 offset:28672
    v_max3_f32 v250, v250, v155, v164
    v_mfma_f32_16x16x32_bf16 v[168:171], a[252:255], v[120:123], v[168:171]
    ds_read_b64_tr_b16 a[250:251], v236 offset:30720
    v_max3_f32 v250, v250, v165, v166
    v_mfma_f32_16x16x32_bf16 v[172:175], a[252:255], v[124:127], v[172:175]
    s_waitcnt lgkmcnt(9)
    v_permlane16_swap_b32 v247, v248
    v_mfma_f32_16x16x32_bf16 a[0:3], v[216:219], a[216:219], a[0:3]
    s_waitcnt lgkmcnt(8)
    v_max_f32 v248, v248, v247
    v_max_f32 v250, v250, v167
    v_mfma_f32_16x16x32_bf16 a[4:7], v[216:219], a[220:223], a[4:7]
    s_waitcnt lgkmcnt(7)
    buffer_load_dwordx4 v238, s[4:7], s44 offen offset:2048 nt lds
    v_mfma_f32_16x16x32_bf16 a[8:11], v[216:219], a[224:227], a[8:11]
    s_waitcnt lgkmcnt(6)
    v_sub_f32 v204, 0, v248
    v_sub_f32 v205, 0, v248
    v_mfma_f32_16x16x32_bf16 a[12:15], v[216:219], a[228:231], a[12:15]
    s_waitcnt lgkmcnt(5)
    v_add_f32 v144, v204, v144
    v_mov_b32 v247, v249
    v_mfma_f32_16x16x32_bf16 a[16:19], v[216:219], a[232:235], a[16:19]
    s_waitcnt lgkmcnt(4)
    v_exp_f32 v144, v144
    v_mfma_f32_16x16x32_bf16 a[20:23], v[216:219], a[236:239], a[20:23]
    s_add_u32 m0, s51, 25472
    v_permlane32_swap_b32 v247, v249
    v_mfma_f32_16x16x32_bf16 v[176:179], a[252:255], v[128:131], v[176:179]
    ds_read_b128 a[252:255], v230 offset:37888
    v_add_f32 v145, v205, v145
    v_mfma_f32_16x16x32_bf16 v[168:171], v[220:223], v[132:135], v[168:171]
    v_exp_f32 v145, v145
    v_mfma_f32_16x16x32_bf16 v[172:175], v[220:223], v[136:139], v[172:175]
    buffer_load_dwordx4 v238, s[4:7], s44 offen offset:128 nt lds
    v_mfma_f32_16x16x32_bf16 v[176:179], v[220:223], v[140:143], v[176:179]
    s_waitcnt lgkmcnt(4)
    ds_read_b128 v[216:219], v231 offset:37888
    v_sub_f32 v206, 0, v248
    v_mfma_f32_16x16x32_bf16 v[180:183], a[240:243], v[96:99], 0
    v_max_f32 v249, v249, v247
    v_add_f32 v146, v206, v146
    v_mfma_f32_16x16x32_bf16 v[184:187], a[240:243], v[100:103], 0
    v_exp_f32 v146, v146
    v_mfma_f32_16x16x32_bf16 v[188:191], a[240:243], v[104:107], 0
    s_waitcnt lgkmcnt(4)
    v_mov_b32 v247, v249
    v_sub_f32 v207, 0, v248
    v_mfma_f32_16x16x32_bf16 v[180:183], a[244:247], v[108:111], v[180:183]
    s_waitcnt lgkmcnt(2)
    v_permlane16_swap_b32 v247, v249
    v_mfma_f32_16x16x32_bf16 a[24:27], a[248:251], a[216:219], a[24:27]
    buffer_load_dwordx4 v238, s[4:7], s44 offen offset:2176 nt lds
    s_add_u32 s44, s44, 8192
    v_mfma_f32_16x16x32_bf16 a[28:31], a[248:251], a[220:223], a[28:31]
    v_add_f32 v224, v224, v144
    v_max_f32 v249, v249, v247
    v_mfma_f32_16x16x32_bf16 a[32:35], a[248:251], a[224:227], a[32:35]
    v_add_f32 v147, v207, v147
    v_sub_f32 v208, 0, v249
    v_mfma_f32_16x16x32_bf16 a[36:39], a[248:251], a[228:231], a[36:39]
    v_exp_f32 v147, v147
    v_mfma_f32_16x16x32_bf16 a[40:43], a[248:251], a[232:235], a[40:43]
    v_add_f32 v224, v224, v145
    v_add_f32 v148, v208, v148
    v_mfma_f32_16x16x32_bf16 a[44:47], a[248:251], a[236:239], a[44:47]
    v_exp_f32 v148, v148
    v_mfma_f32_16x16x32_bf16 v[184:187], a[244:247], v[112:115], v[184:187]
    s_waitcnt vmcnt(6) lgkmcnt(0)
    s_barrier
    ds_read_b64_tr_b16 v[220:221], v236 offset:16384
    v_mfma_f32_16x16x32_bf16 v[188:191], a[244:247], v[116:119], v[188:191]
    s_add_u32 s54, s63, 36864
    ds_read_b64_tr_b16 v[222:223], v236 offset:18432
    v_add_f32 v224, v224, v146
    v_mfma_f32_16x16x32_bf16 v[180:183], a[252:255], v[120:123], v[180:183]
    s_add_u32 m0, s52, 143360
    ds_read_b64_tr_b16 a[240:241], v232
    v_sub_f32 v209, 0, v249
    v_mfma_f32_16x16x32_bf16 v[184:187], a[252:255], v[124:127], v[184:187]
    ds_read_b64_tr_b16 a[242:243], v232 offset:4096
    v_mov_b32 v247, v250
    v_mfma_f32_16x16x32_bf16 v[188:191], a[252:255], v[128:131], v[188:191]
    ds_read_b64_tr_b16 a[244:245], v233
    v_add_f32 v224, v224, v147
    v_mfma_f32_16x16x32_bf16 v[180:183], v[216:219], v[132:135], v[180:183]
    v_permlane32_swap_b32 v247, v250
    v_mfma_f32_16x16x32_bf16 v[184:187], v[216:219], v[136:139], v[184:187]
    ds_read_b64_tr_b16 a[246:247], v233 offset:4096
    v_add_f32 v149, v209, v149
    v_mfma_f32_16x16x32_bf16 v[188:191], v[216:219], v[140:143], v[188:191]
    s_waitcnt lgkmcnt(4)
    v_exp_f32 v149, v149
    v_mfma_f32_16x16x32_bf16 a[48:51], v[220:223], a[216:219], a[48:51]
    ds_read_b64_tr_b16 a[248:249], v234
    v_sub_f32 v210, 0, v249
    v_mfma_f32_16x16x32_bf16 a[52:55], v[220:223], a[220:223], a[52:55]
    ds_read_b64_tr_b16 a[250:251], v234 offset:4096
    v_max_f32 v250, v250, v247
    v_mfma_f32_16x16x32_bf16 a[56:59], v[220:223], a[224:227], a[56:59]
    ds_read_b64_tr_b16 a[252:253], v236 offset:20480
    v_mov_b32 v247, v250
    v_mfma_f32_16x16x32_bf16 a[60:63], v[220:223], a[228:231], a[60:63]
    ds_read_b64_tr_b16 a[254:255], v236 offset:22528
    v_add_f32 v225, v225, v148
    v_mfma_f32_16x16x32_bf16 a[64:67], v[220:223], a[232:235], a[64:67]
    ds_read_b64_tr_b16 v[216:217], v235
    v_add_f32 v150, v210, v150
    v_add_f32 v156, v204, v156
    v_exp_f32 v156, v156
    v_add_f32 v157, v205, v157
    v_exp_f32 v157, v157
    v_add_f32 v158, v206, v158
    v_exp_f32 v158, v158
    v_add_f32 v159, v207, v159
    v_exp_f32 v159, v159
    v_cvt_pk_bf16_f32 v192, v144, v145
    v_cvt_pk_bf16_f32 v193, v146, v147
    v_cvt_pk_bf16_f32 v194, v156, v157
    v_cvt_pk_bf16_f32 v195, v158, v159
    v_mfma_f32_16x16x32_bf16 a[68:71], v[220:223], a[236:239], a[68:71]
    s_waitcnt lgkmcnt(7)
    v_permlane16_swap_b32 v247, v250
    v_sub_f32 v211, 0, v249
    v_exp_f32 v150, v150
    v_add_f32 v151, v211, v151
    v_exp_f32 v151, v151
    v_add_f32 v160, v208, v160
    v_exp_f32 v160, v160
    v_add_f32 v161, v209, v161
    v_exp_f32 v161, v161
    v_add_f32 v162, v210, v162
    v_exp_f32 v162, v162
    v_add_f32 v163, v211, v163
    v_exp_f32 v163, v163
    v_cvt_pk_bf16_f32 v196, v148, v149
    v_cvt_pk_bf16_f32 v197, v150, v151
    v_cvt_pk_bf16_f32 v198, v160, v161
    v_cvt_pk_bf16_f32 v199, v162, v163
    v_mfma_f32_16x16x32_bf16 v[0:3], a[240:243], v[192:195], 0
    ds_read_b64_tr_b16 v[218:219], v235 offset:4096
    v_max_f32 v250, v250, v247
    v_sub_f32 v212, 0, v250
    v_sub_f32 v213, 0, v250
    v_sub_f32 v214, 0, v250
    v_sub_f32 v215, 0, v250
    v_add_f32 v152, v212, v152
    v_exp_f32 v152, v152
    v_add_f32 v153, v213, v153
    v_exp_f32 v153, v153
    v_add_f32 v154, v214, v154
    v_exp_f32 v154, v154
    v_add_f32 v155, v215, v155
    v_exp_f32 v155, v155
    v_add_f32 v164, v212, v164
    v_exp_f32 v164, v164
    v_add_f32 v165, v213, v165
    v_exp_f32 v165, v165
    v_add_f32 v166, v214, v166
    v_exp_f32 v166, v166
    v_add_f32 v167, v215, v167
    v_exp_f32 v167, v167
    v_cvt_pk_bf16_f32 v200, v152, v153
    v_cvt_pk_bf16_f32 v201, v154, v155
    v_cvt_pk_bf16_f32 v202, v164, v165
    v_cvt_pk_bf16_f32 v203, v166, v167
    v_mfma_f32_16x16x32_bf16 v[4:7], a[240:243], v[196:199], 0
    ds_read_b64_tr_b16 v[220:221], v232 offset:1024
    v_add_f32 v225, v225, v149
    v_mfma_f32_16x16x32_bf16 v[8:11], a[240:243], v[200:203], 0
    s_waitcnt lgkmcnt(7)
    ds_read_b64_tr_b16 v[222:223], v232 offset:5120
    v_add_f32 v225, v225, v150
    v_mfma_f32_16x16x32_bf16 v[12:15], a[244:247], v[192:195], 0
    ds_read_b64_tr_b16 a[240:241], v233 offset:1024
    v_add_f32 v225, v225, v151
    v_mfma_f32_16x16x32_bf16 v[16:19], a[244:247], v[196:199], 0
    ds_read_b64_tr_b16 a[242:243], v233 offset:5120
    v_add_f32 v226, v226, v152
    v_mfma_f32_16x16x32_bf16 v[20:23], a[244:247], v[200:203], 0
    s_waitcnt lgkmcnt(8)
    ds_read_b64_tr_b16 a[244:245], v236
    v_add_f32 v226, v226, v153
    v_mfma_f32_16x16x32_bf16 v[24:27], a[248:251], v[192:195], 0
    ds_read_b64_tr_b16 a[246:247], v236 offset:2048
    v_add_f32 v226, v226, v154
    v_mfma_f32_16x16x32_bf16 v[28:31], a[248:251], v[196:199], 0
    s_waitcnt lgkmcnt(8)
    v_add_f32 v226, v226, v155
    v_add_f32 v224, v224, v156
    v_mfma_f32_16x16x32_bf16 a[72:75], a[252:255], a[216:219], a[72:75]
    v_add_f32 v224, v224, v157
    v_add_f32 v168, v204, v168
    v_mfma_f32_16x16x32_bf16 a[76:79], a[252:255], a[220:223], a[76:79]
    buffer_load_dwordx4 v239, s[20:23], s54 offen lds
    s_add_u32 s54, s64, 36864
    v_mfma_f32_16x16x32_bf16 a[80:83], a[252:255], a[224:227], a[80:83]
    s_add_u32 m0, s52, 155648
    v_add_f32 v224, v224, v158
    v_add_f32 v169, v205, v169
    v_mfma_f32_16x16x32_bf16 a[84:87], a[252:255], a[228:231], a[84:87]
    v_exp_f32 v168, v168
    v_mfma_f32_16x16x32_bf16 a[88:91], a[252:255], a[232:235], a[88:91]
    v_exp_f32 v169, v169
    v_mfma_f32_16x16x32_bf16 a[92:95], a[252:255], a[236:239], a[92:95]
    ds_read_b64_tr_b16 a[252:253], v235 offset:1024
    v_add_f32 v224, v224, v159
    v_mfma_f32_16x16x32_bf16 v[32:35], a[248:251], v[200:203], 0
    s_waitcnt lgkmcnt(7)
    buffer_load_dwordx4 v239, s[20:23], s54 offen lds
    v_mfma_f32_16x16x32_bf16 v[36:39], v[216:219], v[192:195], 0
    s_add_u32 s54, s57, 73728
    ds_read_b64_tr_b16 a[248:249], v234 offset:1024
    v_add_f32 v225, v225, v160
    v_mfma_f32_16x16x32_bf16 v[40:43], v[216:219], v[196:199], 0
    s_add_u32 m0, s52, 159744
    ds_read_b64_tr_b16 a[250:251], v234 offset:5120
    v_add_f32 v170, v206, v170
    v_mfma_f32_16x16x32_bf16 v[44:47], v[216:219], v[200:203], 0
    s_waitcnt lgkmcnt(7)
    v_exp_f32 v170, v170
    v_mfma_f32_16x16x32_bf16 v[48:51], v[220:223], v[192:195], 0
    ds_read_b64_tr_b16 a[254:255], v235 offset:5120
    v_add_f32 v224, v224, v168
    v_mfma_f32_16x16x32_bf16 v[52:55], v[220:223], v[196:199], 0
    buffer_load_dwordx4 v239, s[20:23], s54 offen lds
    s_add_u32 m0, s51, 32768
    v_mfma_f32_16x16x32_bf16 v[56:59], v[220:223], v[200:203], 0
    s_waitcnt lgkmcnt(6)
    v_add_f32 v225, v225, v161
    v_add_f32 v171, v207, v171
    v_mfma_f32_16x16x32_bf16 v[60:63], a[240:243], v[192:195], 0
    s_waitcnt lgkmcnt(4)
    v_exp_f32 v171, v171
    v_mfma_f32_16x16x32_bf16 a[96:99], a[244:247], a[216:219], a[96:99]
    v_add_f32 v224, v224, v169
    v_add_f32 v225, v225, v162
    v_mfma_f32_16x16x32_bf16 a[100:103], a[244:247], a[220:223], a[100:103]
    buffer_load_dwordx4 v238, s[8:11], s45 offen nt lds
    v_mfma_f32_16x16x32_bf16 a[104:107], a[244:247], a[224:227], a[104:107]
    v_add_f32 v172, v208, v172
    v_add_f32 v224, v224, v170
    v_mfma_f32_16x16x32_bf16 a[108:111], a[244:247], a[228:231], a[108:111]
    v_exp_f32 v172, v172
    v_mfma_f32_16x16x32_bf16 a[112:115], a[244:247], a[232:235], a[112:115]
    v_add_f32 v225, v225, v163
    v_add_f32 v224, v224, v171
    v_mfma_f32_16x16x32_bf16 a[116:119], a[244:247], a[236:239], a[116:119]
    buffer_load_dwordx4 v238, s[8:11], s45 offen offset:2048 nt lds
    s_add_u32 m0, s51, 33664
    v_mfma_f32_16x16x32_bf16 v[64:67], a[240:243], v[196:199], 0
    s_waitcnt vmcnt(9) lgkmcnt(0)
    s_barrier
    ds_read_b64_tr_b16 v[216:217], v236 offset:4096
    v_mfma_f32_16x16x32_bf16 v[68:71], a[240:243], v[200:203], 0
    s_add_u32 s54, s56, 73728
    ds_read_b64_tr_b16 v[218:219], v236 offset:6144
    v_add_f32 v173, v209, v173
    v_mfma_f32_16x16x32_bf16 v[72:75], a[248:251], v[192:195], 0
    v_exp_f32 v173, v173
    v_mfma_f32_16x16x32_bf16 v[76:79], a[248:251], v[196:199], 0
    ds_read_b128 v[220:223], v230 offset:8192
    v_add_f32 v226, v226, v164
    v_mfma_f32_16x16x32_bf16 v[80:83], a[248:251], v[200:203], 0
    ds_read_b128 a[240:243], v231 offset:8192
    v_add_f32 v225, v225, v172
    v_mfma_f32_16x16x32_bf16 v[84:87], a[252:255], v[192:195], 0
    ds_read_b128 a[244:247], v230 offset:9216
    v_add_f32 v174, v210, v174
    v_mfma_f32_16x16x32_bf16 v[88:91], a[252:255], v[196:199], 0
    v_exp_f32 v174, v174
    v_mfma_f32_16x16x32_bf16 v[92:95], a[252:255], v[200:203], 0
    s_waitcnt lgkmcnt(3)
    buffer_load_dwordx4 v238, s[8:11], s45 offen offset:128 nt lds
    v_mfma_f32_16x16x32_bf16 a[120:123], v[216:219], a[216:219], a[120:123]
    ds_read_b128 a[248:251], v231 offset:9216
    v_add_f32 v226, v226, v165
    v_mfma_f32_16x16x32_bf16 a[124:127], v[216:219], a[220:223], a[124:127]
    ds_read_b64_tr_b16 a[252:253], v236 offset:8192
    v_add_f32 v175, v211, v175
    v_mfma_f32_16x16x32_bf16 a[128:131], v[216:219], a[224:227], a[128:131]
    v_exp_f32 v175, v175
    v_mfma_f32_16x16x32_bf16 a[132:135], v[216:219], a[228:231], a[132:135]
    ds_read_b64_tr_b16 a[254:255], v236 offset:10240
    v_add_f32 v225, v225, v173
    v_mfma_f32_16x16x32_bf16 a[136:139], v[216:219], a[232:235], a[136:139]
    buffer_load_dwordx4 v238, s[8:11], s45 offen offset:2176 nt lds
    s_add_u32 m0, s52, 147456
    v_mfma_f32_16x16x32_bf16 a[140:143], v[216:219], a[236:239], a[140:143]
    s_waitcnt lgkmcnt(5)
    ds_read_b128 v[216:219], v230 offset:12288
    v_add_f32 v226, v226, v166
    v_mfma_f32_16x16x32_bf16 v[144:147], v[220:223], v[96:99], v[204:207]
    s_add_u32 s45, s45, 8192
    v_add_f32 v176, v212, v176
    v_add_f32 v225, v225, v174
    v_mfma_f32_16x16x32_bf16 v[148:151], v[220:223], v[100:103], v[208:211]
    v_exp_f32 v176, v176
    v_mfma_f32_16x16x32_bf16 v[152:155], v[220:223], v[104:107], v[212:215]
    s_waitcnt lgkmcnt(5)
    ds_read_b128 v[220:223], v231 offset:12288
    v_add_f32 v226, v226, v167
    v_mfma_f32_16x16x32_bf16 v[144:147], a[240:243], v[108:111], v[144:147]
    v_add_f32 v177, v213, v177
    v_add_f32 v225, v225, v175
    v_mfma_f32_16x16x32_bf16 v[148:151], a[240:243], v[112:115], v[148:151]
    v_exp_f32 v177, v177
    v_mfma_f32_16x16x32_bf16 v[152:155], a[240:243], v[116:119], v[152:155]
    s_waitcnt lgkmcnt(5)
    ds_read_b128 a[240:243], v230 offset:13312
    v_add_f32 v226, v226, v176
    v_mfma_f32_16x16x32_bf16 v[144:147], a[244:247], v[120:123], v[144:147]
    v_add_f32 v178, v214, v178
    v_add_f32 v226, v226, v177
    v_mfma_f32_16x16x32_bf16 v[148:151], a[244:247], v[124:127], v[148:151]
    v_exp_f32 v178, v178
    v_mfma_f32_16x16x32_bf16 v[152:155], a[244:247], v[128:131], v[152:155]
    s_waitcnt lgkmcnt(5)
    ds_read_b128 a[244:247], v231 offset:13312
    v_add_f32 v179, v215, v179
    v_mfma_f32_16x16x32_bf16 v[144:147], a[248:251], v[132:135], v[144:147]
    v_exp_f32 v179, v179
    v_mfma_f32_16x16x32_bf16 v[148:151], a[248:251], v[136:139], v[148:151]
    v_add_f32 v180, v204, v180
    v_add_f32 v226, v226, v178
    v_mfma_f32_16x16x32_bf16 v[152:155], a[248:251], v[140:143], v[152:155]
    s_waitcnt lgkmcnt(4)
    v_exp_f32 v180, v180
    v_mfma_f32_16x16x32_bf16 a[144:147], a[252:255], a[216:219], a[144:147]
    v_add_f32 v181, v205, v181
    v_add_f32 v226, v226, v179
    v_mfma_f32_16x16x32_bf16 a[148:151], a[252:255], a[220:223], a[148:151]
    v_exp_f32 v181, v181
    v_mfma_f32_16x16x32_bf16 a[152:155], a[252:255], a[224:227], a[152:155]
    v_add_f32 v182, v206, v182
    v_add_f32 v224, v224, v180
    v_mfma_f32_16x16x32_bf16 a[156:159], a[252:255], a[228:231], a[156:159]
    v_exp_f32 v182, v182
    v_mfma_f32_16x16x32_bf16 a[160:163], a[252:255], a[232:235], a[160:163]
    v_add_f32 v224, v224, v181
    v_add_f32 v183, v207, v183
    v_mfma_f32_16x16x32_bf16 a[164:167], a[252:255], a[236:239], a[164:167]
    s_waitcnt lgkmcnt(3)
    v_exp_f32 v183, v183
    v_mfma_f32_16x16x32_bf16 v[156:159], v[216:219], v[96:99], v[204:207]
    v_add_f32 v224, v224, v182
    v_add_f32 v184, v208, v184
    v_mfma_f32_16x16x32_bf16 v[160:163], v[216:219], v[100:103], v[208:211]
    v_exp_f32 v184, v184
    v_mfma_f32_16x16x32_bf16 v[164:167], v[216:219], v[104:107], v[212:215]
    s_waitcnt lgkmcnt(2)
    v_add_f32 v185, v209, v185
    v_add_f32 v224, v224, v183
    v_mfma_f32_16x16x32_bf16 v[156:159], v[220:223], v[108:111], v[156:159]
    v_exp_f32 v185, v185
    v_mfma_f32_16x16x32_bf16 v[160:163], v[220:223], v[112:115], v[160:163]
    s_waitcnt vmcnt(5) lgkmcnt(0)
    s_barrier
    v_add_f32 v186, v210, v186
    v_mfma_f32_16x16x32_bf16 v[164:167], v[220:223], v[116:119], v[164:167]
    v_exp_f32 v186, v186
    v_mfma_f32_16x16x32_bf16 v[156:159], a[240:243], v[120:123], v[156:159]
    ds_read_b64_tr_b16 a[248:249], v236 offset:12288
    v_add_f32 v225, v225, v184
    v_mfma_f32_16x16x32_bf16 v[160:163], a[240:243], v[124:127], v[160:163]
    ds_read_b64_tr_b16 a[250:251], v236 offset:14336
    v_add_f32 v187, v211, v187
    v_mfma_f32_16x16x32_bf16 v[164:167], a[240:243], v[128:131], v[164:167]
    v_exp_f32 v187, v187
    v_mfma_f32_16x16x32_bf16 v[156:159], a[244:247], v[132:135], v[156:159]
    buffer_load_dwordx4 v239, s[20:23], s54 offen lds
    s_add_u32 s54, s58, 73728
    v_mfma_f32_16x16x32_bf16 v[160:163], a[244:247], v[136:139], v[160:163]
    s_add_u32 m0, s52, 131072
    ds_read_b64_tr_b16 a[252:253], v232 offset:16384
    v_add_f32 v225, v225, v185
    v_mfma_f32_16x16x32_bf16 v[164:167], a[244:247], v[140:143], v[164:167]
    s_waitcnt lgkmcnt(1)
    ds_read_b64_tr_b16 a[254:255], v232 offset:20480
    v_add_f32 v225, v225, v186
    v_mfma_f32_16x16x32_bf16 a[168:171], a[248:251], a[216:219], a[168:171]
    ds_read_b64_tr_b16 v[216:217], v233 offset:16384
    v_add_f32 v188, v212, v188
    v_mfma_f32_16x16x32_bf16 a[172:175], a[248:251], a[220:223], a[172:175]
    v_exp_f32 v188, v188
    v_mfma_f32_16x16x32_bf16 a[176:179], a[248:251], a[224:227], a[176:179]
    buffer_load_dwordx4 v239, s[20:23], s54 offen lds
    s_add_u32 s54, s59, 73728
    v_mfma_f32_16x16x32_bf16 a[180:183], a[248:251], a[228:231], a[180:183]
    s_add_u32 m0, s52, 151552
    ds_read_b64_tr_b16 v[218:219], v233 offset:20480
    v_add_f32 v225, v225, v187
    v_mfma_f32_16x16x32_bf16 a[184:187], a[248:251], a[232:235], a[184:187]
    ds_read_b64_tr_b16 v[220:221], v234 offset:16384
    v_add_f32 v189, v213, v189
    v_cvt_pk_bf16_f32 v192, v168, v169
    v_cvt_pk_bf16_f32 v193, v170, v171
    v_cvt_pk_bf16_f32 v194, v180, v181
    v_cvt_pk_bf16_f32 v195, v182, v183
    v_mfma_f32_16x16x32_bf16 a[188:191], a[248:251], a[236:239], a[188:191]
    s_waitcnt lgkmcnt(3)
    v_exp_f32 v189, v189
    v_cvt_pk_bf16_f32 v196, v172, v173
    v_cvt_pk_bf16_f32 v197, v174, v175
    v_cvt_pk_bf16_f32 v198, v184, v185
    v_cvt_pk_bf16_f32 v199, v186, v187
    v_mfma_f32_16x16x32_bf16 v[0:3], a[252:255], v[192:195], v[0:3]
    buffer_load_dwordx4 v239, s[20:23], s54 offen lds
    s_add_u32 m0, s51, 0
    v_add_f32 v190, v214, v190
    v_exp_f32 v190, v190
    v_add_f32 v191, v215, v191
    v_exp_f32 v191, v191
    v_cvt_pk_bf16_f32 v200, v176, v177
    v_cvt_pk_bf16_f32 v201, v178, v179
    v_cvt_pk_bf16_f32 v202, v188, v189
    v_cvt_pk_bf16_f32 v203, v190, v191
    v_mfma_f32_16x16x32_bf16 v[4:7], a[252:255], v[196:199], v[4:7]
    s_add_u32 s54, s60, 73728
    ds_read_b64_tr_b16 v[222:223], v234 offset:20480
    v_add_f32 v226, v226, v188
    v_mfma_f32_16x16x32_bf16 v[8:11], a[252:255], v[200:203], v[8:11]
    s_waitcnt lgkmcnt(2)
    buffer_load_dwordx4 v238, s[4:7], s44 offen nt lds
    v_mfma_f32_16x16x32_bf16 v[12:15], v[216:219], v[192:195], v[12:15]
    ds_read_b64_tr_b16 a[240:241], v235 offset:16384
    v_add_f32 v226, v226, v189
    v_mfma_f32_16x16x32_bf16 v[16:19], v[216:219], v[196:199], v[16:19]
    ds_read_b64_tr_b16 a[242:243], v235 offset:20480
    v_add_f32 v226, v226, v190
    v_mfma_f32_16x16x32_bf16 v[20:23], v[216:219], v[200:203], v[20:23]
    s_waitcnt lgkmcnt(2)
    buffer_load_dwordx4 v238, s[4:7], s44 offen offset:2048 nt lds
    v_mfma_f32_16x16x32_bf16 v[24:27], v[220:223], v[192:195], v[24:27]
    s_add_u32 m0, s51, 896
    ds_read_b64_tr_b16 a[244:245], v236 offset:24576
    v_add_f32 v226, v226, v191
    v_mfma_f32_16x16x32_bf16 v[28:31], v[220:223], v[196:199], v[28:31]
    buffer_load_dwordx4 v238, s[4:7], s44 offen offset:128 nt lds
    v_mfma_f32_16x16x32_bf16 v[32:35], v[220:223], v[200:203], v[32:35]
    s_waitcnt lgkmcnt(1)
    buffer_load_dwordx4 v238, s[4:7], s44 offen offset:2176 nt lds
    v_mfma_f32_16x16x32_bf16 v[36:39], a[240:243], v[192:195], v[36:39]
    s_add_u32 m0, s52, 135168
    ds_read_b64_tr_b16 a[246:247], v236 offset:26624
    ds_read_b64_tr_b16 a[248:249], v232 offset:17408
    v_mfma_f32_16x16x32_bf16 v[40:43], a[240:243], v[196:199], v[40:43]
    s_add_u32 s44, s44, 8192
    ds_read_b64_tr_b16 a[250:251], v232 offset:21504
    ds_read_b64_tr_b16 a[252:253], v233 offset:17408
    v_mfma_f32_16x16x32_bf16 v[44:47], a[240:243], v[200:203], v[44:47]
    s_waitcnt lgkmcnt(3)
    v_exp_f32 v144, v144
    v_mfma_f32_16x16x32_bf16 a[192:195], a[244:247], a[216:219], a[192:195]
    ds_read_b64_tr_b16 a[254:255], v233 offset:21504
    v_add_f32 v224, v224, v144
    v_mfma_f32_16x16x32_bf16 a[196:199], a[244:247], a[220:223], a[196:199]
    v_exp_f32 v145, v145
    v_mfma_f32_16x16x32_bf16 a[200:203], a[244:247], a[224:227], a[200:203]
    v_exp_f32 v146, v146
    v_mfma_f32_16x16x32_bf16 a[204:207], a[244:247], a[228:231], a[204:207]
    buffer_load_dwordx4 v239, s[20:23], s54 offen lds
    s_add_u32 s54, s61, 73728
    v_mfma_f32_16x16x32_bf16 a[208:211], a[244:247], a[232:235], a[208:211]
    s_add_u32 m0, s52, 139264
    ds_read_b64_tr_b16 v[216:217], v234 offset:17408
    v_add_f32 v224, v224, v145
    v_mfma_f32_16x16x32_bf16 a[212:215], a[244:247], a[236:239], a[212:215]
    s_waitcnt lgkmcnt(3)
    ds_read_b64_tr_b16 v[218:219], v234 offset:21504
    v_add_f32 v224, v224, v146
    v_mfma_f32_16x16x32_bf16 v[48:51], a[248:251], v[192:195], v[48:51]
    v_exp_f32 v147, v147
    ds_read_b64_tr_b16 v[220:221], v235 offset:17408
    ds_read_b64_tr_b16 v[222:223], v235 offset:21504
    v_mfma_f32_16x16x32_bf16 v[52:55], a[248:251], v[196:199], v[52:55]
    buffer_load_dwordx4 v239, s[20:23], s54 offen lds
    s_add_u32 m0, s51, 8192
    v_mfma_f32_16x16x32_bf16 v[56:59], a[248:251], v[200:203], v[56:59]
    s_waitcnt lgkmcnt(4)
    v_exp_f32 v148, v148
    v_mfma_f32_16x16x32_bf16 v[60:63], a[252:255], v[192:195], v[60:63]
    buffer_load_dwordx4 v238, s[8:11], s45 offen nt lds
    v_mfma_f32_16x16x32_bf16 v[64:67], a[252:255], v[196:199], v[64:67]
    s_waitcnt vmcnt(9) lgkmcnt(0)
    s_barrier
    ds_read_b128 a[216:219], v237 offset:12288
    v_mfma_f32_16x16x32_bf16 v[68:71], a[252:255], v[200:203], v[68:71]
    s_add_u32 s54, s62, 73728
    ds_read_b64_tr_b16 a[240:241], v236 offset:16384
    v_add_f32 v224, v224, v147
    v_mfma_f32_16x16x32_bf16 v[72:75], v[216:219], v[192:195], v[72:75]
    ds_read_b64_tr_b16 a[242:243], v236 offset:18432
    v_add_f32 v225, v225, v148
    v_mfma_f32_16x16x32_bf16 v[76:79], v[216:219], v[196:199], v[76:79]
    v_exp_f32 v149, v149
    v_mfma_f32_16x16x32_bf16 v[80:83], v[216:219], v[200:203], v[80:83]
    ds_read_b128 a[220:223], v237 offset:13312
    v_add_f32 v225, v225, v149
    v_mfma_f32_16x16x32_bf16 v[84:87], v[220:223], v[192:195], v[84:87]
    ds_read_b128 a[224:227], v237 offset:14336
    ds_read_b128 a[228:231], v237 offset:15360
    v_mfma_f32_16x16x32_bf16 v[88:91], v[220:223], v[196:199], v[88:91]
    buffer_load_dwordx4 v238, s[8:11], s45 offen offset:2048 nt lds
    s_add_u32 m0, s51, 9088
    v_mfma_f32_16x16x32_bf16 v[92:95], v[220:223], v[200:203], v[92:95]
    s_waitcnt lgkmcnt(3)
    ds_read_b128 a[232:235], v237 offset:16384
    ds_read_b128 a[236:239], v237 offset:17408
    v_mfma_f32_16x16x32_bf16 a[0:3], a[240:243], a[216:219], a[0:3]
    s_waitcnt lgkmcnt(4)
    v_exp_f32 v150, v150
    v_mfma_f32_16x16x32_bf16 a[4:7], a[240:243], a[220:223], a[4:7]
    s_waitcnt lgkmcnt(3)
    buffer_load_dwordx4 v238, s[8:11], s45 offen offset:128 nt lds
    v_mfma_f32_16x16x32_bf16 a[8:11], a[240:243], a[224:227], a[8:11]
    s_waitcnt lgkmcnt(2)
    ds_read_b128 a[244:247], v230 offset:24576
    v_add_f32 v225, v225, v150
    v_mfma_f32_16x16x32_bf16 a[12:15], a[240:243], a[228:231], a[12:15]
    s_waitcnt lgkmcnt(2)
    buffer_load_dwordx4 v238, s[8:11], s45 offen offset:2176 nt lds
    v_mfma_f32_16x16x32_bf16 a[16:19], a[240:243], a[232:235], a[16:19]
    s_waitcnt lgkmcnt(1)
    ds_read_b128 a[248:251], v231 offset:24576
    ds_read_b128 a[252:255], v230 offset:25600
    v_mfma_f32_16x16x32_bf16 a[20:23], a[240:243], a[236:239], a[20:23]
    s_waitcnt lgkmcnt(2)
    v_exp_f32 v151, v151
    v_mfma_f32_16x16x32_bf16 v[168:171], a[244:247], v[96:99], v[204:207]
    s_add_u32 m0, s52, 143360
    v_exp_f32 v152, v152
    v_mfma_f32_16x16x32_bf16 v[172:175], a[244:247], v[100:103], v[208:211]
    s_add_u32 s45, s45, 8192
    ds_read_b128 v[216:219], v231 offset:25600
    v_add_f32 v225, v225, v151
    v_mfma_f32_16x16x32_bf16 v[176:179], a[244:247], v[104:107], v[212:215]
    s_waitcnt lgkmcnt(2)
    ds_read_b64_tr_b16 v[220:221], v236 offset:28672
    v_add_f32 v226, v226, v152
    v_mfma_f32_16x16x32_bf16 v[168:171], a[248:251], v[108:111], v[168:171]
    ds_read_b64_tr_b16 v[222:223], v236 offset:30720
    ds_read_b128 a[240:243], v230 offset:28672
    v_mfma_f32_16x16x32_bf16 v[172:175], a[248:251], v[112:115], v[172:175]
    v_exp_f32 v153, v153
    v_mfma_f32_16x16x32_bf16 v[176:179], a[248:251], v[116:119], v[176:179]
    s_waitcnt lgkmcnt(4)
    v_exp_f32 v154, v154
    v_mfma_f32_16x16x32_bf16 v[168:171], a[252:255], v[120:123], v[168:171]
    ds_read_b128 a[244:247], v231 offset:28672
    v_add_f32 v226, v226, v153
    v_mfma_f32_16x16x32_bf16 v[172:175], a[252:255], v[124:127], v[172:175]
    ds_read_b128 a[248:251], v230 offset:29696
    v_add_f32 v226, v226, v154
    v_mfma_f32_16x16x32_bf16 v[176:179], a[252:255], v[128:131], v[176:179]
    s_waitcnt lgkmcnt(5)
    v_exp_f32 v155, v155
    v_mfma_f32_16x16x32_bf16 v[168:171], v[216:219], v[132:135], v[168:171]
    buffer_load_dwordx4 v239, s[20:23], s54 offen lds
    s_add_u32 m0, s51, 16384
    v_mfma_f32_16x16x32_bf16 v[172:175], v[216:219], v[136:139], v[172:175]
    s_add_u32 s54, s64, 73728
    v_exp_f32 v156, v156
    v_mfma_f32_16x16x32_bf16 v[176:179], v[216:219], v[140:143], v[176:179]
    s_waitcnt lgkmcnt(3)
    ds_read_b128 a[252:255], v231 offset:29696
    v_add_f32 v226, v226, v155
    v_mfma_f32_16x16x32_bf16 a[24:27], v[220:223], a[216:219], a[24:27]
    buffer_load_dwordx4 v238, s[4:7], s44 offen nt lds
    v_mfma_f32_16x16x32_bf16 a[28:31], v[220:223], a[220:223], a[28:31]
    v_exp_f32 v157, v157
    v_mfma_f32_16x16x32_bf16 a[32:35], v[220:223], a[224:227], a[32:35]
    buffer_load_dwordx4 v238, s[4:7], s44 offen offset:2048 nt lds
    s_add_u32 m0, s51, 17280
    v_mfma_f32_16x16x32_bf16 a[36:39], v[220:223], a[228:231], a[36:39]
    v_exp_f32 v158, v158
    v_mfma_f32_16x16x32_bf16 a[40:43], v[220:223], a[232:235], a[40:43]
    v_add_f32 v224, v224, v156
    v_cvt_pk_bf16_f32 v192, v144, v145
    v_mfma_f32_16x16x32_bf16 a[44:47], v[220:223], a[236:239], a[44:47]
    s_waitcnt lgkmcnt(3)
    v_exp_f32 v159, v159
    v_mfma_f32_16x16x32_bf16 v[180:183], a[240:243], v[96:99], v[204:207]
    buffer_load_dwordx4 v238, s[4:7], s44 offen offset:128 nt lds
    v_mfma_f32_16x16x32_bf16 v[184:187], a[240:243], v[100:103], v[208:211]
    v_add_f32 v224, v224, v157
    v_cvt_pk_bf16_f32 v193, v146, v147
    v_mfma_f32_16x16x32_bf16 v[188:191], a[240:243], v[104:107], v[212:215]
    s_waitcnt lgkmcnt(2)
    v_exp_f32 v160, v160
    v_mfma_f32_16x16x32_bf16 v[180:183], a[244:247], v[108:111], v[180:183]
    buffer_load_dwordx4 v238, s[4:7], s44 offen offset:2176 nt lds
    s_add_u32 m0, s52, 155648
    v_mfma_f32_16x16x32_bf16 v[184:187], a[244:247], v[112:115], v[184:187]
    s_waitcnt vmcnt(15) lgkmcnt(0)
    s_barrier
    ds_read_b64_tr_b16 v[216:217], v236
    v_mfma_f32_16x16x32_bf16 v[188:191], a[244:247], v[116:119], v[188:191]
    s_add_u32 s44, s44, 8192
    ds_read_b64_tr_b16 v[218:219], v236 offset:2048
    v_add_f32 v224, v224, v158
    v_mfma_f32_16x16x32_bf16 v[180:183], a[248:251], v[120:123], v[180:183]
    ds_read_b64_tr_b16 v[220:221], v232 offset:32768
    v_add_f32 v224, v224, v159
    v_mfma_f32_16x16x32_bf16 v[184:187], a[248:251], v[124:127], v[184:187]
    ds_read_b64_tr_b16 v[222:223], v232 offset:36864
    v_add_f32 v225, v225, v160
    v_mfma_f32_16x16x32_bf16 v[188:191], a[248:251], v[128:131], v[188:191]
    v_exp_f32 v161, v161
    v_mfma_f32_16x16x32_bf16 v[180:183], a[252:255], v[132:135], v[180:183]
    v_exp_f32 v162, v162
    v_mfma_f32_16x16x32_bf16 v[184:187], a[252:255], v[136:139], v[184:187]
    buffer_load_dwordx4 v239, s[20:23], s54 offen lds
    s_add_u32 s54, s63, 73728
    v_mfma_f32_16x16x32_bf16 v[188:191], a[252:255], v[140:143], v[188:191]
    s_waitcnt lgkmcnt(2)
    ds_read_b64_tr_b16 a[240:241], v233 offset:32768
    v_add_f32 v225, v225, v161
    v_mfma_f32_16x16x32_bf16 a[48:51], v[216:219], a[216:219], a[48:51]
    s_add_u32 m0, s52, 147456
    ds_read_b64_tr_b16 a[242:243], v233 offset:36864
    v_add_f32 v225, v225, v162
    v_mfma_f32_16x16x32_bf16 a[52:55], v[216:219], a[220:223], a[52:55]
    v_exp_f32 v163, v163
    v_mfma_f32_16x16x32_bf16 a[56:59], v[216:219], a[224:227], a[56:59]
    ds_read_b64_tr_b16 a[244:245], v234 offset:32768
    v_add_f32 v225, v225, v163
    v_mfma_f32_16x16x32_bf16 a[60:63], v[216:219], a[228:231], a[60:63]
    ds_read_b64_tr_b16 a[246:247], v234 offset:36864
    v_cvt_pk_bf16_f32 v196, v148, v149
    v_mfma_f32_16x16x32_bf16 a[64:67], v[216:219], a[232:235], a[64:67]
    v_exp_f32 v164, v164
    v_cvt_pk_bf16_f32 v194, v156, v157
    v_cvt_pk_bf16_f32 v195, v158, v159
    v_mfma_f32_16x16x32_bf16 a[68:71], v[216:219], a[236:239], a[68:71]
    s_waitcnt lgkmcnt(4)
    v_exp_f32 v165, v165
    v_cvt_pk_bf16_f32 v197, v150, v151
    v_cvt_pk_bf16_f32 v198, v160, v161
    v_cvt_pk_bf16_f32 v199, v162, v163
    v_mfma_f32_16x16x32_bf16 v[0:3], v[220:223], v[192:195], v[0:3]
    ds_read_b64_tr_b16 a[248:249], v235 offset:32768
    v_add_f32 v226, v226, v164
    v_exp_f32 v166, v166
    v_exp_f32 v167, v167
    v_cvt_pk_bf16_f32 v200, v152, v153
    v_cvt_pk_bf16_f32 v201, v154, v155
    v_cvt_pk_bf16_f32 v202, v164, v165
    v_cvt_pk_bf16_f32 v203, v166, v167
    v_mfma_f32_16x16x32_bf16 v[4:7], v[220:223], v[196:199], v[4:7]
    ds_read_b64_tr_b16 a[250:251], v235 offset:36864
    v_add_f32 v226, v226, v165
    v_mfma_f32_16x16x32_bf16 v[8:11], v[220:223], v[200:203], v[8:11]
    s_waitcnt lgkmcnt(4)
    ds_read_b64_tr_b16 a[252:253], v236 offset:20480
    v_add_f32 v226, v226, v166
    v_mfma_f32_16x16x32_bf16 v[12:15], a[240:243], v[192:195], v[12:15]
    ds_read_b64_tr_b16 a[254:255], v236 offset:22528
    v_add_f32 v226, v226, v167
    v_mfma_f32_16x16x32_bf16 v[16:19], a[240:243], v[196:199], v[16:19]
    ds_read_b64_tr_b16 v[216:217], v232 offset:33792
    ds_read_b64_tr_b16 v[218:219], v232 offset:37888
    v_mfma_f32_16x16x32_bf16 v[20:23], a[240:243], v[200:203], v[20:23]
    s_waitcnt lgkmcnt(6)
    v_exp_f32 v168, v168
    v_mfma_f32_16x16x32_bf16 v[24:27], a[244:247], v[192:195], v[24:27]
    ds_read_b64_tr_b16 v[220:221], v233 offset:33792
    v_add_f32 v224, v224, v168
    v_mfma_f32_16x16x32_bf16 v[28:31], a[244:247], v[196:199], v[28:31]
    ds_read_b64_tr_b16 v[222:223], v233 offset:37888
    ds_read_b64_tr_b16 a[240:241], v234 offset:33792
    v_mfma_f32_16x16x32_bf16 v[32:35], a[244:247], v[200:203], v[32:35]
    s_waitcnt lgkmcnt(7)
    v_exp_f32 v169, v169
    v_mfma_f32_16x16x32_bf16 v[36:39], a[248:251], v[192:195], v[36:39]
    v_exp_f32 v170, v170
    v_mfma_f32_16x16x32_bf16 v[40:43], a[248:251], v[196:199], v[40:43]
    buffer_load_dwordx4 v239, s[20:23], s54 offen lds
    s_add_u32 m0, s51, 24576
    v_mfma_f32_16x16x32_bf16 v[44:47], a[248:251], v[200:203], v[44:47]
    s_waitcnt lgkmcnt(5)
    ds_read_b64_tr_b16 a[242:243], v234 offset:37888
    v_add_f32 v224, v224, v169
    v_mfma_f32_16x16x32_bf16 a[72:75], a[252:255], a[216:219], a[72:75]
    s_add_u32 s54, s57, 110592
    v_exp_f32 v171, v171
    v_mfma_f32_16x16x32_bf16 a[76:79], a[252:255], a[220:223], a[76:79]
    buffer_load_dwordx4 v238, s[8:11], s45 offen nt lds
    v_mfma_f32_16x16x32_bf16 a[80:83], a[252:255], a[224:227], a[80:83]
    ds_read_b64_tr_b16 a[244:245], v235 offset:33792
    v_add_f32 v224, v224, v170
    v_mfma_f32_16x16x32_bf16 a[84:87], a[252:255], a[228:231], a[84:87]
    ds_read_b64_tr_b16 a[246:247], v235 offset:37888
    v_add_f32 v224, v224, v171
    v_mfma_f32_16x16x32_bf16 a[88:91], a[252:255], a[232:235], a[88:91]
    v_exp_f32 v172, v172
    v_mfma_f32_16x16x32_bf16 a[92:95], a[252:255], a[236:239], a[92:95]
    s_waitcnt lgkmcnt(6)
    buffer_load_dwordx4 v238, s[8:11], s45 offen offset:2048 nt lds
    v_mfma_f32_16x16x32_bf16 v[48:51], v[216:219], v[192:195], v[48:51]
    s_add_u32 m0, s51, 25472
    v_exp_f32 v173, v173
    v_mfma_f32_16x16x32_bf16 v[52:55], v[216:219], v[196:199], v[52:55]
    buffer_load_dwordx4 v238, s[8:11], s45 offen offset:128 nt lds
    v_mfma_f32_16x16x32_bf16 v[56:59], v[216:219], v[200:203], v[56:59]
    s_waitcnt lgkmcnt(4)
    v_exp_f32 v174, v174
    v_mfma_f32_16x16x32_bf16 v[60:63], v[220:223], v[192:195], v[60:63]
    buffer_load_dwordx4 v238, s[8:11], s45 offen offset:2176 nt lds
    s_add_u32 m0, s52, 159744
    v_mfma_f32_16x16x32_bf16 v[64:67], v[220:223], v[196:199], v[64:67]
    s_waitcnt vmcnt(15) lgkmcnt(0)
    s_barrier
    ds_read_b64_tr_b16 a[248:249], v236 offset:4096
    v_mfma_f32_16x16x32_bf16 v[68:71], v[220:223], v[200:203], v[68:71]
    s_add_u32 s45, s45, 8192
    ds_read_b64_tr_b16 a[250:251], v236 offset:6144
    v_add_f32 v225, v225, v172
    v_mfma_f32_16x16x32_bf16 v[72:75], a[240:243], v[192:195], v[72:75]
    ds_read_b128 a[252:255], v230
    v_add_f32 v225, v225, v173
    v_mfma_f32_16x16x32_bf16 v[76:79], a[240:243], v[196:199], v[76:79]
    buffer_load_dwordx4 v239, s[20:23], s54 offen lds
    s_add_u32 s54, s56, 110592
    v_mfma_f32_16x16x32_bf16 v[80:83], a[240:243], v[200:203], v[80:83]
    s_add_u32 m0, s52, 131072
    ds_read_b128 v[216:219], v231
    v_add_f32 v225, v225, v174
    v_mfma_f32_16x16x32_bf16 v[84:87], a[244:247], v[192:195], v[84:87]
    v_exp_f32 v175, v175
    v_mfma_f32_16x16x32_bf16 v[88:91], a[244:247], v[196:199], v[88:91]
    ds_read_b128 v[220:223], v230 offset:1024
    v_add_f32 v225, v225, v175
    v_mfma_f32_16x16x32_bf16 v[92:95], a[244:247], v[200:203], v[92:95]
    s_waitcnt lgkmcnt(3)
    v_exp_f32 v176, v176
    v_mfma_f32_16x16x32_bf16 a[96:99], a[248:251], a[216:219], a[96:99]
    ds_read_b128 a[240:243], v231 offset:1024
    v_add_f32 v226, v226, v176
    v_mfma_f32_16x16x32_bf16 a[100:103], a[248:251], a[220:223], a[100:103]
    ds_read_b64_tr_b16 a[244:245], v236 offset:8192
    ds_read_b64_tr_b16 a[246:247], v236 offset:10240
    v_mfma_f32_16x16x32_bf16 a[104:107], a[248:251], a[224:227], a[104:107]
    v_exp_f32 v177, v177
    v_mfma_f32_16x16x32_bf16 a[108:111], a[248:251], a[228:231], a[108:111]
    v_exp_f32 v178, v178
    v_mfma_f32_16x16x32_bf16 a[112:115], a[248:251], a[232:235], a[112:115]
    v_add_f32 v226, v226, v177
    v_cvt_pk_bf16_f32 v192, v168, v169
    v_mfma_f32_16x16x32_bf16 a[116:119], a[248:251], a[236:239], a[116:119]
    s_waitcnt lgkmcnt(5)
    ds_read_b128 a[248:251], v230 offset:4096
    v_add_f32 v226, v226, v178
    v_mfma_f32_16x16x32_bf16 v[144:147], a[252:255], v[96:99], v[204:207]
    v_exp_f32 v179, v179
    v_mfma_f32_16x16x32_bf16 v[148:151], a[252:255], v[100:103], v[208:211]
    buffer_load_dwordx4 v239, s[20:23], s54 offen lds
    s_add_u32 m0, s51, 32768
    v_mfma_f32_16x16x32_bf16 v[152:155], a[252:255], v[104:107], v[212:215]
    s_waitcnt lgkmcnt(5)
    ds_read_b128 a[252:255], v231 offset:4096
    v_add_f32 v226, v226, v179
    v_mfma_f32_16x16x32_bf16 v[144:147], v[216:219], v[108:111], v[144:147]
    s_add_u32 s54, s59, 110592
    v_exp_f32 v180, v180
    v_mfma_f32_16x16x32_bf16 v[148:151], v[216:219], v[112:115], v[148:151]
    buffer_load_dwordx4 v238, s[4:7], s44 offen nt lds
    v_mfma_f32_16x16x32_bf16 v[152:155], v[216:219], v[116:119], v[152:155]
    s_waitcnt lgkmcnt(5)
    ds_read_b128 v[216:219], v230 offset:5120
    v_add_f32 v224, v224, v180
    v_mfma_f32_16x16x32_bf16 v[144:147], v[220:223], v[120:123], v[144:147]
    v_exp_f32 v181, v181
    v_mfma_f32_16x16x32_bf16 v[148:151], v[220:223], v[124:127], v[148:151]
    buffer_load_dwordx4 v238, s[4:7], s44 offen offset:2048 nt lds
    s_add_u32 m0, s51, 33664
    v_mfma_f32_16x16x32_bf16 v[152:155], v[220:223], v[128:131], v[152:155]
    s_waitcnt lgkmcnt(5)
    ds_read_b128 v[220:223], v231 offset:5120
    v_add_f32 v224, v224, v181
    v_mfma_f32_16x16x32_bf16 v[144:147], a[240:243], v[132:135], v[144:147]
    v_exp_f32 v182, v182
    v_mfma_f32_16x16x32_bf16 v[148:151], a[240:243], v[136:139], v[148:151]
    v_exp_f32 v183, v183
    v_mfma_f32_16x16x32_bf16 v[152:155], a[240:243], v[140:143], v[152:155]
    s_waitcnt lgkmcnt(4)
    buffer_load_dwordx4 v238, s[4:7], s44 offen offset:128 nt lds
    v_mfma_f32_16x16x32_bf16 a[120:123], a[244:247], a[216:219], a[120:123]
    v_exp_f32 v184, v184
    v_mfma_f32_16x16x32_bf16 a[124:127], a[244:247], a[220:223], a[124:127]
    buffer_load_dwordx4 v238, s[4:7], s44 offen offset:2176 nt lds
    s_add_u32 m0, s52, 151552
    v_mfma_f32_16x16x32_bf16 a[128:131], a[244:247], a[224:227], a[128:131]
    s_add_u32 s44, s44, 8192
    v_add_f32 v224, v224, v182
    v_add_f32 v225, v225, v184
    v_mfma_f32_16x16x32_bf16 a[132:135], a[244:247], a[228:231], a[132:135]
    v_exp_f32 v185, v185
    v_mfma_f32_16x16x32_bf16 a[136:139], a[244:247], a[232:235], a[136:139]
    v_add_f32 v224, v224, v183
    v_add_f32 v225, v225, v185
    v_mfma_f32_16x16x32_bf16 a[140:143], a[244:247], a[236:239], a[140:143]
    s_waitcnt lgkmcnt(3)
    v_exp_f32 v186, v186
    v_mfma_f32_16x16x32_bf16 v[156:159], a[248:251], v[96:99], v[204:207]
    buffer_load_dwordx4 v239, s[20:23], s54 offen lds
    v_mfma_f32_16x16x32_bf16 v[160:163], a[248:251], v[100:103], v[208:211]
    v_exp_f32 v187, v187
    v_mfma_f32_16x16x32_bf16 v[164:167], a[248:251], v[104:107], v[212:215]
    s_waitcnt lgkmcnt(2)
    v_exp_f32 v188, v188
    v_mfma_f32_16x16x32_bf16 v[156:159], a[252:255], v[108:111], v[156:159]
    v_add_f32 v225, v225, v186
    v_cvt_pk_bf16_f32 v193, v170, v171
    v_mfma_f32_16x16x32_bf16 v[160:163], a[252:255], v[112:115], v[160:163]
    s_waitcnt vmcnt(11) lgkmcnt(0)
    s_barrier
    ds_read_b64_tr_b16 a[240:241], v236 offset:12288
    v_mfma_f32_16x16x32_bf16 v[164:167], a[252:255], v[116:119], v[164:167]
    s_add_u32 s54, s58, 110592
    ds_read_b64_tr_b16 a[242:243], v236 offset:14336
    v_add_f32 v225, v225, v187
    v_mfma_f32_16x16x32_bf16 v[156:159], v[216:219], v[120:123], v[156:159]
    s_add_u32 m0, s52, 135168
    ds_read_b64_tr_b16 a[244:245], v232 offset:8192
    v_add_f32 v226, v226, v188
    v_mfma_f32_16x16x32_bf16 v[160:163], v[216:219], v[124:127], v[160:163]
    ds_read_b64_tr_b16 a[246:247], v232 offset:12288
    v_cvt_pk_bf16_f32 v196, v172, v173
    v_mfma_f32_16x16x32_bf16 v[164:167], v[216:219], v[128:131], v[164:167]
    ds_read_b64_tr_b16 a[248:249], v233 offset:8192
    v_cvt_pk_bf16_f32 v197, v174, v175
    v_mfma_f32_16x16x32_bf16 v[156:159], v[220:223], v[132:135], v[156:159]
    ds_read_b64_tr_b16 a[250:251], v233 offset:12288
    v_cvt_pk_bf16_f32 v200, v176, v177
    v_mfma_f32_16x16x32_bf16 v[160:163], v[220:223], v[136:139], v[160:163]
    ds_read_b64_tr_b16 a[252:253], v234 offset:8192
    v_cvt_pk_bf16_f32 v201, v178, v179
    v_mfma_f32_16x16x32_bf16 v[164:167], v[220:223], v[140:143], v[164:167]
    s_waitcnt lgkmcnt(5)
    ds_read_b64_tr_b16 a[254:255], v234 offset:12288
    v_cvt_pk_bf16_f32 v194, v180, v181
    v_mfma_f32_16x16x32_bf16 a[144:147], a[240:243], a[216:219], a[144:147]
    v_exp_f32 v189, v189
    v_mfma_f32_16x16x32_bf16 a[148:151], a[240:243], a[220:223], a[148:151]
    ds_read_b64_tr_b16 v[216:217], v235 offset:8192
    v_add_f32 v226, v226, v189
    v_mfma_f32_16x16x32_bf16 a[152:155], a[240:243], a[224:227], a[152:155]
    ds_read_b64_tr_b16 v[218:219], v235 offset:12288
    v_cvt_pk_bf16_f32 v195, v182, v183
    v_mfma_f32_16x16x32_bf16 a[156:159], a[240:243], a[228:231], a[156:159]
    v_exp_f32 v190, v190
    v_mfma_f32_16x16x32_bf16 a[160:163], a[240:243], a[232:235], a[160:163]
    ds_read_b64_tr_b16 v[220:221], v236 offset:16384
    v_add_f32 v226, v226, v190
    v_mfma_f32_16x16x32_bf16 a[164:167], a[240:243], a[236:239], a[164:167]
    s_waitcnt lgkmcnt(7)
    ds_read_b64_tr_b16 v[222:223], v236 offset:18432
    v_cvt_pk_bf16_f32 v198, v184, v185
    v_cvt_pk_bf16_f32 v199, v186, v187
    v_mfma_f32_16x16x32_bf16 v[0:3], a[244:247], v[192:195], v[0:3]
    v_exp_f32 v191, v191
    v_cvt_pk_bf16_f32 v202, v188, v189
    v_cvt_pk_bf16_f32 v203, v190, v191
    v_mfma_f32_16x16x32_bf16 v[4:7], a[244:247], v[196:199], v[4:7]
    ds_read_b64_tr_b16 a[240:241], v232 offset:9216
    v_add_f32 v226, v226, v191
    v_mfma_f32_16x16x32_bf16 v[8:11], a[244:247], v[200:203], v[8:11]
    s_waitcnt lgkmcnt(7)
    ds_read_b64_tr_b16 a[242:243], v232 offset:13312
    ds_read_b64_tr_b16 a[244:245], v233 offset:9216
    v_mfma_f32_16x16x32_bf16 v[12:15], a[248:251], v[192:195], v[12:15]
    v_exp_f32 v144, v144
    v_mfma_f32_16x16x32_bf16 v[16:19], a[248:251], v[196:199], v[16:19]
    ds_read_b64_tr_b16 a[246:247], v233 offset:13312
    v_add_f32 v224, v224, v144
    v_mfma_f32_16x16x32_bf16 v[20:23], a[248:251], v[200:203], v[20:23]
    s_waitcnt lgkmcnt(8)
    v_exp_f32 v145, v145
    v_mfma_f32_16x16x32_bf16 v[24:27], a[252:255], v[192:195], v[24:27]
    v_exp_f32 v146, v146
    v_mfma_f32_16x16x32_bf16 v[28:31], a[252:255], v[196:199], v[28:31]
    buffer_load_dwordx4 v239, s[20:23], s54 offen lds
    s_add_u32 s54, s60, 110592
    v_mfma_f32_16x16x32_bf16 v[32:35], a[252:255], v[200:203], v[32:35]
    s_waitcnt lgkmcnt(6)
    ds_read_b64_tr_b16 a[248:249], v234 offset:9216
    v_add_f32 v224, v224, v145
    v_mfma_f32_16x16x32_bf16 v[36:39], v[216:219], v[192:195], v[36:39]
    s_add_u32 m0, s52, 139264
    ds_read_b64_tr_b16 a[250:251], v234 offset:13312
    v_add_f32 v224, v224, v146
    v_mfma_f32_16x16x32_bf16 v[40:43], v[216:219], v[196:199], v[40:43]
    v_exp_f32 v147, v147
    v_mfma_f32_16x16x32_bf16 v[44:47], v[216:219], v[200:203], v[44:47]
    s_waitcnt lgkmcnt(6)
    buffer_load_dwordx4 v239, s[20:23], s54 offen lds
    v_mfma_f32_16x16x32_bf16 a[168:171], v[220:223], a[216:219], a[168:171]
    s_add_u32 m0, s51, 0
    ds_read_b64_tr_b16 a[252:253], v235 offset:9216
    v_add_f32 v224, v224, v147
    v_mfma_f32_16x16x32_bf16 a[172:175], v[220:223], a[220:223], a[172:175]
    v_exp_f32 v148, v148
    v_mfma_f32_16x16x32_bf16 a[176:179], v[220:223], a[224:227], a[176:179]
    ds_read_b64_tr_b16 a[254:255], v235 offset:13312
    v_add_f32 v225, v225, v148
    v_mfma_f32_16x16x32_bf16 a[180:183], v[220:223], a[228:231], a[180:183]
    buffer_load_dwordx4 v238, s[8:11], s45 offen nt lds
    v_mfma_f32_16x16x32_bf16 a[184:187], v[220:223], a[232:235], a[184:187]
    v_exp_f32 v149, v149
    v_mfma_f32_16x16x32_bf16 a[188:191], v[220:223], a[236:239], a[188:191]
    s_waitcnt lgkmcnt(6)
    buffer_load_dwordx4 v238, s[8:11], s45 offen offset:2048 nt lds
    v_mfma_f32_16x16x32_bf16 v[48:51], a[240:243], v[192:195], v[48:51]
    s_add_u32 m0, s51, 896
    v_exp_f32 v150, v150
    v_mfma_f32_16x16x32_bf16 v[52:55], a[240:243], v[196:199], v[52:55]
    buffer_load_dwordx4 v238, s[8:11], s45 offen offset:128 nt lds
    v_mfma_f32_16x16x32_bf16 v[56:59], a[240:243], v[200:203], v[56:59]
    s_waitcnt lgkmcnt(4)
    buffer_load_dwordx4 v238, s[8:11], s45 offen offset:2176 nt lds
    v_mfma_f32_16x16x32_bf16 v[60:63], a[244:247], v[192:195], v[60:63]
    s_add_u32 s45, s45, 8192
    v_add_f32 v225, v225, v149
    v_mfma_f32_16x16x32_bf16 v[64:67], a[244:247], v[196:199], v[64:67]
    s_waitcnt vmcnt(11) lgkmcnt(0)
    s_barrier
    ds_read_b64_tr_b16 v[216:217], v236 offset:24576
    v_mfma_f32_16x16x32_bf16 v[68:71], a[244:247], v[200:203], v[68:71]
    s_add_u32 s54, s61, 110592
    ds_read_b64_tr_b16 v[218:219], v236 offset:26624
    v_add_f32 v225, v225, v150
    v_mfma_f32_16x16x32_bf16 v[72:75], a[248:251], v[192:195], v[72:75]
    s_add_u32 m0, s52, 143360
    ds_read_b128 v[220:223], v230 offset:16384
    ds_read_b128 a[240:243], v231 offset:16384
    v_mfma_f32_16x16x32_bf16 v[76:79], a[248:251], v[196:199], v[76:79]
    v_exp_f32 v151, v151
    v_mfma_f32_16x16x32_bf16 v[80:83], a[248:251], v[200:203], v[80:83]
    ds_read_b128 a[244:247], v230 offset:17408
    v_add_f32 v225, v225, v151
    v_mfma_f32_16x16x32_bf16 v[84:87], a[252:255], v[192:195], v[84:87]
    v_exp_f32 v152, v152
    v_mfma_f32_16x16x32_bf16 v[88:91], a[252:255], v[196:199], v[88:91]
    ds_read_b128 a[248:251], v231 offset:17408
    v_add_f32 v226, v226, v152
    v_mfma_f32_16x16x32_bf16 v[92:95], a[252:255], v[200:203], v[92:95]
    s_waitcnt lgkmcnt(4)
    ds_read_b64_tr_b16 a[252:253], v236
    ds_read_b64_tr_b16 a[254:255], v236 offset:2048
    v_mfma_f32_16x16x32_bf16 a[192:195], v[216:219], a[216:219], a[192:195]
    ds_read_b128 a[216:219], v237 offset:18432
    v_cvt_pk_bf16_f32 v192, v144, v145
    v_mfma_f32_16x16x32_bf16 a[196:199], v[216:219], a[220:223], a[196:199]
    v_exp_f32 v153, v153
    v_mfma_f32_16x16x32_bf16 a[200:203], v[216:219], a[224:227], a[200:203]
    ds_read_b128 a[220:223], v237 offset:19456
    v_add_f32 v226, v226, v153
    v_mfma_f32_16x16x32_bf16 a[204:207], v[216:219], a[228:231], a[204:207]
    ds_read_b128 a[224:227], v237 offset:20480
    ds_read_b128 a[228:231], v237 offset:21504
    v_mfma_f32_16x16x32_bf16 a[208:211], v[216:219], a[232:235], a[208:211]
    ds_read_b128 a[232:235], v237 offset:22528
    v_cvt_pk_bf16_f32 v193, v146, v147
    v_mfma_f32_16x16x32_bf16 a[212:215], v[216:219], a[236:239], a[212:215]
    s_waitcnt lgkmcnt(10)
    v_exp_f32 v154, v154
    v_mfma_f32_16x16x32_bf16 v[168:171], v[220:223], v[96:99], v[204:207]
    ds_read_b128 a[236:239], v237 offset:23552
    v_add_f32 v226, v226, v154
    v_mfma_f32_16x16x32_bf16 v[172:175], v[220:223], v[100:103], v[208:211]
    ds_read_b128 v[216:219], v230 offset:20480
    v_cvt_pk_bf16_f32 v196, v148, v149
    v_mfma_f32_16x16x32_bf16 v[176:179], v[220:223], v[104:107], v[212:215]
    s_waitcnt lgkmcnt(11)
    ds_read_b128 v[220:223], v231 offset:20480
    v_cvt_pk_bf16_f32 v197, v150, v151
    v_mfma_f32_16x16x32_bf16 v[168:171], a[240:243], v[108:111], v[168:171]
    v_exp_f32 v155, v155
    v_mfma_f32_16x16x32_bf16 v[172:175], a[240:243], v[112:115], v[172:175]
    buffer_load_dwordx4 v239, s[20:23], s54 offen lds
    s_add_u32 s54, s62, 110592
    v_mfma_f32_16x16x32_bf16 v[176:179], a[240:243], v[116:119], v[176:179]
    s_waitcnt lgkmcnt(11)
    ds_read_b128 a[240:243], v230 offset:21504
    v_add_f32 v226, v226, v155
    v_mfma_f32_16x16x32_bf16 v[168:171], a[244:247], v[120:123], v[168:171]
    s_add_u32 m0, s52, 147456
    v_exp_f32 v156, v156
    v_mfma_f32_16x16x32_bf16 v[172:175], a[244:247], v[124:127], v[172:175]
    buffer_load_dwordx4 v239, s[20:23], s54 offen lds
    s_add_u32 m0, s51, 8192
    v_mfma_f32_16x16x32_bf16 v[176:179], a[244:247], v[128:131], v[176:179]
    s_waitcnt lgkmcnt(11)
    ds_read_b128 a[244:247], v231 offset:21504
    v_add_f32 v224, v224, v156
    v_mfma_f32_16x16x32_bf16 v[168:171], a[248:251], v[132:135], v[168:171]
    v_exp_f32 v157, v157
    v_mfma_f32_16x16x32_bf16 v[172:175], a[248:251], v[136:139], v[172:175]
    buffer_load_dwordx4 v238, s[4:7], s44 offen nt lds
    v_mfma_f32_16x16x32_bf16 v[176:179], a[248:251], v[140:143], v[176:179]
    s_waitcnt lgkmcnt(9)
    v_exp_f32 v158, v158
    v_mfma_f32_16x16x32_bf16 a[0:3], a[252:255], a[216:219], a[0:3]
    s_waitcnt lgkmcnt(8)
    v_exp_f32 v159, v159
    v_mfma_f32_16x16x32_bf16 a[4:7], a[252:255], a[220:223], a[4:7]
    s_waitcnt lgkmcnt(7)
    buffer_load_dwordx4 v238, s[4:7], s44 offen offset:2048 nt lds
    v_mfma_f32_16x16x32_bf16 a[8:11], a[252:255], a[224:227], a[8:11]
    s_waitcnt lgkmcnt(6)
    v_add_f32 v224, v224, v157
    v_cvt_pk_bf16_f32 v200, v152, v153
    v_mfma_f32_16x16x32_bf16 a[12:15], a[252:255], a[228:231], a[12:15]
    s_waitcnt lgkmcnt(5)
    v_exp_f32 v160, v160
    v_mfma_f32_16x16x32_bf16 a[16:19], a[252:255], a[232:235], a[16:19]
    s_waitcnt lgkmcnt(4)
    v_add_f32 v224, v224, v158
    v_add_f32 v225, v225, v160
    v_mfma_f32_16x16x32_bf16 a[20:23], a[252:255], a[236:239], a[20:23]
    s_waitcnt lgkmcnt(3)
    v_exp_f32 v161, v161
    v_mfma_f32_16x16x32_bf16 v[180:183], v[216:219], v[96:99], v[204:207]
    s_add_u32 m0, s51, 9088
    v_add_f32 v224, v224, v159
    v_add_f32 v225, v225, v161
    v_mfma_f32_16x16x32_bf16 v[184:187], v[216:219], v[100:103], v[208:211]
    buffer_load_dwordx4 v238, s[4:7], s44 offen offset:128 nt lds
    v_mfma_f32_16x16x32_bf16 v[188:191], v[216:219], v[104:107], v[212:215]
    s_waitcnt lgkmcnt(2)
    v_exp_f32 v162, v162
    v_mfma_f32_16x16x32_bf16 v[180:183], v[220:223], v[108:111], v[180:183]
    buffer_load_dwordx4 v238, s[4:7], s44 offen offset:2176 nt lds
    s_add_u32 s44, s44, 8192
    v_mfma_f32_16x16x32_bf16 v[184:187], v[220:223], v[112:115], v[184:187]
    s_waitcnt vmcnt(11) lgkmcnt(0)
    s_barrier
    ds_read_b64_tr_b16 a[248:249], v236 offset:28672
    v_mfma_f32_16x16x32_bf16 v[188:191], v[220:223], v[116:119], v[188:191]
    s_add_u32 s54, s63, 110592
    ds_read_b64_tr_b16 a[250:251], v236 offset:30720
    v_add_f32 v225, v225, v162
    v_mfma_f32_16x16x32_bf16 v[180:183], a[240:243], v[120:123], v[180:183]
    s_add_u32 m0, s52, 131072
    ds_read_b64_tr_b16 a[252:253], v232 offset:24576
    v_cvt_pk_bf16_f32 v201, v154, v155
    v_mfma_f32_16x16x32_bf16 v[184:187], a[240:243], v[124:127], v[184:187]
    ds_read_b64_tr_b16 a[254:255], v232 offset:28672
    v_cvt_pk_bf16_f32 v194, v156, v157
    v_mfma_f32_16x16x32_bf16 v[188:191], a[240:243], v[128:131], v[188:191]
    ds_read_b64_tr_b16 v[216:217], v233 offset:24576
    v_cvt_pk_bf16_f32 v195, v158, v159
    v_mfma_f32_16x16x32_bf16 v[180:183], a[244:247], v[132:135], v[180:183]
    ds_read_b64_tr_b16 v[218:219], v233 offset:28672
    v_cvt_pk_bf16_f32 v198, v160, v161
    v_mfma_f32_16x16x32_bf16 v[184:187], a[244:247], v[136:139], v[184:187]
    v_exp_f32 v163, v163
    v_mfma_f32_16x16x32_bf16 v[188:191], a[244:247], v[140:143], v[188:191]
    s_waitcnt lgkmcnt(4)
    ds_read_b64_tr_b16 v[220:221], v234 offset:24576
    v_add_f32 v225, v225, v163
    v_mfma_f32_16x16x32_bf16 a[24:27], a[248:251], a[216:219], a[24:27]
    ds_read_b64_tr_b16 v[222:223], v234 offset:28672
    v_cvt_pk_bf16_f32 v199, v162, v163
    v_mfma_f32_16x16x32_bf16 a[28:31], a[248:251], a[220:223], a[28:31]
    v_exp_f32 v164, v164
    v_mfma_f32_16x16x32_bf16 a[32:35], a[248:251], a[224:227], a[32:35]
    v_exp_f32 v165, v165
    v_mfma_f32_16x16x32_bf16 a[36:39], a[248:251], a[228:231], a[36:39]
    ds_read_b64_tr_b16 a[240:241], v235 offset:24576
    v_add_f32 v226, v226, v164
    v_mfma_f32_16x16x32_bf16 a[40:43], a[248:251], a[232:235], a[40:43]
    ds_read_b64_tr_b16 a[242:243], v235 offset:28672
    v_add_f32 v226, v226, v165
    v_mfma_f32_16x16x32_bf16 a[44:47], a[248:251], a[236:239], a[44:47]
    s_waitcnt lgkmcnt(6)
    v_exp_f32 v166, v166
    v_mfma_f32_16x16x32_bf16 v[0:3], a[252:255], v[192:195], v[0:3]
    ds_read_b64_tr_b16 a[244:245], v236 offset:4096
    v_add_f32 v226, v226, v166
    v_exp_f32 v167, v167
    v_cvt_pk_bf16_f32 v202, v164, v165
    v_cvt_pk_bf16_f32 v203, v166, v167
    v_mfma_f32_16x16x32_bf16 v[4:7], a[252:255], v[196:199], v[4:7]
    ds_read_b64_tr_b16 a[246:247], v236 offset:6144
    v_add_f32 v226, v226, v167
    v_mfma_f32_16x16x32_bf16 v[8:11], a[252:255], v[200:203], v[8:11]
    s_waitcnt lgkmcnt(6)
    ds_read_b64_tr_b16 a[248:249], v232 offset:25600
    ds_read_b64_tr_b16 a[250:251], v232 offset:29696
    v_mfma_f32_16x16x32_bf16 v[12:15], v[216:219], v[192:195], v[12:15]
    v_exp_f32 v168, v168
    v_mfma_f32_16x16x32_bf16 v[16:19], v[216:219], v[196:199], v[16:19]
    ds_read_b64_tr_b16 a[252:253], v233 offset:25600
    v_add_f32 v224, v224, v168
    v_mfma_f32_16x16x32_bf16 v[20:23], v[216:219], v[200:203], v[20:23]
    s_waitcnt lgkmcnt(7)
    ds_read_b64_tr_b16 a[254:255], v233 offset:29696
    ds_read_b64_tr_b16 v[216:217], v234 offset:25600
    v_mfma_f32_16x16x32_bf16 v[24:27], v[220:223], v[192:195], v[24:27]
    v_exp_f32 v169, v169
    v_mfma_f32_16x16x32_bf16 v[28:31], v[220:223], v[196:199], v[28:31]
    v_exp_f32 v170, v170
    v_mfma_f32_16x16x32_bf16 v[32:35], v[220:223], v[200:203], v[32:35]
    s_waitcnt lgkmcnt(7)
    buffer_load_dwordx4 v239, s[20:23], s54 offen lds
    v_mfma_f32_16x16x32_bf16 v[36:39], a[240:243], v[192:195], v[36:39]
    s_add_u32 s54, s64, 110592
    ds_read_b64_tr_b16 v[218:219], v234 offset:29696
    v_add_f32 v224, v224, v169
    v_mfma_f32_16x16x32_bf16 v[40:43], a[240:243], v[196:199], v[40:43]
    s_add_u32 m0, s52, 155648
    v_exp_f32 v171, v171
    v_mfma_f32_16x16x32_bf16 v[44:47], a[240:243], v[200:203], v[44:47]
    s_waitcnt lgkmcnt(6)
    buffer_load_dwordx4 v239, s[20:23], s54 offen lds
    v_mfma_f32_16x16x32_bf16 a[48:51], a[244:247], a[216:219], a[48:51]
    s_add_u32 m0, s51, 16384
    ds_read_b64_tr_b16 v[220:221], v235 offset:25600
    v_add_f32 v224, v224, v170
    v_mfma_f32_16x16x32_bf16 a[52:55], a[244:247], a[220:223], a[52:55]
    ds_read_b64_tr_b16 v[222:223], v235 offset:29696
    v_add_f32 v224, v224, v171
    v_mfma_f32_16x16x32_bf16 a[56:59], a[244:247], a[224:227], a[56:59]
    v_exp_f32 v172, v172
    v_mfma_f32_16x16x32_bf16 a[60:63], a[244:247], a[228:231], a[60:63]
    buffer_load_dwordx4 v238, s[8:11], s45 offen nt lds
    v_mfma_f32_16x16x32_bf16 a[64:67], a[244:247], a[232:235], a[64:67]
    v_exp_f32 v173, v173
    v_mfma_f32_16x16x32_bf16 a[68:71], a[244:247], a[236:239], a[68:71]
    s_waitcnt lgkmcnt(6)
    buffer_load_dwordx4 v238, s[8:11], s45 offen offset:2048 nt lds
    v_mfma_f32_16x16x32_bf16 v[48:51], a[248:251], v[192:195], v[48:51]
    s_add_u32 m0, s51, 17280
    v_exp_f32 v174, v174
    v_mfma_f32_16x16x32_bf16 v[52:55], a[248:251], v[196:199], v[52:55]
    buffer_load_dwordx4 v238, s[8:11], s45 offen offset:128 nt lds
    v_mfma_f32_16x16x32_bf16 v[56:59], a[248:251], v[200:203], v[56:59]
    s_waitcnt lgkmcnt(4)
    v_add_f32 v225, v225, v172
    v_mfma_f32_16x16x32_bf16 v[60:63], a[252:255], v[192:195], v[60:63]
    buffer_load_dwordx4 v238, s[8:11], s45 offen offset:2176 nt lds
    s_add_u32 s45, s45, 8192
    v_mfma_f32_16x16x32_bf16 v[64:67], a[252:255], v[196:199], v[64:67]
    s_waitcnt vmcnt(16) lgkmcnt(0)
    s_barrier
    ds_read_b64_tr_b16 a[240:241], v236 offset:20480
    v_mfma_f32_16x16x32_bf16 v[68:71], a[252:255], v[200:203], v[68:71]
    s_add_u32 s54, s56, 147456
    ds_read_b64_tr_b16 a[242:243], v236 offset:22528
    v_add_f32 v225, v225, v173
    v_mfma_f32_16x16x32_bf16 v[72:75], v[216:219], v[192:195], v[72:75]
    s_add_u32 m0, s52, 135168
    ds_read_b128 a[244:247], v230 offset:32768
    v_add_f32 v225, v225, v174
    v_mfma_f32_16x16x32_bf16 v[76:79], v[216:219], v[196:199], v[76:79]
    ds_read_b128 a[248:251], v231 offset:32768
    ds_read_b128 a[252:255], v230 offset:33792
    v_mfma_f32_16x16x32_bf16 v[80:83], v[216:219], v[200:203], v[80:83]
    v_exp_f32 v175, v175
    v_mfma_f32_16x16x32_bf16 v[84:87], v[220:223], v[192:195], v[84:87]
    v_exp_f32 v176, v176
    v_mfma_f32_16x16x32_bf16 v[88:91], v[220:223], v[196:199], v[88:91]
    ds_read_b128 v[216:219], v231 offset:33792
    v_add_f32 v225, v225, v175
    v_mfma_f32_16x16x32_bf16 v[92:95], v[220:223], v[200:203], v[92:95]
    s_waitcnt lgkmcnt(4)
    ds_read_b64_tr_b16 v[220:221], v236 offset:8192
    v_add_f32 v226, v226, v176
    v_mfma_f32_16x16x32_bf16 a[72:75], a[240:243], a[216:219], a[72:75]
    ds_read_b64_tr_b16 v[222:223], v236 offset:10240
    v_cvt_pk_bf16_f32 v192, v168, v169
    v_mfma_f32_16x16x32_bf16 a[76:79], a[240:243], a[220:223], a[76:79]
    v_exp_f32 v177, v177
    v_mfma_f32_16x16x32_bf16 a[80:83], a[240:243], a[224:227], a[80:83]
    v_exp_f32 v178, v178
    v_mfma_f32_16x16x32_bf16 a[84:87], a[240:243], a[228:231], a[84:87]
    v_add_f32 v226, v226, v177
    v_cvt_pk_bf16_f32 v193, v170, v171
    v_mfma_f32_16x16x32_bf16 a[88:91], a[240:243], a[232:235], a[88:91]
    v_exp_f32 v179, v179
    v_mfma_f32_16x16x32_bf16 a[92:95], a[240:243], a[236:239], a[92:95]
    s_waitcnt lgkmcnt(5)
    ds_read_b128 a[240:243], v230 offset:36864
    v_add_f32 v226, v226, v178
    v_mfma_f32_16x16x32_bf16 v[144:147], a[244:247], v[96:99], v[204:207]
    buffer_load_dwordx4 v239, s[20:23], s54 offen lds
    s_add_u32 s54, s57, 147456
    v_mfma_f32_16x16x32_bf16 v[148:151], a[244:247], v[100:103], v[208:211]
    s_add_u32 m0, s52, 159744
    v_exp_f32 v180, v180
    v_mfma_f32_16x16x32_bf16 v[152:155], a[244:247], v[104:107], v[212:215]
    s_waitcnt lgkmcnt(5)
    ds_read_b128 a[244:247], v231 offset:36864
    v_add_f32 v226, v226, v179
    v_mfma_f32_16x16x32_bf16 v[144:147], a[248:251], v[108:111], v[144:147]
    buffer_load_dwordx4 v239, s[20:23], s54 offen lds
    s_add_u32 m0, s51, 24576
    v_mfma_f32_16x16x32_bf16 v[148:151], a[248:251], v[112:115], v[148:151]
    v_exp_f32 v181, v181
    v_mfma_f32_16x16x32_bf16 v[152:155], a[248:251], v[116:119], v[152:155]
    s_waitcnt lgkmcnt(5)
    ds_read_b128 a[248:251], v230 offset:37888
    v_add_f32 v224, v224, v180
    v_mfma_f32_16x16x32_bf16 v[144:147], a[252:255], v[120:123], v[144:147]
    buffer_load_dwordx4 v238, s[4:7], s44 offen nt lds
    v_mfma_f32_16x16x32_bf16 v[148:151], a[252:255], v[124:127], v[148:151]
    v_exp_f32 v182, v182
    v_mfma_f32_16x16x32_bf16 v[152:155], a[252:255], v[128:131], v[152:155]
    s_waitcnt lgkmcnt(5)
    ds_read_b128 a[252:255], v231 offset:37888
    v_add_f32 v224, v224, v181
    v_mfma_f32_16x16x32_bf16 v[144:147], v[216:219], v[132:135], v[144:147]
    v_exp_f32 v183, v183
    v_mfma_f32_16x16x32_bf16 v[148:151], v[216:219], v[136:139], v[148:151]
    buffer_load_dwordx4 v238, s[4:7], s44 offen offset:2048 nt lds
    s_add_u32 m0, s51, 25472
    v_mfma_f32_16x16x32_bf16 v[152:155], v[216:219], v[140:143], v[152:155]
    s_waitcnt lgkmcnt(4)
    v_exp_f32 v184, v184
    v_mfma_f32_16x16x32_bf16 a[96:99], v[220:223], a[216:219], a[96:99]
    buffer_load_dwordx4 v238, s[4:7], s44 offen offset:128 nt lds
    v_mfma_f32_16x16x32_bf16 a[100:103], v[220:223], a[220:223], a[100:103]
    v_add_f32 v224, v224, v182
    v_add_f32 v225, v225, v184
    v_mfma_f32_16x16x32_bf16 a[104:107], v[220:223], a[224:227], a[104:107]
    v_exp_f32 v185, v185
    v_mfma_f32_16x16x32_bf16 a[108:111], v[220:223], a[228:231], a[108:111]
    v_add_f32 v224, v224, v183
    v_add_f32 v225, v225, v185
    v_mfma_f32_16x16x32_bf16 a[112:115], v[220:223], a[232:235], a[112:115]
    v_exp_f32 v186, v186
    v_mfma_f32_16x16x32_bf16 a[116:119], v[220:223], a[236:239], a[116:119]
    s_waitcnt lgkmcnt(3)
    buffer_load_dwordx4 v238, s[4:7], s44 offen offset:2176 nt lds
    v_mfma_f32_16x16x32_bf16 v[156:159], a[240:243], v[96:99], v[204:207]
    s_add_u32 s44, s44, 8192
    v_exp_f32 v187, v187
    v_mfma_f32_16x16x32_bf16 v[160:163], a[240:243], v[100:103], v[208:211]
    v_exp_f32 v188, v188
    v_mfma_f32_16x16x32_bf16 v[164:167], a[240:243], v[104:107], v[212:215]
    s_waitcnt lgkmcnt(2)
    v_add_f32 v225, v225, v186
    v_add_f32 v226, v226, v188
    v_mfma_f32_16x16x32_bf16 v[156:159], a[244:247], v[108:111], v[156:159]
    v_exp_f32 v189, v189
    v_mfma_f32_16x16x32_bf16 v[160:163], a[244:247], v[112:115], v[160:163]
    s_waitcnt vmcnt(16) lgkmcnt(0)
    s_barrier
    ds_read_b64_tr_b16 v[216:217], v236 offset:12288
    v_mfma_f32_16x16x32_bf16 v[164:167], a[244:247], v[116:119], v[164:167]
    s_add_u32 s54, s58, 147456
    ds_read_b64_tr_b16 v[218:219], v236 offset:14336
    v_add_f32 v225, v225, v187
    v_mfma_f32_16x16x32_bf16 v[156:159], a[248:251], v[120:123], v[156:159]
    s_add_u32 m0, s52, 139264
    ds_read_b64_tr_b16 v[220:221], v232
    v_cvt_pk_bf16_f32 v196, v172, v173
    v_mfma_f32_16x16x32_bf16 v[160:163], a[248:251], v[124:127], v[160:163]
    s_add_u32 s95, s95, 294912
    ds_read_b64_tr_b16 v[222:223], v232 offset:4096
    v_add_f32 v226, v226, v189
    v_mfma_f32_16x16x32_bf16 v[164:167], a[248:251], v[128:131], v[164:167]
    ds_read_b64_tr_b16 a[240:241], v233
    v_cvt_pk_bf16_f32 v197, v174, v175
    v_mfma_f32_16x16x32_bf16 v[156:159], a[252:255], v[132:135], v[156:159]
    ds_read_b64_tr_b16 a[242:243], v233 offset:4096
    v_cvt_pk_bf16_f32 v200, v176, v177
    v_mfma_f32_16x16x32_bf16 v[160:163], a[252:255], v[136:139], v[160:163]
    ds_read_b64_tr_b16 a[244:245], v234
    v_cvt_pk_bf16_f32 v201, v178, v179
    v_mfma_f32_16x16x32_bf16 v[164:167], a[252:255], v[140:143], v[164:167]
    s_waitcnt lgkmcnt(5)
    ds_read_b64_tr_b16 a[246:247], v234 offset:4096
    v_cvt_pk_bf16_f32 v194, v180, v181
    v_mfma_f32_16x16x32_bf16 a[120:123], v[216:219], a[216:219], a[120:123]
    ds_read_b64_tr_b16 a[248:249], v235
    v_cvt_pk_bf16_f32 v195, v182, v183
    v_mfma_f32_16x16x32_bf16 a[124:127], v[216:219], a[220:223], a[124:127]
    ds_read_b64_tr_b16 a[250:251], v235 offset:4096
    v_cvt_pk_bf16_f32 v198, v184, v185
    v_mfma_f32_16x16x32_bf16 a[128:131], v[216:219], a[224:227], a[128:131]
    v_exp_f32 v190, v190
    v_mfma_f32_16x16x32_bf16 a[132:135], v[216:219], a[228:231], a[132:135]
    ds_read_b64_tr_b16 a[252:253], v236 offset:16384
    v_add_f32 v226, v226, v190
    v_mfma_f32_16x16x32_bf16 a[136:139], v[216:219], a[232:235], a[136:139]
    ds_read_b64_tr_b16 a[254:255], v236 offset:18432
    v_cvt_pk_bf16_f32 v199, v186, v187
    v_mfma_f32_16x16x32_bf16 a[140:143], v[216:219], a[236:239], a[140:143]
    s_waitcnt lgkmcnt(8)
    v_exp_f32 v191, v191
    v_mfma_f32_16x16x32_bf16 v[0:3], v[220:223], v[192:195], v[0:3]
    ds_read_b64_tr_b16 v[216:217], v232 offset:1024
    v_add_f32 v226, v226, v191
    v_cvt_pk_bf16_f32 v202, v188, v189
    v_cvt_pk_bf16_f32 v203, v190, v191
    v_mfma_f32_16x16x32_bf16 v[4:7], v[220:223], v[196:199], v[4:7]
    v_exp_f32 v144, v144
    v_mfma_f32_16x16x32_bf16 v[8:11], v[220:223], v[200:203], v[8:11]
    s_waitcnt lgkmcnt(7)
    ds_read_b64_tr_b16 v[218:219], v232 offset:5120
    v_add_f32 v224, v224, v144
    v_mfma_f32_16x16x32_bf16 v[12:15], a[240:243], v[192:195], v[12:15]
    ds_read_b64_tr_b16 v[220:221], v233 offset:1024
    ds_read_b64_tr_b16 v[222:223], v233 offset:5120
    v_mfma_f32_16x16x32_bf16 v[16:19], a[240:243], v[196:199], v[16:19]
    v_exp_f32 v145, v145
    v_mfma_f32_16x16x32_bf16 v[20:23], a[240:243], v[200:203], v[20:23]
    s_waitcnt lgkmcnt(8)
    v_exp_f32 v146, v146
    v_mfma_f32_16x16x32_bf16 v[24:27], a[244:247], v[192:195], v[24:27]
    buffer_load_dwordx4 v239, s[20:23], s54 offen lds
    s_add_u32 s54, s59, 147456
    v_mfma_f32_16x16x32_bf16 v[28:31], a[244:247], v[196:199], v[28:31]
    s_add_u32 m0, s52, 151552
    ds_read_b64_tr_b16 a[240:241], v234 offset:1024
    v_add_f32 v224, v224, v145
    v_mfma_f32_16x16x32_bf16 v[32:35], a[244:247], v[200:203], v[32:35]
    s_waitcnt lgkmcnt(7)
    ds_read_b64_tr_b16 a[242:243], v234 offset:5120
    v_add_f32 v224, v224, v146
    v_mfma_f32_16x16x32_bf16 v[36:39], a[248:251], v[192:195], v[36:39]
    v_exp_f32 v147, v147
    v_mfma_f32_16x16x32_bf16 v[40:43], a[248:251], v[196:199], v[40:43]
    buffer_load_dwordx4 v239, s[20:23], s54 offen lds
    s_add_u32 m0, s51, 32768
    v_mfma_f32_16x16x32_bf16 v[44:47], a[248:251], v[200:203], v[44:47]
    s_waitcnt lgkmcnt(6)
    ds_read_b64_tr_b16 a[244:245], v235 offset:1024
    v_add_f32 v224, v224, v147
    v_mfma_f32_16x16x32_bf16 a[144:147], a[252:255], a[216:219], a[144:147]
    v_exp_f32 v148, v148
    v_mfma_f32_16x16x32_bf16 a[148:151], a[252:255], a[220:223], a[148:151]
    ds_read_b64_tr_b16 a[246:247], v235 offset:5120
    v_add_f32 v225, v225, v148
    v_mfma_f32_16x16x32_bf16 a[152:155], a[252:255], a[224:227], a[152:155]
    buffer_load_dwordx4 v238, s[8:11], s45 offen nt lds
    v_mfma_f32_16x16x32_bf16 a[156:159], a[252:255], a[228:231], a[156:159]
    v_exp_f32 v149, v149
    v_mfma_f32_16x16x32_bf16 a[160:163], a[252:255], a[232:235], a[160:163]
    buffer_load_dwordx4 v238, s[8:11], s45 offen offset:2048 nt lds
    s_add_u32 m0, s51, 33664
    v_mfma_f32_16x16x32_bf16 a[164:167], a[252:255], a[236:239], a[164:167]
    s_waitcnt lgkmcnt(6)
    v_exp_f32 v150, v150
    v_mfma_f32_16x16x32_bf16 v[48:51], v[216:219], v[192:195], v[48:51]
    buffer_load_dwordx4 v238, s[8:11], s45 offen offset:128 nt lds
    v_mfma_f32_16x16x32_bf16 v[52:55], v[216:219], v[196:199], v[52:55]
    buffer_load_dwordx4 v238, s[8:11], s45 offen offset:2176 nt lds
    s_add_u32 s45, s45, 8192
    v_mfma_f32_16x16x32_bf16 v[56:59], v[216:219], v[200:203], v[56:59]
    s_waitcnt lgkmcnt(4)
    v_add_f32 v225, v225, v149
    v_mfma_f32_16x16x32_bf16 v[60:63], v[220:223], v[192:195], v[60:63]
    v_exp_f32 v151, v151
    v_mfma_f32_16x16x32_bf16 v[64:67], v[220:223], v[196:199], v[64:67]
    s_waitcnt vmcnt(16) lgkmcnt(0)
    s_barrier
    ds_read_b64_tr_b16 a[248:249], v236
    v_mfma_f32_16x16x32_bf16 v[68:71], v[220:223], v[200:203], v[68:71]
    s_add_u32 s54, s60, 147456
    ds_read_b64_tr_b16 a[250:251], v236 offset:2048
    v_add_f32 v225, v225, v150
    v_mfma_f32_16x16x32_bf16 v[72:75], a[240:243], v[192:195], v[72:75]
    s_add_u32 m0, s52, 143360
    ds_read_b128 a[252:255], v230 offset:8192
    v_add_f32 v225, v225, v151
    v_mfma_f32_16x16x32_bf16 v[76:79], a[240:243], v[196:199], v[76:79]
    ds_read_b128 v[216:219], v231 offset:8192
    ds_read_b128 v[220:223], v230 offset:9216
    v_mfma_f32_16x16x32_bf16 v[80:83], a[240:243], v[200:203], v[80:83]
    v_exp_f32 v152, v152
    v_mfma_f32_16x16x32_bf16 v[84:87], a[244:247], v[192:195], v[84:87]
    ds_read_b128 a[240:243], v231 offset:9216
    v_add_f32 v226, v226, v152
    v_mfma_f32_16x16x32_bf16 v[88:91], a[244:247], v[196:199], v[88:91]
    v_exp_f32 v153, v153
    v_mfma_f32_16x16x32_bf16 v[92:95], a[244:247], v[200:203], v[92:95]
    s_waitcnt lgkmcnt(4)
    ds_read_b64_tr_b16 a[244:245], v236 offset:24576
    v_add_f32 v226, v226, v153
    v_mfma_f32_16x16x32_bf16 a[168:171], a[248:251], a[216:219], a[168:171]
    ds_read_b64_tr_b16 a[246:247], v236 offset:26624
    v_cvt_pk_bf16_f32 v192, v144, v145
    v_mfma_f32_16x16x32_bf16 a[172:175], a[248:251], a[220:223], a[172:175]
    v_exp_f32 v154, v154
    v_mfma_f32_16x16x32_bf16 a[176:179], a[248:251], a[224:227], a[176:179]
    v_exp_f32 v155, v155
    v_mfma_f32_16x16x32_bf16 a[180:183], a[248:251], a[228:231], a[180:183]
    v_add_f32 v226, v226, v154
    v_cvt_pk_bf16_f32 v193, v146, v147
    v_mfma_f32_16x16x32_bf16 a[184:187], a[248:251], a[232:235], a[184:187]
    buffer_load_dwordx4 v239, s[20:23], s54 offen lds
    s_add_u32 m0, s51, 0
    v_mfma_f32_16x16x32_bf16 a[188:191], a[248:251], a[236:239], a[188:191]
    s_waitcnt lgkmcnt(5)
    ds_read_b128 a[248:251], v230 offset:12288
    v_add_f32 v226, v226, v155
    v_mfma_f32_16x16x32_bf16 v[168:171], a[252:255], v[96:99], v[204:207]
    s_add_u32 s54, s62, 147456
    v_exp_f32 v156, v156
    v_mfma_f32_16x16x32_bf16 v[172:175], a[252:255], v[100:103], v[208:211]
    buffer_load_dwordx4 v238, s[4:7], s44 offen nt lds
    v_mfma_f32_16x16x32_bf16 v[176:179], a[252:255], v[104:107], v[212:215]
    s_waitcnt lgkmcnt(5)
    ds_read_b128 a[252:255], v231 offset:12288
    v_add_f32 v224, v224, v156
    v_mfma_f32_16x16x32_bf16 v[168:171], v[216:219], v[108:111], v[168:171]
    v_exp_f32 v157, v157
    v_mfma_f32_16x16x32_bf16 v[172:175], v[216:219], v[112:115], v[172:175]
    buffer_load_dwordx4 v238, s[4:7], s44 offen offset:2048 nt lds
    s_add_u32 m0, s51, 896
    v_mfma_f32_16x16x32_bf16 v[176:179], v[216:219], v[116:119], v[176:179]
    s_waitcnt lgkmcnt(5)
    ds_read_b128 v[216:219], v230 offset:13312
    v_add_f32 v224, v224, v157
    v_mfma_f32_16x16x32_bf16 v[168:171], v[220:223], v[120:123], v[168:171]
    v_exp_f32 v158, v158
    v_mfma_f32_16x16x32_bf16 v[172:175], v[220:223], v[124:127], v[172:175]
    v_exp_f32 v159, v159
    v_mfma_f32_16x16x32_bf16 v[176:179], v[220:223], v[128:131], v[176:179]
    s_waitcnt lgkmcnt(5)
    ds_read_b128 v[220:223], v231 offset:13312
    v_add_f32 v224, v224, v158
    v_mfma_f32_16x16x32_bf16 v[168:171], a[240:243], v[132:135], v[168:171]
    buffer_load_dwordx4 v238, s[4:7], s44 offen offset:128 nt lds
    v_mfma_f32_16x16x32_bf16 v[172:175], a[240:243], v[136:139], v[172:175]
    v_exp_f32 v160, v160
    v_mfma_f32_16x16x32_bf16 v[176:179], a[240:243], v[140:143], v[176:179]
    s_waitcnt lgkmcnt(4)
    buffer_load_dwordx4 v238, s[4:7], s44 offen offset:2176 nt lds
    v_mfma_f32_16x16x32_bf16 a[192:195], a[244:247], a[216:219], a[192:195]
    s_add_u32 m0, s52, 147456
    ds_read_b128 a[216:219], v237 offset:24576
    v_add_f32 v224, v224, v159
    v_mfma_f32_16x16x32_bf16 a[196:199], a[244:247], a[220:223], a[196:199]
    s_add_u32 s44, s44, 8192
    ds_read_b128 a[220:223], v237 offset:25600
    v_add_f32 v225, v225, v160
    v_mfma_f32_16x16x32_bf16 a[200:203], a[244:247], a[224:227], a[200:203]
    ds_read_b128 a[224:227], v237 offset:26624
    v_cvt_pk_bf16_f32 v196, v148, v149
    v_mfma_f32_16x16x32_bf16 a[204:207], a[244:247], a[228:231], a[204:207]
    ds_read_b128 a[228:231], v237 offset:27648
    v_cvt_pk_bf16_f32 v197, v150, v151
    v_mfma_f32_16x16x32_bf16 a[208:211], a[244:247], a[232:235], a[208:211]
    ds_read_b128 a[232:235], v237 offset:28672
    v_cvt_pk_bf16_f32 v200, v152, v153
    v_mfma_f32_16x16x32_bf16 a[212:215], a[244:247], a[236:239], a[212:215]
    s_waitcnt lgkmcnt(8)
    ds_read_b128 a[236:239], v237 offset:29696
    v_cvt_pk_bf16_f32 v201, v154, v155
    v_mfma_f32_16x16x32_bf16 v[180:183], a[248:251], v[96:99], v[204:207]
    v_exp_f32 v161, v161
    v_mfma_f32_16x16x32_bf16 v[184:187], a[248:251], v[100:103], v[208:211]
    v_exp_f32 v162, v162
    v_mfma_f32_16x16x32_bf16 v[188:191], a[248:251], v[104:107], v[212:215]
    s_waitcnt lgkmcnt(8)
    buffer_load_dwordx4 v239, s[20:23], s54 offen lds
    v_mfma_f32_16x16x32_bf16 v[180:183], a[252:255], v[108:111], v[180:183]
    v_exp_f32 v163, v163
    v_mfma_f32_16x16x32_bf16 v[184:187], a[252:255], v[112:115], v[184:187]
    s_waitcnt vmcnt(16) lgkmcnt(6)
    s_barrier
    ds_read_b64_tr_b16 a[240:241], v236 offset:4096
    v_mfma_f32_16x16x32_bf16 v[188:191], a[252:255], v[116:119], v[188:191]
    s_add_u32 s54, s61, 147456
    ds_read_b64_tr_b16 a[242:243], v236 offset:6144
    v_add_f32 v225, v225, v161
    v_mfma_f32_16x16x32_bf16 v[180:183], v[216:219], v[120:123], v[180:183]
    s_add_u32 m0, s52, 131072
    ds_read_b64_tr_b16 a[244:245], v232 offset:16384
    v_add_f32 v225, v225, v162
    v_mfma_f32_16x16x32_bf16 v[184:187], v[216:219], v[124:127], v[184:187]
    ds_read_b64_tr_b16 a[246:247], v232 offset:20480
    v_add_f32 v225, v225, v163
    v_mfma_f32_16x16x32_bf16 v[188:191], v[216:219], v[128:131], v[188:191]
    ds_read_b64_tr_b16 a[248:249], v233 offset:16384
    v_cvt_pk_bf16_f32 v194, v156, v157
    v_mfma_f32_16x16x32_bf16 v[180:183], v[220:223], v[132:135], v[180:183]
    ds_read_b64_tr_b16 a[250:251], v233 offset:20480
    v_cvt_pk_bf16_f32 v195, v158, v159
    v_mfma_f32_16x16x32_bf16 v[184:187], v[220:223], v[136:139], v[184:187]
    ds_read_b64_tr_b16 a[252:253], v234 offset:16384
    v_cvt_pk_bf16_f32 v198, v160, v161
    v_mfma_f32_16x16x32_bf16 v[188:191], v[220:223], v[140:143], v[188:191]
    s_waitcnt lgkmcnt(5)
    ds_read_b64_tr_b16 a[254:255], v234 offset:20480
    v_cvt_pk_bf16_f32 v199, v162, v163
    v_mfma_f32_16x16x32_bf16 a[0:3], a[240:243], a[216:219], a[0:3]
    v_exp_f32 v164, v164
    v_mfma_f32_16x16x32_bf16 a[4:7], a[240:243], a[220:223], a[4:7]
    v_exp_f32 v165, v165
    v_mfma_f32_16x16x32_bf16 a[8:11], a[240:243], a[224:227], a[8:11]
    ds_read_b64_tr_b16 v[216:217], v235 offset:16384
    v_add_f32 v226, v226, v164
    v_mfma_f32_16x16x32_bf16 a[12:15], a[240:243], a[228:231], a[12:15]
    ds_read_b64_tr_b16 v[218:219], v235 offset:20480
    v_add_f32 v226, v226, v165
    v_mfma_f32_16x16x32_bf16 a[16:19], a[240:243], a[232:235], a[16:19]
    v_exp_f32 v166, v166
    v_mfma_f32_16x16x32_bf16 a[20:23], a[240:243], a[236:239], a[20:23]
    s_waitcnt lgkmcnt(6)
    ds_read_b64_tr_b16 v[220:221], v236 offset:28672
    v_add_f32 v226, v226, v166
    v_mfma_f32_16x16x32_bf16 v[0:3], a[244:247], v[192:195], v[0:3]
    ds_read_b64_tr_b16 v[222:223], v236 offset:30720
    v_cvt_pk_bf16_f32 v202, v164, v165
    v_exp_f32 v167, v167
    s_nop 0
    v_cvt_pk_bf16_f32 v203, v166, v167
    v_mfma_f32_16x16x32_bf16 v[4:7], a[244:247], v[196:199], v[4:7]
    ds_read_b64_tr_b16 a[240:241], v232 offset:17408
    v_add_f32 v226, v226, v167
    v_mfma_f32_16x16x32_bf16 v[8:11], a[244:247], v[200:203], v[8:11]
    s_waitcnt lgkmcnt(7)
    ds_read_b64_tr_b16 a[242:243], v232 offset:21504
    ds_read_b64_tr_b16 a[244:245], v233 offset:17408
    v_mfma_f32_16x16x32_bf16 v[12:15], a[248:251], v[192:195], v[12:15]
    v_exp_f32 v168, v168
    v_mfma_f32_16x16x32_bf16 v[16:19], a[248:251], v[196:199], v[16:19]
    ds_read_b64_tr_b16 a[246:247], v233 offset:21504
    v_add_f32 v224, v224, v168
    v_mfma_f32_16x16x32_bf16 v[20:23], a[248:251], v[200:203], v[20:23]
    s_waitcnt lgkmcnt(8)
    v_exp_f32 v169, v169
    v_mfma_f32_16x16x32_bf16 v[24:27], a[252:255], v[192:195], v[24:27]
    v_exp_f32 v170, v170
    v_mfma_f32_16x16x32_bf16 v[28:31], a[252:255], v[196:199], v[28:31]
    buffer_load_dwordx4 v239, s[20:23], s54 offen lds
    s_add_u32 m0, s51, 8192
    v_mfma_f32_16x16x32_bf16 v[32:35], a[252:255], v[200:203], v[32:35]
    s_waitcnt lgkmcnt(6)
    ds_read_b64_tr_b16 a[248:249], v234 offset:17408
    v_add_f32 v224, v224, v169
    v_mfma_f32_16x16x32_bf16 v[36:39], v[216:219], v[192:195], v[36:39]
    s_add_u32 s54, s64, 147456
    ds_read_b64_tr_b16 a[250:251], v234 offset:21504
    v_add_f32 v224, v224, v170
    v_mfma_f32_16x16x32_bf16 v[40:43], v[216:219], v[196:199], v[40:43]
    v_exp_f32 v171, v171
    v_mfma_f32_16x16x32_bf16 v[44:47], v[216:219], v[200:203], v[44:47]
    s_waitcnt lgkmcnt(6)
    buffer_load_dwordx4 v238, s[8:11], s45 offen nt lds
    v_mfma_f32_16x16x32_bf16 a[24:27], v[220:223], a[216:219], a[24:27]
    ds_read_b64_tr_b16 a[252:253], v235 offset:17408
    v_add_f32 v224, v224, v171
    v_mfma_f32_16x16x32_bf16 a[28:31], v[220:223], a[220:223], a[28:31]
    v_exp_f32 v172, v172
    v_mfma_f32_16x16x32_bf16 a[32:35], v[220:223], a[224:227], a[32:35]
    ds_read_b64_tr_b16 a[254:255], v235 offset:21504
    v_add_f32 v225, v225, v172
    v_mfma_f32_16x16x32_bf16 a[36:39], v[220:223], a[228:231], a[36:39]
    buffer_load_dwordx4 v238, s[8:11], s45 offen offset:2048 nt lds
    s_add_u32 m0, s51, 9088
    v_mfma_f32_16x16x32_bf16 a[40:43], v[220:223], a[232:235], a[40:43]
    v_exp_f32 v173, v173
    v_mfma_f32_16x16x32_bf16 a[44:47], v[220:223], a[236:239], a[44:47]
    s_waitcnt lgkmcnt(6)
    buffer_load_dwordx4 v238, s[8:11], s45 offen offset:128 nt lds
    v_mfma_f32_16x16x32_bf16 v[48:51], a[240:243], v[192:195], v[48:51]
    v_exp_f32 v174, v174
    v_mfma_f32_16x16x32_bf16 v[52:55], a[240:243], v[196:199], v[52:55]
    buffer_load_dwordx4 v238, s[8:11], s45 offen offset:2176 nt lds
    s_add_u32 m0, s52, 155648
    v_mfma_f32_16x16x32_bf16 v[56:59], a[240:243], v[200:203], v[56:59]
    s_waitcnt lgkmcnt(4)
    buffer_load_dwordx4 v239, s[20:23], s54 offen lds
    v_mfma_f32_16x16x32_bf16 v[60:63], a[244:247], v[192:195], v[60:63]
    s_add_u32 s45, s45, 8192
    v_add_f32 v225, v225, v173
    v_mfma_f32_16x16x32_bf16 v[64:67], a[244:247], v[196:199], v[64:67]
    s_waitcnt vmcnt(16) lgkmcnt(0)
    s_barrier
    ds_read_b64_tr_b16 v[216:217], v236 offset:8192
    v_mfma_f32_16x16x32_bf16 v[68:71], a[244:247], v[200:203], v[68:71]
    s_add_u32 s54, s63, 147456
    ds_read_b64_tr_b16 v[218:219], v236 offset:10240
    v_add_f32 v225, v225, v174
    v_mfma_f32_16x16x32_bf16 v[72:75], a[248:251], v[192:195], v[72:75]
    s_add_u32 m0, s52, 135168
    ds_read_b128 v[220:223], v230 offset:24576
    ds_read_b128 a[240:243], v231 offset:24576
    v_mfma_f32_16x16x32_bf16 v[76:79], a[248:251], v[196:199], v[76:79]
    v_exp_f32 v175, v175
    v_mfma_f32_16x16x32_bf16 v[80:83], a[248:251], v[200:203], v[80:83]
    ds_read_b128 a[244:247], v230 offset:25600
    v_add_f32 v225, v225, v175
    v_mfma_f32_16x16x32_bf16 v[84:87], a[252:255], v[192:195], v[84:87]
    v_exp_f32 v176, v176
    v_mfma_f32_16x16x32_bf16 v[88:91], a[252:255], v[196:199], v[88:91]
    ds_read_b128 a[248:251], v231 offset:25600
    v_add_f32 v226, v226, v176
    v_mfma_f32_16x16x32_bf16 v[92:95], a[252:255], v[200:203], v[92:95]
    s_waitcnt lgkmcnt(4)
    ds_read_b64_tr_b16 a[252:253], v236 offset:20480
    ds_read_b64_tr_b16 a[254:255], v236 offset:22528
    v_mfma_f32_16x16x32_bf16 a[48:51], v[216:219], a[216:219], a[48:51]
    v_exp_f32 v177, v177
    v_mfma_f32_16x16x32_bf16 a[52:55], v[216:219], a[220:223], a[52:55]
    v_exp_f32 v178, v178
    v_mfma_f32_16x16x32_bf16 a[56:59], v[216:219], a[224:227], a[56:59]
    v_add_f32 v226, v226, v177
    v_cvt_pk_bf16_f32 v192, v168, v169
    v_mfma_f32_16x16x32_bf16 a[60:63], v[216:219], a[228:231], a[60:63]
    v_exp_f32 v179, v179
    v_mfma_f32_16x16x32_bf16 a[64:67], v[216:219], a[232:235], a[64:67]
    v_add_f32 v226, v226, v178
    v_cvt_pk_bf16_f32 v193, v170, v171
    v_mfma_f32_16x16x32_bf16 a[68:71], v[216:219], a[236:239], a[68:71]
    s_waitcnt lgkmcnt(5)
    ds_read_b128 v[216:219], v230 offset:28672
    v_add_f32 v226, v226, v179
    v_mfma_f32_16x16x32_bf16 v[144:147], v[220:223], v[96:99], v[204:207]
    buffer_load_dwordx4 v239, s[20:23], s54 offen lds
    s_add_u32 m0, s51, 16384
    v_mfma_f32_16x16x32_bf16 v[148:151], v[220:223], v[100:103], v[208:211]
    s_add_u32 s54, s57, 184320
    v_exp_f32 v180, v180
    v_mfma_f32_16x16x32_bf16 v[152:155], v[220:223], v[104:107], v[212:215]
    s_waitcnt lgkmcnt(5)
    ds_read_b128 v[220:223], v231 offset:28672
    v_add_f32 v224, v224, v180
    v_mfma_f32_16x16x32_bf16 v[144:147], a[240:243], v[108:111], v[144:147]
    buffer_load_dwordx4 v238, s[4:7], s44 offen nt lds
    v_mfma_f32_16x16x32_bf16 v[148:151], a[240:243], v[112:115], v[148:151]
    v_exp_f32 v181, v181
    v_mfma_f32_16x16x32_bf16 v[152:155], a[240:243], v[116:119], v[152:155]
    s_waitcnt lgkmcnt(5)
    ds_read_b128 a[240:243], v230 offset:29696
    v_add_f32 v224, v224, v181
    v_mfma_f32_16x16x32_bf16 v[144:147], a[244:247], v[120:123], v[144:147]
    buffer_load_dwordx4 v238, s[4:7], s44 offen offset:2048 nt lds
    s_add_u32 m0, s51, 17280
    v_mfma_f32_16x16x32_bf16 v[148:151], a[244:247], v[124:127], v[148:151]
    v_exp_f32 v182, v182
    v_mfma_f32_16x16x32_bf16 v[152:155], a[244:247], v[128:131], v[152:155]
    s_waitcnt lgkmcnt(5)
    ds_read_b128 a[244:247], v231 offset:29696
    v_add_f32 v224, v224, v182
    v_mfma_f32_16x16x32_bf16 v[144:147], a[248:251], v[132:135], v[144:147]
    v_exp_f32 v183, v183
    v_mfma_f32_16x16x32_bf16 v[148:151], a[248:251], v[136:139], v[148:151]
    buffer_load_dwordx4 v238, s[4:7], s44 offen offset:128 nt lds
    v_mfma_f32_16x16x32_bf16 v[152:155], a[248:251], v[140:143], v[152:155]
    s_waitcnt lgkmcnt(4)
    v_exp_f32 v184, v184
    v_mfma_f32_16x16x32_bf16 a[72:75], a[252:255], a[216:219], a[72:75]
    buffer_load_dwordx4 v238, s[4:7], s44 offen offset:2176 nt lds
    s_add_u32 m0, s52, 159744
    v_mfma_f32_16x16x32_bf16 a[76:79], a[252:255], a[220:223], a[76:79]
    s_add_u32 s44, s44, 8192
    v_exp_f32 v185, v185
    v_mfma_f32_16x16x32_bf16 a[80:83], a[252:255], a[224:227], a[80:83]
    v_add_f32 v224, v224, v183
    v_add_f32 v225, v225, v184
    v_mfma_f32_16x16x32_bf16 a[84:87], a[252:255], a[228:231], a[84:87]
    v_exp_f32 v186, v186
    v_mfma_f32_16x16x32_bf16 a[88:91], a[252:255], a[232:235], a[88:91]
    buffer_load_dwordx4 v239, s[20:23], s54 offen lds
    v_mfma_f32_16x16x32_bf16 a[92:95], a[252:255], a[236:239], a[92:95]
    s_waitcnt lgkmcnt(3)
    v_exp_f32 v187, v187
    v_mfma_f32_16x16x32_bf16 v[156:159], v[216:219], v[96:99], v[204:207]
    v_add_f32 v225, v225, v185
    v_cvt_pk_bf16_f32 v196, v172, v173
    v_mfma_f32_16x16x32_bf16 v[160:163], v[216:219], v[100:103], v[208:211]
    v_exp_f32 v188, v188
    v_mfma_f32_16x16x32_bf16 v[164:167], v[216:219], v[104:107], v[212:215]
    s_waitcnt lgkmcnt(2)
    v_add_f32 v225, v225, v186
    v_add_f32 v226, v226, v188
    v_mfma_f32_16x16x32_bf16 v[156:159], v[220:223], v[108:111], v[156:159]
    v_exp_f32 v189, v189
    v_mfma_f32_16x16x32_bf16 v[160:163], v[220:223], v[112:115], v[160:163]
    s_waitcnt vmcnt(11) lgkmcnt(0)
    s_barrier
    ds_read_b64_tr_b16 a[248:249], v236 offset:12288
    v_mfma_f32_16x16x32_bf16 v[164:167], v[220:223], v[116:119], v[164:167]
    s_add_u32 s54, s56, 184320
    ds_read_b64_tr_b16 a[250:251], v236 offset:14336
    v_add_f32 v225, v225, v187
    v_mfma_f32_16x16x32_bf16 v[156:159], a[240:243], v[120:123], v[156:159]
    s_add_u32 m0, s52, 139264
    ds_read_b64_tr_b16 a[252:253], v232 offset:32768
    v_add_f32 v226, v226, v189
    v_mfma_f32_16x16x32_bf16 v[160:163], a[240:243], v[124:127], v[160:163]
    ds_read_b64_tr_b16 a[254:255], v232 offset:36864
    v_cvt_pk_bf16_f32 v197, v174, v175
    v_mfma_f32_16x16x32_bf16 v[164:167], a[240:243], v[128:131], v[164:167]
    ds_read_b64_tr_b16 v[216:217], v233 offset:32768
    v_cvt_pk_bf16_f32 v200, v176, v177
    v_mfma_f32_16x16x32_bf16 v[156:159], a[244:247], v[132:135], v[156:159]
    ds_read_b64_tr_b16 v[218:219], v233 offset:36864
    v_cvt_pk_bf16_f32 v201, v178, v179
    v_mfma_f32_16x16x32_bf16 v[160:163], a[244:247], v[136:139], v[160:163]
    ds_read_b64_tr_b16 v[220:221], v234 offset:32768
    v_cvt_pk_bf16_f32 v194, v180, v181
    v_mfma_f32_16x16x32_bf16 v[164:167], a[244:247], v[140:143], v[164:167]
    s_waitcnt lgkmcnt(5)
    ds_read_b64_tr_b16 v[222:223], v234 offset:36864
    v_cvt_pk_bf16_f32 v195, v182, v183
    v_mfma_f32_16x16x32_bf16 a[96:99], a[248:251], a[216:219], a[96:99]
    ds_read_b64_tr_b16 a[240:241], v235 offset:32768
    v_cvt_pk_bf16_f32 v198, v184, v185
    v_mfma_f32_16x16x32_bf16 a[100:103], a[248:251], a[220:223], a[100:103]
    ds_read_b64_tr_b16 a[242:243], v235 offset:36864
    v_cvt_pk_bf16_f32 v199, v186, v187
    v_mfma_f32_16x16x32_bf16 a[104:107], a[248:251], a[224:227], a[104:107]
    v_exp_f32 v190, v190
    v_mfma_f32_16x16x32_bf16 a[108:111], a[248:251], a[228:231], a[108:111]
    ds_read_b64_tr_b16 a[244:245], v236
    v_add_f32 v226, v226, v190
    v_mfma_f32_16x16x32_bf16 a[112:115], a[248:251], a[232:235], a[112:115]
    ds_read_b64_tr_b16 a[246:247], v236 offset:2048
    v_cvt_pk_bf16_f32 v202, v188, v189
    v_mfma_f32_16x16x32_bf16 a[116:119], a[248:251], a[236:239], a[116:119]
    s_waitcnt lgkmcnt(8)
    v_exp_f32 v191, v191
    v_mfma_f32_16x16x32_bf16 v[0:3], a[252:255], v[192:195], v[0:3]
    ds_read_b64_tr_b16 a[248:249], v232 offset:33792
    v_add_f32 v226, v226, v191
    v_cvt_pk_bf16_f32 v203, v190, v191
    v_mfma_f32_16x16x32_bf16 v[4:7], a[252:255], v[196:199], v[4:7]
    v_exp_f32 v144, v144
    v_mfma_f32_16x16x32_bf16 v[8:11], a[252:255], v[200:203], v[8:11]
    s_waitcnt lgkmcnt(7)
    ds_read_b64_tr_b16 a[250:251], v232 offset:37888
    v_add_f32 v224, v224, v144
    v_mfma_f32_16x16x32_bf16 v[12:15], v[216:219], v[192:195], v[12:15]
    ds_read_b64_tr_b16 a[252:253], v233 offset:33792
    ds_read_b64_tr_b16 a[254:255], v233 offset:37888
    v_mfma_f32_16x16x32_bf16 v[16:19], v[216:219], v[196:199], v[16:19]
    v_exp_f32 v145, v145
    v_mfma_f32_16x16x32_bf16 v[20:23], v[216:219], v[200:203], v[20:23]
    s_waitcnt lgkmcnt(8)
    v_exp_f32 v146, v146
    v_mfma_f32_16x16x32_bf16 v[24:27], v[220:223], v[192:195], v[24:27]
    buffer_load_dwordx4 v239, s[20:23], s54 offen lds
    s_add_u32 s54, s58, 184320
    v_mfma_f32_16x16x32_bf16 v[28:31], v[220:223], v[196:199], v[28:31]
    s_add_u32 m0, s52, 151552
    ds_read_b64_tr_b16 v[216:217], v234 offset:33792
    v_add_f32 v224, v224, v145
    v_mfma_f32_16x16x32_bf16 v[32:35], v[220:223], v[200:203], v[32:35]
    s_waitcnt lgkmcnt(7)
    ds_read_b64_tr_b16 v[218:219], v234 offset:37888
    v_add_f32 v224, v224, v146
    v_mfma_f32_16x16x32_bf16 v[36:39], a[240:243], v[192:195], v[36:39]
    v_exp_f32 v147, v147
    v_mfma_f32_16x16x32_bf16 v[40:43], a[240:243], v[196:199], v[40:43]
    buffer_load_dwordx4 v239, s[20:23], s54 offen lds
    s_add_u32 m0, s51, 24576
    v_mfma_f32_16x16x32_bf16 v[44:47], a[240:243], v[200:203], v[44:47]
    s_waitcnt lgkmcnt(6)
    ds_read_b64_tr_b16 v[220:221], v235 offset:33792
    v_add_f32 v224, v224, v147
    v_mfma_f32_16x16x32_bf16 a[120:123], a[244:247], a[216:219], a[120:123]
    v_exp_f32 v148, v148
    v_mfma_f32_16x16x32_bf16 a[124:127], a[244:247], a[220:223], a[124:127]
    ds_read_b64_tr_b16 v[222:223], v235 offset:37888
    v_add_f32 v225, v225, v148
    v_mfma_f32_16x16x32_bf16 a[128:131], a[244:247], a[224:227], a[128:131]
    buffer_load_dwordx4 v238, s[8:11], s45 offen nt lds
    v_mfma_f32_16x16x32_bf16 a[132:135], a[244:247], a[228:231], a[132:135]
    v_exp_f32 v149, v149
    v_mfma_f32_16x16x32_bf16 a[136:139], a[244:247], a[232:235], a[136:139]
    buffer_load_dwordx4 v238, s[8:11], s45 offen offset:2048 nt lds
    s_add_u32 m0, s51, 25472
    v_mfma_f32_16x16x32_bf16 a[140:143], a[244:247], a[236:239], a[140:143]
    s_waitcnt lgkmcnt(6)
    v_exp_f32 v150, v150
    v_mfma_f32_16x16x32_bf16 v[48:51], a[248:251], v[192:195], v[48:51]
    buffer_load_dwordx4 v238, s[8:11], s45 offen offset:128 nt lds
    v_mfma_f32_16x16x32_bf16 v[52:55], a[248:251], v[196:199], v[52:55]
    buffer_load_dwordx4 v238, s[8:11], s45 offen offset:2176 nt lds
    s_add_u32 s45, s45, 8192
    v_mfma_f32_16x16x32_bf16 v[56:59], a[248:251], v[200:203], v[56:59]
    s_waitcnt lgkmcnt(4)
    v_add_f32 v225, v225, v149
    v_mfma_f32_16x16x32_bf16 v[60:63], a[252:255], v[192:195], v[60:63]
    v_exp_f32 v151, v151
    v_mfma_f32_16x16x32_bf16 v[64:67], a[252:255], v[196:199], v[64:67]
    s_waitcnt vmcnt(11) lgkmcnt(0)
    s_barrier
    ds_read_b64_tr_b16 a[240:241], v236 offset:16384
    v_mfma_f32_16x16x32_bf16 v[68:71], a[252:255], v[200:203], v[68:71]
    s_add_u32 s54, s59, 184320
    ds_read_b64_tr_b16 a[242:243], v236 offset:18432
    v_add_f32 v225, v225, v150
    v_mfma_f32_16x16x32_bf16 v[72:75], v[216:219], v[192:195], v[72:75]
    s_add_u32 m0, s52, 131072
    ds_read_b128 a[244:247], v230
    v_add_f32 v225, v225, v151
    v_mfma_f32_16x16x32_bf16 v[76:79], v[216:219], v[196:199], v[76:79]
    ds_read_b128 a[248:251], v231
    ds_read_b128 a[252:255], v230 offset:1024
    v_mfma_f32_16x16x32_bf16 v[80:83], v[216:219], v[200:203], v[80:83]
    v_exp_f32 v152, v152
    v_mfma_f32_16x16x32_bf16 v[84:87], v[220:223], v[192:195], v[84:87]
    ds_read_b128 v[216:219], v231 offset:1024
    v_add_f32 v226, v226, v152
    v_mfma_f32_16x16x32_bf16 v[88:91], v[220:223], v[196:199], v[88:91]
    v_exp_f32 v153, v153
    v_mfma_f32_16x16x32_bf16 v[92:95], v[220:223], v[200:203], v[92:95]
    s_waitcnt lgkmcnt(4)
    ds_read_b64_tr_b16 v[220:221], v236 offset:4096
    v_add_f32 v226, v226, v153
    v_mfma_f32_16x16x32_bf16 a[144:147], a[240:243], a[216:219], a[144:147]
    ds_read_b64_tr_b16 v[222:223], v236 offset:6144
    v_cvt_pk_bf16_f32 v192, v144, v145
    v_mfma_f32_16x16x32_bf16 a[148:151], a[240:243], a[220:223], a[148:151]
    v_exp_f32 v154, v154
    v_mfma_f32_16x16x32_bf16 a[152:155], a[240:243], a[224:227], a[152:155]
    v_exp_f32 v155, v155
    v_mfma_f32_16x16x32_bf16 a[156:159], a[240:243], a[228:231], a[156:159]
    v_add_f32 v226, v226, v154
    v_cvt_pk_bf16_f32 v193, v146, v147
    v_mfma_f32_16x16x32_bf16 a[160:163], a[240:243], a[232:235], a[160:163]
    buffer_load_dwordx4 v239, s[20:23], s54 offen lds
    s_add_u32 s54, s60, 184320
    v_mfma_f32_16x16x32_bf16 a[164:167], a[240:243], a[236:239], a[164:167]
    s_waitcnt lgkmcnt(5)
    ds_read_b128 a[240:243], v230 offset:4096
    v_add_f32 v226, v226, v155
    v_mfma_f32_16x16x32_bf16 v[168:171], a[244:247], v[96:99], v[204:207]
    s_add_u32 m0, s52, 143360
    v_exp_f32 v156, v156
    v_mfma_f32_16x16x32_bf16 v[172:175], a[244:247], v[100:103], v[208:211]
    buffer_load_dwordx4 v239, s[20:23], s54 offen lds
    s_add_u32 m0, s51, 32768
    v_mfma_f32_16x16x32_bf16 v[176:179], a[244:247], v[104:107], v[212:215]
    s_waitcnt lgkmcnt(5)
    ds_read_b128 a[244:247], v231 offset:4096
    v_add_f32 v224, v224, v156
    v_mfma_f32_16x16x32_bf16 v[168:171], a[248:251], v[108:111], v[168:171]
    v_exp_f32 v157, v157
    v_mfma_f32_16x16x32_bf16 v[172:175], a[248:251], v[112:115], v[172:175]
    buffer_load_dwordx4 v238, s[4:7], s44 offen nt lds
    v_mfma_f32_16x16x32_bf16 v[176:179], a[248:251], v[116:119], v[176:179]
    s_waitcnt lgkmcnt(5)
    ds_read_b128 a[248:251], v230 offset:5120
    v_add_f32 v224, v224, v157
    v_mfma_f32_16x16x32_bf16 v[168:171], a[252:255], v[120:123], v[168:171]
    v_exp_f32 v158, v158
    v_mfma_f32_16x16x32_bf16 v[172:175], a[252:255], v[124:127], v[172:175]
    v_exp_f32 v159, v159
    v_mfma_f32_16x16x32_bf16 v[176:179], a[252:255], v[128:131], v[176:179]
    s_waitcnt lgkmcnt(5)
    ds_read_b128 a[252:255], v231 offset:5120
    v_add_f32 v224, v224, v158
    v_mfma_f32_16x16x32_bf16 v[168:171], v[216:219], v[132:135], v[168:171]
    buffer_load_dwordx4 v238, s[4:7], s44 offen offset:2048 nt lds
    s_add_u32 m0, s51, 33664
    v_mfma_f32_16x16x32_bf16 v[172:175], v[216:219], v[136:139], v[172:175]
    v_exp_f32 v160, v160
    v_mfma_f32_16x16x32_bf16 v[176:179], v[216:219], v[140:143], v[176:179]
    s_waitcnt lgkmcnt(4)
    buffer_load_dwordx4 v238, s[4:7], s44 offen offset:128 nt lds
    v_mfma_f32_16x16x32_bf16 a[168:171], v[220:223], a[216:219], a[168:171]
    v_exp_f32 v161, v161
    v_mfma_f32_16x16x32_bf16 a[172:175], v[220:223], a[220:223], a[172:175]
    v_add_f32 v224, v224, v159
    v_add_f32 v225, v225, v160
    v_mfma_f32_16x16x32_bf16 a[176:179], v[220:223], a[224:227], a[176:179]
    v_exp_f32 v162, v162
    v_mfma_f32_16x16x32_bf16 a[180:183], v[220:223], a[228:231], a[180:183]
    buffer_load_dwordx4 v238, s[4:7], s44 offen offset:2176 nt lds
    s_add_u32 s44, s44, 8192
    v_mfma_f32_16x16x32_bf16 a[184:187], v[220:223], a[232:235], a[184:187]
    v_exp_f32 v163, v163
    v_mfma_f32_16x16x32_bf16 a[188:191], v[220:223], a[236:239], a[188:191]
    s_waitcnt lgkmcnt(3)
    v_add_f32 v225, v225, v161
    v_cvt_pk_bf16_f32 v196, v148, v149
    v_mfma_f32_16x16x32_bf16 v[180:183], a[240:243], v[96:99], v[204:207]
    v_exp_f32 v164, v164
    v_mfma_f32_16x16x32_bf16 v[184:187], a[240:243], v[100:103], v[208:211]
    v_add_f32 v225, v225, v162
    v_add_f32 v226, v226, v164
    v_mfma_f32_16x16x32_bf16 v[188:191], a[240:243], v[104:107], v[212:215]
    s_waitcnt lgkmcnt(2)
    v_exp_f32 v165, v165
    v_mfma_f32_16x16x32_bf16 v[180:183], a[244:247], v[108:111], v[180:183]
    v_add_f32 v225, v225, v163
    v_add_f32 v226, v226, v165
    v_mfma_f32_16x16x32_bf16 v[184:187], a[244:247], v[112:115], v[184:187]
    s_waitcnt vmcnt(11) lgkmcnt(0)
    s_barrier
    ds_read_b64_tr_b16 v[216:217], v236 offset:24576
    v_mfma_f32_16x16x32_bf16 v[188:191], a[244:247], v[116:119], v[188:191]
    s_add_u32 s54, s61, 184320
    ds_read_b64_tr_b16 v[218:219], v236 offset:26624
    v_cvt_pk_bf16_f32 v197, v150, v151
    v_mfma_f32_16x16x32_bf16 v[180:183], a[248:251], v[120:123], v[180:183]
    s_add_u32 m0, s52, 135168
    ds_read_b64_tr_b16 v[220:221], v232 offset:8192
    v_cvt_pk_bf16_f32 v200, v152, v153
    v_mfma_f32_16x16x32_bf16 v[184:187], a[248:251], v[124:127], v[184:187]
    ds_read_b64_tr_b16 v[222:223], v232 offset:12288
    v_cvt_pk_bf16_f32 v201, v154, v155
    v_mfma_f32_16x16x32_bf16 v[188:191], a[248:251], v[128:131], v[188:191]
    ds_read_b64_tr_b16 a[240:241], v233 offset:8192
    v_cvt_pk_bf16_f32 v194, v156, v157
    v_mfma_f32_16x16x32_bf16 v[180:183], a[252:255], v[132:135], v[180:183]
    ds_read_b64_tr_b16 a[242:243], v233 offset:12288
    v_cvt_pk_bf16_f32 v195, v158, v159
    v_mfma_f32_16x16x32_bf16 v[184:187], a[252:255], v[136:139], v[184:187]
    ds_read_b64_tr_b16 a[244:245], v234 offset:8192
    v_cvt_pk_bf16_f32 v198, v160, v161
    v_mfma_f32_16x16x32_bf16 v[188:191], a[252:255], v[140:143], v[188:191]
    s_waitcnt lgkmcnt(5)
    ds_read_b64_tr_b16 a[246:247], v234 offset:12288
    v_cvt_pk_bf16_f32 v199, v162, v163
    v_mfma_f32_16x16x32_bf16 a[192:195], v[216:219], a[216:219], a[192:195]
    ds_read_b64_tr_b16 a[248:249], v235 offset:8192
    v_cvt_pk_bf16_f32 v202, v164, v165
    v_mfma_f32_16x16x32_bf16 a[196:199], v[216:219], a[220:223], a[196:199]
    ds_read_b64_tr_b16 a[250:251], v235 offset:12288
    ds_read_b128 a[216:219], v237 offset:30720
    v_mfma_f32_16x16x32_bf16 a[200:203], v[216:219], a[224:227], a[200:203]
    v_exp_f32 v166, v166
    v_mfma_f32_16x16x32_bf16 a[204:207], v[216:219], a[228:231], a[204:207]
    ds_read_b64_tr_b16 a[252:253], v236 offset:8192
    v_add_f32 v226, v226, v166
    v_mfma_f32_16x16x32_bf16 a[208:211], v[216:219], a[232:235], a[208:211]
    ds_read_b64_tr_b16 a[254:255], v236 offset:10240
    ds_read_b128 a[220:223], v237 offset:31744
    v_mfma_f32_16x16x32_bf16 a[212:215], v[216:219], a[236:239], a[212:215]
    s_waitcnt lgkmcnt(10)
    v_exp_f32 v167, v167
    v_mfma_f32_16x16x32_bf16 v[0:3], v[220:223], v[192:195], v[0:3]
    ds_read_b128 a[224:227], v237 offset:32768
    v_add_f32 v226, v226, v167
    v_cvt_pk_bf16_f32 v203, v166, v167
    v_mfma_f32_16x16x32_bf16 v[4:7], v[220:223], v[196:199], v[4:7]
    ds_read_b128 a[228:231], v237 offset:33792
    ds_read_b128 a[232:235], v237 offset:34816
    v_mfma_f32_16x16x32_bf16 v[8:11], v[220:223], v[200:203], v[8:11]
    s_waitcnt lgkmcnt(11)
    ds_read_b128 a[236:239], v237 offset:35840
    ds_read_b64_tr_b16 v[216:217], v232 offset:9216
    v_mfma_f32_16x16x32_bf16 v[12:15], a[240:243], v[192:195], v[12:15]
    ds_read_b64_tr_b16 v[218:219], v232 offset:13312
    ds_read_b64_tr_b16 v[220:221], v233 offset:9216
    v_mfma_f32_16x16x32_bf16 v[16:19], a[240:243], v[196:199], v[16:19]
    v_exp_f32 v168, v168
    v_mfma_f32_16x16x32_bf16 v[20:23], a[240:243], v[200:203], v[20:23]
    s_waitcnt lgkmcnt(13)
    ds_read_b64_tr_b16 v[222:223], v233 offset:13312
    v_add_f32 v224, v224, v168
    v_mfma_f32_16x16x32_bf16 v[24:27], a[244:247], v[192:195], v[24:27]
    v_exp_f32 v169, v169
    v_mfma_f32_16x16x32_bf16 v[28:31], a[244:247], v[196:199], v[28:31]
    v_exp_f32 v170, v170
    v_mfma_f32_16x16x32_bf16 v[32:35], a[244:247], v[200:203], v[32:35]
    s_waitcnt lgkmcnt(12)
    buffer_load_dwordx4 v239, s[20:23], s54 offen lds
    v_mfma_f32_16x16x32_bf16 v[36:39], a[248:251], v[192:195], v[36:39]
    s_add_u32 s54, s62, 184320
    ds_read_b64_tr_b16 a[240:241], v234 offset:9216
    v_add_f32 v224, v224, v169
    v_mfma_f32_16x16x32_bf16 v[40:43], a[248:251], v[196:199], v[40:43]
    s_add_u32 m0, s52, 147456
    ds_read_b64_tr_b16 a[242:243], v234 offset:13312
    v_add_f32 v224, v224, v170
    v_mfma_f32_16x16x32_bf16 v[44:47], a[248:251], v[200:203], v[44:47]
    s_waitcnt lgkmcnt(11)
    v_exp_f32 v171, v171
    v_mfma_f32_16x16x32_bf16 a[0:3], a[252:255], a[216:219], a[0:3]
    s_waitcnt lgkmcnt(10)
    buffer_load_dwordx4 v239, s[20:23], s54 offen lds
    v_mfma_f32_16x16x32_bf16 a[4:7], a[252:255], a[220:223], a[4:7]
    s_waitcnt lgkmcnt(9)
    ds_read_b64_tr_b16 a[244:245], v235 offset:9216
    v_add_f32 v224, v224, v171
    v_mfma_f32_16x16x32_bf16 a[8:11], a[252:255], a[224:227], a[8:11]
    s_waitcnt lgkmcnt(9)
    v_exp_f32 v172, v172
    v_mfma_f32_16x16x32_bf16 a[12:15], a[252:255], a[228:231], a[12:15]
    s_waitcnt lgkmcnt(8)
    ds_read_b64_tr_b16 a[246:247], v235 offset:13312
    v_add_f32 v225, v225, v172
    v_mfma_f32_16x16x32_bf16 a[16:19], a[252:255], a[232:235], a[16:19]
    s_waitcnt lgkmcnt(8)
    v_exp_f32 v173, v173
    v_mfma_f32_16x16x32_bf16 a[20:23], a[252:255], a[236:239], a[20:23]
    s_waitcnt lgkmcnt(6)
    v_exp_f32 v174, v174
    v_mfma_f32_16x16x32_bf16 v[48:51], v[216:219], v[192:195], v[48:51]
    s_add_u32 m0, s51, 0
    v_add_f32 v225, v225, v173
    v_mfma_f32_16x16x32_bf16 v[52:55], v[216:219], v[196:199], v[52:55]
    buffer_load_dwordx4 v238, s[8:11], s45 offen nt lds
    v_mfma_f32_16x16x32_bf16 v[56:59], v[216:219], v[200:203], v[56:59]
    s_waitcnt lgkmcnt(4)
    buffer_load_dwordx4 v238, s[8:11], s45 offen offset:2048 nt lds
    v_mfma_f32_16x16x32_bf16 v[60:63], v[220:223], v[192:195], v[60:63]
    s_add_u32 m0, s51, 896
    v_exp_f32 v175, v175
    v_mfma_f32_16x16x32_bf16 v[64:67], v[220:223], v[196:199], v[64:67]
    s_waitcnt vmcnt(14) lgkmcnt(0)
    s_barrier
    ds_read_b64_tr_b16 a[248:249], v236 offset:28672
    v_mfma_f32_16x16x32_bf16 v[68:71], v[220:223], v[200:203], v[68:71]
    s_add_u32 s54, s63, 184320
    ds_read_b64_tr_b16 a[250:251], v236 offset:30720
    v_add_f32 v225, v225, v174
    v_mfma_f32_16x16x32_bf16 v[72:75], a[240:243], v[192:195], v[72:75]
    buffer_load_dwordx4 v238, s[8:11], s45 offen offset:128 nt lds
    v_mfma_f32_16x16x32_bf16 v[76:79], a[240:243], v[196:199], v[76:79]
    ds_read_b128 a[252:255], v230 offset:16384
    v_add_f32 v225, v225, v175
    v_mfma_f32_16x16x32_bf16 v[80:83], a[240:243], v[200:203], v[80:83]
    buffer_load_dwordx4 v238, s[8:11], s45 offen offset:2176 nt lds
    s_add_u32 m0, s52, 139264
    v_mfma_f32_16x16x32_bf16 v[84:87], a[244:247], v[192:195], v[84:87]
    s_add_u32 s45, s45, 8192
    ds_read_b128 v[216:219], v231 offset:16384
    ds_read_b128 v[220:223], v230 offset:17408
    v_mfma_f32_16x16x32_bf16 v[88:91], a[244:247], v[196:199], v[88:91]
    v_exp_f32 v176, v176
    v_mfma_f32_16x16x32_bf16 v[92:95], a[244:247], v[200:203], v[92:95]
    s_waitcnt lgkmcnt(3)
    ds_read_b128 a[240:243], v231 offset:17408
    v_add_f32 v226, v226, v176
    v_mfma_f32_16x16x32_bf16 a[24:27], a[248:251], a[216:219], a[24:27]
    ds_read_b64_tr_b16 a[244:245], v236 offset:20480
    ds_read_b64_tr_b16 a[246:247], v236 offset:22528
    v_mfma_f32_16x16x32_bf16 a[28:31], a[248:251], a[220:223], a[28:31]
    v_exp_f32 v177, v177
    v_mfma_f32_16x16x32_bf16 a[32:35], a[248:251], a[224:227], a[32:35]
    v_exp_f32 v178, v178
    v_mfma_f32_16x16x32_bf16 a[36:39], a[248:251], a[228:231], a[36:39]
    v_add_f32 v226, v226, v177
    v_cvt_pk_bf16_f32 v192, v168, v169
    v_mfma_f32_16x16x32_bf16 a[40:43], a[248:251], a[232:235], a[40:43]
    v_exp_f32 v179, v179
    v_mfma_f32_16x16x32_bf16 a[44:47], a[248:251], a[236:239], a[44:47]
    s_waitcnt lgkmcnt(5)
    ds_read_b128 a[248:251], v230 offset:20480
    v_add_f32 v226, v226, v178
    v_mfma_f32_16x16x32_bf16 v[144:147], a[252:255], v[96:99], v[204:207]
    buffer_load_dwordx4 v239, s[20:23], s54 offen lds
    s_add_u32 s54, s64, 184320
    v_mfma_f32_16x16x32_bf16 v[148:151], a[252:255], v[100:103], v[208:211]
    s_add_u32 m0, s52, 155648
    v_exp_f32 v180, v180
    v_mfma_f32_16x16x32_bf16 v[152:155], a[252:255], v[104:107], v[212:215]
    s_waitcnt lgkmcnt(5)
    ds_read_b128 a[252:255], v231 offset:20480
    v_add_f32 v226, v226, v179
    v_mfma_f32_16x16x32_bf16 v[144:147], v[216:219], v[108:111], v[144:147]
    buffer_load_dwordx4 v239, s[20:23], s54 offen lds
    s_add_u32 m0, s51, 8192
    v_mfma_f32_16x16x32_bf16 v[148:151], v[216:219], v[112:115], v[148:151]
    v_exp_f32 v181, v181
    v_mfma_f32_16x16x32_bf16 v[152:155], v[216:219], v[116:119], v[152:155]
    s_waitcnt lgkmcnt(5)
    ds_read_b128 v[216:219], v230 offset:21504
    v_add_f32 v224, v224, v180
    v_mfma_f32_16x16x32_bf16 v[144:147], v[220:223], v[120:123], v[144:147]
    buffer_load_dwordx4 v238, s[4:7], s44 offen nt lds
    v_mfma_f32_16x16x32_bf16 v[148:151], v[220:223], v[124:127], v[148:151]
    v_exp_f32 v182, v182
    v_mfma_f32_16x16x32_bf16 v[152:155], v[220:223], v[128:131], v[152:155]
    s_waitcnt lgkmcnt(5)
    ds_read_b128 v[220:223], v231 offset:21504
    v_add_f32 v224, v224, v181
    v_mfma_f32_16x16x32_bf16 v[144:147], a[240:243], v[132:135], v[144:147]
    v_exp_f32 v183, v183
    v_mfma_f32_16x16x32_bf16 v[148:151], a[240:243], v[136:139], v[148:151]
    buffer_load_dwordx4 v238, s[4:7], s44 offen offset:2048 nt lds
    s_add_u32 m0, s51, 9088
    v_mfma_f32_16x16x32_bf16 v[152:155], a[240:243], v[140:143], v[152:155]
    s_waitcnt lgkmcnt(4)
    v_exp_f32 v184, v184
    v_mfma_f32_16x16x32_bf16 a[48:51], a[244:247], a[216:219], a[48:51]
    buffer_load_dwordx4 v238, s[4:7], s44 offen offset:128 nt lds
    v_mfma_f32_16x16x32_bf16 a[52:55], a[244:247], a[220:223], a[52:55]
    v_add_f32 v224, v224, v182
    v_add_f32 v225, v225, v184
    v_mfma_f32_16x16x32_bf16 a[56:59], a[244:247], a[224:227], a[56:59]
    v_exp_f32 v185, v185
    v_mfma_f32_16x16x32_bf16 a[60:63], a[244:247], a[228:231], a[60:63]
    v_add_f32 v224, v224, v183
    v_add_f32 v225, v225, v185
    v_mfma_f32_16x16x32_bf16 a[64:67], a[244:247], a[232:235], a[64:67]
    v_exp_f32 v186, v186
    v_mfma_f32_16x16x32_bf16 a[68:71], a[244:247], a[236:239], a[68:71]
    s_waitcnt lgkmcnt(3)
    buffer_load_dwordx4 v238, s[4:7], s44 offen offset:2176 nt lds
    v_mfma_f32_16x16x32_bf16 v[156:159], a[248:251], v[96:99], v[204:207]
    s_add_u32 s44, s44, 8192
    v_exp_f32 v187, v187
    v_mfma_f32_16x16x32_bf16 v[160:163], a[248:251], v[100:103], v[208:211]
    v_exp_f32 v188, v188
    v_mfma_f32_16x16x32_bf16 v[164:167], a[248:251], v[104:107], v[212:215]
    s_waitcnt lgkmcnt(2)
    v_add_f32 v225, v225, v186
    v_cvt_pk_bf16_f32 v193, v170, v171
    v_mfma_f32_16x16x32_bf16 v[156:159], a[252:255], v[108:111], v[156:159]
    v_exp_f32 v189, v189
    v_mfma_f32_16x16x32_bf16 v[160:163], a[252:255], v[112:115], v[160:163]
    s_waitcnt vmcnt(16) lgkmcnt(0)
    s_barrier
    ds_read_b64_tr_b16 a[240:241], v236
    v_mfma_f32_16x16x32_bf16 v[164:167], a[252:255], v[116:119], v[164:167]
    s_add_u32 s54, s56, 221184
    ds_read_b64_tr_b16 a[242:243], v236 offset:2048
    v_add_f32 v225, v225, v187
    v_mfma_f32_16x16x32_bf16 v[156:159], v[216:219], v[120:123], v[156:159]
    s_add_u32 m0, s52, 151552
    ds_read_b64_tr_b16 a[244:245], v232 offset:24576
    v_add_f32 v226, v226, v188
    v_mfma_f32_16x16x32_bf16 v[160:163], v[216:219], v[124:127], v[160:163]
    ds_read_b64_tr_b16 a[246:247], v232 offset:28672
    v_cvt_pk_bf16_f32 v196, v172, v173
    v_mfma_f32_16x16x32_bf16 v[164:167], v[216:219], v[128:131], v[164:167]
    ds_read_b64_tr_b16 a[248:249], v233 offset:24576
    v_add_f32 v226, v226, v189
    v_mfma_f32_16x16x32_bf16 v[156:159], v[220:223], v[132:135], v[156:159]
    ds_read_b64_tr_b16 a[250:251], v233 offset:28672
    v_cvt_pk_bf16_f32 v197, v174, v175
    v_mfma_f32_16x16x32_bf16 v[160:163], v[220:223], v[136:139], v[160:163]
    ds_read_b64_tr_b16 a[252:253], v234 offset:24576
    v_cvt_pk_bf16_f32 v200, v176, v177
    v_mfma_f32_16x16x32_bf16 v[164:167], v[220:223], v[140:143], v[164:167]
    s_waitcnt lgkmcnt(5)
    ds_read_b64_tr_b16 a[254:255], v234 offset:28672
    v_cvt_pk_bf16_f32 v201, v178, v179
    v_mfma_f32_16x16x32_bf16 a[72:75], a[240:243], a[216:219], a[72:75]
    ds_read_b64_tr_b16 v[216:217], v235 offset:24576
    v_cvt_pk_bf16_f32 v194, v180, v181
    v_mfma_f32_16x16x32_bf16 a[76:79], a[240:243], a[220:223], a[76:79]
    ds_read_b64_tr_b16 v[218:219], v235 offset:28672
    v_cvt_pk_bf16_f32 v195, v182, v183
    v_mfma_f32_16x16x32_bf16 a[80:83], a[240:243], a[224:227], a[80:83]
    v_exp_f32 v190, v190
    v_mfma_f32_16x16x32_bf16 a[84:87], a[240:243], a[228:231], a[84:87]
    ds_read_b64_tr_b16 v[220:221], v236 offset:12288
    v_add_f32 v226, v226, v190
    v_mfma_f32_16x16x32_bf16 a[88:91], a[240:243], a[232:235], a[88:91]
    ds_read_b64_tr_b16 v[222:223], v236 offset:14336
    v_cvt_pk_bf16_f32 v198, v184, v185
    v_mfma_f32_16x16x32_bf16 a[92:95], a[240:243], a[236:239], a[92:95]
    s_waitcnt lgkmcnt(8)
    v_exp_f32 v191, v191
    v_cvt_pk_bf16_f32 v199, v186, v187
    v_mfma_f32_16x16x32_bf16 v[0:3], a[244:247], v[192:195], v[0:3]
    ds_read_b64_tr_b16 a[240:241], v232 offset:25600
    v_add_f32 v226, v226, v191
    v_cvt_pk_bf16_f32 v202, v188, v189
    v_cvt_pk_bf16_f32 v203, v190, v191
    v_mfma_f32_16x16x32_bf16 v[4:7], a[244:247], v[196:199], v[4:7]
    v_exp_f32 v144, v144
    v_mfma_f32_16x16x32_bf16 v[8:11], a[244:247], v[200:203], v[8:11]
    s_waitcnt lgkmcnt(7)
    ds_read_b64_tr_b16 a[242:243], v232 offset:29696
    v_add_f32 v224, v224, v144
    v_mfma_f32_16x16x32_bf16 v[12:15], a[248:251], v[192:195], v[12:15]
    ds_read_b64_tr_b16 a[244:245], v233 offset:25600
    ds_read_b64_tr_b16 a[246:247], v233 offset:29696
    v_mfma_f32_16x16x32_bf16 v[16:19], a[248:251], v[196:199], v[16:19]
    v_exp_f32 v145, v145
    v_mfma_f32_16x16x32_bf16 v[20:23], a[248:251], v[200:203], v[20:23]
    s_waitcnt lgkmcnt(8)
    v_exp_f32 v146, v146
    v_mfma_f32_16x16x32_bf16 v[24:27], a[252:255], v[192:195], v[24:27]
    buffer_load_dwordx4 v239, s[20:23], s54 offen lds
    s_add_u32 s54, s57, 221184
    v_mfma_f32_16x16x32_bf16 v[28:31], a[252:255], v[196:199], v[28:31]
    s_add_u32 m0, s52, 159744
    ds_read_b64_tr_b16 a[248:249], v234 offset:25600
    v_add_f32 v224, v224, v145
    v_mfma_f32_16x16x32_bf16 v[32:35], a[252:255], v[200:203], v[32:35]
    s_waitcnt lgkmcnt(7)
    ds_read_b64_tr_b16 a[250:251], v234 offset:29696
    v_add_f32 v224, v224, v146
    v_mfma_f32_16x16x32_bf16 v[36:39], v[216:219], v[192:195], v[36:39]
    v_exp_f32 v147, v147
    v_mfma_f32_16x16x32_bf16 v[40:43], v[216:219], v[196:199], v[40:43]
    buffer_load_dwordx4 v239, s[20:23], s54 offen lds
    s_add_u32 m0, s51, 16384
    v_mfma_f32_16x16x32_bf16 v[44:47], v[216:219], v[200:203], v[44:47]
    s_waitcnt lgkmcnt(6)
    ds_read_b64_tr_b16 a[252:253], v235 offset:25600
    v_add_f32 v224, v224, v147
    v_mfma_f32_16x16x32_bf16 a[96:99], v[220:223], a[216:219], a[96:99]
    v_exp_f32 v148, v148
    v_mfma_f32_16x16x32_bf16 a[100:103], v[220:223], a[220:223], a[100:103]
    ds_read_b64_tr_b16 a[254:255], v235 offset:29696
    v_add_f32 v225, v225, v148
    v_mfma_f32_16x16x32_bf16 a[104:107], v[220:223], a[224:227], a[104:107]
    buffer_load_dwordx4 v238, s[8:11], s45 offen nt lds
    v_mfma_f32_16x16x32_bf16 a[108:111], v[220:223], a[228:231], a[108:111]
    v_exp_f32 v149, v149
    v_mfma_f32_16x16x32_bf16 a[112:115], v[220:223], a[232:235], a[112:115]
    buffer_load_dwordx4 v238, s[8:11], s45 offen offset:2048 nt lds
    s_add_u32 m0, s51, 17280
    v_mfma_f32_16x16x32_bf16 a[116:119], v[220:223], a[236:239], a[116:119]
    s_waitcnt lgkmcnt(6)
    v_exp_f32 v150, v150
    v_mfma_f32_16x16x32_bf16 v[48:51], a[240:243], v[192:195], v[48:51]
    buffer_load_dwordx4 v238, s[8:11], s45 offen offset:128 nt lds
    v_mfma_f32_16x16x32_bf16 v[52:55], a[240:243], v[196:199], v[52:55]
    buffer_load_dwordx4 v238, s[8:11], s45 offen offset:2176 nt lds
    s_add_u32 s45, s45, 8192
    v_mfma_f32_16x16x32_bf16 v[56:59], a[240:243], v[200:203], v[56:59]
    s_waitcnt lgkmcnt(4)
    v_add_f32 v225, v225, v149
    v_mfma_f32_16x16x32_bf16 v[60:63], a[244:247], v[192:195], v[60:63]
    v_exp_f32 v151, v151
    v_mfma_f32_16x16x32_bf16 v[64:67], a[244:247], v[196:199], v[64:67]
    s_waitcnt vmcnt(16) lgkmcnt(0)
    s_barrier
    ds_read_b64_tr_b16 v[216:217], v236 offset:4096
    v_mfma_f32_16x16x32_bf16 v[68:71], a[244:247], v[200:203], v[68:71]
    s_add_u32 s54, s58, 221184
    ds_read_b64_tr_b16 v[218:219], v236 offset:6144
    v_add_f32 v225, v225, v150
    v_mfma_f32_16x16x32_bf16 v[72:75], a[248:251], v[192:195], v[72:75]
    s_add_u32 m0, s52, 131072
    ds_read_b128 v[220:223], v230 offset:32768
    v_add_f32 v225, v225, v151
    v_mfma_f32_16x16x32_bf16 v[76:79], a[248:251], v[196:199], v[76:79]
    ds_read_b128 a[240:243], v231 offset:32768
    ds_read_b128 a[244:247], v230 offset:33792
    v_mfma_f32_16x16x32_bf16 v[80:83], a[248:251], v[200:203], v[80:83]
    v_exp_f32 v152, v152
    v_mfma_f32_16x16x32_bf16 v[84:87], a[252:255], v[192:195], v[84:87]
    ds_read_b128 a[248:251], v231 offset:33792
    v_add_f32 v226, v226, v152
    v_mfma_f32_16x16x32_bf16 v[88:91], a[252:255], v[196:199], v[88:91]
    v_exp_f32 v153, v153
    v_mfma_f32_16x16x32_bf16 v[92:95], a[252:255], v[200:203], v[92:95]
    s_waitcnt lgkmcnt(4)
    ds_read_b64_tr_b16 a[252:253], v236 offset:16384
    v_add_f32 v226, v226, v153
    v_mfma_f32_16x16x32_bf16 a[120:123], v[216:219], a[216:219], a[120:123]
    ds_read_b64_tr_b16 a[254:255], v236 offset:18432
    v_cvt_pk_bf16_f32 v192, v144, v145
    v_mfma_f32_16x16x32_bf16 a[124:127], v[216:219], a[220:223], a[124:127]
    v_exp_f32 v154, v154
    v_mfma_f32_16x16x32_bf16 a[128:131], v[216:219], a[224:227], a[128:131]
    v_exp_f32 v155, v155
    v_mfma_f32_16x16x32_bf16 a[132:135], v[216:219], a[228:231], a[132:135]
    v_add_f32 v226, v226, v154
    v_cvt_pk_bf16_f32 v193, v146, v147
    v_mfma_f32_16x16x32_bf16 a[136:139], v[216:219], a[232:235], a[136:139]
    buffer_load_dwordx4 v239, s[20:23], s54 offen lds
    s_add_u32 m0, s51, 24576
    v_mfma_f32_16x16x32_bf16 a[140:143], v[216:219], a[236:239], a[140:143]
    s_waitcnt lgkmcnt(5)
    ds_read_b128 v[216:219], v230 offset:36864
    v_add_f32 v226, v226, v155
    v_mfma_f32_16x16x32_bf16 v[168:171], v[220:223], v[96:99], v[204:207]
    s_add_u32 s54, s60, 221184
    v_exp_f32 v156, v156
    v_mfma_f32_16x16x32_bf16 v[172:175], v[220:223], v[100:103], v[208:211]
    buffer_load_dwordx4 v238, s[4:7], s44 offen nt lds
    v_mfma_f32_16x16x32_bf16 v[176:179], v[220:223], v[104:107], v[212:215]
    s_waitcnt lgkmcnt(5)
    ds_read_b128 v[220:223], v231 offset:36864
    v_add_f32 v224, v224, v156
    v_mfma_f32_16x16x32_bf16 v[168:171], a[240:243], v[108:111], v[168:171]
    v_exp_f32 v157, v157
    v_mfma_f32_16x16x32_bf16 v[172:175], a[240:243], v[112:115], v[172:175]
    buffer_load_dwordx4 v238, s[4:7], s44 offen offset:2048 nt lds
    s_add_u32 m0, s51, 25472
    v_mfma_f32_16x16x32_bf16 v[176:179], a[240:243], v[116:119], v[176:179]
    s_waitcnt lgkmcnt(5)
    ds_read_b128 a[240:243], v230 offset:37888
    v_add_f32 v224, v224, v157
    v_mfma_f32_16x16x32_bf16 v[168:171], a[244:247], v[120:123], v[168:171]
    v_exp_f32 v158, v158
    v_mfma_f32_16x16x32_bf16 v[172:175], a[244:247], v[124:127], v[172:175]
    v_exp_f32 v159, v159
    v_mfma_f32_16x16x32_bf16 v[176:179], a[244:247], v[128:131], v[176:179]
    s_waitcnt lgkmcnt(5)
    ds_read_b128 a[244:247], v231 offset:37888
    v_add_f32 v224, v224, v158
    v_mfma_f32_16x16x32_bf16 v[168:171], a[248:251], v[132:135], v[168:171]
    buffer_load_dwordx4 v238, s[4:7], s44 offen offset:128 nt lds
    v_mfma_f32_16x16x32_bf16 v[172:175], a[248:251], v[136:139], v[172:175]
    v_exp_f32 v160, v160
    v_mfma_f32_16x16x32_bf16 v[176:179], a[248:251], v[140:143], v[176:179]
    s_waitcnt lgkmcnt(4)
    buffer_load_dwordx4 v238, s[4:7], s44 offen offset:2176 nt lds
    v_mfma_f32_16x16x32_bf16 a[144:147], a[252:255], a[216:219], a[144:147]
    s_add_u32 m0, s52, 143360
    v_exp_f32 v161, v161
    v_mfma_f32_16x16x32_bf16 a[148:151], a[252:255], a[220:223], a[148:151]
    s_add_u32 s44, s44, 8192
    v_add_f32 v224, v224, v159
    v_add_f32 v225, v225, v160
    v_mfma_f32_16x16x32_bf16 a[152:155], a[252:255], a[224:227], a[152:155]
    v_exp_f32 v162, v162
    v_mfma_f32_16x16x32_bf16 a[156:159], a[252:255], a[228:231], a[156:159]
    buffer_load_dwordx4 v239, s[20:23], s54 offen lds
    v_mfma_f32_16x16x32_bf16 a[160:163], a[252:255], a[232:235], a[160:163]
    v_exp_f32 v163, v163
    v_mfma_f32_16x16x32_bf16 a[164:167], a[252:255], a[236:239], a[164:167]
    s_waitcnt lgkmcnt(3)
    v_add_f32 v225, v225, v161
    v_cvt_pk_bf16_f32 v196, v148, v149
    v_mfma_f32_16x16x32_bf16 v[180:183], v[216:219], v[96:99], v[204:207]
    v_exp_f32 v164, v164
    v_mfma_f32_16x16x32_bf16 v[184:187], v[216:219], v[100:103], v[208:211]
    v_add_f32 v225, v225, v162
    v_add_f32 v226, v226, v164
    v_mfma_f32_16x16x32_bf16 v[188:191], v[216:219], v[104:107], v[212:215]
    s_waitcnt lgkmcnt(2)
    v_exp_f32 v165, v165
    v_mfma_f32_16x16x32_bf16 v[180:183], v[220:223], v[108:111], v[180:183]
    v_add_f32 v225, v225, v163
    v_add_f32 v226, v226, v165
    v_mfma_f32_16x16x32_bf16 v[184:187], v[220:223], v[112:115], v[184:187]
    s_waitcnt vmcnt(16) lgkmcnt(0)
    s_barrier
    ds_read_b64_tr_b16 a[248:249], v236 offset:8192
    v_mfma_f32_16x16x32_bf16 v[188:191], v[220:223], v[116:119], v[188:191]
    s_add_u32 s54, s59, 221184
    ds_read_b64_tr_b16 a[250:251], v236 offset:10240
    v_cvt_pk_bf16_f32 v197, v150, v151
    v_mfma_f32_16x16x32_bf16 v[180:183], a[240:243], v[120:123], v[180:183]
    s_add_u32 m0, s52, 135168
    ds_read_b64_tr_b16 a[252:253], v232
    v_cvt_pk_bf16_f32 v200, v152, v153
    v_mfma_f32_16x16x32_bf16 v[184:187], a[240:243], v[124:127], v[184:187]
    ds_read_b64_tr_b16 a[254:255], v232 offset:4096
    v_cvt_pk_bf16_f32 v201, v154, v155
    v_mfma_f32_16x16x32_bf16 v[188:191], a[240:243], v[128:131], v[188:191]
    ds_read_b64_tr_b16 v[216:217], v233
    v_cvt_pk_bf16_f32 v194, v156, v157
    v_mfma_f32_16x16x32_bf16 v[180:183], a[244:247], v[132:135], v[180:183]
    ds_read_b64_tr_b16 v[218:219], v233 offset:4096
    v_cvt_pk_bf16_f32 v195, v158, v159
    v_mfma_f32_16x16x32_bf16 v[184:187], a[244:247], v[136:139], v[184:187]
    ds_read_b64_tr_b16 v[220:221], v234
    v_cvt_pk_bf16_f32 v198, v160, v161
    v_mfma_f32_16x16x32_bf16 v[188:191], a[244:247], v[140:143], v[188:191]
    s_waitcnt lgkmcnt(5)
    ds_read_b64_tr_b16 v[222:223], v234 offset:4096
    v_cvt_pk_bf16_f32 v199, v162, v163
    v_mfma_f32_16x16x32_bf16 a[168:171], a[248:251], a[216:219], a[168:171]
    ds_read_b64_tr_b16 a[240:241], v235
    v_cvt_pk_bf16_f32 v202, v164, v165
    v_mfma_f32_16x16x32_bf16 a[172:175], a[248:251], a[220:223], a[172:175]
    ds_read_b64_tr_b16 a[242:243], v235 offset:4096
    ds_read_b64_tr_b16 a[244:245], v236 offset:24576
    v_mfma_f32_16x16x32_bf16 a[176:179], a[248:251], a[224:227], a[176:179]
    v_exp_f32 v166, v166
    v_mfma_f32_16x16x32_bf16 a[180:183], a[248:251], a[228:231], a[180:183]
    ds_read_b64_tr_b16 a[246:247], v236 offset:26624
    v_add_f32 v226, v226, v166
    v_mfma_f32_16x16x32_bf16 a[184:187], a[248:251], a[232:235], a[184:187]
    v_exp_f32 v167, v167
    v_mfma_f32_16x16x32_bf16 a[188:191], a[248:251], a[236:239], a[188:191]
    s_waitcnt lgkmcnt(8)
    ds_read_b64_tr_b16 a[248:249], v232 offset:1024
    v_add_f32 v226, v226, v167
    v_mfma_f32_16x16x32_bf16 v[0:3], a[252:255], v[192:195], v[0:3]
    ds_read_b64_tr_b16 a[250:251], v232 offset:5120
    v_cvt_pk_bf16_f32 v203, v166, v167
    v_mfma_f32_16x16x32_bf16 v[4:7], a[252:255], v[196:199], v[4:7]
    v_exp_f32 v168, v168
    v_mfma_f32_16x16x32_bf16 v[8:11], a[252:255], v[200:203], v[8:11]
    s_waitcnt lgkmcnt(8)
    ds_read_b64_tr_b16 a[252:253], v233 offset:1024
    v_add_f32 v224, v224, v168
    v_mfma_f32_16x16x32_bf16 v[12:15], v[216:219], v[192:195], v[12:15]
    v_exp_f32 v169, v169
    v_mfma_f32_16x16x32_bf16 v[16:19], v[216:219], v[196:199], v[16:19]
    ds_read_b64_tr_b16 a[254:255], v233 offset:5120
    v_add_f32 v224, v224, v169
    v_mfma_f32_16x16x32_bf16 v[20:23], v[216:219], v[200:203], v[20:23]
    s_waitcnt lgkmcnt(8)
    v_exp_f32 v170, v170
    v_mfma_f32_16x16x32_bf16 v[24:27], v[220:223], v[192:195], v[24:27]
    buffer_load_dwordx4 v239, s[20:23], s54 offen lds
    s_add_u32 m0, s51, 32768
    v_mfma_f32_16x16x32_bf16 v[28:31], v[220:223], v[196:199], v[28:31]
    s_add_u32 s54, s62, 221184
    ds_read_b64_tr_b16 v[216:217], v234 offset:1024
    v_add_f32 v224, v224, v170
    v_mfma_f32_16x16x32_bf16 v[32:35], v[220:223], v[200:203], v[32:35]
    s_waitcnt lgkmcnt(7)
    ds_read_b64_tr_b16 v[218:219], v234 offset:5120
    ds_read_b64_tr_b16 v[220:221], v235 offset:1024
    v_mfma_f32_16x16x32_bf16 v[36:39], a[240:243], v[192:195], v[36:39]
    v_exp_f32 v171, v171
    v_mfma_f32_16x16x32_bf16 v[40:43], a[240:243], v[196:199], v[40:43]
    buffer_load_dwordx4 v238, s[8:11], s45 offen nt lds
    v_mfma_f32_16x16x32_bf16 v[44:47], a[240:243], v[200:203], v[44:47]
    s_waitcnt lgkmcnt(7)
    ds_read_b64_tr_b16 v[222:223], v235 offset:5120
    v_add_f32 v224, v224, v171
    v_mfma_f32_16x16x32_bf16 a[192:195], a[244:247], a[216:219], a[192:195]
    v_exp_f32 v172, v172
    v_mfma_f32_16x16x32_bf16 a[196:199], a[244:247], a[220:223], a[196:199]
    buffer_load_dwordx4 v238, s[8:11], s45 offen offset:2048 nt lds
    s_add_u32 m0, s51, 33664
    v_mfma_f32_16x16x32_bf16 a[200:203], a[244:247], a[224:227], a[200:203]
    ds_read_b128 a[216:219], v237 offset:36864
    v_add_f32 v225, v225, v172
    v_mfma_f32_16x16x32_bf16 a[204:207], a[244:247], a[228:231], a[204:207]
    v_exp_f32 v173, v173
    v_mfma_f32_16x16x32_bf16 a[208:211], a[244:247], a[232:235], a[208:211]
    ds_read_b128 a[220:223], v237 offset:37888
    v_add_f32 v225, v225, v173
    v_mfma_f32_16x16x32_bf16 a[212:215], a[244:247], a[236:239], a[212:215]
    s_waitcnt lgkmcnt(8)
    ds_read_b128 a[224:227], v237 offset:38912
    ds_read_b128 a[228:231], v237 offset:39936
    v_mfma_f32_16x16x32_bf16 v[48:51], a[248:251], v[192:195], v[48:51]
    buffer_load_dwordx4 v238, s[8:11], s45 offen offset:128 nt lds
    v_mfma_f32_16x16x32_bf16 v[52:55], a[248:251], v[196:199], v[52:55]
    ds_read_b128 a[232:235], v237 offset:40960
    ds_read_b128 a[236:239], v237 offset:41984
    v_mfma_f32_16x16x32_bf16 v[56:59], a[248:251], v[200:203], v[56:59]
    s_waitcnt lgkmcnt(10)
    v_exp_f32 v174, v174
    v_mfma_f32_16x16x32_bf16 v[60:63], a[252:255], v[192:195], v[60:63]
    buffer_load_dwordx4 v238, s[8:11], s45 offen offset:2176 nt lds
    s_add_u32 m0, s52, 147456
    v_mfma_f32_16x16x32_bf16 v[64:67], a[252:255], v[196:199], v[64:67]
    s_waitcnt vmcnt(15) lgkmcnt(6)
    s_barrier
    ds_read_b64_tr_b16 a[240:241], v236 offset:20480
    v_mfma_f32_16x16x32_bf16 v[68:71], a[252:255], v[200:203], v[68:71]
    s_add_u32 s45, s45, 8192
    ds_read_b64_tr_b16 a[242:243], v236 offset:22528
    v_add_f32 v225, v225, v174
    v_mfma_f32_16x16x32_bf16 v[72:75], v[216:219], v[192:195], v[72:75]
    ds_read_b128 a[244:247], v230 offset:8192
    ds_read_b128 a[248:251], v231 offset:8192
    v_mfma_f32_16x16x32_bf16 v[76:79], v[216:219], v[196:199], v[76:79]
    buffer_load_dwordx4 v239, s[20:23], s54 offen lds
    s_add_u32 s54, s61, 221184
    v_mfma_f32_16x16x32_bf16 v[80:83], v[216:219], v[200:203], v[80:83]
    s_add_u32 m0, s52, 139264
    v_exp_f32 v175, v175
    v_mfma_f32_16x16x32_bf16 v[84:87], v[220:223], v[192:195], v[84:87]
    ds_read_b128 a[252:255], v230 offset:9216
    v_add_f32 v225, v225, v175
    v_mfma_f32_16x16x32_bf16 v[88:91], v[220:223], v[196:199], v[88:91]
    v_exp_f32 v176, v176
    v_mfma_f32_16x16x32_bf16 v[92:95], v[220:223], v[200:203], v[92:95]
    s_waitcnt lgkmcnt(3)
    ds_read_b128 v[216:219], v231 offset:9216
    v_add_f32 v226, v226, v176
    v_mfma_f32_16x16x32_bf16 a[0:3], a[240:243], a[216:219], a[0:3]
    ds_read_b64_tr_b16 v[220:221], v236 offset:28672
    ds_read_b64_tr_b16 v[222:223], v236 offset:30720
    v_mfma_f32_16x16x32_bf16 a[4:7], a[240:243], a[220:223], a[4:7]
    v_exp_f32 v177, v177
    v_mfma_f32_16x16x32_bf16 a[8:11], a[240:243], a[224:227], a[8:11]
    v_exp_f32 v178, v178
    v_mfma_f32_16x16x32_bf16 a[12:15], a[240:243], a[228:231], a[12:15]
    v_add_f32 v226, v226, v177
    v_cvt_pk_bf16_f32 v192, v168, v169
    v_mfma_f32_16x16x32_bf16 a[16:19], a[240:243], a[232:235], a[16:19]
    v_exp_f32 v179, v179
    v_mfma_f32_16x16x32_bf16 a[20:23], a[240:243], a[236:239], a[20:23]
    s_waitcnt lgkmcnt(5)
    ds_read_b128 a[240:243], v230 offset:12288
    v_add_f32 v226, v226, v178
    v_mfma_f32_16x16x32_bf16 v[144:147], a[244:247], v[96:99], v[204:207]
    buffer_load_dwordx4 v239, s[20:23], s54 offen lds
    s_add_u32 m0, s51, 0
    v_mfma_f32_16x16x32_bf16 v[148:151], a[244:247], v[100:103], v[208:211]
    s_add_u32 s54, s64, 221184
    v_exp_f32 v180, v180
    v_mfma_f32_16x16x32_bf16 v[152:155], a[244:247], v[104:107], v[212:215]
    s_waitcnt lgkmcnt(5)
    ds_read_b128 a[244:247], v231 offset:12288
    v_add_f32 v226, v226, v179
    v_mfma_f32_16x16x32_bf16 v[144:147], a[248:251], v[108:111], v[144:147]
    buffer_load_dwordx4 v238, s[4:7], s44 offen nt lds
    v_mfma_f32_16x16x32_bf16 v[148:151], a[248:251], v[112:115], v[148:151]
    v_exp_f32 v181, v181
    v_mfma_f32_16x16x32_bf16 v[152:155], a[248:251], v[116:119], v[152:155]
    s_waitcnt lgkmcnt(5)
    ds_read_b128 a[248:251], v230 offset:13312
    v_add_f32 v224, v224, v180
    v_mfma_f32_16x16x32_bf16 v[144:147], a[252:255], v[120:123], v[144:147]
    buffer_load_dwordx4 v238, s[4:7], s44 offen offset:2048 nt lds
    s_add_u32 m0, s51, 896
    v_mfma_f32_16x16x32_bf16 v[148:151], a[252:255], v[124:127], v[148:151]
    v_exp_f32 v182, v182
    v_mfma_f32_16x16x32_bf16 v[152:155], a[252:255], v[128:131], v[152:155]
    s_waitcnt lgkmcnt(5)
    ds_read_b128 a[252:255], v231 offset:13312
    v_add_f32 v224, v224, v181
    v_mfma_f32_16x16x32_bf16 v[144:147], v[216:219], v[132:135], v[144:147]
    v_exp_f32 v183, v183
    v_mfma_f32_16x16x32_bf16 v[148:151], v[216:219], v[136:139], v[148:151]
    buffer_load_dwordx4 v238, s[4:7], s44 offen offset:128 nt lds
    v_mfma_f32_16x16x32_bf16 v[152:155], v[216:219], v[140:143], v[152:155]
    s_waitcnt lgkmcnt(4)
    v_exp_f32 v184, v184
    v_mfma_f32_16x16x32_bf16 a[24:27], v[220:223], a[216:219], a[24:27]
    buffer_load_dwordx4 v238, s[4:7], s44 offen offset:2176 nt lds
    s_add_u32 m0, s52, 155648
    v_mfma_f32_16x16x32_bf16 a[28:31], v[220:223], a[220:223], a[28:31]
    s_add_u32 s44, s44, 8192
    v_add_f32 v224, v224, v182
    v_add_f32 v225, v225, v184
    v_mfma_f32_16x16x32_bf16 a[32:35], v[220:223], a[224:227], a[32:35]
    v_exp_f32 v185, v185
    v_mfma_f32_16x16x32_bf16 a[36:39], v[220:223], a[228:231], a[36:39]
    v_add_f32 v224, v224, v183
    v_add_f32 v225, v225, v185
    v_mfma_f32_16x16x32_bf16 a[40:43], v[220:223], a[232:235], a[40:43]
    v_exp_f32 v186, v186
    v_mfma_f32_16x16x32_bf16 a[44:47], v[220:223], a[236:239], a[44:47]
    s_waitcnt lgkmcnt(3)
    buffer_load_dwordx4 v239, s[20:23], s54 offen lds
    v_mfma_f32_16x16x32_bf16 v[156:159], a[240:243], v[96:99], v[204:207]
    v_exp_f32 v187, v187
    v_mfma_f32_16x16x32_bf16 v[160:163], a[240:243], v[100:103], v[208:211]
    v_exp_f32 v188, v188
    v_mfma_f32_16x16x32_bf16 v[164:167], a[240:243], v[104:107], v[212:215]
    s_waitcnt lgkmcnt(2)
    v_add_f32 v225, v225, v186
    v_cvt_pk_bf16_f32 v193, v170, v171
    v_mfma_f32_16x16x32_bf16 v[156:159], a[244:247], v[108:111], v[156:159]
    v_exp_f32 v189, v189
    v_mfma_f32_16x16x32_bf16 v[160:163], a[244:247], v[112:115], v[160:163]
    s_waitcnt vmcnt(11) lgkmcnt(0)
    s_barrier
    ds_read_b64_tr_b16 v[216:217], v236
    v_mfma_f32_16x16x32_bf16 v[164:167], a[244:247], v[116:119], v[164:167]
    s_add_u32 s54, s63, 221184
    ds_read_b64_tr_b16 v[218:219], v236 offset:2048
    v_add_f32 v225, v225, v187
    v_mfma_f32_16x16x32_bf16 v[156:159], a[248:251], v[120:123], v[156:159]
    s_add_u32 m0, s52, 151552
    ds_read_b64_tr_b16 v[220:221], v232 offset:16384
    v_add_f32 v226, v226, v188
    v_mfma_f32_16x16x32_bf16 v[160:163], a[248:251], v[124:127], v[160:163]
    ds_read_b64_tr_b16 v[222:223], v232 offset:20480
    v_cvt_pk_bf16_f32 v196, v172, v173
    v_mfma_f32_16x16x32_bf16 v[164:167], a[248:251], v[128:131], v[164:167]
    ds_read_b64_tr_b16 a[240:241], v233 offset:16384
    v_add_f32 v226, v226, v189
    v_mfma_f32_16x16x32_bf16 v[156:159], a[252:255], v[132:135], v[156:159]
    ds_read_b64_tr_b16 a[242:243], v233 offset:20480
    v_cvt_pk_bf16_f32 v197, v174, v175
    v_mfma_f32_16x16x32_bf16 v[160:163], a[252:255], v[136:139], v[160:163]
    ds_read_b64_tr_b16 a[244:245], v234 offset:16384
    v_cvt_pk_bf16_f32 v200, v176, v177
    v_mfma_f32_16x16x32_bf16 v[164:167], a[252:255], v[140:143], v[164:167]
    s_waitcnt lgkmcnt(5)
    ds_read_b64_tr_b16 a[246:247], v234 offset:20480
    v_cvt_pk_bf16_f32 v201, v178, v179
    v_mfma_f32_16x16x32_bf16 a[48:51], v[216:219], a[216:219], a[48:51]
    ds_read_b64_tr_b16 a[248:249], v235 offset:16384
    v_cvt_pk_bf16_f32 v194, v180, v181
    v_mfma_f32_16x16x32_bf16 a[52:55], v[216:219], a[220:223], a[52:55]
    ds_read_b64_tr_b16 a[250:251], v235 offset:20480
    v_cvt_pk_bf16_f32 v195, v182, v183
    v_mfma_f32_16x16x32_bf16 a[56:59], v[216:219], a[224:227], a[56:59]
    v_exp_f32 v190, v190
    v_mfma_f32_16x16x32_bf16 a[60:63], v[216:219], a[228:231], a[60:63]
    ds_read_b64_tr_b16 a[252:253], v236 offset:4096
    v_add_f32 v226, v226, v190
    v_mfma_f32_16x16x32_bf16 a[64:67], v[216:219], a[232:235], a[64:67]
    ds_read_b64_tr_b16 a[254:255], v236 offset:6144
    v_cvt_pk_bf16_f32 v198, v184, v185
    v_mfma_f32_16x16x32_bf16 a[68:71], v[216:219], a[236:239], a[68:71]
    s_waitcnt lgkmcnt(8)
    v_exp_f32 v191, v191
    v_cvt_pk_bf16_f32 v199, v186, v187
    v_mfma_f32_16x16x32_bf16 v[0:3], v[220:223], v[192:195], v[0:3]
    ds_read_b64_tr_b16 v[216:217], v232 offset:17408
    v_add_f32 v226, v226, v191
    v_cvt_pk_bf16_f32 v202, v188, v189
    v_cvt_pk_bf16_f32 v203, v190, v191
    v_mfma_f32_16x16x32_bf16 v[4:7], v[220:223], v[196:199], v[4:7]
    v_exp_f32 v144, v144
    v_mfma_f32_16x16x32_bf16 v[8:11], v[220:223], v[200:203], v[8:11]
    s_waitcnt lgkmcnt(7)
    ds_read_b64_tr_b16 v[218:219], v232 offset:21504
    v_add_f32 v224, v224, v144
    v_mfma_f32_16x16x32_bf16 v[12:15], a[240:243], v[192:195], v[12:15]
    ds_read_b64_tr_b16 v[220:221], v233 offset:17408
    ds_read_b64_tr_b16 v[222:223], v233 offset:21504
    v_mfma_f32_16x16x32_bf16 v[16:19], a[240:243], v[196:199], v[16:19]
    v_exp_f32 v145, v145
    v_mfma_f32_16x16x32_bf16 v[20:23], a[240:243], v[200:203], v[20:23]
    s_waitcnt lgkmcnt(8)
    v_exp_f32 v146, v146
    v_mfma_f32_16x16x32_bf16 v[24:27], a[244:247], v[192:195], v[24:27]
    buffer_load_dwordx4 v239, s[20:23], s54 offen lds
    s_add_u32 s54, s56, 258048
    v_mfma_f32_16x16x32_bf16 v[28:31], a[244:247], v[196:199], v[28:31]
    s_add_u32 m0, s52, 159744
    ds_read_b64_tr_b16 a[240:241], v234 offset:17408
    v_add_f32 v224, v224, v145
    v_mfma_f32_16x16x32_bf16 v[32:35], a[244:247], v[200:203], v[32:35]
    s_waitcnt lgkmcnt(7)
    ds_read_b64_tr_b16 a[242:243], v234 offset:21504
    v_add_f32 v224, v224, v146
    v_mfma_f32_16x16x32_bf16 v[36:39], a[248:251], v[192:195], v[36:39]
    v_exp_f32 v147, v147
    v_mfma_f32_16x16x32_bf16 v[40:43], a[248:251], v[196:199], v[40:43]
    buffer_load_dwordx4 v239, s[20:23], s54 offen lds
    s_add_u32 m0, s51, 8192
    v_mfma_f32_16x16x32_bf16 v[44:47], a[248:251], v[200:203], v[44:47]
    s_waitcnt lgkmcnt(6)
    ds_read_b64_tr_b16 a[244:245], v235 offset:17408
    v_add_f32 v224, v224, v147
    v_mfma_f32_16x16x32_bf16 a[72:75], a[252:255], a[216:219], a[72:75]
    v_exp_f32 v148, v148
    v_mfma_f32_16x16x32_bf16 a[76:79], a[252:255], a[220:223], a[76:79]
    ds_read_b64_tr_b16 a[246:247], v235 offset:21504
    v_add_f32 v225, v225, v148
    v_mfma_f32_16x16x32_bf16 a[80:83], a[252:255], a[224:227], a[80:83]
    buffer_load_dwordx4 v238, s[8:11], s45 offen nt lds
    v_mfma_f32_16x16x32_bf16 a[84:87], a[252:255], a[228:231], a[84:87]
    v_exp_f32 v149, v149
    v_mfma_f32_16x16x32_bf16 a[88:91], a[252:255], a[232:235], a[88:91]
    buffer_load_dwordx4 v238, s[8:11], s45 offen offset:2048 nt lds
    s_add_u32 m0, s51, 9088
    v_mfma_f32_16x16x32_bf16 a[92:95], a[252:255], a[236:239], a[92:95]
    s_waitcnt lgkmcnt(6)
    v_exp_f32 v150, v150
    v_mfma_f32_16x16x32_bf16 v[48:51], v[216:219], v[192:195], v[48:51]
    buffer_load_dwordx4 v238, s[8:11], s45 offen offset:128 nt lds
    v_mfma_f32_16x16x32_bf16 v[52:55], v[216:219], v[196:199], v[52:55]
    buffer_load_dwordx4 v238, s[8:11], s45 offen offset:2176 nt lds
    s_add_u32 s45, s45, 8192
    v_mfma_f32_16x16x32_bf16 v[56:59], v[216:219], v[200:203], v[56:59]
    s_waitcnt lgkmcnt(4)
    v_add_f32 v225, v225, v149
    v_mfma_f32_16x16x32_bf16 v[60:63], v[220:223], v[192:195], v[60:63]
    v_exp_f32 v151, v151
    v_mfma_f32_16x16x32_bf16 v[64:67], v[220:223], v[196:199], v[64:67]
    s_waitcnt vmcnt(11) lgkmcnt(0)
    s_barrier
    ds_read_b64_tr_b16 a[248:249], v236 offset:12288
    v_mfma_f32_16x16x32_bf16 v[68:71], v[220:223], v[200:203], v[68:71]
    s_add_u32 s54, s57, 258048
    ds_read_b64_tr_b16 a[250:251], v236 offset:14336
    v_add_f32 v225, v225, v150
    v_mfma_f32_16x16x32_bf16 v[72:75], a[240:243], v[192:195], v[72:75]
    s_add_u32 m0, s52, 131072
    ds_read_b128 a[252:255], v230 offset:24576
    v_add_f32 v225, v225, v151
    v_mfma_f32_16x16x32_bf16 v[76:79], a[240:243], v[196:199], v[76:79]
    ds_read_b128 v[216:219], v231 offset:24576
    ds_read_b128 v[220:223], v230 offset:25600
    v_mfma_f32_16x16x32_bf16 v[80:83], a[240:243], v[200:203], v[80:83]
    v_exp_f32 v152, v152
    v_mfma_f32_16x16x32_bf16 v[84:87], a[244:247], v[192:195], v[84:87]
    ds_read_b128 a[240:243], v231 offset:25600
    v_add_f32 v226, v226, v152
    v_mfma_f32_16x16x32_bf16 v[88:91], a[244:247], v[196:199], v[88:91]
    v_exp_f32 v153, v153
    v_mfma_f32_16x16x32_bf16 v[92:95], a[244:247], v[200:203], v[92:95]
    s_waitcnt lgkmcnt(4)
    ds_read_b64_tr_b16 a[244:245], v236 offset:8192
    v_add_f32 v226, v226, v153
    v_mfma_f32_16x16x32_bf16 a[96:99], a[248:251], a[216:219], a[96:99]
    ds_read_b64_tr_b16 a[246:247], v236 offset:10240
    v_cvt_pk_bf16_f32 v192, v144, v145
    v_mfma_f32_16x16x32_bf16 a[100:103], a[248:251], a[220:223], a[100:103]
    v_exp_f32 v154, v154
    v_mfma_f32_16x16x32_bf16 a[104:107], a[248:251], a[224:227], a[104:107]
    v_exp_f32 v155, v155
    v_mfma_f32_16x16x32_bf16 a[108:111], a[248:251], a[228:231], a[108:111]
    v_add_f32 v226, v226, v154
    v_cvt_pk_bf16_f32 v193, v146, v147
    v_mfma_f32_16x16x32_bf16 a[112:115], a[248:251], a[232:235], a[112:115]
    buffer_load_dwordx4 v239, s[20:23], s54 offen lds
    s_add_u32 s54, s58, 258048
    v_mfma_f32_16x16x32_bf16 a[116:119], a[248:251], a[236:239], a[116:119]
    s_waitcnt lgkmcnt(5)
    ds_read_b128 a[248:251], v230 offset:28672
    v_add_f32 v226, v226, v155
    v_mfma_f32_16x16x32_bf16 v[168:171], a[252:255], v[96:99], v[204:207]
    s_add_u32 m0, s52, 135168
    v_exp_f32 v156, v156
    v_mfma_f32_16x16x32_bf16 v[172:175], a[252:255], v[100:103], v[208:211]
    buffer_load_dwordx4 v239, s[20:23], s54 offen lds
    s_add_u32 m0, s51, 16384
    v_mfma_f32_16x16x32_bf16 v[176:179], a[252:255], v[104:107], v[212:215]
    s_waitcnt lgkmcnt(5)
    ds_read_b128 a[252:255], v231 offset:28672
    v_add_f32 v224, v224, v156
    v_mfma_f32_16x16x32_bf16 v[168:171], v[216:219], v[108:111], v[168:171]
    v_exp_f32 v157, v157
    v_mfma_f32_16x16x32_bf16 v[172:175], v[216:219], v[112:115], v[172:175]
    buffer_load_dwordx4 v238, s[4:7], s44 offen nt lds
    v_mfma_f32_16x16x32_bf16 v[176:179], v[216:219], v[116:119], v[176:179]
    s_waitcnt lgkmcnt(5)
    ds_read_b128 v[216:219], v230 offset:29696
    v_add_f32 v224, v224, v157
    v_mfma_f32_16x16x32_bf16 v[168:171], v[220:223], v[120:123], v[168:171]
    v_exp_f32 v158, v158
    v_mfma_f32_16x16x32_bf16 v[172:175], v[220:223], v[124:127], v[172:175]
    v_exp_f32 v159, v159
    v_mfma_f32_16x16x32_bf16 v[176:179], v[220:223], v[128:131], v[176:179]
    s_waitcnt lgkmcnt(5)
    ds_read_b128 v[220:223], v231 offset:29696
    v_add_f32 v224, v224, v158
    v_mfma_f32_16x16x32_bf16 v[168:171], a[240:243], v[132:135], v[168:171]
    buffer_load_dwordx4 v238, s[4:7], s44 offen offset:2048 nt lds
    s_add_u32 m0, s51, 17280
    v_mfma_f32_16x16x32_bf16 v[172:175], a[240:243], v[136:139], v[172:175]
    v_exp_f32 v160, v160
    v_mfma_f32_16x16x32_bf16 v[176:179], a[240:243], v[140:143], v[176:179]
    s_waitcnt lgkmcnt(4)
    buffer_load_dwordx4 v238, s[4:7], s44 offen offset:128 nt lds
    v_mfma_f32_16x16x32_bf16 a[120:123], a[244:247], a[216:219], a[120:123]
    v_exp_f32 v161, v161
    v_mfma_f32_16x16x32_bf16 a[124:127], a[244:247], a[220:223], a[124:127]
    v_add_f32 v224, v224, v159
    v_add_f32 v225, v225, v160
    v_mfma_f32_16x16x32_bf16 a[128:131], a[244:247], a[224:227], a[128:131]
    v_exp_f32 v162, v162
    v_mfma_f32_16x16x32_bf16 a[132:135], a[244:247], a[228:231], a[132:135]
    buffer_load_dwordx4 v238, s[4:7], s44 offen offset:2176 nt lds
    s_add_u32 s44, s44, 8192
    v_mfma_f32_16x16x32_bf16 a[136:139], a[244:247], a[232:235], a[136:139]
    s_add_u32 s44, s44, s68
    v_exp_f32 v163, v163
    v_mfma_f32_16x16x32_bf16 a[140:143], a[244:247], a[236:239], a[140:143]
    s_waitcnt lgkmcnt(3)
    v_add_f32 v225, v225, v161
    v_cvt_pk_bf16_f32 v196, v148, v149
    v_mfma_f32_16x16x32_bf16 v[180:183], a[248:251], v[96:99], v[204:207]
    v_exp_f32 v164, v164
    v_mfma_f32_16x16x32_bf16 v[184:187], a[248:251], v[100:103], v[208:211]
    v_add_f32 v225, v225, v162
    v_add_f32 v226, v226, v164
    v_mfma_f32_16x16x32_bf16 v[188:191], a[248:251], v[104:107], v[212:215]
    s_waitcnt lgkmcnt(2)
    v_exp_f32 v165, v165
    v_mfma_f32_16x16x32_bf16 v[180:183], a[252:255], v[108:111], v[180:183]
    v_add_f32 v225, v225, v163
    v_add_f32 v226, v226, v165
    v_mfma_f32_16x16x32_bf16 v[184:187], a[252:255], v[112:115], v[184:187]
    s_waitcnt vmcnt(11) lgkmcnt(0)
    s_barrier
    ds_read_b64_tr_b16 a[240:241], v236 offset:16384
    v_mfma_f32_16x16x32_bf16 v[188:191], a[252:255], v[116:119], v[188:191]
    s_add_u32 s54, s59, 258048
    ds_read_b64_tr_b16 a[242:243], v236 offset:18432
    v_cvt_pk_bf16_f32 v197, v150, v151
    v_mfma_f32_16x16x32_bf16 v[180:183], v[216:219], v[120:123], v[180:183]
    s_add_u32 m0, s52, 139264
    ds_read_b64_tr_b16 a[244:245], v232 offset:32768
    v_cvt_pk_bf16_f32 v200, v152, v153
    v_mfma_f32_16x16x32_bf16 v[184:187], v[216:219], v[124:127], v[184:187]
    ds_read_b64_tr_b16 a[246:247], v232 offset:36864
    v_cvt_pk_bf16_f32 v201, v154, v155
    v_mfma_f32_16x16x32_bf16 v[188:191], v[216:219], v[128:131], v[188:191]
    ds_read_b64_tr_b16 a[248:249], v233 offset:32768
    v_cvt_pk_bf16_f32 v194, v156, v157
    v_mfma_f32_16x16x32_bf16 v[180:183], v[220:223], v[132:135], v[180:183]
    ds_read_b64_tr_b16 a[250:251], v233 offset:36864
    v_cvt_pk_bf16_f32 v195, v158, v159
    v_mfma_f32_16x16x32_bf16 v[184:187], v[220:223], v[136:139], v[184:187]
    ds_read_b64_tr_b16 a[252:253], v234 offset:32768
    v_cvt_pk_bf16_f32 v198, v160, v161
    v_mfma_f32_16x16x32_bf16 v[188:191], v[220:223], v[140:143], v[188:191]
    s_waitcnt lgkmcnt(5)
    ds_read_b64_tr_b16 a[254:255], v234 offset:36864
    v_cvt_pk_bf16_f32 v199, v162, v163
    v_mfma_f32_16x16x32_bf16 a[144:147], a[240:243], a[216:219], a[144:147]
    ds_read_b64_tr_b16 v[216:217], v235 offset:32768
    v_cvt_pk_bf16_f32 v202, v164, v165
    v_mfma_f32_16x16x32_bf16 a[148:151], a[240:243], a[220:223], a[148:151]
    ds_read_b64_tr_b16 v[218:219], v235 offset:36864
    ds_read_b64_tr_b16 v[220:221], v236 offset:20480
    v_mfma_f32_16x16x32_bf16 a[152:155], a[240:243], a[224:227], a[152:155]
    v_exp_f32 v166, v166
    v_mfma_f32_16x16x32_bf16 a[156:159], a[240:243], a[228:231], a[156:159]
    ds_read_b64_tr_b16 v[222:223], v236 offset:22528
    v_add_f32 v226, v226, v166
    v_mfma_f32_16x16x32_bf16 a[160:163], a[240:243], a[232:235], a[160:163]
    v_exp_f32 v167, v167
    v_mfma_f32_16x16x32_bf16 a[164:167], a[240:243], a[236:239], a[164:167]
    s_waitcnt lgkmcnt(8)
    ds_read_b64_tr_b16 a[240:241], v232 offset:33792
    v_add_f32 v226, v226, v167
    v_mfma_f32_16x16x32_bf16 v[0:3], a[244:247], v[192:195], v[0:3]
    ds_read_b64_tr_b16 a[242:243], v232 offset:37888
    v_cvt_pk_bf16_f32 v203, v166, v167
    v_mfma_f32_16x16x32_bf16 v[4:7], a[244:247], v[196:199], v[4:7]
    v_exp_f32 v168, v168
    v_mfma_f32_16x16x32_bf16 v[8:11], a[244:247], v[200:203], v[8:11]
    s_waitcnt lgkmcnt(8)
    ds_read_b64_tr_b16 a[244:245], v233 offset:33792
    v_add_f32 v224, v224, v168
    v_mfma_f32_16x16x32_bf16 v[12:15], a[248:251], v[192:195], v[12:15]
    v_exp_f32 v169, v169
    v_mfma_f32_16x16x32_bf16 v[16:19], a[248:251], v[196:199], v[16:19]
    ds_read_b64_tr_b16 a[246:247], v233 offset:37888
    v_add_f32 v224, v224, v169
    v_mfma_f32_16x16x32_bf16 v[20:23], a[248:251], v[200:203], v[20:23]
    s_waitcnt lgkmcnt(8)
    v_exp_f32 v170, v170
    v_mfma_f32_16x16x32_bf16 v[24:27], a[252:255], v[192:195], v[24:27]
    buffer_load_dwordx4 v239, s[20:23], s54 offen lds
    s_add_u32 s54, s60, 258048
    v_mfma_f32_16x16x32_bf16 v[28:31], a[252:255], v[196:199], v[28:31]
    s_add_u32 m0, s52, 143360
    ds_read_b64_tr_b16 a[248:249], v234 offset:33792
    v_add_f32 v224, v224, v170
    v_mfma_f32_16x16x32_bf16 v[32:35], a[252:255], v[200:203], v[32:35]
    s_waitcnt lgkmcnt(7)
    ds_read_b64_tr_b16 a[250:251], v234 offset:37888
    ds_read_b64_tr_b16 a[252:253], v235 offset:33792
    v_mfma_f32_16x16x32_bf16 v[36:39], v[216:219], v[192:195], v[36:39]
    v_exp_f32 v171, v171
    v_mfma_f32_16x16x32_bf16 v[40:43], v[216:219], v[196:199], v[40:43]
    buffer_load_dwordx4 v239, s[20:23], s54 offen lds
    s_add_u32 m0, s51, 24576
    v_mfma_f32_16x16x32_bf16 v[44:47], v[216:219], v[200:203], v[44:47]
    s_waitcnt lgkmcnt(7)
    ds_read_b64_tr_b16 a[254:255], v235 offset:37888
    v_add_f32 v224, v224, v171
    v_mfma_f32_16x16x32_bf16 a[168:171], v[220:223], a[216:219], a[168:171]
    v_exp_f32 v172, v172
    v_mfma_f32_16x16x32_bf16 a[172:175], v[220:223], a[220:223], a[172:175]
    buffer_load_dwordx4 v238, s[8:11], s45 offen nt lds
    v_mfma_f32_16x16x32_bf16 a[176:179], v[220:223], a[224:227], a[176:179]
    v_exp_f32 v173, v173
    v_mfma_f32_16x16x32_bf16 a[180:183], v[220:223], a[228:231], a[180:183]
    buffer_load_dwordx4 v238, s[8:11], s45 offen offset:2048 nt lds
    s_add_u32 m0, s51, 25472
    v_mfma_f32_16x16x32_bf16 a[184:187], v[220:223], a[232:235], a[184:187]
    v_exp_f32 v174, v174
    v_mfma_f32_16x16x32_bf16 a[188:191], v[220:223], a[236:239], a[188:191]
    s_waitcnt lgkmcnt(6)
    buffer_load_dwordx4 v238, s[8:11], s45 offen offset:128 nt lds
    v_mfma_f32_16x16x32_bf16 v[48:51], a[240:243], v[192:195], v[48:51]
    v_add_f32 v225, v225, v172
    v_mfma_f32_16x16x32_bf16 v[52:55], a[240:243], v[196:199], v[52:55]
    buffer_load_dwordx4 v238, s[8:11], s45 offen offset:2176 nt lds
    s_add_u32 s45, s45, 8192
    v_mfma_f32_16x16x32_bf16 v[56:59], a[240:243], v[200:203], v[56:59]
    s_waitcnt lgkmcnt(4)
    v_add_f32 v225, v225, v173
    v_mfma_f32_16x16x32_bf16 v[60:63], a[244:247], v[192:195], v[60:63]
    v_exp_f32 v175, v175
    v_mfma_f32_16x16x32_bf16 v[64:67], a[244:247], v[196:199], v[64:67]
    s_waitcnt vmcnt(16) lgkmcnt(0)
    s_barrier
    ds_read_b64_tr_b16 v[216:217], v236 offset:24576
    v_mfma_f32_16x16x32_bf16 v[68:71], a[244:247], v[200:203], v[68:71]
    s_add_u32 s54, s61, 258048
    ds_read_b64_tr_b16 v[218:219], v236 offset:26624
    v_add_f32 v225, v225, v174
    v_mfma_f32_16x16x32_bf16 v[72:75], a[248:251], v[192:195], v[72:75]
    s_add_u32 m0, s52, 147456
    ds_read_b128 v[220:223], v230
    v_add_f32 v225, v225, v175
    v_mfma_f32_16x16x32_bf16 v[76:79], a[248:251], v[196:199], v[76:79]
    ds_read_b128 a[240:243], v231
    ds_read_b128 a[244:247], v230 offset:1024
    v_mfma_f32_16x16x32_bf16 v[80:83], a[248:251], v[200:203], v[80:83]
    v_exp_f32 v176, v176
    v_mfma_f32_16x16x32_bf16 v[84:87], a[252:255], v[192:195], v[84:87]
    ds_read_b128 a[248:251], v231 offset:1024
    v_add_f32 v226, v226, v176
    v_mfma_f32_16x16x32_bf16 v[88:91], a[252:255], v[196:199], v[88:91]
    v_exp_f32 v177, v177
    v_mfma_f32_16x16x32_bf16 v[92:95], a[252:255], v[200:203], v[92:95]
    s_waitcnt lgkmcnt(4)
    ds_read_b64_tr_b16 a[252:253], v236 offset:28672
    v_add_f32 v226, v226, v177
    v_mfma_f32_16x16x32_bf16 a[192:195], v[216:219], a[216:219], a[192:195]
    ds_read_b128 a[216:219], v237 offset:43008
    ds_read_b64_tr_b16 a[254:255], v236 offset:30720
    v_mfma_f32_16x16x32_bf16 a[196:199], v[216:219], a[220:223], a[196:199]
    ds_read_b128 a[220:223], v237 offset:44032
    v_cvt_pk_bf16_f32 v192, v168, v169
    v_mfma_f32_16x16x32_bf16 a[200:203], v[216:219], a[224:227], a[200:203]
    ds_read_b128 a[224:227], v237 offset:45056
    v_cvt_pk_bf16_f32 v193, v170, v171
    v_mfma_f32_16x16x32_bf16 a[204:207], v[216:219], a[228:231], a[204:207]
    ds_read_b128 a[228:231], v237 offset:46080
    v_cvt_pk_bf16_f32 v196, v172, v173
    v_mfma_f32_16x16x32_bf16 a[208:211], v[216:219], a[232:235], a[208:211]
    ds_read_b128 a[232:235], v237 offset:47104
    v_cvt_pk_bf16_f32 v197, v174, v175
    v_mfma_f32_16x16x32_bf16 a[212:215], v[216:219], a[236:239], a[212:215]
    s_waitcnt lgkmcnt(10)
    v_exp_f32 v178, v178
    v_mfma_f32_16x16x32_bf16 v[144:147], v[220:223], v[96:99], v[204:207]
    ds_read_b128 a[236:239], v237 offset:48128
    v_add_f32 v226, v226, v178
    v_mfma_f32_16x16x32_bf16 v[148:151], v[220:223], v[100:103], v[208:211]
    ds_read_b128 v[216:219], v230 offset:4096
    v_cvt_pk_bf16_f32 v200, v176, v177
    v_mfma_f32_16x16x32_bf16 v[152:155], v[220:223], v[104:107], v[212:215]
    s_waitcnt lgkmcnt(11)
    v_exp_f32 v179, v179
    v_mfma_f32_16x16x32_bf16 v[144:147], a[240:243], v[108:111], v[144:147]
    ds_read_b128 v[220:223], v231 offset:4096
    v_add_f32 v226, v226, v179
    v_mfma_f32_16x16x32_bf16 v[148:151], a[240:243], v[112:115], v[148:151]
    buffer_load_dwordx4 v239, s[20:23], s54 offen lds
    s_add_u32 s54, s62, 258048
    v_mfma_f32_16x16x32_bf16 v[152:155], a[240:243], v[116:119], v[152:155]
    s_waitcnt lgkmcnt(11)
    ds_read_b128 a[240:243], v230 offset:5120
    v_cvt_pk_bf16_f32 v201, v178, v179
    v_mfma_f32_16x16x32_bf16 v[144:147], a[244:247], v[120:123], v[144:147]
    s_add_u32 m0, s52, 151552
    v_exp_f32 v180, v180
    v_mfma_f32_16x16x32_bf16 v[148:151], a[244:247], v[124:127], v[148:151]
    buffer_load_dwordx4 v239, s[20:23], s54 offen lds
    s_add_u32 m0, s51, 32768
    v_mfma_f32_16x16x32_bf16 v[152:155], a[244:247], v[128:131], v[152:155]
    s_waitcnt lgkmcnt(11)
    ds_read_b128 a[244:247], v231 offset:5120
    v_add_f32 v224, v224, v180
    v_mfma_f32_16x16x32_bf16 v[144:147], a[248:251], v[132:135], v[144:147]
    v_exp_f32 v181, v181
    v_mfma_f32_16x16x32_bf16 v[148:151], a[248:251], v[136:139], v[148:151]
    buffer_load_dwordx4 v238, s[8:11], s45 offen nt lds
    v_mfma_f32_16x16x32_bf16 v[152:155], a[248:251], v[140:143], v[152:155]
    s_waitcnt lgkmcnt(9)
    v_exp_f32 v182, v182
    v_mfma_f32_16x16x32_bf16 a[0:3], a[252:255], a[216:219], a[0:3]
    s_waitcnt lgkmcnt(8)
    v_exp_f32 v183, v183
    v_mfma_f32_16x16x32_bf16 a[4:7], a[252:255], a[220:223], a[4:7]
    s_waitcnt lgkmcnt(7)
    buffer_load_dwordx4 v238, s[8:11], s45 offen offset:2048 nt lds
    v_mfma_f32_16x16x32_bf16 a[8:11], a[252:255], a[224:227], a[8:11]
    s_waitcnt lgkmcnt(6)
    v_add_f32 v224, v224, v181
    v_cvt_pk_bf16_f32 v194, v180, v181
    v_mfma_f32_16x16x32_bf16 a[12:15], a[252:255], a[228:231], a[12:15]
    s_waitcnt lgkmcnt(5)
    v_exp_f32 v184, v184
    v_mfma_f32_16x16x32_bf16 a[16:19], a[252:255], a[232:235], a[16:19]
    s_waitcnt lgkmcnt(4)
    v_add_f32 v224, v224, v182
    v_add_f32 v225, v225, v184
    v_mfma_f32_16x16x32_bf16 a[20:23], a[252:255], a[236:239], a[20:23]
    s_waitcnt lgkmcnt(3)
    v_exp_f32 v185, v185
    v_mfma_f32_16x16x32_bf16 v[156:159], v[216:219], v[96:99], v[204:207]
    s_add_u32 m0, s51, 33664
    v_add_f32 v224, v224, v183
    v_add_f32 v225, v225, v185
    v_mfma_f32_16x16x32_bf16 v[160:163], v[216:219], v[100:103], v[208:211]
    buffer_load_dwordx4 v238, s[8:11], s45 offen offset:128 nt lds
    v_mfma_f32_16x16x32_bf16 v[164:167], v[216:219], v[104:107], v[212:215]
    s_waitcnt lgkmcnt(2)
    v_exp_f32 v186, v186
    v_mfma_f32_16x16x32_bf16 v[156:159], v[220:223], v[108:111], v[156:159]
    buffer_load_dwordx4 v238, s[8:11], s45 offen offset:2176 nt lds
    s_add_u32 s45, s45, 8192
    s_cmp_eq_u32 s53, 3
    s_cbranch_scc1 L_tailf
    v_mfma_f32_16x16x32_bf16 v[160:163], v[220:223], v[112:115], v[160:163]
    s_waitcnt vmcnt(16) lgkmcnt(0)
    s_barrier
    ds_read_b64_tr_b16 a[248:249], v236
    v_mfma_f32_16x16x32_bf16 v[164:167], v[220:223], v[116:119], v[164:167]
    s_add_u32 s54, s63, 258048
    ds_read_b64_tr_b16 a[250:251], v236 offset:2048
    v_add_f32 v225, v225, v186
    v_mfma_f32_16x16x32_bf16 v[156:159], a[240:243], v[120:123], v[156:159]
    s_add_u32 m0, s52, 155648
    ds_read_b64_tr_b16 a[252:253], v232 offset:8192
    v_cvt_pk_bf16_f32 v195, v182, v183
    v_mfma_f32_16x16x32_bf16 v[160:163], a[240:243], v[124:127], v[160:163]
    s_add_u32 s45, s45, s68
    ds_read_b64_tr_b16 a[254:255], v232 offset:12288
    v_cvt_pk_bf16_f32 v198, v184, v185
    v_mfma_f32_16x16x32_bf16 v[164:167], a[240:243], v[128:131], v[164:167]
    ds_read_b64_tr_b16 v[216:217], v233 offset:8192
    ds_read_b64_tr_b16 v[218:219], v233 offset:12288
    v_mfma_f32_16x16x32_bf16 v[156:159], a[244:247], v[132:135], v[156:159]
    v_exp_f32 v187, v187
    v_mfma_f32_16x16x32_bf16 v[160:163], a[244:247], v[136:139], v[160:163]
    ds_read_b64_tr_b16 v[220:221], v234 offset:8192
    v_add_f32 v225, v225, v187
    v_mfma_f32_16x16x32_bf16 v[164:167], a[244:247], v[140:143], v[164:167]
    s_waitcnt lgkmcnt(5)
    ds_read_b64_tr_b16 v[222:223], v234 offset:12288
    v_cvt_pk_bf16_f32 v199, v186, v187
    v_mfma_f32_16x16x32_bf16 a[24:27], a[248:251], a[216:219], a[24:27]
    v_exp_f32 v188, v188
    v_mfma_f32_16x16x32_bf16 a[28:31], a[248:251], a[220:223], a[28:31]
    v_exp_f32 v189, v189
    v_mfma_f32_16x16x32_bf16 a[32:35], a[248:251], a[224:227], a[32:35]
    ds_read_b64_tr_b16 a[240:241], v235 offset:8192
    v_add_f32 v226, v226, v188
    v_mfma_f32_16x16x32_bf16 a[36:39], a[248:251], a[228:231], a[36:39]
    ds_read_b64_tr_b16 a[242:243], v235 offset:12288
    v_add_f32 v226, v226, v189
    v_mfma_f32_16x16x32_bf16 a[40:43], a[248:251], a[232:235], a[40:43]
    v_exp_f32 v190, v190
    v_mfma_f32_16x16x32_bf16 a[44:47], a[248:251], a[236:239], a[44:47]
    s_waitcnt lgkmcnt(6)
    ds_read_b64_tr_b16 a[244:245], v236 offset:4096
    v_add_f32 v226, v226, v190
    v_mfma_f32_16x16x32_bf16 v[0:3], a[252:255], v[192:195], v[0:3]
    ds_read_b64_tr_b16 a[246:247], v236 offset:6144
    v_cvt_pk_bf16_f32 v202, v188, v189
    v_exp_f32 v191, v191
    s_nop 0
    v_cvt_pk_bf16_f32 v203, v190, v191
    v_mfma_f32_16x16x32_bf16 v[4:7], a[252:255], v[196:199], v[4:7]
    ds_read_b64_tr_b16 a[248:249], v232 offset:9216
    v_add_f32 v226, v226, v191
    v_mfma_f32_16x16x32_bf16 v[8:11], a[252:255], v[200:203], v[8:11]
    s_waitcnt lgkmcnt(7)
    ds_read_b64_tr_b16 a[250:251], v232 offset:13312
    ds_read_b64_tr_b16 a[252:253], v233 offset:9216
    v_mfma_f32_16x16x32_bf16 v[12:15], v[216:219], v[192:195], v[12:15]
    v_exp_f32 v144, v144
    v_mfma_f32_16x16x32_bf16 v[16:19], v[216:219], v[196:199], v[16:19]
    ds_read_b64_tr_b16 a[254:255], v233 offset:13312
    v_add_f32 v224, v224, v144
    v_mfma_f32_16x16x32_bf16 v[20:23], v[216:219], v[200:203], v[20:23]
    s_waitcnt lgkmcnt(8)
    v_exp_f32 v145, v145
    v_mfma_f32_16x16x32_bf16 v[24:27], v[220:223], v[192:195], v[24:27]
    v_exp_f32 v146, v146
    v_mfma_f32_16x16x32_bf16 v[28:31], v[220:223], v[196:199], v[28:31]
    buffer_load_dwordx4 v239, s[20:23], s54 offen lds
    s_add_u32 s54, s64, 258048
    v_mfma_f32_16x16x32_bf16 v[32:35], v[220:223], v[200:203], v[32:35]
    s_waitcnt lgkmcnt(6)
    ds_read_b64_tr_b16 v[216:217], v234 offset:9216
    v_add_f32 v224, v224, v145
    v_mfma_f32_16x16x32_bf16 v[36:39], a[240:243], v[192:195], v[36:39]
    s_add_u32 m0, s52, 159744
    ds_read_b64_tr_b16 v[218:219], v234 offset:13312
    v_add_f32 v224, v224, v146
    v_mfma_f32_16x16x32_bf16 v[40:43], a[240:243], v[196:199], v[40:43]
    v_exp_f32 v147, v147
    v_mfma_f32_16x16x32_bf16 v[44:47], a[240:243], v[200:203], v[44:47]
    s_waitcnt lgkmcnt(6)
    buffer_load_dwordx4 v239, s[20:23], s54 offen lds
    v_mfma_f32_16x16x32_bf16 a[48:51], a[244:247], a[216:219], a[48:51]
    s_add_u32 m0, s51, 0
    ds_read_b64_tr_b16 v[220:221], v235 offset:9216
    v_add_f32 v224, v224, v147
    v_mfma_f32_16x16x32_bf16 a[52:55], a[244:247], a[220:223], a[52:55]
    v_exp_f32 v148, v148
    v_mfma_f32_16x16x32_bf16 a[56:59], a[244:247], a[224:227], a[56:59]
    ds_read_b64_tr_b16 v[222:223], v235 offset:13312
    v_add_f32 v225, v225, v148
    v_mfma_f32_16x16x32_bf16 a[60:63], a[244:247], a[228:231], a[60:63]
    buffer_load_dwordx4 v240, s[12:15], s46 offen lds
    v_mfma_f32_16x16x32_bf16 a[64:67], a[244:247], a[232:235], a[64:67]
    v_exp_f32 v149, v149
    v_mfma_f32_16x16x32_bf16 a[68:71], a[244:247], a[236:239], a[68:71]
    s_waitcnt lgkmcnt(6)
    buffer_load_dwordx4 v241, s[12:15], s46 offen offset:2048 lds
    v_mfma_f32_16x16x32_bf16 v[48:51], a[248:251], v[192:195], v[48:51]
    s_add_u32 m0, s51, 896
    v_exp_f32 v150, v150
    v_mfma_f32_16x16x32_bf16 v[52:55], a[248:251], v[196:199], v[52:55]
    buffer_load_dwordx4 v240, s[12:15], s46 offen offset:128 lds
    v_mfma_f32_16x16x32_bf16 v[56:59], a[248:251], v[200:203], v[56:59]
    s_waitcnt lgkmcnt(4)
    buffer_load_dwordx4 v241, s[12:15], s46 offen offset:2176 lds
    v_mfma_f32_16x16x32_bf16 v[60:63], a[252:255], v[192:195], v[60:63]
    s_add_u32 s46, s46, 262144
    v_add_f32 v225, v225, v149
    v_mfma_f32_16x16x32_bf16 v[64:67], a[252:255], v[196:199], v[64:67]
    s_waitcnt vmcnt(16) lgkmcnt(0)
    s_barrier
    ds_read_b64_tr_b16 a[240:241], v236 offset:8192
    v_mfma_f32_16x16x32_bf16 v[68:71], a[252:255], v[200:203], v[68:71]
    s_add_u32 m0, s51, 8192
    ds_read_b64_tr_b16 a[242:243], v236 offset:10240
    v_add_f32 v225, v225, v150
    v_mfma_f32_16x16x32_bf16 v[72:75], v[216:219], v[192:195], v[72:75]
    ds_read_b128 a[244:247], v230 offset:16384
    ds_read_b128 a[248:251], v231 offset:16384
    v_mfma_f32_16x16x32_bf16 v[76:79], v[216:219], v[196:199], v[76:79]
    v_exp_f32 v151, v151
    v_mfma_f32_16x16x32_bf16 v[80:83], v[216:219], v[200:203], v[80:83]
    ds_read_b128 a[252:255], v230 offset:17408
    v_add_f32 v225, v225, v151
    v_mfma_f32_16x16x32_bf16 v[84:87], v[220:223], v[192:195], v[84:87]
    v_exp_f32 v152, v152
    v_mfma_f32_16x16x32_bf16 v[88:91], v[220:223], v[196:199], v[88:91]
    ds_read_b128 v[216:219], v231 offset:17408
    v_add_f32 v226, v226, v152
    v_mfma_f32_16x16x32_bf16 v[92:95], v[220:223], v[200:203], v[92:95]
    s_waitcnt lgkmcnt(4)
    ds_read_b64_tr_b16 v[220:221], v236 offset:12288
    ds_read_b64_tr_b16 v[222:223], v236 offset:14336
    v_mfma_f32_16x16x32_bf16 a[72:75], a[240:243], a[216:219], a[72:75]
    v_exp_f32 v153, v153
    v_mfma_f32_16x16x32_bf16 a[76:79], a[240:243], a[220:223], a[76:79]
    v_exp_f32 v154, v154
    v_mfma_f32_16x16x32_bf16 a[80:83], a[240:243], a[224:227], a[80:83]
    v_add_f32 v226, v226, v153
    v_cvt_pk_bf16_f32 v192, v144, v145
    v_mfma_f32_16x16x32_bf16 a[84:87], a[240:243], a[228:231], a[84:87]
    v_exp_f32 v155, v155
    v_mfma_f32_16x16x32_bf16 a[88:91], a[240:243], a[232:235], a[88:91]
    v_add_f32 v226, v226, v154
    v_cvt_pk_bf16_f32 v193, v146, v147
    v_mfma_f32_16x16x32_bf16 a[92:95], a[240:243], a[236:239], a[92:95]
    s_waitcnt lgkmcnt(5)
    ds_read_b128 a[240:243], v230 offset:20480
    v_add_f32 v226, v226, v155
    v_mfma_f32_16x16x32_bf16 v[168:171], a[244:247], v[96:99], v[204:207]
    buffer_load_dwordx4 v240, s[12:15], s46 offen lds
    v_mfma_f32_16x16x32_bf16 v[172:175], a[244:247], v[100:103], v[208:211]
    v_exp_f32 v156, v156
    v_mfma_f32_16x16x32_bf16 v[176:179], a[244:247], v[104:107], v[212:215]
    s_waitcnt lgkmcnt(5)
    ds_read_b128 a[244:247], v231 offset:20480
    v_add_f32 v224, v224, v156
    v_mfma_f32_16x16x32_bf16 v[168:171], a[248:251], v[108:111], v[168:171]
    buffer_load_dwordx4 v241, s[12:15], s46 offen offset:2048 lds
    s_add_u32 m0, s51, 9088
    v_mfma_f32_16x16x32_bf16 v[172:175], a[248:251], v[112:115], v[172:175]
    v_exp_f32 v157, v157
    v_mfma_f32_16x16x32_bf16 v[176:179], a[248:251], v[116:119], v[176:179]
    s_waitcnt lgkmcnt(5)
    ds_read_b128 a[248:251], v230 offset:21504
    v_add_f32 v224, v224, v157
    v_mfma_f32_16x16x32_bf16 v[168:171], a[252:255], v[120:123], v[168:171]
    buffer_load_dwordx4 v240, s[12:15], s46 offen offset:128 lds
    v_mfma_f32_16x16x32_bf16 v[172:175], a[252:255], v[124:127], v[172:175]
    v_exp_f32 v158, v158
    v_mfma_f32_16x16x32_bf16 v[176:179], a[252:255], v[128:131], v[176:179]
    s_waitcnt lgkmcnt(5)
    ds_read_b128 a[252:255], v231 offset:21504
    v_add_f32 v224, v224, v158
    v_mfma_f32_16x16x32_bf16 v[168:171], v[216:219], v[132:135], v[168:171]
    v_exp_f32 v159, v159
    v_mfma_f32_16x16x32_bf16 v[172:175], v[216:219], v[136:139], v[172:175]
    buffer_load_dwordx4 v241, s[12:15], s46 offen offset:2176 lds
    s_add_u32 s46, s46, 262144
    v_mfma_f32_16x16x32_bf16 v[176:179], v[216:219], v[140:143], v[176:179]
    s_waitcnt lgkmcnt(4)
    v_exp_f32 v160, v160
    v_mfma_f32_16x16x32_bf16 a[96:99], v[220:223], a[216:219], a[96:99]
    buffer_load_dword v251, v227, s[12:15], s94 offen
    s_cmp_lt_u32 s53, 2
    s_cselect_b32 s54, 512, 0
    s_add_u32 s94, s94, s54
    v_mfma_f32_16x16x32_bf16 a[100:103], v[220:223], a[220:223], a[100:103]
    v_exp_f32 v161, v161
    v_mfma_f32_16x16x32_bf16 a[104:107], v[220:223], a[224:227], a[104:107]
    v_add_f32 v224, v224, v159
    v_add_f32 v225, v225, v160
    v_mfma_f32_16x16x32_bf16 a[108:111], v[220:223], a[228:231], a[108:111]
    v_exp_f32 v162, v162
    v_mfma_f32_16x16x32_bf16 a[112:115], v[220:223], a[232:235], a[112:115]
    v_exp_f32 v163, v163
    v_mfma_f32_16x16x32_bf16 a[116:119], v[220:223], a[236:239], a[116:119]
    s_waitcnt lgkmcnt(3)
    v_add_f32 v225, v225, v161
    v_cvt_pk_bf16_f32 v196, v148, v149
    v_mfma_f32_16x16x32_bf16 v[180:183], a[240:243], v[96:99], v[204:207]
    v_exp_f32 v164, v164
    v_mfma_f32_16x16x32_bf16 v[184:187], a[240:243], v[100:103], v[208:211]
    v_add_f32 v225, v225, v162
    v_add_f32 v226, v226, v164
    v_mfma_f32_16x16x32_bf16 v[188:191], a[240:243], v[104:107], v[212:215]
    s_waitcnt lgkmcnt(2)
    v_exp_f32 v165, v165
    v_mfma_f32_16x16x32_bf16 v[180:183], a[244:247], v[108:111], v[180:183]
    v_add_f32 v225, v225, v163
    v_add_f32 v226, v226, v165
    v_mfma_f32_16x16x32_bf16 v[184:187], a[244:247], v[112:115], v[184:187]
    s_waitcnt vmcnt(15) lgkmcnt(0)
    s_barrier
    ds_read_b64_tr_b16 v[216:217], v236 offset:16384
    v_mfma_f32_16x16x32_bf16 v[188:191], a[244:247], v[116:119], v[188:191]
    s_add_u32 m0, s52, 131072
    ds_read_b64_tr_b16 v[218:219], v236 offset:18432
    v_cvt_pk_bf16_f32 v197, v150, v151
    v_mfma_f32_16x16x32_bf16 v[180:183], a[248:251], v[120:123], v[180:183]
    ds_read_b64_tr_b16 v[220:221], v232 offset:24576
    v_cvt_pk_bf16_f32 v200, v152, v153
    v_mfma_f32_16x16x32_bf16 v[184:187], a[248:251], v[124:127], v[184:187]
    ds_read_b64_tr_b16 v[222:223], v232 offset:28672
    v_cvt_pk_bf16_f32 v201, v154, v155
    v_mfma_f32_16x16x32_bf16 v[188:191], a[248:251], v[128:131], v[188:191]
    ds_read_b64_tr_b16 a[240:241], v233 offset:24576
    v_cvt_pk_bf16_f32 v194, v156, v157
    v_mfma_f32_16x16x32_bf16 v[180:183], a[252:255], v[132:135], v[180:183]
    ds_read_b64_tr_b16 a[242:243], v233 offset:28672
    v_cvt_pk_bf16_f32 v195, v158, v159
    v_mfma_f32_16x16x32_bf16 v[184:187], a[252:255], v[136:139], v[184:187]
    ds_read_b64_tr_b16 a[244:245], v234 offset:24576
    v_cvt_pk_bf16_f32 v198, v160, v161
    v_mfma_f32_16x16x32_bf16 v[188:191], a[252:255], v[140:143], v[188:191]
    s_waitcnt lgkmcnt(5)
    ds_read_b64_tr_b16 a[246:247], v234 offset:28672
    v_cvt_pk_bf16_f32 v199, v162, v163
    v_mfma_f32_16x16x32_bf16 a[120:123], v[216:219], a[216:219], a[120:123]
    ds_read_b64_tr_b16 a[248:249], v235 offset:24576
    v_cvt_pk_bf16_f32 v202, v164, v165
    v_mfma_f32_16x16x32_bf16 a[124:127], v[216:219], a[220:223], a[124:127]
    ds_read_b64_tr_b16 a[250:251], v235 offset:28672
    ds_read_b64_tr_b16 a[252:253], v236 offset:20480
    v_mfma_f32_16x16x32_bf16 a[128:131], v[216:219], a[224:227], a[128:131]
    v_exp_f32 v166, v166
    v_mfma_f32_16x16x32_bf16 a[132:135], v[216:219], a[228:231], a[132:135]
    ds_read_b64_tr_b16 a[254:255], v236 offset:22528
    v_add_f32 v226, v226, v166
    v_mfma_f32_16x16x32_bf16 a[136:139], v[216:219], a[232:235], a[136:139]
    v_exp_f32 v167, v167
    v_mfma_f32_16x16x32_bf16 a[140:143], v[216:219], a[236:239], a[140:143]
    s_waitcnt lgkmcnt(8)
    ds_read_b64_tr_b16 v[216:217], v232 offset:25600
    v_add_f32 v226, v226, v167
    v_mfma_f32_16x16x32_bf16 v[0:3], v[220:223], v[192:195], v[0:3]
    ds_read_b64_tr_b16 v[218:219], v232 offset:29696
    v_cvt_pk_bf16_f32 v203, v166, v167
    v_mfma_f32_16x16x32_bf16 v[4:7], v[220:223], v[196:199], v[4:7]
    v_exp_f32 v168, v168
    v_mfma_f32_16x16x32_bf16 v[8:11], v[220:223], v[200:203], v[8:11]
    s_waitcnt lgkmcnt(8)
    v_exp_f32 v169, v169
    v_mfma_f32_16x16x32_bf16 v[12:15], a[240:243], v[192:195], v[12:15]
    ds_read_b64_tr_b16 v[220:221], v233 offset:25600
    v_add_f32 v224, v224, v168
    v_mfma_f32_16x16x32_bf16 v[16:19], a[240:243], v[196:199], v[16:19]
    ds_read_b64_tr_b16 v[222:223], v233 offset:29696
    v_add_f32 v224, v224, v169
    v_mfma_f32_16x16x32_bf16 v[20:23], a[240:243], v[200:203], v[20:23]
    s_waitcnt lgkmcnt(8)
    v_exp_f32 v170, v170
    v_mfma_f32_16x16x32_bf16 v[24:27], a[244:247], v[192:195], v[24:27]
    buffer_load_dwordx4 v239, s[16:19], s47 offen lds
    s_add_u32 m0, s52, 135168
    v_mfma_f32_16x16x32_bf16 v[28:31], a[244:247], v[196:199], v[28:31]
    ds_read_b64_tr_b16 a[240:241], v234 offset:25600
    v_add_f32 v224, v224, v170
    v_mfma_f32_16x16x32_bf16 v[32:35], a[244:247], v[200:203], v[32:35]
    s_waitcnt lgkmcnt(7)
    ds_read_b64_tr_b16 a[242:243], v234 offset:29696
    ds_read_b64_tr_b16 a[244:245], v235 offset:25600
    v_mfma_f32_16x16x32_bf16 v[36:39], a[248:251], v[192:195], v[36:39]
    v_exp_f32 v171, v171
    v_mfma_f32_16x16x32_bf16 v[40:43], a[248:251], v[196:199], v[40:43]
    v_exp_f32 v172, v172
    v_mfma_f32_16x16x32_bf16 v[44:47], a[248:251], v[200:203], v[44:47]
    s_waitcnt lgkmcnt(7)
    buffer_load_dwordx4 v239, s[16:19], s48 offen lds
    v_mfma_f32_16x16x32_bf16 a[144:147], a[252:255], a[216:219], a[144:147]
    s_add_u32 m0, s52, 139264
    ds_read_b64_tr_b16 a[246:247], v235 offset:29696
    v_add_f32 v224, v224, v171
    v_mfma_f32_16x16x32_bf16 a[148:151], a[252:255], a[220:223], a[148:151]
    v_exp_f32 v173, v173
    v_mfma_f32_16x16x32_bf16 a[152:155], a[252:255], a[224:227], a[152:155]
    buffer_load_dwordx4 v239, s[16:19], s49 offen lds
    s_add_u32 m0, s51, 16384
    v_mfma_f32_16x16x32_bf16 a[156:159], a[252:255], a[228:231], a[156:159]
    v_exp_f32 v174, v174
    v_mfma_f32_16x16x32_bf16 a[160:163], a[252:255], a[232:235], a[160:163]
    buffer_load_dwordx4 v240, s[12:15], s46 offen lds
    v_mfma_f32_16x16x32_bf16 a[164:167], a[252:255], a[236:239], a[164:167]
    s_waitcnt lgkmcnt(6)
    v_exp_f32 v175, v175
    v_mfma_f32_16x16x32_bf16 v[48:51], v[216:219], v[192:195], v[48:51]
    v_add_f32 v225, v225, v172
    v_mfma_f32_16x16x32_bf16 v[52:55], v[216:219], v[196:199], v[52:55]
    v_exp_f32 v176, v176
    v_mfma_f32_16x16x32_bf16 v[56:59], v[216:219], v[200:203], v[56:59]
    s_waitcnt lgkmcnt(4)
    v_add_f32 v225, v225, v173
    v_add_f32 v226, v226, v176
    v_mfma_f32_16x16x32_bf16 v[60:63], v[220:223], v[192:195], v[60:63]
    buffer_load_dwordx4 v241, s[12:15], s46 offen offset:2048 lds
    s_add_u32 m0, s51, 17280
    v_mfma_f32_16x16x32_bf16 v[64:67], v[220:223], v[196:199], v[64:67]
    s_waitcnt vmcnt(14) lgkmcnt(0)
    s_barrier
    ds_read_b64_tr_b16 a[248:249], v236 offset:24576
    v_mfma_f32_16x16x32_bf16 v[68:71], v[220:223], v[200:203], v[68:71]
    ds_read_b64_tr_b16 a[250:251], v236 offset:26624
    v_add_f32 v225, v225, v174
    v_mfma_f32_16x16x32_bf16 v[72:75], a[240:243], v[192:195], v[72:75]
    ds_read_b64_tr_b16 a[252:253], v232 offset:32768
    v_add_f32 v225, v225, v175
    v_mfma_f32_16x16x32_bf16 v[76:79], a[240:243], v[196:199], v[76:79]
    ds_read_b64_tr_b16 a[254:255], v232 offset:36864
    ds_read_b64_tr_b16 v[216:217], v233 offset:32768
    v_mfma_f32_16x16x32_bf16 v[80:83], a[240:243], v[200:203], v[80:83]
    v_exp_f32 v177, v177
    v_mfma_f32_16x16x32_bf16 v[84:87], a[244:247], v[192:195], v[84:87]
    buffer_load_dwordx4 v240, s[12:15], s46 offen offset:128 lds
    v_mfma_f32_16x16x32_bf16 v[88:91], a[244:247], v[196:199], v[88:91]
    ds_read_b64_tr_b16 v[218:219], v233 offset:36864
    v_add_f32 v226, v226, v177
    v_mfma_f32_16x16x32_bf16 v[92:95], a[244:247], v[200:203], v[92:95]
    s_waitcnt lgkmcnt(4)
    v_exp_f32 v178, v178
    v_mfma_f32_16x16x32_bf16 a[168:171], a[248:251], a[216:219], a[168:171]
    buffer_load_dwordx4 v241, s[12:15], s46 offen offset:2176 lds
    s_add_u32 s46, s46, 262144
    v_mfma_f32_16x16x32_bf16 a[172:175], a[248:251], a[220:223], a[172:175]
    s_add_u32 m0, s51, 24576
    ds_read_b64_tr_b16 v[220:221], v234 offset:32768
    v_add_f32 v226, v226, v178
    v_mfma_f32_16x16x32_bf16 a[176:179], a[248:251], a[224:227], a[176:179]
    ds_read_b64_tr_b16 v[222:223], v234 offset:36864
    ds_read_b64_tr_b16 a[240:241], v235 offset:32768
    v_mfma_f32_16x16x32_bf16 a[180:183], a[248:251], a[228:231], a[180:183]
    v_exp_f32 v179, v179
    v_mfma_f32_16x16x32_bf16 a[184:187], a[248:251], a[232:235], a[184:187]
    v_exp_f32 v180, v180
    v_exp_f32 v181, v181
    v_exp_f32 v182, v182
    v_exp_f32 v183, v183
    v_cvt_pk_bf16_f32 v192, v168, v169
    v_cvt_pk_bf16_f32 v193, v170, v171
    v_cvt_pk_bf16_f32 v194, v180, v181
    v_cvt_pk_bf16_f32 v195, v182, v183
    v_mfma_f32_16x16x32_bf16 a[188:191], a[248:251], a[236:239], a[188:191]
    s_waitcnt lgkmcnt(5)
    ds_read_b64_tr_b16 a[242:243], v235 offset:36864
    v_add_f32 v226, v226, v179
    v_exp_f32 v184, v184
    v_exp_f32 v185, v185
    v_exp_f32 v186, v186
    v_exp_f32 v187, v187
    v_cvt_pk_bf16_f32 v196, v172, v173
    v_cvt_pk_bf16_f32 v197, v174, v175
    v_cvt_pk_bf16_f32 v198, v184, v185
    v_cvt_pk_bf16_f32 v199, v186, v187
    v_mfma_f32_16x16x32_bf16 v[0:3], a[252:255], v[192:195], v[0:3]
    ds_read_b64_tr_b16 a[244:245], v236 offset:28672
    v_add_f32 v224, v224, v180
    v_exp_f32 v188, v188
    v_exp_f32 v189, v189
    v_exp_f32 v190, v190
    v_exp_f32 v191, v191
    v_cvt_pk_bf16_f32 v200, v176, v177
    v_cvt_pk_bf16_f32 v201, v178, v179
    v_cvt_pk_bf16_f32 v202, v188, v189
    v_cvt_pk_bf16_f32 v203, v190, v191
    v_mfma_f32_16x16x32_bf16 v[4:7], a[252:255], v[196:199], v[4:7]
    ds_read_b64_tr_b16 a[246:247], v236 offset:30720
    v_add_f32 v224, v224, v181
    v_mfma_f32_16x16x32_bf16 v[8:11], a[252:255], v[200:203], v[8:11]
    s_waitcnt lgkmcnt(6)
    ds_read_b64_tr_b16 a[248:249], v232 offset:33792
    v_add_f32 v224, v224, v182
    v_mfma_f32_16x16x32_bf16 v[12:15], v[216:219], v[192:195], v[12:15]
    ds_read_b64_tr_b16 a[250:251], v232 offset:37888
    v_add_f32 v224, v224, v183
    v_mfma_f32_16x16x32_bf16 v[16:19], v[216:219], v[196:199], v[16:19]
    ds_read_b64_tr_b16 a[252:253], v233 offset:33792
    v_add_f32 v225, v225, v184
    v_mfma_f32_16x16x32_bf16 v[20:23], v[216:219], v[200:203], v[20:23]
    s_waitcnt lgkmcnt(7)
    ds_read_b64_tr_b16 a[254:255], v233 offset:37888
    v_add_f32 v225, v225, v185
    v_mfma_f32_16x16x32_bf16 v[24:27], v[220:223], v[192:195], v[24:27]
    buffer_load_dwordx4 v240, s[12:15], s46 offen lds
    v_mfma_f32_16x16x32_bf16 v[28:31], v[220:223], v[196:199], v[28:31]
    ds_read_b64_tr_b16 v[216:217], v234 offset:33792
    v_add_f32 v225, v225, v186
    v_mfma_f32_16x16x32_bf16 v[32:35], v[220:223], v[200:203], v[32:35]
    s_waitcnt lgkmcnt(7)
    ds_read_b64_tr_b16 v[218:219], v234 offset:37888
    v_add_f32 v225, v225, v187
    v_mfma_f32_16x16x32_bf16 v[36:39], a[240:243], v[192:195], v[36:39]
    buffer_load_dwordx4 v241, s[12:15], s46 offen offset:2048 lds
    s_add_u32 m0, s51, 25472
    v_mfma_f32_16x16x32_bf16 v[40:43], a[240:243], v[196:199], v[40:43]
    ds_read_b64_tr_b16 v[220:221], v235 offset:33792
    v_add_f32 v226, v226, v188
    v_mfma_f32_16x16x32_bf16 v[44:47], a[240:243], v[200:203], v[44:47]
    s_waitcnt lgkmcnt(7)
    ds_read_b64_tr_b16 v[222:223], v235 offset:37888
    v_add_f32 v226, v226, v189
    v_mfma_f32_16x16x32_bf16 a[192:195], a[244:247], a[216:219], a[192:195]
    buffer_load_dwordx4 v240, s[12:15], s46 offen offset:128 lds
    v_mfma_f32_16x16x32_bf16 a[196:199], a[244:247], a[220:223], a[196:199]
    buffer_load_dwordx4 v241, s[12:15], s46 offen offset:2176 lds
    s_add_u32 m0, s52, 143232
    v_mfma_f32_16x16x32_bf16 a[200:203], a[244:247], a[224:227], a[200:203]
    s_add_u32 s46, s46, 262144
    buffer_load_dwordx4 v239, s[16:19], s47 offen offset:128 lds
    v_mfma_f32_16x16x32_bf16 a[204:207], a[244:247], a[228:231], a[204:207]
    s_add_u32 m0, s52, 147328
    v_add_f32 v226, v226, v190
    v_add_f32 v247, v224, v225
    v_mfma_f32_16x16x32_bf16 a[208:211], a[244:247], a[232:235], a[208:211]
    buffer_load_dwordx4 v239, s[16:19], s48 offen offset:128 lds
    s_add_u32 m0, s52, 151424
    v_mfma_f32_16x16x32_bf16 a[212:215], a[244:247], a[236:239], a[212:215]
    s_waitcnt lgkmcnt(6)
    v_add_f32 v226, v226, v191
    v_mfma_f32_16x16x32_bf16 v[48:51], a[248:251], v[192:195], v[48:51]
    buffer_load_dwordx4 v239, s[16:19], s49 offen offset:128 lds
    v_mfma_f32_16x16x32_bf16 v[52:55], a[248:251], v[196:199], v[52:55]
    s_waitcnt vmcnt(11)
    s_barrier
    ds_read_b64_tr_b16 a[240:241], v242
    v_mfma_f32_16x16x32_bf16 v[56:59], a[248:251], v[200:203], v[56:59]
    s_waitcnt lgkmcnt(5)
    ds_read_b64_tr_b16 a[242:243], v242 offset:512
    ds_read_b128 a[216:219], v244
    v_mfma_f32_16x16x32_bf16 v[60:63], a[252:255], v[192:195], v[60:63]
    ds_read_b128 a[220:223], v244 offset:2048
    ds_read_b128 a[224:227], v244 offset:4096
    v_mfma_f32_16x16x32_bf16 v[64:67], a[252:255], v[196:199], v[64:67]
    ds_read_b64_tr_b16 a[244:245], v242 offset:8
    ds_read_b64_tr_b16 a[246:247], v242 offset:520
    v_mfma_f32_16x16x32_bf16 v[68:71], a[252:255], v[200:203], v[68:71]
    s_waitcnt lgkmcnt(9)
    ds_read_b64_tr_b16 a[248:249], v243
    ds_read_b64_tr_b16 a[250:251], v243 offset:512
    v_mfma_f32_16x16x32_bf16 v[72:75], v[216:219], v[192:195], v[72:75]
    ds_read_b128 a[228:231], v245
    v_add_f32 v247, v247, v226
    v_mfma_f32_16x16x32_bf16 v[76:79], v[216:219], v[196:199], v[76:79]
    ds_read_b128 a[232:235], v245 offset:2048
    v_cmp_nle_f32 s[98:99], v247, s50
    v_mfma_f32_16x16x32_bf16 v[80:83], v[216:219], v[200:203], v[80:83]
    s_waitcnt lgkmcnt(11)
    ds_read_b128 a[236:239], v245 offset:4096
    v_mfma_f32_16x16x32_bf16 v[84:87], v[220:223], v[192:195], v[84:87]
    v_mfma_f32_16x16x32_bf16 v[88:91], v[220:223], v[196:199], v[88:91]
    v_mfma_f32_16x16x32_bf16 v[92:95], v[220:223], v[200:203], v[92:95]
    s_add_u32 s53, s53, 1
    s_cmp_lg_u64 s[98:99], 0
    s_cbranch_scc1 L_slow1e
L_ret1:
    s_branch L_loop
L_tailf:
    v_mfma_f32_16x16x32_bf16 v[160:163], v[220:223], v[112:115], v[160:163]
    s_waitcnt vmcnt(16) lgkmcnt(0)
    s_barrier
    ds_read_b64_tr_b16 a[248:249], v236
    s_cmp_lt_u32 s53, 2
    s_cselect_b32 s54, 512, 0
    s_add_u32 s94, s94, s54
    v_mfma_f32_16x16x32_bf16 v[164:167], v[220:223], v[116:119], v[164:167]
    s_add_u32 s54, s63, 258048
    ds_read_b64_tr_b16 a[250:251], v236 offset:2048
    v_add_f32 v225, v225, v186
    v_mfma_f32_16x16x32_bf16 v[156:159], a[240:243], v[120:123], v[156:159]
    s_add_u32 m0, s52, 155648
    ds_read_b64_tr_b16 a[252:253], v232 offset:8192
    v_cvt_pk_bf16_f32 v195, v182, v183
    v_mfma_f32_16x16x32_bf16 v[160:163], a[240:243], v[124:127], v[160:163]
    s_add_u32 s45, s45, s68
    ds_read_b64_tr_b16 a[254:255], v232 offset:12288
    v_cvt_pk_bf16_f32 v198, v184, v185
    v_mfma_f32_16x16x32_bf16 v[164:167], a[240:243], v[128:131], v[164:167]
    ds_read_b64_tr_b16 v[216:217], v233 offset:8192
    ds_read_b64_tr_b16 v[218:219], v233 offset:12288
    v_mfma_f32_16x16x32_bf16 v[156:159], a[244:247], v[132:135], v[156:159]
    v_exp_f32 v187, v187
    v_mfma_f32_16x16x32_bf16 v[160:163], a[244:247], v[136:139], v[160:163]
    ds_read_b64_tr_b16 v[220:221], v234 offset:8192
    v_add_f32 v225, v225, v187
    v_mfma_f32_16x16x32_bf16 v[164:167], a[244:247], v[140:143], v[164:167]
    s_waitcnt lgkmcnt(5)
    ds_read_b64_tr_b16 v[222:223], v234 offset:12288
    v_cvt_pk_bf16_f32 v199, v186, v187
    v_mfma_f32_16x16x32_bf16 a[24:27], a[248:251], a[216:219], a[24:27]
    v_exp_f32 v188, v188
    v_mfma_f32_16x16x32_bf16 a[28:31], a[248:251], a[220:223], a[28:31]
    v_exp_f32 v189, v189
    v_mfma_f32_16x16x32_bf16 a[32:35], a[248:251], a[224:227], a[32:35]
    ds_read_b64_tr_b16 a[240:241], v235 offset:8192
    v_add_f32 v226, v226, v188
    v_mfma_f32_16x16x32_bf16 a[36:39], a[248:251], a[228:231], a[36:39]
    ds_read_b64_tr_b16 a[242:243], v235 offset:12288
    v_add_f32 v226, v226, v189
    v_mfma_f32_16x16x32_bf16 a[40:43], a[248:251], a[232:235], a[40:43]
    v_exp_f32 v190, v190
    v_mfma_f32_16x16x32_bf16 a[44:47], a[248:251], a[236:239], a[44:47]
    s_waitcnt lgkmcnt(6)
    ds_read_b64_tr_b16 a[244:245], v236 offset:4096
    v_add_f32 v226, v226, v190
    v_mfma_f32_16x16x32_bf16 v[0:3], a[252:255], v[192:195], v[0:3]
    ds_read_b64_tr_b16 a[246:247], v236 offset:6144
    v_cvt_pk_bf16_f32 v202, v188, v189
    v_exp_f32 v191, v191
    s_nop 0
    v_cvt_pk_bf16_f32 v203, v190, v191
    v_mfma_f32_16x16x32_bf16 v[4:7], a[252:255], v[196:199], v[4:7]
    ds_read_b64_tr_b16 a[248:249], v232 offset:9216
    v_add_f32 v226, v226, v191
    v_mfma_f32_16x16x32_bf16 v[8:11], a[252:255], v[200:203], v[8:11]
    s_waitcnt lgkmcnt(7)
    ds_read_b64_tr_b16 a[250:251], v232 offset:13312
    ds_read_b64_tr_b16 a[252:253], v233 offset:9216
    v_mfma_f32_16x16x32_bf16 v[12:15], v[216:219], v[192:195], v[12:15]
    v_exp_f32 v144, v144
    v_mfma_f32_16x16x32_bf16 v[16:19], v[216:219], v[196:199], v[16:19]
    ds_read_b64_tr_b16 a[254:255], v233 offset:13312
    v_add_f32 v224, v224, v144
    v_mfma_f32_16x16x32_bf16 v[20:23], v[216:219], v[200:203], v[20:23]
    s_waitcnt lgkmcnt(8)
    v_exp_f32 v145, v145
    v_mfma_f32_16x16x32_bf16 v[24:27], v[220:223], v[192:195], v[24:27]
    v_exp_f32 v146, v146
    v_mfma_f32_16x16x32_bf16 v[28:31], v[220:223], v[196:199], v[28:31]
    buffer_load_dwordx4 v239, s[20:23], s54 offen lds
    s_add_u32 s54, s64, 258048
    v_mfma_f32_16x16x32_bf16 v[32:35], v[220:223], v[200:203], v[32:35]
    s_waitcnt lgkmcnt(6)
    ds_read_b64_tr_b16 v[216:217], v234 offset:9216
    v_add_f32 v224, v224, v145
    v_mfma_f32_16x16x32_bf16 v[36:39], a[240:243], v[192:195], v[36:39]
    s_add_u32 m0, s52, 159744
    ds_read_b64_tr_b16 v[218:219], v234 offset:13312
    v_add_f32 v224, v224, v146
    v_mfma_f32_16x16x32_bf16 v[40:43], a[240:243], v[196:199], v[40:43]
    v_exp_f32 v147, v147
    v_mfma_f32_16x16x32_bf16 v[44:47], a[240:243], v[200:203], v[44:47]
    s_waitcnt lgkmcnt(6)
    buffer_load_dwordx4 v239, s[20:23], s54 offen lds
    v_mfma_f32_16x16x32_bf16 a[48:51], a[244:247], a[216:219], a[48:51]
    s_add_u32 s54, s82, 0
    ds_read_b64_tr_b16 v[220:221], v235 offset:9216
    v_add_f32 v224, v224, v147
    v_mfma_f32_16x16x32_bf16 a[52:55], a[244:247], a[220:223], a[52:55]
    s_add_u32 m0, s52, 49152
    v_exp_f32 v148, v148
    v_mfma_f32_16x16x32_bf16 a[56:59], a[244:247], a[224:227], a[56:59]
    ds_read_b64_tr_b16 v[222:223], v235 offset:13312
    v_add_f32 v225, v225, v148
    v_mfma_f32_16x16x32_bf16 a[60:63], a[244:247], a[228:231], a[60:63]
    buffer_load_dwordx4 v239, s[20:23], s54 offen lds
    s_add_u32 s54, s82, 36864
    v_mfma_f32_16x16x32_bf16 a[64:67], a[244:247], a[232:235], a[64:67]
    s_add_u32 m0, s52, 53248
    v_exp_f32 v149, v149
    v_mfma_f32_16x16x32_bf16 a[68:71], a[244:247], a[236:239], a[68:71]
    s_waitcnt lgkmcnt(6)
    buffer_load_dwordx4 v239, s[20:23], s54 offen lds
    v_mfma_f32_16x16x32_bf16 v[48:51], a[248:251], v[192:195], v[48:51]
    s_add_u32 s54, s82, 73728
    v_exp_f32 v150, v150
    v_mfma_f32_16x16x32_bf16 v[52:55], a[248:251], v[196:199], v[52:55]
    s_add_u32 m0, s52, 90112
    v_add_f32 v225, v225, v149
    v_mfma_f32_16x16x32_bf16 v[56:59], a[248:251], v[200:203], v[56:59]
    s_waitcnt lgkmcnt(4)
    buffer_load_dwordx4 v239, s[20:23], s54 offen lds
    v_mfma_f32_16x16x32_bf16 v[60:63], a[252:255], v[192:195], v[60:63]
    s_add_u32 s54, s82, 110592
    v_exp_f32 v151, v151
    v_mfma_f32_16x16x32_bf16 v[64:67], a[252:255], v[196:199], v[64:67]
    s_waitcnt vmcnt(15) lgkmcnt(0)
    s_barrier
    ds_read_b64_tr_b16 a[240:241], v236 offset:8192
    v_mfma_f32_16x16x32_bf16 v[68:71], a[252:255], v[200:203], v[68:71]
    s_add_u32 m0, s52, 94208
    ds_read_b64_tr_b16 a[242:243], v236 offset:10240
    v_add_f32 v225, v225, v150
    v_mfma_f32_16x16x32_bf16 v[72:75], v[216:219], v[192:195], v[72:75]
    ds_read_b128 a[244:247], v230 offset:16384
    v_add_f32 v225, v225, v151
    v_mfma_f32_16x16x32_bf16 v[76:79], v[216:219], v[196:199], v[76:79]
    buffer_load_dwordx4 v239, s[20:23], s54 offen lds
    s_add_u32 s54, s82, 147456
    v_mfma_f32_16x16x32_bf16 v[80:83], v[216:219], v[200:203], v[80:83]
    s_add_u32 m0, s52, 57344
    ds_read_b128 a[248:251], v231 offset:16384
    ds_read_b128 a[252:255], v230 offset:17408
    v_mfma_f32_16x16x32_bf16 v[84:87], v[220:223], v[192:195], v[84:87]
    v_exp_f32 v152, v152
    v_mfma_f32_16x16x32_bf16 v[88:91], v[220:223], v[196:199], v[88:91]
    ds_read_b128 v[216:219], v231 offset:17408
    v_add_f32 v226, v226, v152
    v_mfma_f32_16x16x32_bf16 v[92:95], v[220:223], v[200:203], v[92:95]
    s_waitcnt lgkmcnt(4)
    ds_read_b64_tr_b16 v[220:221], v236 offset:12288
    ds_read_b64_tr_b16 v[222:223], v236 offset:14336
    v_mfma_f32_16x16x32_bf16 a[72:75], a[240:243], a[216:219], a[72:75]
    v_exp_f32 v153, v153
    v_mfma_f32_16x16x32_bf16 a[76:79], a[240:243], a[220:223], a[76:79]
    v_exp_f32 v154, v154
    v_mfma_f32_16x16x32_bf16 a[80:83], a[240:243], a[224:227], a[80:83]
    v_add_f32 v226, v226, v153
    v_cvt_pk_bf16_f32 v192, v144, v145
    v_mfma_f32_16x16x32_bf16 a[84:87], a[240:243], a[228:231], a[84:87]
    v_exp_f32 v155, v155
    v_mfma_f32_16x16x32_bf16 a[88:91], a[240:243], a[232:235], a[88:91]
    v_add_f32 v226, v226, v154
    v_cvt_pk_bf16_f32 v193, v146, v147
    v_mfma_f32_16x16x32_bf16 a[92:95], a[240:243], a[236:239], a[92:95]
    s_waitcnt lgkmcnt(5)
    ds_read_b128 a[240:243], v230 offset:20480
    v_add_f32 v226, v226, v155
    v_mfma_f32_16x16x32_bf16 v[168:171], a[244:247], v[96:99], v[204:207]
    buffer_load_dwordx4 v239, s[20:23], s54 offen lds
    s_add_u32 s54, s82, 184320
    v_mfma_f32_16x16x32_bf16 v[172:175], a[244:247], v[100:103], v[208:211]
    s_add_u32 m0, s52, 61440
    v_exp_f32 v156, v156
    v_mfma_f32_16x16x32_bf16 v[176:179], a[244:247], v[104:107], v[212:215]
    s_waitcnt lgkmcnt(5)
    ds_read_b128 a[244:247], v231 offset:20480
    v_add_f32 v224, v224, v156
    v_mfma_f32_16x16x32_bf16 v[168:171], a[248:251], v[108:111], v[168:171]
    buffer_load_dwordx4 v239, s[20:23], s54 offen lds
    s_add_u32 s54, s82, 221184
    v_mfma_f32_16x16x32_bf16 v[172:175], a[248:251], v[112:115], v[172:175]
    s_add_u32 m0, s52, 98304
    v_exp_f32 v157, v157
    v_mfma_f32_16x16x32_bf16 v[176:179], a[248:251], v[116:119], v[176:179]
    s_waitcnt lgkmcnt(5)
    ds_read_b128 a[248:251], v230 offset:21504
    v_add_f32 v224, v224, v157
    v_mfma_f32_16x16x32_bf16 v[168:171], a[252:255], v[120:123], v[168:171]
    buffer_load_dwordx4 v239, s[20:23], s54 offen lds
    s_add_u32 s54, s82, 258048
    v_mfma_f32_16x16x32_bf16 v[172:175], a[252:255], v[124:127], v[172:175]
    s_add_u32 m0, s52, 102400
    v_exp_f32 v158, v158
    v_mfma_f32_16x16x32_bf16 v[176:179], a[252:255], v[128:131], v[176:179]
    s_waitcnt lgkmcnt(5)
    ds_read_b128 a[252:255], v231 offset:21504
    v_add_f32 v224, v224, v158
    v_mfma_f32_16x16x32_bf16 v[168:171], v[216:219], v[132:135], v[168:171]
    v_exp_f32 v159, v159
    v_mfma_f32_16x16x32_bf16 v[172:175], v[216:219], v[136:139], v[172:175]
    buffer_load_dwordx4 v239, s[20:23], s54 offen lds
    s_add_u32 s54, s83, 0
    v_mfma_f32_16x16x32_bf16 v[176:179], v[216:219], v[140:143], v[176:179]
    s_waitcnt lgkmcnt(4)
    v_exp_f32 v160, v160
    v_mfma_f32_16x16x32_bf16 a[96:99], v[220:223], a[216:219], a[96:99]
    s_add_u32 m0, s52, 131072
    v_exp_f32 v161, v161
    v_mfma_f32_16x16x32_bf16 a[100:103], v[220:223], a[220:223], a[100:103]
    buffer_load_dwordx4 v239, s[20:23], s54 offen lds
    s_add_u32 s54, s83, 36864
    v_mfma_f32_16x16x32_bf16 a[104:107], v[220:223], a[224:227], a[104:107]
    s_add_u32 m0, s52, 135168
    v_add_f32 v224, v224, v159
    v_add_f32 v225, v225, v160
    v_mfma_f32_16x16x32_bf16 a[108:111], v[220:223], a[228:231], a[108:111]
    v_exp_f32 v162, v162
    v_mfma_f32_16x16x32_bf16 a[112:115], v[220:223], a[232:235], a[112:115]
    buffer_load_dwordx4 v239, s[20:23], s54 offen lds
    v_mfma_f32_16x16x32_bf16 a[116:119], v[220:223], a[236:239], a[116:119]
    s_waitcnt lgkmcnt(3)
    v_exp_f32 v163, v163
    v_mfma_f32_16x16x32_bf16 v[180:183], a[240:243], v[96:99], v[204:207]
    v_add_f32 v225, v225, v161
    v_cvt_pk_bf16_f32 v196, v148, v149
    v_mfma_f32_16x16x32_bf16 v[184:187], a[240:243], v[100:103], v[208:211]
    v_exp_f32 v164, v164
    v_mfma_f32_16x16x32_bf16 v[188:191], a[240:243], v[104:107], v[212:215]
    s_waitcnt lgkmcnt(2)
    v_add_f32 v225, v225, v162
    v_add_f32 v226, v226, v164
    v_mfma_f32_16x16x32_bf16 v[180:183], a[244:247], v[108:111], v[180:183]
    v_exp_f32 v165, v165
    v_mfma_f32_16x16x32_bf16 v[184:187], a[244:247], v[112:115], v[184:187]
    s_waitcnt vmcnt(16) lgkmcnt(0)
    s_barrier
    ds_read_b64_tr_b16 v[216:217], v236 offset:16384
    v_mfma_f32_16x16x32_bf16 v[188:191], a[244:247], v[116:119], v[188:191]
    s_add_u32 s54, s83, 73728
    ds_read_b64_tr_b16 v[218:219], v236 offset:18432
    v_add_f32 v225, v225, v163
    v_mfma_f32_16x16x32_bf16 v[180:183], a[248:251], v[120:123], v[180:183]
    s_add_u32 m0, s52, 65536
    ds_read_b64_tr_b16 v[220:221], v232 offset:24576
    v_add_f32 v226, v226, v165
    v_mfma_f32_16x16x32_bf16 v[184:187], a[248:251], v[124:127], v[184:187]
    ds_read_b64_tr_b16 v[222:223], v232 offset:28672
    v_cvt_pk_bf16_f32 v197, v150, v151
    v_mfma_f32_16x16x32_bf16 v[188:191], a[248:251], v[128:131], v[188:191]
    ds_read_b64_tr_b16 a[240:241], v233 offset:24576
    v_cvt_pk_bf16_f32 v200, v152, v153
    v_mfma_f32_16x16x32_bf16 v[180:183], a[252:255], v[132:135], v[180:183]
    ds_read_b64_tr_b16 a[242:243], v233 offset:28672
    v_cvt_pk_bf16_f32 v201, v154, v155
    v_mfma_f32_16x16x32_bf16 v[184:187], a[252:255], v[136:139], v[184:187]
    ds_read_b64_tr_b16 a[244:245], v234 offset:24576
    v_cvt_pk_bf16_f32 v194, v156, v157
    v_mfma_f32_16x16x32_bf16 v[188:191], a[252:255], v[140:143], v[188:191]
    s_waitcnt lgkmcnt(5)
    ds_read_b64_tr_b16 a[246:247], v234 offset:28672
    v_cvt_pk_bf16_f32 v195, v158, v159
    v_mfma_f32_16x16x32_bf16 a[120:123], v[216:219], a[216:219], a[120:123]
    ds_read_b64_tr_b16 a[248:249], v235 offset:24576
    v_cvt_pk_bf16_f32 v198, v160, v161
    v_mfma_f32_16x16x32_bf16 a[124:127], v[216:219], a[220:223], a[124:127]
    ds_read_b64_tr_b16 a[250:251], v235 offset:28672
    v_cvt_pk_bf16_f32 v199, v162, v163
    v_mfma_f32_16x16x32_bf16 a[128:131], v[216:219], a[224:227], a[128:131]
    v_exp_f32 v166, v166
    v_mfma_f32_16x16x32_bf16 a[132:135], v[216:219], a[228:231], a[132:135]
    ds_read_b64_tr_b16 a[252:253], v236 offset:20480
    v_add_f32 v226, v226, v166
    v_mfma_f32_16x16x32_bf16 a[136:139], v[216:219], a[232:235], a[136:139]
    ds_read_b64_tr_b16 a[254:255], v236 offset:22528
    v_cvt_pk_bf16_f32 v202, v164, v165
    v_mfma_f32_16x16x32_bf16 a[140:143], v[216:219], a[236:239], a[140:143]
    s_waitcnt lgkmcnt(8)
    v_exp_f32 v167, v167
    v_mfma_f32_16x16x32_bf16 v[0:3], v[220:223], v[192:195], v[0:3]
    ds_read_b64_tr_b16 v[216:217], v232 offset:25600
    v_add_f32 v226, v226, v167
    v_cvt_pk_bf16_f32 v203, v166, v167
    v_mfma_f32_16x16x32_bf16 v[4:7], v[220:223], v[196:199], v[4:7]
    v_exp_f32 v168, v168
    v_mfma_f32_16x16x32_bf16 v[8:11], v[220:223], v[200:203], v[8:11]
    s_waitcnt lgkmcnt(7)
    ds_read_b64_tr_b16 v[218:219], v232 offset:29696
    v_add_f32 v224, v224, v168
    v_mfma_f32_16x16x32_bf16 v[12:15], a[240:243], v[192:195], v[12:15]
    v_exp_f32 v169, v169
    v_mfma_f32_16x16x32_bf16 v[16:19], a[240:243], v[196:199], v[16:19]
    ds_read_b64_tr_b16 v[220:221], v233 offset:25600
    v_add_f32 v224, v224, v169
    v_mfma_f32_16x16x32_bf16 v[20:23], a[240:243], v[200:203], v[20:23]
    s_waitcnt lgkmcnt(7)
    ds_read_b64_tr_b16 v[222:223], v233 offset:29696
    ds_read_b64_tr_b16 a[240:241], v234 offset:25600
    v_mfma_f32_16x16x32_bf16 v[24:27], a[244:247], v[192:195], v[24:27]
    v_exp_f32 v170, v170
    v_mfma_f32_16x16x32_bf16 v[28:31], a[244:247], v[196:199], v[28:31]
    buffer_load_dwordx4 v239, s[20:23], s54 offen lds
    s_add_u32 s54, s83, 110592
    v_mfma_f32_16x16x32_bf16 v[32:35], a[244:247], v[200:203], v[32:35]
    s_waitcnt lgkmcnt(7)
    ds_read_b64_tr_b16 a[242:243], v234 offset:29696
    v_add_f32 v224, v224, v170
    v_mfma_f32_16x16x32_bf16 v[36:39], a[248:251], v[192:195], v[36:39]
    s_add_u32 m0, s52, 69632
    v_exp_f32 v171, v171
    v_mfma_f32_16x16x32_bf16 v[40:43], a[248:251], v[196:199], v[40:43]
    v_exp_f32 v172, v172
    v_mfma_f32_16x16x32_bf16 v[44:47], a[248:251], v[200:203], v[44:47]
    s_waitcnt lgkmcnt(6)
    buffer_load_dwordx4 v239, s[20:23], s54 offen lds
    v_mfma_f32_16x16x32_bf16 a[144:147], a[252:255], a[216:219], a[144:147]
    s_add_u32 s54, s83, 147456
    ds_read_b64_tr_b16 a[244:245], v235 offset:25600
    v_add_f32 v224, v224, v171
    v_mfma_f32_16x16x32_bf16 a[148:151], a[252:255], a[220:223], a[148:151]
    s_add_u32 m0, s52, 106496
    ds_read_b64_tr_b16 a[246:247], v235 offset:29696
    v_add_f32 v225, v225, v172
    v_mfma_f32_16x16x32_bf16 a[152:155], a[252:255], a[224:227], a[152:155]
    v_exp_f32 v173, v173
    v_mfma_f32_16x16x32_bf16 a[156:159], a[252:255], a[228:231], a[156:159]
    buffer_load_dwordx4 v239, s[20:23], s54 offen lds
    s_add_u32 s54, s83, 184320
    v_mfma_f32_16x16x32_bf16 a[160:163], a[252:255], a[232:235], a[160:163]
    s_add_u32 m0, s52, 110592
    v_exp_f32 v174, v174
    v_mfma_f32_16x16x32_bf16 a[164:167], a[252:255], a[236:239], a[164:167]
    s_waitcnt lgkmcnt(6)
    buffer_load_dwordx4 v239, s[20:23], s54 offen lds
    v_mfma_f32_16x16x32_bf16 v[48:51], v[216:219], v[192:195], v[48:51]
    s_add_u32 s54, s83, 221184
    v_exp_f32 v175, v175
    v_mfma_f32_16x16x32_bf16 v[52:55], v[216:219], v[196:199], v[52:55]
    s_add_u32 m0, s52, 143360
    v_exp_f32 v176, v176
    v_mfma_f32_16x16x32_bf16 v[56:59], v[216:219], v[200:203], v[56:59]
    s_waitcnt lgkmcnt(4)
    v_add_f32 v225, v225, v173
    v_add_f32 v226, v226, v176
    v_mfma_f32_16x16x32_bf16 v[60:63], v[220:223], v[192:195], v[60:63]
    buffer_load_dwordx4 v239, s[20:23], s54 offen lds
    s_add_u32 s54, s83, 258048
    v_mfma_f32_16x16x32_bf16 v[64:67], v[220:223], v[196:199], v[64:67]
    s_waitcnt vmcnt(15) lgkmcnt(0)
    s_barrier
    ds_read_b64_tr_b16 a[248:249], v236 offset:24576
    v_mfma_f32_16x16x32_bf16 v[68:71], v[220:223], v[200:203], v[68:71]
    s_add_u32 m0, s52, 139264
    ds_read_b64_tr_b16 a[250:251], v236 offset:26624
    v_add_f32 v225, v225, v174
    v_mfma_f32_16x16x32_bf16 v[72:75], a[240:243], v[192:195], v[72:75]
    ds_read_b64_tr_b16 a[252:253], v232 offset:32768
    v_add_f32 v225, v225, v175
    v_mfma_f32_16x16x32_bf16 v[76:79], a[240:243], v[196:199], v[76:79]
    ds_read_b64_tr_b16 a[254:255], v232 offset:36864
    ds_read_b64_tr_b16 v[216:217], v233 offset:32768
    v_mfma_f32_16x16x32_bf16 v[80:83], a[240:243], v[200:203], v[80:83]
    v_exp_f32 v177, v177
    v_mfma_f32_16x16x32_bf16 v[84:87], a[244:247], v[192:195], v[84:87]
    buffer_load_dwordx4 v239, s[20:23], s54 offen lds
    v_mfma_f32_16x16x32_bf16 v[88:91], a[244:247], v[196:199], v[88:91]
    ds_read_b64_tr_b16 v[218:219], v233 offset:36864
    v_add_f32 v226, v226, v177
    v_mfma_f32_16x16x32_bf16 v[92:95], a[244:247], v[200:203], v[92:95]
    s_waitcnt lgkmcnt(4)
    v_exp_f32 v178, v178
    v_mfma_f32_16x16x32_bf16 a[168:171], a[248:251], a[216:219], a[168:171]
    ds_read_b64_tr_b16 v[220:221], v234 offset:32768
    v_add_f32 v226, v226, v178
    v_mfma_f32_16x16x32_bf16 a[172:175], a[248:251], a[220:223], a[172:175]
    ds_read_b64_tr_b16 v[222:223], v234 offset:36864
    ds_read_b64_tr_b16 a[240:241], v235 offset:32768
    v_mfma_f32_16x16x32_bf16 a[176:179], a[248:251], a[224:227], a[176:179]
    v_exp_f32 v179, v179
    v_mfma_f32_16x16x32_bf16 a[180:183], a[248:251], a[228:231], a[180:183]
    v_exp_f32 v180, v180
    v_mfma_f32_16x16x32_bf16 a[184:187], a[248:251], a[232:235], a[184:187]
    ds_read_b64_tr_b16 a[242:243], v235 offset:36864
    v_add_f32 v226, v226, v179
    v_exp_f32 v181, v181
    v_exp_f32 v182, v182
    v_exp_f32 v183, v183
    v_cvt_pk_bf16_f32 v192, v168, v169
    v_cvt_pk_bf16_f32 v193, v170, v171
    v_cvt_pk_bf16_f32 v194, v180, v181
    v_cvt_pk_bf16_f32 v195, v182, v183
    v_mfma_f32_16x16x32_bf16 a[188:191], a[248:251], a[236:239], a[188:191]
    s_waitcnt lgkmcnt(6)
    ds_read_b64_tr_b16 a[244:245], v236 offset:28672
    v_add_f32 v224, v224, v180
    v_exp_f32 v184, v184
    v_exp_f32 v185, v185
    v_exp_f32 v186, v186
    v_exp_f32 v187, v187
    v_cvt_pk_bf16_f32 v196, v172, v173
    v_cvt_pk_bf16_f32 v197, v174, v175
    v_cvt_pk_bf16_f32 v198, v184, v185
    v_cvt_pk_bf16_f32 v199, v186, v187
    v_mfma_f32_16x16x32_bf16 v[0:3], a[252:255], v[192:195], v[0:3]
    ds_read_b64_tr_b16 a[246:247], v236 offset:30720
    v_add_f32 v224, v224, v181
    v_exp_f32 v188, v188
    v_exp_f32 v189, v189
    v_exp_f32 v190, v190
    v_exp_f32 v191, v191
    v_cvt_pk_bf16_f32 v200, v176, v177
    v_cvt_pk_bf16_f32 v201, v178, v179
    v_cvt_pk_bf16_f32 v202, v188, v189
    v_cvt_pk_bf16_f32 v203, v190, v191
    v_mfma_f32_16x16x32_bf16 v[4:7], a[252:255], v[196:199], v[4:7]
    ds_read_b64_tr_b16 a[248:249], v232 offset:33792
    v_add_f32 v224, v224, v182
    v_mfma_f32_16x16x32_bf16 v[8:11], a[252:255], v[200:203], v[8:11]
    s_waitcnt lgkmcnt(7)
    ds_read_b64_tr_b16 a[250:251], v232 offset:37888
    v_add_f32 v224, v224, v183
    v_mfma_f32_16x16x32_bf16 v[12:15], v[216:219], v[192:195], v[12:15]
    ds_read_b64_tr_b16 a[252:253], v233 offset:33792
    v_add_f32 v225, v225, v184
    v_mfma_f32_16x16x32_bf16 v[16:19], v[216:219], v[196:199], v[16:19]
    ds_read_b64_tr_b16 a[254:255], v233 offset:37888
    v_add_f32 v225, v225, v185
    v_mfma_f32_16x16x32_bf16 v[20:23], v[216:219], v[200:203], v[20:23]
    s_waitcnt lgkmcnt(8)
    ds_read_b64_tr_b16 v[216:217], v234 offset:33792
    v_add_f32 v225, v225, v186
    v_mfma_f32_16x16x32_bf16 v[24:27], v[220:223], v[192:195], v[24:27]
    ds_read_b64_tr_b16 v[218:219], v234 offset:37888
    v_add_f32 v225, v225, v187
    v_mfma_f32_16x16x32_bf16 v[28:31], v[220:223], v[196:199], v[28:31]
    v_add_f32 v226, v226, v188
    v_add_f32 v247, v224, v225
    v_mfma_f32_16x16x32_bf16 v[32:35], v[220:223], v[200:203], v[32:35]
    s_waitcnt lgkmcnt(8)
    ds_read_b64_tr_b16 v[220:221], v235 offset:33792
    v_add_f32 v226, v226, v189
    v_mfma_f32_16x16x32_bf16 v[36:39], a[240:243], v[192:195], v[36:39]
    ds_read_b64_tr_b16 v[222:223], v235 offset:37888
    v_add_f32 v226, v226, v190
    v_mfma_f32_16x16x32_bf16 v[40:43], a[240:243], v[196:199], v[40:43]
    v_add_f32 v226, v226, v191
    v_mfma_f32_16x16x32_bf16 v[44:47], a[240:243], v[200:203], v[44:47]
    s_waitcnt lgkmcnt(8)
    v_add_f32 v247, v247, v226
    v_mfma_f32_16x16x32_bf16 a[192:195], a[244:247], a[216:219], a[192:195]
    v_cmp_nle_f32 s[98:99], v247, s50
    v_mfma_f32_16x16x32_bf16 a[196:199], a[244:247], a[220:223], a[196:199]
    v_mfma_f32_16x16x32_bf16 a[200:203], a[244:247], a[224:227], a[200:203]
    v_mfma_f32_16x16x32_bf16 a[204:207], a[244:247], a[228:231], a[204:207]
    v_mfma_f32_16x16x32_bf16 a[208:211], a[244:247], a[232:235], a[208:211]
    v_mfma_f32_16x16x32_bf16 a[212:215], a[244:247], a[236:239], a[212:215]
    s_waitcnt lgkmcnt(6)
    v_mfma_f32_16x16x32_bf16 v[48:51], a[248:251], v[192:195], v[48:51]
    v_mfma_f32_16x16x32_bf16 v[52:55], a[248:251], v[196:199], v[52:55]
    s_barrier
    v_mfma_f32_16x16x32_bf16 v[56:59], a[248:251], v[200:203], v[56:59]
    s_waitcnt lgkmcnt(4)
    v_mfma_f32_16x16x32_bf16 v[60:63], a[252:255], v[192:195], v[60:63]
    v_mfma_f32_16x16x32_bf16 v[64:67], a[252:255], v[196:199], v[64:67]
    v_mfma_f32_16x16x32_bf16 v[68:71], a[252:255], v[200:203], v[68:71]
    s_waitcnt lgkmcnt(2)
    v_mfma_f32_16x16x32_bf16 v[72:75], v[216:219], v[192:195], v[72:75]
    v_mfma_f32_16x16x32_bf16 v[76:79], v[216:219], v[196:199], v[76:79]
    v_mfma_f32_16x16x32_bf16 v[80:83], v[216:219], v[200:203], v[80:83]
    s_waitcnt lgkmcnt(0)
    v_mfma_f32_16x16x32_bf16 v[84:87], v[220:223], v[192:195], v[84:87]
    v_mfma_f32_16x16x32_bf16 v[88:91], v[220:223], v[196:199], v[88:91]
    v_mfma_f32_16x16x32_bf16 v[92:95], v[220:223], v[200:203], v[92:95]
L_chk2:
    s_cmp_lg_u64 s[98:99], 0
    s_cbranch_scc1 L_slow2e
L_ret2:
    s_waitcnt lgkmcnt(0)
    s_barrier
    v_subrev_u32 v230, 81920, v236
    v_subrev_u32 v231, 16384, v236
    s_and_b32 s3, s55, 0xfc
    s_add_u32 s3, s3, 64
    v_mov_b32 v232, s3
    s_add_u32 s54, s84, 0
    buffer_load_dword v252, v232, s[32:35], 0 offen sc1
    s_lshl_b32 s97, s55, 8
    s_add_u32 s97, s97, 67108864
    s_lshl_b32 s3, s66, 2
    v_mov_b32 v233, s3
    v_mov_b32 v234, 1
    s_add_u32 m0, s52, 73728
    v_mov_b32 v235, 0
    v_mov_b32 v247, v224
    s_nop 1
    v_permlane32_swap_b32 v247, v224
    v_add_f32 v224, v224, v247
    buffer_load_dwordx4 v239, s[20:23], s54 offen lds
    v_mov_b32 v247, v224
    s_nop 1
    v_permlane16_swap_b32 v247, v224
    v_add_f32 v224, v224, v247
    v_rcp_f32 v248, v224
    s_add_u32 s54, s84, 36864
    v_mov_b32 v247, v225
    s_nop 1
    v_permlane32_swap_b32 v247, v225
    v_add_f32 v225, v225, v247
    v_mov_b32 v247, v225
    s_add_u32 m0, s52, 77824
    s_nop 0
    v_permlane16_swap_b32 v247, v225
    v_add_f32 v225, v225, v247
    v_rcp_f32 v249, v225
    v_mov_b32 v247, v226
    buffer_load_dwordx4 v239, s[20:23], s54 offen lds
    s_nop 0
    v_permlane32_swap_b32 v247, v226
    v_add_f32 v226, v226, v247
    v_mov_b32 v247, v226
    s_nop 1
    v_permlane16_swap_b32 v247, v226
    s_add_u32 s54, s84, 73728
    v_add_f32 v226, v226, v247
    v_rcp_f32 v250, v226
    v_mul_f32 v0, v248, v0
    v_mul_f32 v1, v248, v1
    s_add_u32 m0, s52, 114688
    v_mul_f32 v2, v248, v2
    v_mul_f32 v3, v248, v3
    v_mul_f32 v12, v248, v12
    v_mul_f32 v13, v248, v13
    buffer_load_dwordx4 v239, s[20:23], s54 offen lds
    v_mul_f32 v14, v248, v14
    v_mul_f32 v15, v248, v15
    v_cvt_pk_bf16_f32 v0, v0, v1
    v_cvt_pk_bf16_f32 v1, v2, v3
    s_add_u32 s54, s84, 110592
    v_cvt_pk_bf16_f32 v2, v12, v13
    v_cvt_pk_bf16_f32 v3, v14, v15
    ds_write_b128 v246, v[0:3]
    v_mul_f32 v4, v249, v4
    s_add_u32 m0, s52, 118784
    v_mul_f32 v5, v249, v5
    v_mul_f32 v6, v249, v6
    v_mul_f32 v7, v249, v7
    v_mul_f32 v16, v249, v16
    buffer_load_dwordx4 v239, s[20:23], s54 offen lds
    v_mul_f32 v17, v249, v17
    v_mul_f32 v18, v249, v18
    v_mul_f32 v19, v249, v19
    v_cvt_pk_bf16_f32 v4, v4, v5
    s_add_u32 s54, s84, 147456
    v_cvt_pk_bf16_f32 v5, v6, v7
    v_cvt_pk_bf16_f32 v6, v16, v17
    v_cvt_pk_bf16_f32 v7, v18, v19
    ds_write_b128 v246, v[4:7] offset:1024
    s_add_u32 m0, s52, 147456
    v_mul_f32 v8, v250, v8
    v_mul_f32 v9, v250, v9
    v_mul_f32 v10, v250, v10
    v_mul_f32 v11, v250, v11
    buffer_load_dwordx4 v239, s[20:23], s54 offen lds
    v_mul_f32 v20, v250, v20
    v_mul_f32 v21, v250, v21
    v_mul_f32 v22, v250, v22
    v_mul_f32 v23, v250, v23
    s_add_u32 s54, s84, 184320
    v_cvt_pk_bf16_f32 v8, v8, v9
    v_cvt_pk_bf16_f32 v9, v10, v11
    v_cvt_pk_bf16_f32 v10, v20, v21
    v_cvt_pk_bf16_f32 v11, v22, v23
    s_add_u32 m0, s52, 151552
    ds_write_b128 v246, v[8:11] offset:2048
    v_mul_f32 v24, v248, v24
    v_mul_f32 v25, v248, v25
    v_mul_f32 v26, v248, v26
    buffer_load_dwordx4 v239, s[20:23], s54 offen lds
    v_mul_f32 v27, v248, v27
    v_mul_f32 v36, v248, v36
    v_mul_f32 v37, v248, v37
    v_mul_f32 v38, v248, v38
    s_add_u32 s54, s84, 221184
    v_mul_f32 v39, v248, v39
    v_cvt_pk_bf16_f32 v24, v24, v25
    v_cvt_pk_bf16_f32 v25, v26, v27
    v_cvt_pk_bf16_f32 v26, v36, v37
    s_add_u32 m0, s52, 155648
    v_cvt_pk_bf16_f32 v27, v38, v39
    ds_write_b128 v246, v[24:27] offset:6144
    v_mul_f32 v28, v249, v28
    v_mul_f32 v29, v249, v29
    buffer_load_dwordx4 v239, s[20:23], s54 offen lds
    v_mul_f32 v30, v249, v30
    v_mul_f32 v31, v249, v31
    v_mul_f32 v40, v249, v40
    v_mul_f32 v41, v249, v41
    s_add_u32 s54, s84, 258048
    v_mul_f32 v42, v249, v42
    v_mul_f32 v43, v249, v43
    v_cvt_pk_bf16_f32 v28, v28, v29
    v_cvt_pk_bf16_f32 v29, v30, v31
    s_add_u32 m0, s52, 159744
    v_cvt_pk_bf16_f32 v30, v40, v41
    v_cvt_pk_bf16_f32 v31, v42, v43
    ds_write_b128 v246, v[28:31] offset:7168
    v_mul_f32 v32, v250, v32
    buffer_load_dwordx4 v239, s[20:23], s54 offen lds
    v_mul_f32 v33, v250, v33
    v_mul_f32 v34, v250, v34
    v_mul_f32 v35, v250, v35
    v_mul_f32 v44, v250, v44
    s_add_u32 s54, s85, 0
    v_mul_f32 v45, v250, v45
    v_mul_f32 v46, v250, v46
    v_mul_f32 v47, v250, v47
    v_cvt_pk_bf16_f32 v32, v32, v33
    s_add_u32 m0, s52, 81920
    v_cvt_pk_bf16_f32 v33, v34, v35
    v_cvt_pk_bf16_f32 v34, v44, v45
    v_cvt_pk_bf16_f32 v35, v46, v47
    ds_write_b128 v246, v[32:35] offset:8192
    buffer_load_dwordx4 v239, s[20:23], s54 offen lds
    v_mul_f32 v48, v248, v48
    v_mul_f32 v49, v248, v49
    v_mul_f32 v50, v248, v50
    v_mul_f32 v51, v248, v51
    s_add_u32 s54, s85, 36864
    v_mul_f32 v60, v248, v60
    v_mul_f32 v61, v248, v61
    v_mul_f32 v62, v248, v62
    v_mul_f32 v63, v248, v63
    s_add_u32 m0, s52, 86016
    v_cvt_pk_bf16_f32 v48, v48, v49
    v_cvt_pk_bf16_f32 v49, v50, v51
    v_cvt_pk_bf16_f32 v50, v60, v61
    v_cvt_pk_bf16_f32 v51, v62, v63
    buffer_load_dwordx4 v239, s[20:23], s54 offen lds
    ds_write_b128 v246, v[48:51] offset:12288
    v_mul_f32 v52, v249, v52
    v_mul_f32 v53, v249, v53
    v_mul_f32 v54, v249, v54
    s_add_u32 s54, s85, 73728
    v_mul_f32 v55, v249, v55
    v_mul_f32 v64, v249, v64
    v_mul_f32 v65, v249, v65
    v_mul_f32 v66, v249, v66
    s_add_u32 m0, s52, 122880
    v_mul_f32 v67, v249, v67
    v_cvt_pk_bf16_f32 v52, v52, v53
    v_cvt_pk_bf16_f32 v53, v54, v55
    v_cvt_pk_bf16_f32 v54, v64, v65
    buffer_load_dwordx4 v239, s[20:23], s54 offen lds
    v_cvt_pk_bf16_f32 v55, v66, v67
    ds_write_b128 v246, v[52:55] offset:13312
    v_mul_f32 v56, v250, v56
    v_mul_f32 v57, v250, v57
    s_add_u32 s54, s85, 110592
    v_mul_f32 v58, v250, v58
    v_mul_f32 v59, v250, v59
    v_mul_f32 v68, v250, v68
    v_mul_f32 v69, v250, v69
    s_add_u32 m0, s52, 126976
    v_mul_f32 v70, v250, v70
    v_mul_f32 v71, v250, v71
    v_cvt_pk_bf16_f32 v56, v56, v57
    v_cvt_pk_bf16_f32 v57, v58, v59
    buffer_load_dwordx4 v239, s[20:23], s54 offen lds
    v_cvt_pk_bf16_f32 v58, v68, v69
    v_cvt_pk_bf16_f32 v59, v70, v71
    ds_write_b128 v246, v[56:59] offset:14336
    v_mul_f32 v72, v248, v72
    v_mul_f32 v73, v248, v73
    v_mul_f32 v74, v248, v74
    v_mul_f32 v75, v248, v75
    v_mul_f32 v84, v248, v84
    v_mul_f32 v85, v248, v85
    v_mul_f32 v86, v248, v86
    v_mul_f32 v87, v248, v87
    v_cvt_pk_bf16_f32 v72, v72, v73
    v_cvt_pk_bf16_f32 v73, v74, v75
    v_cvt_pk_bf16_f32 v74, v84, v85
    v_cvt_pk_bf16_f32 v75, v86, v87
    ds_write_b128 v246, v[72:75] offset:18432
    v_mul_f32 v76, v249, v76
    v_mul_f32 v77, v249, v77
    v_mul_f32 v78, v249, v78
    v_mul_f32 v79, v249, v79
    v_mul_f32 v88, v249, v88
    v_mul_f32 v89, v249, v89
    v_mul_f32 v90, v249, v90
    v_mul_f32 v91, v249, v91
    v_cvt_pk_bf16_f32 v76, v76, v77
    v_cvt_pk_bf16_f32 v77, v78, v79
    v_cvt_pk_bf16_f32 v78, v88, v89
    v_cvt_pk_bf16_f32 v79, v90, v91
    ds_write_b128 v246, v[76:79] offset:19456
    v_mul_f32 v80, v250, v80
    v_mul_f32 v81, v250, v81
    v_mul_f32 v82, v250, v82
    v_mul_f32 v83, v250, v83
    v_mul_f32 v92, v250, v92
    v_mul_f32 v93, v250, v93
    v_mul_f32 v94, v250, v94
    v_mul_f32 v95, v250, v95
    v_cvt_pk_bf16_f32 v80, v80, v81
    v_cvt_pk_bf16_f32 v81, v82, v83
    v_cvt_pk_bf16_f32 v82, v92, v93
    v_cvt_pk_bf16_f32 v83, v94, v95
    ds_write_b128 v246, v[80:83] offset:20480
    s_waitcnt lgkmcnt(0)
    s_waitcnt vmcnt(21)
    s_barrier
    ds_read_b128 v[0:3], v237
    ds_read_b128 v[4:7], v237 offset:1024
    ds_read_b64_tr_b16 a[240:241], v230
    ds_read_b64_tr_b16 a[242:243], v230 offset:2048
    s_waitcnt lgkmcnt(0)
    v_mfma_f32_16x16x32_bf16 a[0:3], a[240:243], v[0:3], a[0:3]
    ds_read_b128 v[8:11], v237 offset:2048
    ds_read_b128 v[12:15], v237 offset:3072
    v_mfma_f32_16x16x32_bf16 a[4:7], a[240:243], v[4:7], a[4:7]
    s_waitcnt lgkmcnt(1)
    ds_read_b128 v[16:19], v237 offset:4096
    ds_read_b128 v[20:23], v237 offset:5120
    v_mfma_f32_16x16x32_bf16 a[8:11], a[240:243], v[8:11], a[8:11]
    s_waitcnt lgkmcnt(2)
    ds_read_b128 v[24:27], v237 offset:6144
    ds_read_b64_tr_b16 a[244:245], v230 offset:4096
    v_mfma_f32_16x16x32_bf16 a[12:15], a[240:243], v[12:15], a[12:15]
    s_waitcnt lgkmcnt(3)
    ds_read_b64_tr_b16 a[246:247], v230 offset:6144
    ds_read_b128 v[28:31], v237 offset:7168
    v_mfma_f32_16x16x32_bf16 a[16:19], a[240:243], v[16:19], a[16:19]
    s_waitcnt lgkmcnt(4)
    ds_read_b128 v[32:35], v237 offset:8192
    ds_read_b128 v[36:39], v237 offset:9216
    v_mfma_f32_16x16x32_bf16 a[20:23], a[240:243], v[20:23], a[20:23]
    s_waitcnt lgkmcnt(3)
    ds_read_b128 v[40:43], v237 offset:10240
    ds_read_b128 v[44:47], v237 offset:11264
    v_mfma_f32_16x16x32_bf16 a[0:3], a[244:247], v[24:27], a[0:3]
    s_waitcnt lgkmcnt(4)
    ds_read_b128 v[48:51], v237 offset:12288
    ds_read_b64_tr_b16 a[248:249], v230 offset:40960
    v_mfma_f32_16x16x32_bf16 a[4:7], a[244:247], v[28:31], a[4:7]
    s_waitcnt lgkmcnt(5)
    ds_read_b64_tr_b16 a[250:251], v230 offset:43008
    ds_read_b128 v[52:55], v237 offset:13312
    v_mfma_f32_16x16x32_bf16 a[8:11], a[244:247], v[32:35], a[8:11]
    s_waitcnt lgkmcnt(6)
    ds_read_b128 v[56:59], v237 offset:14336
    ds_read_b128 v[60:63], v237 offset:15360
    v_mfma_f32_16x16x32_bf16 a[12:15], a[244:247], v[36:39], a[12:15]
    s_waitcnt lgkmcnt(7)
    ds_read_b128 v[64:67], v237 offset:16384
    ds_read_b128 v[68:71], v237 offset:17408
    v_mfma_f32_16x16x32_bf16 a[16:19], a[244:247], v[40:43], a[16:19]
    s_waitcnt lgkmcnt(8)
    ds_read_b128 v[72:75], v237 offset:18432
    ds_read_b64_tr_b16 a[252:253], v230 offset:45056
    v_mfma_f32_16x16x32_bf16 a[20:23], a[244:247], v[44:47], a[20:23]
    s_waitcnt lgkmcnt(7)
    ds_read_b64_tr_b16 a[254:255], v230 offset:47104
    ds_read_b128 v[76:79], v237 offset:19456
    v_mfma_f32_16x16x32_bf16 a[0:3], a[248:251], v[48:51], a[0:3]
    s_waitcnt lgkmcnt(8)
    ds_read_b128 v[80:83], v237 offset:20480
    ds_read_b128 v[84:87], v237 offset:21504
    v_mfma_f32_16x16x32_bf16 a[4:7], a[248:251], v[52:55], a[4:7]
    s_waitcnt lgkmcnt(9)
    ds_read_b128 v[88:91], v237 offset:22528
    ds_read_b128 v[92:95], v237 offset:23552
    v_mfma_f32_16x16x32_bf16 a[8:11], a[248:251], v[56:59], a[8:11]
    s_waitcnt lgkmcnt(10)
    ds_read_b128 v[96:99], v237 offset:24576
    ds_read_b64_tr_b16 v[216:217], v230 offset:8192
    v_mfma_f32_16x16x32_bf16 a[12:15], a[248:251], v[60:63], a[12:15]
    s_waitcnt lgkmcnt(11)
    ds_read_b64_tr_b16 v[218:219], v230 offset:10240
    ds_read_b128 v[100:103], v237 offset:25600
    v_mfma_f32_16x16x32_bf16 a[16:19], a[248:251], v[64:67], a[16:19]
    s_waitcnt lgkmcnt(12)
    ds_read_b128 v[104:107], v237 offset:26624
    ds_read_b128 v[108:111], v237 offset:27648
    v_mfma_f32_16x16x32_bf16 a[20:23], a[248:251], v[68:71], a[20:23]
    s_waitcnt lgkmcnt(11)
    ds_read_b128 v[112:115], v237 offset:28672
    ds_read_b128 v[116:119], v237 offset:29696
    v_mfma_f32_16x16x32_bf16 a[0:3], a[252:255], v[72:75], a[0:3]
    s_waitcnt lgkmcnt(12)
    ds_read_b128 v[120:123], v237 offset:30720
    ds_read_b64_tr_b16 v[220:221], v230 offset:12288
    v_mfma_f32_16x16x32_bf16 a[4:7], a[252:255], v[76:79], a[4:7]
    s_waitcnt lgkmcnt(13)
    ds_read_b64_tr_b16 v[222:223], v230 offset:14336
    ds_read_b128 v[124:127], v237 offset:31744
    v_mfma_f32_16x16x32_bf16 a[8:11], a[252:255], v[80:83], a[8:11]
    s_waitcnt lgkmcnt(14)
    ds_read_b128 v[128:131], v237 offset:32768
    ds_read_b128 v[132:135], v237 offset:33792
    v_mfma_f32_16x16x32_bf16 a[12:15], a[252:255], v[84:87], a[12:15]
    s_waitcnt lgkmcnt(15)
    ds_read_b128 v[136:139], v237 offset:34816
    ds_read_b128 v[140:143], v237 offset:35840
    v_mfma_f32_16x16x32_bf16 a[16:19], a[252:255], v[88:91], a[16:19]
    s_waitcnt lgkmcnt(15)
    ds_read_b128 v[144:147], v237 offset:36864
    ds_read_b64_tr_b16 a[240:241], v230 offset:49152
    v_mfma_f32_16x16x32_bf16 a[20:23], a[252:255], v[92:95], a[20:23]
    s_waitcnt lgkmcnt(15)
    ds_read_b64_tr_b16 a[242:243], v230 offset:51200
    ds_read_b128 v[148:151], v237 offset:37888
    v_mfma_f32_16x16x32_bf16 a[0:3], v[216:219], v[96:99], a[0:3]
    s_waitcnt lgkmcnt(15)
    ds_read_b128 v[152:155], v237 offset:38912
    ds_read_b128 v[156:159], v237 offset:39936
    v_mfma_f32_16x16x32_bf16 a[4:7], v[216:219], v[100:103], a[4:7]
    s_waitcnt lgkmcnt(15)
    ds_read_b128 v[160:163], v237 offset:40960
    ds_read_b128 v[164:167], v237 offset:41984
    v_mfma_f32_16x16x32_bf16 a[8:11], v[216:219], v[104:107], a[8:11]
    s_waitcnt lgkmcnt(15)
    ds_read_b128 v[168:171], v237 offset:43008
    ds_read_b64_tr_b16 a[244:245], v230 offset:53248
    v_mfma_f32_16x16x32_bf16 a[12:15], v[216:219], v[108:111], a[12:15]
    s_waitcnt lgkmcnt(15)
    ds_read_b64_tr_b16 a[246:247], v230 offset:55296
    ds_read_b128 v[172:175], v237 offset:44032
    v_mfma_f32_16x16x32_bf16 a[16:19], v[216:219], v[112:115], a[16:19]
    s_waitcnt lgkmcnt(15)
    ds_read_b128 v[176:179], v237 offset:45056
    ds_read_b128 v[180:183], v237 offset:46080
    v_mfma_f32_16x16x32_bf16 a[20:23], v[216:219], v[116:119], a[20:23]
    s_waitcnt lgkmcnt(15)
    ds_read_b128 v[184:187], v237 offset:47104
    ds_read_b128 v[188:191], v237 offset:48128
    v_mfma_f32_16x16x32_bf16 a[0:3], v[220:223], v[120:123], a[0:3]
    s_waitcnt lgkmcnt(15)
    v_mfma_f32_16x16x32_bf16 a[4:7], v[220:223], v[124:127], a[4:7]
    s_waitcnt lgkmcnt(15)
    v_mfma_f32_16x16x32_bf16 a[8:11], v[220:223], v[128:131], a[8:11]
    s_waitcnt lgkmcnt(15)
    v_mfma_f32_16x16x32_bf16 a[12:15], v[220:223], v[132:135], a[12:15]
    s_waitcnt lgkmcnt(15)
    v_mfma_f32_16x16x32_bf16 a[16:19], v[220:223], v[136:139], a[16:19]
    s_waitcnt lgkmcnt(15)
    v_mfma_f32_16x16x32_bf16 a[20:23], v[220:223], v[140:143], a[20:23]
    s_waitcnt lgkmcnt(13)
    v_mfma_f32_16x16x32_bf16 a[0:3], a[240:243], v[144:147], a[0:3]
    s_waitcnt lgkmcnt(12)
    v_mfma_f32_16x16x32_bf16 a[4:7], a[240:243], v[148:151], a[4:7]
    s_waitcnt lgkmcnt(11)
    v_mfma_f32_16x16x32_bf16 a[8:11], a[240:243], v[152:155], a[8:11]
    s_waitcnt vmcnt(13) lgkmcnt(10)
    s_barrier
    v_mfma_f32_16x16x32_bf16 a[12:15], a[240:243], v[156:159], a[12:15]
    s_waitcnt lgkmcnt(9)
    ds_read_b64_tr_b16 a[248:249], v231 offset:16384
    ds_read_b64_tr_b16 a[250:251], v231 offset:18432
    v_mfma_f32_16x16x32_bf16 a[16:19], a[240:243], v[160:163], a[16:19]
    s_waitcnt lgkmcnt(10)
    ds_read_b64_tr_b16 a[252:253], v231 offset:20480
    ds_read_b64_tr_b16 a[254:255], v231 offset:22528
    v_mfma_f32_16x16x32_bf16 a[20:23], a[240:243], v[164:167], a[20:23]
    s_waitcnt lgkmcnt(9)
    ds_read_b64_tr_b16 v[216:217], v230 offset:16384
    ds_read_b64_tr_b16 v[218:219], v230 offset:18432
    v_mfma_f32_16x16x32_bf16 a[0:3], a[244:247], v[168:171], a[0:3]
    s_waitcnt lgkmcnt(10)
    ds_read_b64_tr_b16 v[220:221], v230 offset:20480
    ds_read_b64_tr_b16 v[222:223], v230 offset:22528
    v_mfma_f32_16x16x32_bf16 a[4:7], a[244:247], v[172:175], a[4:7]
    s_waitcnt lgkmcnt(11)
    ds_read_b64_tr_b16 a[240:241], v230 offset:57344
    ds_read_b64_tr_b16 a[242:243], v230 offset:59392
    v_mfma_f32_16x16x32_bf16 a[8:11], a[244:247], v[176:179], a[8:11]
    s_waitcnt lgkmcnt(12)
    v_accvgpr_read_b32 v192, a0
    v_accvgpr_read_b32 v193, a1
    v_mfma_f32_16x16x32_bf16 a[12:15], a[244:247], v[180:183], a[12:15]
    s_waitcnt lgkmcnt(11)
    v_accvgpr_read_b32 v194, a2
    v_accvgpr_read_b32 v195, a3
    v_mfma_f32_16x16x32_bf16 a[16:19], a[244:247], v[184:187], a[16:19]
    s_waitcnt lgkmcnt(10)
    v_cvt_pk_bf16_f32 v192, v192, v193
    v_accvgpr_read_b32 v196, a4
    v_mfma_f32_16x16x32_bf16 a[20:23], a[244:247], v[188:191], a[20:23]
    s_waitcnt lgkmcnt(8)
    ds_read_b64_tr_b16 a[244:245], v230 offset:61440
    v_accvgpr_read_b32 v197, a5
    v_mfma_f32_16x16x32_bf16 a[24:27], a[248:251], v[0:3], a[24:27]
    s_add_u32 s54, s85, 147456
    ds_read_b64_tr_b16 a[246:247], v230 offset:63488
    v_accvgpr_read_b32 v198, a6
    v_mfma_f32_16x16x32_bf16 a[28:31], a[248:251], v[4:7], a[28:31]
    s_add_u32 m0, s52, 49152
    v_accvgpr_read_b32 v199, a7
    v_cvt_pk_bf16_f32 v193, v194, v195
    v_mfma_f32_16x16x32_bf16 a[32:35], a[248:251], v[8:11], a[32:35]
    buffer_load_dwordx4 v239, s[20:23], s54 offen lds
    s_add_u32 s54, s85, 184320
    v_mfma_f32_16x16x32_bf16 a[36:39], a[248:251], v[12:15], a[36:39]
    s_add_u32 m0, s52, 53248
    v_cvt_pk_bf16_f32 v194, v196, v197
    v_cvt_pk_bf16_f32 v195, v198, v199
    v_mfma_f32_16x16x32_bf16 a[40:43], a[248:251], v[16:19], a[40:43]
    buffer_load_dwordx4 v239, s[20:23], s54 offen lds
    s_add_u32 s54, s85, 221184
    v_mfma_f32_16x16x32_bf16 a[44:47], a[248:251], v[20:23], a[44:47]
    s_waitcnt lgkmcnt(8)
    buffer_store_dwordx4 v[192:195], v237, s[24:27], s72 offen sc1
    v_mfma_f32_16x16x32_bf16 a[24:27], a[252:255], v[24:27], a[24:27]
    s_add_u32 m0, s52, 90112
    ds_read_b64_tr_b16 a[248:249], v231 offset:28672
    v_accvgpr_read_b32 v200, a8
    v_mfma_f32_16x16x32_bf16 a[28:31], a[252:255], v[28:31], a[28:31]
    buffer_load_dwordx4 v239, s[20:23], s54 offen lds
    s_add_u32 s54, s85, 258048
    v_mfma_f32_16x16x32_bf16 a[32:35], a[252:255], v[32:35], a[32:35]
    s_add_u32 m0, s52, 94208
    ds_read_b64_tr_b16 a[250:251], v231 offset:30720
    v_accvgpr_read_b32 v201, a9
    v_mfma_f32_16x16x32_bf16 a[36:39], a[252:255], v[36:39], a[36:39]
    buffer_load_dwordx4 v239, s[20:23], s54 offen lds
    s_add_u32 s54, s86, 0
    v_mfma_f32_16x16x32_bf16 a[40:43], a[252:255], v[40:43], a[40:43]
    s_add_u32 m0, s52, 57344
    v_accvgpr_read_b32 v202, a10
    v_accvgpr_read_b32 v203, a11
    v_mfma_f32_16x16x32_bf16 a[44:47], a[252:255], v[44:47], a[44:47]
    s_waitcnt lgkmcnt(8)
    buffer_load_dwordx4 v239, s[20:23], s54 offen lds
    v_mfma_f32_16x16x32_bf16 a[24:27], v[216:219], v[48:51], a[24:27]
    s_add_u32 s54, s86, 36864
    ds_read_b64_tr_b16 a[252:253], v231 offset:24576
    v_cvt_pk_bf16_f32 v200, v200, v201
    v_mfma_f32_16x16x32_bf16 a[28:31], v[216:219], v[52:55], a[28:31]
    s_add_u32 m0, s52, 61440
    ds_read_b64_tr_b16 a[254:255], v231 offset:26624
    v_accvgpr_read_b32 v204, a12
    v_mfma_f32_16x16x32_bf16 a[32:35], v[216:219], v[56:59], a[32:35]
    buffer_load_dwordx4 v239, s[20:23], s54 offen lds
    v_mfma_f32_16x16x32_bf16 a[36:39], v[216:219], v[60:63], a[36:39]
    v_accvgpr_read_b32 v205, a13
    v_accvgpr_read_b32 v206, a14
    v_mfma_f32_16x16x32_bf16 a[40:43], v[216:219], v[64:67], a[40:43]
    v_accvgpr_read_b32 v207, a15
    v_cvt_pk_bf16_f32 v201, v202, v203
    v_mfma_f32_16x16x32_bf16 a[44:47], v[216:219], v[68:71], a[44:47]
    s_waitcnt lgkmcnt(8)
    v_cvt_pk_bf16_f32 v202, v204, v205
    v_cvt_pk_bf16_f32 v203, v206, v207
    v_mfma_f32_16x16x32_bf16 a[24:27], v[220:223], v[72:75], a[24:27]
    buffer_store_dwordx4 v[200:203], v237, s[24:27], s72 offen offset:1024 sc1
    v_mfma_f32_16x16x32_bf16 a[28:31], v[220:223], v[76:79], a[28:31]
    v_accvgpr_read_b32 v208, a16
    v_accvgpr_read_b32 v209, a17
    v_mfma_f32_16x16x32_bf16 a[32:35], v[220:223], v[80:83], a[32:35]
    v_accvgpr_read_b32 v210, a18
    v_accvgpr_read_b32 v211, a19
    v_mfma_f32_16x16x32_bf16 a[36:39], v[220:223], v[84:87], a[36:39]
    v_cvt_pk_bf16_f32 v208, v208, v209
    v_accvgpr_read_b32 v212, a20
    v_mfma_f32_16x16x32_bf16 a[40:43], v[220:223], v[88:91], a[40:43]
    v_accvgpr_read_b32 v213, a21
    v_accvgpr_read_b32 v214, a22
    v_mfma_f32_16x16x32_bf16 a[44:47], v[220:223], v[92:95], a[44:47]
    s_waitcnt lgkmcnt(6)
    v_accvgpr_read_b32 v215, a23
    v_cvt_pk_bf16_f32 v209, v210, v211
    v_mfma_f32_16x16x32_bf16 a[24:27], a[240:243], v[96:99], a[24:27]
    v_cvt_pk_bf16_f32 v210, v212, v213
    v_cvt_pk_bf16_f32 v211, v214, v215
    v_mfma_f32_16x16x32_bf16 a[28:31], a[240:243], v[100:103], a[28:31]
    buffer_store_dwordx4 v[208:211], v237, s[24:27], s72 offen offset:2048 sc1
    v_mfma_f32_16x16x32_bf16 a[32:35], a[240:243], v[104:107], a[32:35]
    v_mfma_f32_16x16x32_bf16 a[36:39], a[240:243], v[108:111], a[36:39]
    v_mfma_f32_16x16x32_bf16 a[40:43], a[240:243], v[112:115], a[40:43]
    v_mfma_f32_16x16x32_bf16 a[44:47], a[240:243], v[116:119], a[44:47]
    s_waitcnt lgkmcnt(4)
    v_mfma_f32_16x16x32_bf16 a[24:27], a[244:247], v[120:123], a[24:27]
    v_mfma_f32_16x16x32_bf16 a[28:31], a[244:247], v[124:127], a[28:31]
    v_mfma_f32_16x16x32_bf16 a[32:35], a[244:247], v[128:131], a[32:35]
    v_mfma_f32_16x16x32_bf16 a[36:39], a[244:247], v[132:135], a[36:39]
    v_mfma_f32_16x16x32_bf16 a[40:43], a[244:247], v[136:139], a[40:43]
    v_mfma_f32_16x16x32_bf16 a[44:47], a[244:247], v[140:143], a[44:47]
    s_waitcnt lgkmcnt(2)
    v_mfma_f32_16x16x32_bf16 a[24:27], a[248:251], v[144:147], a[24:27]
    v_mfma_f32_16x16x32_bf16 a[28:31], a[248:251], v[148:151], a[28:31]
    v_mfma_f32_16x16x32_bf16 a[32:35], a[248:251], v[152:155], a[32:35]
    s_waitcnt vmcnt(13)
    s_barrier
    v_mfma_f32_16x16x32_bf16 a[36:39], a[248:251], v[156:159], a[36:39]
    s_add_u32 s54, s86, 73728
    ds_read_b64_tr_b16 v[216:217], v230 offset:24576
    ds_read_b64_tr_b16 v[218:219], v230 offset:26624
    v_mfma_f32_16x16x32_bf16 a[40:43], a[248:251], v[160:163], a[40:43]
    s_add_u32 m0, s52, 98304
    ds_read_b64_tr_b16 v[220:221], v230 offset:28672
    ds_read_b64_tr_b16 v[222:223], v230 offset:30720
    v_mfma_f32_16x16x32_bf16 a[44:47], a[248:251], v[164:167], a[44:47]
    s_waitcnt lgkmcnt(4)
    buffer_load_dwordx4 v239, s[20:23], s54 offen lds
    v_mfma_f32_16x16x32_bf16 a[24:27], a[252:255], v[168:171], a[24:27]
    s_add_u32 s54, s86, 110592
    ds_read_b64_tr_b16 a[240:241], v231
    ds_read_b64_tr_b16 a[242:243], v231 offset:2048
    v_mfma_f32_16x16x32_bf16 a[28:31], a[252:255], v[172:175], a[28:31]
    s_add_u32 m0, s52, 102400
    ds_read_b64_tr_b16 a[244:245], v231 offset:4096
    ds_read_b64_tr_b16 a[246:247], v231 offset:6144
    v_mfma_f32_16x16x32_bf16 a[32:35], a[252:255], v[176:179], a[32:35]
    buffer_load_dwordx4 v239, s[20:23], s54 offen lds
    s_add_u32 s54, s86, 147456
    v_mfma_f32_16x16x32_bf16 a[36:39], a[252:255], v[180:183], a[36:39]
    s_add_u32 m0, s52, 131072
    ds_read_b64_tr_b16 a[248:249], v231 offset:32768
    v_accvgpr_read_b32 v192, a24
    v_mfma_f32_16x16x32_bf16 a[40:43], a[252:255], v[184:187], a[40:43]
    ds_read_b64_tr_b16 a[250:251], v231 offset:34816
    v_accvgpr_read_b32 v193, a25
    v_mfma_f32_16x16x32_bf16 a[44:47], a[252:255], v[188:191], a[44:47]
    s_waitcnt lgkmcnt(8)
    ds_read_b64_tr_b16 a[252:253], v231 offset:36864
    v_accvgpr_read_b32 v194, a26
    v_mfma_f32_16x16x32_bf16 a[48:51], v[216:219], v[0:3], a[48:51]
    buffer_load_dwordx4 v239, s[20:23], s54 offen lds
    s_add_u32 s54, s86, 184320
    v_mfma_f32_16x16x32_bf16 a[52:55], v[216:219], v[4:7], a[52:55]
    s_add_u32 m0, s52, 135168
    ds_read_b64_tr_b16 a[254:255], v231 offset:38912
    v_accvgpr_read_b32 v195, a27
    v_mfma_f32_16x16x32_bf16 a[56:59], v[216:219], v[8:11], a[56:59]
    v_cvt_pk_bf16_f32 v192, v192, v193
    v_accvgpr_read_b32 v196, a28
    v_mfma_f32_16x16x32_bf16 a[60:63], v[216:219], v[12:15], a[60:63]
    v_accvgpr_read_b32 v197, a29
    v_accvgpr_read_b32 v198, a30
    v_mfma_f32_16x16x32_bf16 a[64:67], v[216:219], v[16:19], a[64:67]
    buffer_load_dwordx4 v239, s[20:23], s54 offen lds
    s_add_u32 s54, s86, 221184
    v_mfma_f32_16x16x32_bf16 a[68:71], v[216:219], v[20:23], a[68:71]
    s_waitcnt lgkmcnt(8)
    ds_read_b64_tr_b16 v[216:217], v231 offset:40960
    v_accvgpr_read_b32 v199, a31
    v_mfma_f32_16x16x32_bf16 a[48:51], v[220:223], v[24:27], a[48:51]
    s_add_u32 m0, s52, 65536
    ds_read_b64_tr_b16 v[218:219], v231 offset:43008
    v_cvt_pk_bf16_f32 v193, v194, v195
    v_mfma_f32_16x16x32_bf16 a[52:55], v[220:223], v[28:31], a[52:55]
    v_cvt_pk_bf16_f32 v194, v196, v197
    v_cvt_pk_bf16_f32 v195, v198, v199
    v_mfma_f32_16x16x32_bf16 a[56:59], v[220:223], v[32:35], a[56:59]
    buffer_store_dwordx4 v[192:195], v237, s[24:27], s73 offen sc1
    v_mfma_f32_16x16x32_bf16 a[60:63], v[220:223], v[36:39], a[60:63]
    buffer_load_dwordx4 v239, s[20:23], s54 offen lds
    s_add_u32 s54, s86, 258048
    v_mfma_f32_16x16x32_bf16 a[64:67], v[220:223], v[40:43], a[64:67]
    s_add_u32 m0, s52, 69632
    v_accvgpr_read_b32 v200, a32
    v_accvgpr_read_b32 v201, a33
    v_mfma_f32_16x16x32_bf16 a[68:71], v[220:223], v[44:47], a[68:71]
    s_waitcnt lgkmcnt(8)
    ds_read_b64_tr_b16 v[220:221], v231 offset:45056
    v_accvgpr_read_b32 v202, a34
    v_mfma_f32_16x16x32_bf16 a[48:51], a[240:243], v[48:51], a[48:51]
    ds_read_b64_tr_b16 v[222:223], v231 offset:47104
    v_accvgpr_read_b32 v203, a35
    v_mfma_f32_16x16x32_bf16 a[52:55], a[240:243], v[52:55], a[52:55]
    buffer_load_dwordx4 v239, s[20:23], s54 offen lds
    s_add_u32 s54, s87, 0
    v_mfma_f32_16x16x32_bf16 a[56:59], a[240:243], v[56:59], a[56:59]
    s_add_u32 m0, s52, 106496
    v_cvt_pk_bf16_f32 v200, v200, v201
    v_accvgpr_read_b32 v204, a36
    v_mfma_f32_16x16x32_bf16 a[60:63], a[240:243], v[60:63], a[60:63]
    v_accvgpr_read_b32 v205, a37
    v_accvgpr_read_b32 v206, a38
    v_mfma_f32_16x16x32_bf16 a[64:67], a[240:243], v[64:67], a[64:67]
    v_accvgpr_read_b32 v207, a39
    v_cvt_pk_bf16_f32 v201, v202, v203
    v_mfma_f32_16x16x32_bf16 a[68:71], a[240:243], v[68:71], a[68:71]
    s_waitcnt lgkmcnt(8)
    v_cvt_pk_bf16_f32 v202, v204, v205
    v_cvt_pk_bf16_f32 v203, v206, v207
    v_mfma_f32_16x16x32_bf16 a[48:51], a[244:247], v[72:75], a[48:51]
    buffer_load_dwordx4 v239, s[20:23], s54 offen lds
    s_add_u32 s54, s87, 36864
    v_mfma_f32_16x16x32_bf16 a[52:55], a[244:247], v[76:79], a[52:55]
    s_add_u32 m0, s52, 110592
    buffer_store_dwordx4 v[200:203], v237, s[24:27], s73 offen offset:1024 sc1
    v_mfma_f32_16x16x32_bf16 a[56:59], a[244:247], v[80:83], a[56:59]
    v_accvgpr_read_b32 v208, a40
    v_accvgpr_read_b32 v209, a41
    v_mfma_f32_16x16x32_bf16 a[60:63], a[244:247], v[84:87], a[60:63]
    v_accvgpr_read_b32 v210, a42
    v_accvgpr_read_b32 v211, a43
    v_mfma_f32_16x16x32_bf16 a[64:67], a[244:247], v[88:91], a[64:67]
    buffer_load_dwordx4 v239, s[20:23], s54 offen lds
    v_mfma_f32_16x16x32_bf16 a[68:71], a[244:247], v[92:95], a[68:71]
    s_waitcnt lgkmcnt(6)
    v_cvt_pk_bf16_f32 v208, v208, v209
    v_accvgpr_read_b32 v212, a44
    v_mfma_f32_16x16x32_bf16 a[48:51], a[248:251], v[96:99], a[48:51]
    v_accvgpr_read_b32 v213, a45
    v_accvgpr_read_b32 v214, a46
    v_mfma_f32_16x16x32_bf16 a[52:55], a[248:251], v[100:103], a[52:55]
    v_accvgpr_read_b32 v215, a47
    v_cvt_pk_bf16_f32 v209, v210, v211
    v_mfma_f32_16x16x32_bf16 a[56:59], a[248:251], v[104:107], a[56:59]
    v_cvt_pk_bf16_f32 v210, v212, v213
    v_cvt_pk_bf16_f32 v211, v214, v215
    v_mfma_f32_16x16x32_bf16 a[60:63], a[248:251], v[108:111], a[60:63]
    buffer_store_dwordx4 v[208:211], v237, s[24:27], s73 offen offset:2048 sc1
    v_mfma_f32_16x16x32_bf16 a[64:67], a[248:251], v[112:115], a[64:67]
    v_mfma_f32_16x16x32_bf16 a[68:71], a[248:251], v[116:119], a[68:71]
    s_waitcnt lgkmcnt(4)
    v_mfma_f32_16x16x32_bf16 a[48:51], a[252:255], v[120:123], a[48:51]
    v_mfma_f32_16x16x32_bf16 a[52:55], a[252:255], v[124:127], a[52:55]
    v_mfma_f32_16x16x32_bf16 a[56:59], a[252:255], v[128:131], a[56:59]
    v_mfma_f32_16x16x32_bf16 a[60:63], a[252:255], v[132:135], a[60:63]
    v_mfma_f32_16x16x32_bf16 a[64:67], a[252:255], v[136:139], a[64:67]
    v_mfma_f32_16x16x32_bf16 a[68:71], a[252:255], v[140:143], a[68:71]
    s_waitcnt lgkmcnt(2)
    v_mfma_f32_16x16x32_bf16 a[48:51], v[216:219], v[144:147], a[48:51]
    v_mfma_f32_16x16x32_bf16 a[52:55], v[216:219], v[148:151], a[52:55]
    v_mfma_f32_16x16x32_bf16 a[56:59], v[216:219], v[152:155], a[56:59]
    s_waitcnt vmcnt(15)
    s_barrier
    v_mfma_f32_16x16x32_bf16 a[60:63], v[216:219], v[156:159], a[60:63]
    s_add_u32 s54, s87, 73728
    ds_read_b64_tr_b16 a[240:241], v230 offset:32768
    ds_read_b64_tr_b16 a[242:243], v230 offset:34816
    v_mfma_f32_16x16x32_bf16 a[64:67], v[216:219], v[160:163], a[64:67]
    s_add_u32 m0, s52, 143360
    ds_read_b64_tr_b16 a[244:245], v230 offset:36864
    ds_read_b64_tr_b16 a[246:247], v230 offset:38912
    v_mfma_f32_16x16x32_bf16 a[68:71], v[216:219], v[164:167], a[68:71]
    s_waitcnt lgkmcnt(4)
    buffer_load_dwordx4 v239, s[20:23], s54 offen lds
    v_mfma_f32_16x16x32_bf16 a[48:51], v[220:223], v[168:171], a[48:51]
    s_add_u32 s54, s87, 110592
    ds_read_b64_tr_b16 a[248:249], v231 offset:8192
    ds_read_b64_tr_b16 a[250:251], v231 offset:10240
    v_mfma_f32_16x16x32_bf16 a[52:55], v[220:223], v[172:175], a[52:55]
    s_add_u32 m0, s52, 139264
    ds_read_b64_tr_b16 a[252:253], v231 offset:12288
    ds_read_b64_tr_b16 a[254:255], v231 offset:14336
    v_mfma_f32_16x16x32_bf16 a[56:59], v[220:223], v[176:179], a[56:59]
    buffer_load_dwordx4 v239, s[20:23], s54 offen lds
    s_add_u32 s54, s87, 147456
    v_mfma_f32_16x16x32_bf16 a[60:63], v[220:223], v[180:183], a[60:63]
    s_add_u32 m0, s52, 73728
    ds_read_b64_tr_b16 v[216:217], v230
    v_accvgpr_read_b32 v192, a48
    v_mfma_f32_16x16x32_bf16 a[64:67], v[220:223], v[184:187], a[64:67]
    ds_read_b64_tr_b16 v[218:219], v230 offset:2048
    v_accvgpr_read_b32 v193, a49
    v_mfma_f32_16x16x32_bf16 a[68:71], v[220:223], v[188:191], a[68:71]
    s_waitcnt lgkmcnt(8)
    ds_read_b64_tr_b16 v[220:221], v230 offset:4096
    v_accvgpr_read_b32 v194, a50
    v_mfma_f32_16x16x32_bf16 a[72:75], a[240:243], v[0:3], a[72:75]
    buffer_load_dwordx4 v239, s[20:23], s54 offen lds
    s_add_u32 s54, s87, 184320
    v_mfma_f32_16x16x32_bf16 a[76:79], a[240:243], v[4:7], a[76:79]
    s_add_u32 m0, s52, 77824
    ds_read_b64_tr_b16 v[222:223], v230 offset:6144
    v_accvgpr_read_b32 v195, a51
    v_mfma_f32_16x16x32_bf16 a[80:83], a[240:243], v[8:11], a[80:83]
    v_cvt_pk_bf16_f32 v192, v192, v193
    v_accvgpr_read_b32 v196, a52
    v_mfma_f32_16x16x32_bf16 a[84:87], a[240:243], v[12:15], a[84:87]
    v_accvgpr_read_b32 v197, a53
    v_accvgpr_read_b32 v198, a54
    v_mfma_f32_16x16x32_bf16 a[88:91], a[240:243], v[16:19], a[88:91]
    buffer_load_dwordx4 v239, s[20:23], s54 offen lds
    s_add_u32 s54, s87, 221184
    v_mfma_f32_16x16x32_bf16 a[92:95], a[240:243], v[20:23], a[92:95]
    s_waitcnt lgkmcnt(8)
    ds_read_b64_tr_b16 a[240:241], v230 offset:40960
    v_accvgpr_read_b32 v199, a55
    v_mfma_f32_16x16x32_bf16 a[72:75], a[244:247], v[24:27], a[72:75]
    s_add_u32 m0, s52, 114688
    ds_read_b64_tr_b16 a[242:243], v230 offset:43008
    v_cvt_pk_bf16_f32 v193, v194, v195
    v_mfma_f32_16x16x32_bf16 a[76:79], a[244:247], v[28:31], a[76:79]
    v_cvt_pk_bf16_f32 v194, v196, v197
    v_cvt_pk_bf16_f32 v195, v198, v199
    v_mfma_f32_16x16x32_bf16 a[80:83], a[244:247], v[32:35], a[80:83]
    buffer_store_dwordx4 v[192:195], v237, s[24:27], s74 offen sc1
    v_mfma_f32_16x16x32_bf16 a[84:87], a[244:247], v[36:39], a[84:87]
    buffer_load_dwordx4 v239, s[20:23], s54 offen lds
    s_add_u32 s54, s87, 258048
    v_mfma_f32_16x16x32_bf16 a[88:91], a[244:247], v[40:43], a[88:91]
    s_add_u32 m0, s52, 118784
    v_accvgpr_read_b32 v200, a56
    v_accvgpr_read_b32 v201, a57
    v_mfma_f32_16x16x32_bf16 a[92:95], a[244:247], v[44:47], a[92:95]
    s_waitcnt lgkmcnt(8)
    ds_read_b64_tr_b16 a[244:245], v230 offset:45056
    v_accvgpr_read_b32 v202, a58
    v_mfma_f32_16x16x32_bf16 a[72:75], a[248:251], v[48:51], a[72:75]
    ds_read_b64_tr_b16 a[246:247], v230 offset:47104
    v_accvgpr_read_b32 v203, a59
    v_mfma_f32_16x16x32_bf16 a[76:79], a[248:251], v[52:55], a[76:79]
    buffer_load_dwordx4 v239, s[20:23], s54 offen lds
    s_add_u32 s54, s88, 0
    v_mfma_f32_16x16x32_bf16 a[80:83], a[248:251], v[56:59], a[80:83]
    s_add_u32 m0, s52, 147456
    v_cvt_pk_bf16_f32 v200, v200, v201
    v_accvgpr_read_b32 v204, a60
    v_mfma_f32_16x16x32_bf16 a[84:87], a[248:251], v[60:63], a[84:87]
    v_accvgpr_read_b32 v205, a61
    v_accvgpr_read_b32 v206, a62
    v_mfma_f32_16x16x32_bf16 a[88:91], a[248:251], v[64:67], a[88:91]
    v_accvgpr_read_b32 v207, a63
    v_cvt_pk_bf16_f32 v201, v202, v203
    v_mfma_f32_16x16x32_bf16 a[92:95], a[248:251], v[68:71], a[92:95]
    s_waitcnt lgkmcnt(8)
    v_cvt_pk_bf16_f32 v202, v204, v205
    v_cvt_pk_bf16_f32 v203, v206, v207
    v_mfma_f32_16x16x32_bf16 a[72:75], a[252:255], v[72:75], a[72:75]
    buffer_load_dwordx4 v239, s[20:23], s54 offen lds
    s_add_u32 s54, s88, 36864
    v_mfma_f32_16x16x32_bf16 a[76:79], a[252:255], v[76:79], a[76:79]
    s_add_u32 m0, s52, 151552
    buffer_store_dwordx4 v[200:203], v237, s[24:27], s74 offen offset:1024 sc1
    v_mfma_f32_16x16x32_bf16 a[80:83], a[252:255], v[80:83], a[80:83]
    v_accvgpr_read_b32 v208, a64
    v_accvgpr_read_b32 v209, a65
    v_mfma_f32_16x16x32_bf16 a[84:87], a[252:255], v[84:87], a[84:87]
    v_accvgpr_read_b32 v210, a66
    v_accvgpr_read_b32 v211, a67
    v_mfma_f32_16x16x32_bf16 a[88:91], a[252:255], v[88:91], a[88:91]
    buffer_load_dwordx4 v239, s[20:23], s54 offen lds
    v_mfma_f32_16x16x32_bf16 a[92:95], a[252:255], v[92:95], a[92:95]
    s_waitcnt lgkmcnt(6)
    v_cvt_pk_bf16_f32 v208, v208, v209
    v_accvgpr_read_b32 v212, a68
    v_mfma_f32_16x16x32_bf16 a[72:75], v[216:219], v[96:99], a[72:75]
    v_accvgpr_read_b32 v213, a69
    v_accvgpr_read_b32 v214, a70
    v_mfma_f32_16x16x32_bf16 a[76:79], v[216:219], v[100:103], a[76:79]
    v_accvgpr_read_b32 v215, a71
    v_cvt_pk_bf16_f32 v209, v210, v211
    v_mfma_f32_16x16x32_bf16 a[80:83], v[216:219], v[104:107], a[80:83]
    v_cvt_pk_bf16_f32 v210, v212, v213
    v_cvt_pk_bf16_f32 v211, v214, v215
    v_mfma_f32_16x16x32_bf16 a[84:87], v[216:219], v[108:111], a[84:87]
    buffer_store_dwordx4 v[208:211], v237, s[24:27], s74 offen offset:2048 sc1
    v_mfma_f32_16x16x32_bf16 a[88:91], v[216:219], v[112:115], a[88:91]
    v_mfma_f32_16x16x32_bf16 a[92:95], v[216:219], v[116:119], a[92:95]
    s_waitcnt lgkmcnt(4)
    v_mfma_f32_16x16x32_bf16 a[72:75], v[220:223], v[120:123], a[72:75]
    v_mfma_f32_16x16x32_bf16 a[76:79], v[220:223], v[124:127], a[76:79]
    v_mfma_f32_16x16x32_bf16 a[80:83], v[220:223], v[128:131], a[80:83]
    v_mfma_f32_16x16x32_bf16 a[84:87], v[220:223], v[132:135], a[84:87]
    v_mfma_f32_16x16x32_bf16 a[88:91], v[220:223], v[136:139], a[88:91]
    v_mfma_f32_16x16x32_bf16 a[92:95], v[220:223], v[140:143], a[92:95]
    s_waitcnt lgkmcnt(2)
    v_mfma_f32_16x16x32_bf16 a[72:75], a[240:243], v[144:147], a[72:75]
    v_mfma_f32_16x16x32_bf16 a[76:79], a[240:243], v[148:151], a[76:79]
    v_mfma_f32_16x16x32_bf16 a[80:83], a[240:243], v[152:155], a[80:83]
    s_waitcnt vmcnt(15)
    s_barrier
    v_mfma_f32_16x16x32_bf16 a[84:87], a[240:243], v[156:159], a[84:87]
    s_add_u32 s54, s88, 73728
    ds_read_b64_tr_b16 a[248:249], v230 offset:8192
    ds_read_b64_tr_b16 a[250:251], v230 offset:10240
    v_mfma_f32_16x16x32_bf16 a[88:91], a[240:243], v[160:163], a[88:91]
    s_add_u32 m0, s52, 155648
    ds_read_b64_tr_b16 a[252:253], v230 offset:12288
    ds_read_b64_tr_b16 a[254:255], v230 offset:14336
    v_mfma_f32_16x16x32_bf16 a[92:95], a[240:243], v[164:167], a[92:95]
    s_waitcnt lgkmcnt(4)
    buffer_load_dwordx4 v239, s[20:23], s54 offen lds
    v_mfma_f32_16x16x32_bf16 a[72:75], a[244:247], v[168:171], a[72:75]
    s_add_u32 s54, s88, 110592
    ds_read_b64_tr_b16 v[216:217], v230 offset:49152
    ds_read_b64_tr_b16 v[218:219], v230 offset:51200
    v_mfma_f32_16x16x32_bf16 a[76:79], a[244:247], v[172:175], a[76:79]
    s_add_u32 m0, s52, 159744
    ds_read_b64_tr_b16 v[220:221], v230 offset:53248
    ds_read_b64_tr_b16 v[222:223], v230 offset:55296
    v_mfma_f32_16x16x32_bf16 a[80:83], a[244:247], v[176:179], a[80:83]
    buffer_load_dwordx4 v239, s[20:23], s54 offen lds
    s_add_u32 s54, s88, 147456
    v_mfma_f32_16x16x32_bf16 a[84:87], a[244:247], v[180:183], a[84:87]
    s_add_u32 m0, s52, 81920
    ds_read_b64_tr_b16 a[240:241], v231 offset:16384
    v_accvgpr_read_b32 v192, a72
    v_mfma_f32_16x16x32_bf16 a[88:91], a[244:247], v[184:187], a[88:91]
    ds_read_b64_tr_b16 a[242:243], v231 offset:18432
    v_accvgpr_read_b32 v193, a73
    v_mfma_f32_16x16x32_bf16 a[92:95], a[244:247], v[188:191], a[92:95]
    s_waitcnt lgkmcnt(8)
    ds_read_b64_tr_b16 a[244:245], v231 offset:20480
    v_accvgpr_read_b32 v194, a74
    v_mfma_f32_16x16x32_bf16 a[96:99], a[248:251], v[0:3], a[96:99]
    buffer_load_dwordx4 v239, s[20:23], s54 offen lds
    s_add_u32 s54, s88, 184320
    v_mfma_f32_16x16x32_bf16 a[100:103], a[248:251], v[4:7], a[100:103]
    s_add_u32 m0, s52, 86016
    ds_read_b64_tr_b16 a[246:247], v231 offset:22528
    v_accvgpr_read_b32 v195, a75
    v_mfma_f32_16x16x32_bf16 a[104:107], a[248:251], v[8:11], a[104:107]
    v_cvt_pk_bf16_f32 v192, v192, v193
    v_accvgpr_read_b32 v196, a76
    v_mfma_f32_16x16x32_bf16 a[108:111], a[248:251], v[12:15], a[108:111]
    v_accvgpr_read_b32 v197, a77
    v_accvgpr_read_b32 v198, a78
    v_mfma_f32_16x16x32_bf16 a[112:115], a[248:251], v[16:19], a[112:115]
    buffer_load_dwordx4 v239, s[20:23], s54 offen lds
    s_add_u32 s54, s88, 221184
    v_mfma_f32_16x16x32_bf16 a[116:119], a[248:251], v[20:23], a[116:119]
    s_waitcnt lgkmcnt(8)
    ds_read_b64_tr_b16 a[248:249], v230 offset:16384
    v_accvgpr_read_b32 v199, a79
    v_mfma_f32_16x16x32_bf16 a[96:99], a[252:255], v[24:27], a[96:99]
    s_add_u32 m0, s52, 122880
    ds_read_b64_tr_b16 a[250:251], v230 offset:18432
    v_cvt_pk_bf16_f32 v193, v194, v195
    v_mfma_f32_16x16x32_bf16 a[100:103], a[252:255], v[28:31], a[100:103]
    v_cvt_pk_bf16_f32 v194, v196, v197
    v_cvt_pk_bf16_f32 v195, v198, v199
    v_mfma_f32_16x16x32_bf16 a[104:107], a[252:255], v[32:35], a[104:107]
    buffer_store_dwordx4 v[192:195], v237, s[24:27], s75 offen sc1
    v_mfma_f32_16x16x32_bf16 a[108:111], a[252:255], v[36:39], a[108:111]
    buffer_load_dwordx4 v239, s[20:23], s54 offen lds
    s_add_u32 s54, s88, 258048
    v_mfma_f32_16x16x32_bf16 a[112:115], a[252:255], v[40:43], a[112:115]
    s_add_u32 m0, s52, 126976
    v_accvgpr_read_b32 v200, a80
    v_accvgpr_read_b32 v201, a81
    v_mfma_f32_16x16x32_bf16 a[116:119], a[252:255], v[44:47], a[116:119]
    s_waitcnt lgkmcnt(8)
    ds_read_b64_tr_b16 a[252:253], v230 offset:20480
    v_accvgpr_read_b32 v202, a82
    v_mfma_f32_16x16x32_bf16 a[96:99], v[216:219], v[48:51], a[96:99]
    ds_read_b64_tr_b16 a[254:255], v230 offset:22528
    v_accvgpr_read_b32 v203, a83
    v_mfma_f32_16x16x32_bf16 a[100:103], v[216:219], v[52:55], a[100:103]
    buffer_load_dwordx4 v239, s[20:23], s54 offen lds
    s_add_u32 s54, s89, 0
    v_mfma_f32_16x16x32_bf16 a[104:107], v[216:219], v[56:59], a[104:107]
    s_add_u32 m0, s52, 49152
    v_cvt_pk_bf16_f32 v200, v200, v201
    v_accvgpr_read_b32 v204, a84
    v_mfma_f32_16x16x32_bf16 a[108:111], v[216:219], v[60:63], a[108:111]
    v_accvgpr_read_b32 v205, a85
    v_accvgpr_read_b32 v206, a86
    v_mfma_f32_16x16x32_bf16 a[112:115], v[216:219], v[64:67], a[112:115]
    v_accvgpr_read_b32 v207, a87
    v_cvt_pk_bf16_f32 v201, v202, v203
    v_mfma_f32_16x16x32_bf16 a[116:119], v[216:219], v[68:71], a[116:119]
    s_waitcnt lgkmcnt(8)
    v_cvt_pk_bf16_f32 v202, v204, v205
    v_cvt_pk_bf16_f32 v203, v206, v207
    v_mfma_f32_16x16x32_bf16 a[96:99], v[220:223], v[72:75], a[96:99]
    buffer_load_dwordx4 v239, s[20:23], s54 offen lds
    s_add_u32 s54, s89, 36864
    v_mfma_f32_16x16x32_bf16 a[100:103], v[220:223], v[76:79], a[100:103]
    s_add_u32 m0, s52, 53248
    buffer_store_dwordx4 v[200:203], v237, s[24:27], s75 offen offset:1024 sc1
    v_mfma_f32_16x16x32_bf16 a[104:107], v[220:223], v[80:83], a[104:107]
    v_accvgpr_read_b32 v208, a88
    v_accvgpr_read_b32 v209, a89
    v_mfma_f32_16x16x32_bf16 a[108:111], v[220:223], v[84:87], a[108:111]
    v_accvgpr_read_b32 v210, a90
    v_accvgpr_read_b32 v211, a91
    v_mfma_f32_16x16x32_bf16 a[112:115], v[220:223], v[88:91], a[112:115]
    buffer_load_dwordx4 v239, s[20:23], s54 offen lds
    v_mfma_f32_16x16x32_bf16 a[116:119], v[220:223], v[92:95], a[116:119]
    s_waitcnt lgkmcnt(6)
    v_cvt_pk_bf16_f32 v208, v208, v209
    v_accvgpr_read_b32 v212, a92
    v_mfma_f32_16x16x32_bf16 a[96:99], a[240:243], v[96:99], a[96:99]
    v_accvgpr_read_b32 v213, a93
    v_accvgpr_read_b32 v214, a94
    v_mfma_f32_16x16x32_bf16 a[100:103], a[240:243], v[100:103], a[100:103]
    v_accvgpr_read_b32 v215, a95
    v_cvt_pk_bf16_f32 v209, v210, v211
    v_mfma_f32_16x16x32_bf16 a[104:107], a[240:243], v[104:107], a[104:107]
    v_cvt_pk_bf16_f32 v210, v212, v213
    v_cvt_pk_bf16_f32 v211, v214, v215
    v_mfma_f32_16x16x32_bf16 a[108:111], a[240:243], v[108:111], a[108:111]
    buffer_store_dwordx4 v[208:211], v237, s[24:27], s75 offen offset:2048 sc1
    v_mfma_f32_16x16x32_bf16 a[112:115], a[240:243], v[112:115], a[112:115]
    v_mfma_f32_16x16x32_bf16 a[116:119], a[240:243], v[116:119], a[116:119]
    s_waitcnt lgkmcnt(4)
    v_mfma_f32_16x16x32_bf16 a[96:99], a[244:247], v[120:123], a[96:99]
    v_mfma_f32_16x16x32_bf16 a[100:103], a[244:247], v[124:127], a[100:103]
    v_mfma_f32_16x16x32_bf16 a[104:107], a[244:247], v[128:131], a[104:107]
    v_mfma_f32_16x16x32_bf16 a[108:111], a[244:247], v[132:135], a[108:111]
    v_mfma_f32_16x16x32_bf16 a[112:115], a[244:247], v[136:139], a[112:115]
    v_mfma_f32_16x16x32_bf16 a[116:119], a[244:247], v[140:143], a[116:119]
    s_waitcnt lgkmcnt(2)
    v_mfma_f32_16x16x32_bf16 a[96:99], a[248:251], v[144:147], a[96:99]
    v_mfma_f32_16x16x32_bf16 a[100:103], a[248:251], v[148:151], a[100:103]
    v_mfma_f32_16x16x32_bf16 a[104:107], a[248:251], v[152:155], a[104:107]
    s_waitcnt vmcnt(15)
    s_barrier
    v_mfma_f32_16x16x32_bf16 a[108:111], a[248:251], v[156:159], a[108:111]
    s_add_u32 s54, s89, 73728
    ds_read_b64_tr_b16 v[216:217], v230 offset:57344
    ds_read_b64_tr_b16 v[218:219], v230 offset:59392
    v_mfma_f32_16x16x32_bf16 a[112:115], a[248:251], v[160:163], a[112:115]
    s_add_u32 m0, s52, 90112
    ds_read_b64_tr_b16 v[220:221], v230 offset:61440
    ds_read_b64_tr_b16 v[222:223], v230 offset:63488
    v_mfma_f32_16x16x32_bf16 a[116:119], a[248:251], v[164:167], a[116:119]
    s_waitcnt lgkmcnt(4)
    buffer_load_dwordx4 v239, s[20:23], s54 offen lds
    v_mfma_f32_16x16x32_bf16 a[96:99], a[252:255], v[168:171], a[96:99]
    s_add_u32 s54, s89, 110592
    ds_read_b64_tr_b16 a[240:241], v231 offset:28672
    ds_read_b64_tr_b16 a[242:243], v231 offset:30720
    v_mfma_f32_16x16x32_bf16 a[100:103], a[252:255], v[172:175], a[100:103]
    s_add_u32 m0, s52, 94208
    ds_read_b64_tr_b16 a[244:245], v231 offset:24576
    ds_read_b64_tr_b16 a[246:247], v231 offset:26624
    v_mfma_f32_16x16x32_bf16 a[104:107], a[252:255], v[176:179], a[104:107]
    buffer_load_dwordx4 v239, s[20:23], s54 offen lds
    s_add_u32 s54, s89, 147456
    v_mfma_f32_16x16x32_bf16 a[108:111], a[252:255], v[180:183], a[108:111]
    s_add_u32 m0, s52, 57344
    ds_read_b64_tr_b16 a[248:249], v230 offset:24576
    v_accvgpr_read_b32 v192, a96
    v_mfma_f32_16x16x32_bf16 a[112:115], a[252:255], v[184:187], a[112:115]
    ds_read_b64_tr_b16 a[250:251], v230 offset:26624
    v_accvgpr_read_b32 v193, a97
    v_mfma_f32_16x16x32_bf16 a[116:119], a[252:255], v[188:191], a[116:119]
    s_waitcnt lgkmcnt(8)
    ds_read_b64_tr_b16 a[252:253], v230 offset:28672
    v_accvgpr_read_b32 v194, a98
    v_mfma_f32_16x16x32_bf16 a[120:123], v[216:219], v[0:3], a[120:123]
    buffer_load_dwordx4 v239, s[20:23], s54 offen lds
    s_add_u32 s54, s89, 184320
    v_mfma_f32_16x16x32_bf16 a[124:127], v[216:219], v[4:7], a[124:127]
    s_add_u32 m0, s52, 61440
    ds_read_b64_tr_b16 a[254:255], v230 offset:30720
    v_accvgpr_read_b32 v195, a99
    v_mfma_f32_16x16x32_bf16 a[128:131], v[216:219], v[8:11], a[128:131]
    v_cvt_pk_bf16_f32 v192, v192, v193
    v_accvgpr_read_b32 v196, a100
    v_mfma_f32_16x16x32_bf16 a[132:135], v[216:219], v[12:15], a[132:135]
    v_accvgpr_read_b32 v197, a101
    v_accvgpr_read_b32 v198, a102
    v_mfma_f32_16x16x32_bf16 a[136:139], v[216:219], v[16:19], a[136:139]
    buffer_load_dwordx4 v239, s[20:23], s54 offen lds
    s_add_u32 s54, s89, 221184
    v_mfma_f32_16x16x32_bf16 a[140:143], v[216:219], v[20:23], a[140:143]
    s_waitcnt lgkmcnt(8)
    ds_read_b64_tr_b16 v[216:217], v231
    v_accvgpr_read_b32 v199, a103
    v_mfma_f32_16x16x32_bf16 a[120:123], v[220:223], v[24:27], a[120:123]
    s_add_u32 m0, s52, 98304
    ds_read_b64_tr_b16 v[218:219], v231 offset:2048
    v_cvt_pk_bf16_f32 v193, v194, v195
    v_mfma_f32_16x16x32_bf16 a[124:127], v[220:223], v[28:31], a[124:127]
    v_cvt_pk_bf16_f32 v194, v196, v197
    v_cvt_pk_bf16_f32 v195, v198, v199
    v_mfma_f32_16x16x32_bf16 a[128:131], v[220:223], v[32:35], a[128:131]
    buffer_store_dwordx4 v[192:195], v237, s[24:27], s76 offen sc1
    v_mfma_f32_16x16x32_bf16 a[132:135], v[220:223], v[36:39], a[132:135]
    buffer_load_dwordx4 v239, s[20:23], s54 offen lds
    s_add_u32 s54, s89, 258048
    v_mfma_f32_16x16x32_bf16 a[136:139], v[220:223], v[40:43], a[136:139]
    s_add_u32 m0, s52, 102400
    v_accvgpr_read_b32 v200, a104
    v_accvgpr_read_b32 v201, a105
    v_mfma_f32_16x16x32_bf16 a[140:143], v[220:223], v[44:47], a[140:143]
    s_waitcnt lgkmcnt(8)
    ds_read_b64_tr_b16 v[220:221], v231 offset:4096
    v_accvgpr_read_b32 v202, a106
    v_mfma_f32_16x16x32_bf16 a[120:123], a[240:243], v[48:51], a[120:123]
    ds_read_b64_tr_b16 v[222:223], v231 offset:6144
    v_accvgpr_read_b32 v203, a107
    v_mfma_f32_16x16x32_bf16 a[124:127], a[240:243], v[52:55], a[124:127]
    buffer_load_dwordx4 v239, s[20:23], s54 offen lds
    s_add_u32 s54, s90, 0
    v_mfma_f32_16x16x32_bf16 a[128:131], a[240:243], v[56:59], a[128:131]
    s_add_u32 m0, s52, 131072
    v_cvt_pk_bf16_f32 v200, v200, v201
    v_accvgpr_read_b32 v204, a108
    v_mfma_f32_16x16x32_bf16 a[132:135], a[240:243], v[60:63], a[132:135]
    v_accvgpr_read_b32 v205, a109
    v_accvgpr_read_b32 v206, a110
    v_mfma_f32_16x16x32_bf16 a[136:139], a[240:243], v[64:67], a[136:139]
    v_accvgpr_read_b32 v207, a111
    v_cvt_pk_bf16_f32 v201, v202, v203
    v_mfma_f32_16x16x32_bf16 a[140:143], a[240:243], v[68:71], a[140:143]
    s_waitcnt lgkmcnt(8)
    v_cvt_pk_bf16_f32 v202, v204, v205
    v_cvt_pk_bf16_f32 v203, v206, v207
    v_mfma_f32_16x16x32_bf16 a[120:123], a[244:247], v[72:75], a[120:123]
    buffer_load_dwordx4 v239, s[20:23], s54 offen lds
    s_add_u32 s54, s90, 36864
    v_mfma_f32_16x16x32_bf16 a[124:127], a[244:247], v[76:79], a[124:127]
    s_add_u32 m0, s52, 135168
    buffer_store_dwordx4 v[200:203], v237, s[24:27], s76 offen offset:1024 sc1
    v_mfma_f32_16x16x32_bf16 a[128:131], a[244:247], v[80:83], a[128:131]
    v_accvgpr_read_b32 v208, a112
    v_accvgpr_read_b32 v209, a113
    v_mfma_f32_16x16x32_bf16 a[132:135], a[244:247], v[84:87], a[132:135]
    v_accvgpr_read_b32 v210, a114
    v_accvgpr_read_b32 v211, a115
    v_mfma_f32_16x16x32_bf16 a[136:139], a[244:247], v[88:91], a[136:139]
    buffer_load_dwordx4 v239, s[20:23], s54 offen lds
    v_mfma_f32_16x16x32_bf16 a[140:143], a[244:247], v[92:95], a[140:143]
    s_waitcnt lgkmcnt(6)
    v_cvt_pk_bf16_f32 v208, v208, v209
    v_accvgpr_read_b32 v212, a116
    v_mfma_f32_16x16x32_bf16 a[120:123], a[248:251], v[96:99], a[120:123]
    v_accvgpr_read_b32 v213, a117
    v_accvgpr_read_b32 v214, a118
    v_mfma_f32_16x16x32_bf16 a[124:127], a[248:251], v[100:103], a[124:127]
    v_accvgpr_read_b32 v215, a119
    v_cvt_pk_bf16_f32 v209, v210, v211
    v_mfma_f32_16x16x32_bf16 a[128:131], a[248:251], v[104:107], a[128:131]
    v_cvt_pk_bf16_f32 v210, v212, v213
    v_cvt_pk_bf16_f32 v211, v214, v215
    v_mfma_f32_16x16x32_bf16 a[132:135], a[248:251], v[108:111], a[132:135]
    buffer_store_dwordx4 v[208:211], v237, s[24:27], s76 offen offset:2048 sc1
    v_mfma_f32_16x16x32_bf16 a[136:139], a[248:251], v[112:115], a[136:139]
    v_mfma_f32_16x16x32_bf16 a[140:143], a[248:251], v[116:119], a[140:143]
    s_waitcnt lgkmcnt(4)
    v_mfma_f32_16x16x32_bf16 a[120:123], a[252:255], v[120:123], a[120:123]
    v_mfma_f32_16x16x32_bf16 a[124:127], a[252:255], v[124:127], a[124:127]
    v_mfma_f32_16x16x32_bf16 a[128:131], a[252:255], v[128:131], a[128:131]
    v_mfma_f32_16x16x32_bf16 a[132:135], a[252:255], v[132:135], a[132:135]
    v_mfma_f32_16x16x32_bf16 a[136:139], a[252:255], v[136:139], a[136:139]
    v_mfma_f32_16x16x32_bf16 a[140:143], a[252:255], v[140:143], a[140:143]
    s_waitcnt lgkmcnt(2)
    v_mfma_f32_16x16x32_bf16 a[120:123], v[216:219], v[144:147], a[120:123]
    v_mfma_f32_16x16x32_bf16 a[124:127], v[216:219], v[148:151], a[124:127]
    v_mfma_f32_16x16x32_bf16 a[128:131], v[216:219], v[152:155], a[128:131]
    s_waitcnt vmcnt(15)
    s_barrier
    v_mfma_f32_16x16x32_bf16 a[132:135], v[216:219], v[156:159], a[132:135]
    s_add_u32 s54, s90, 73728
    ds_read_b64_tr_b16 a[240:241], v231 offset:32768
    ds_read_b64_tr_b16 a[242:243], v231 offset:34816
    v_mfma_f32_16x16x32_bf16 a[136:139], v[216:219], v[160:163], a[136:139]
    s_add_u32 m0, s52, 65536
    ds_read_b64_tr_b16 a[244:245], v231 offset:36864
    ds_read_b64_tr_b16 a[246:247], v231 offset:38912
    v_mfma_f32_16x16x32_bf16 a[140:143], v[216:219], v[164:167], a[140:143]
    s_waitcnt lgkmcnt(4)
    buffer_load_dwordx4 v239, s[20:23], s54 offen lds
    v_mfma_f32_16x16x32_bf16 a[120:123], v[220:223], v[168:171], a[120:123]
    s_add_u32 s54, s90, 110592
    ds_read_b64_tr_b16 a[248:249], v231 offset:40960
    ds_read_b64_tr_b16 a[250:251], v231 offset:43008
    v_mfma_f32_16x16x32_bf16 a[124:127], v[220:223], v[172:175], a[124:127]
    s_add_u32 m0, s52, 69632
    ds_read_b64_tr_b16 a[252:253], v231 offset:45056
    ds_read_b64_tr_b16 a[254:255], v231 offset:47104
    v_mfma_f32_16x16x32_bf16 a[128:131], v[220:223], v[176:179], a[128:131]
    buffer_load_dwordx4 v239, s[20:23], s54 offen lds
    s_add_u32 s54, s90, 147456
    v_mfma_f32_16x16x32_bf16 a[132:135], v[220:223], v[180:183], a[132:135]
    s_add_u32 m0, s52, 106496
    ds_read_b64_tr_b16 v[216:217], v230 offset:32768
    v_accvgpr_read_b32 v192, a120
    v_mfma_f32_16x16x32_bf16 a[136:139], v[220:223], v[184:187], a[136:139]
    ds_read_b64_tr_b16 v[218:219], v230 offset:34816
    v_accvgpr_read_b32 v193, a121
    v_mfma_f32_16x16x32_bf16 a[140:143], v[220:223], v[188:191], a[140:143]
    s_waitcnt lgkmcnt(8)
    ds_read_b64_tr_b16 v[220:221], v230 offset:36864
    v_accvgpr_read_b32 v194, a122
    v_mfma_f32_16x16x32_bf16 a[144:147], a[240:243], v[0:3], a[144:147]
    buffer_load_dwordx4 v239, s[20:23], s54 offen lds
    s_add_u32 s54, s90, 184320
    v_mfma_f32_16x16x32_bf16 a[148:151], a[240:243], v[4:7], a[148:151]
    s_add_u32 m0, s52, 110592
    ds_read_b64_tr_b16 v[222:223], v230 offset:38912
    v_accvgpr_read_b32 v195, a123
    v_mfma_f32_16x16x32_bf16 a[152:155], a[240:243], v[8:11], a[152:155]
    v_cvt_pk_bf16_f32 v192, v192, v193
    v_accvgpr_read_b32 v196, a124
    v_mfma_f32_16x16x32_bf16 a[156:159], a[240:243], v[12:15], a[156:159]
    v_accvgpr_read_b32 v197, a125
    v_accvgpr_read_b32 v198, a126
    v_mfma_f32_16x16x32_bf16 a[160:163], a[240:243], v[16:19], a[160:163]
    buffer_load_dwordx4 v239, s[20:23], s54 offen lds
    s_add_u32 s54, s90, 221184
    v_mfma_f32_16x16x32_bf16 a[164:167], a[240:243], v[20:23], a[164:167]
    s_waitcnt lgkmcnt(8)
    ds_read_b64_tr_b16 a[240:241], v231 offset:8192
    v_accvgpr_read_b32 v199, a127
    v_mfma_f32_16x16x32_bf16 a[144:147], a[244:247], v[24:27], a[144:147]
    s_add_u32 m0, s52, 143360
    ds_read_b64_tr_b16 a[242:243], v231 offset:10240
    v_cvt_pk_bf16_f32 v193, v194, v195
    v_mfma_f32_16x16x32_bf16 a[148:151], a[244:247], v[28:31], a[148:151]
    v_cvt_pk_bf16_f32 v194, v196, v197
    v_cvt_pk_bf16_f32 v195, v198, v199
    v_mfma_f32_16x16x32_bf16 a[152:155], a[244:247], v[32:35], a[152:155]
    buffer_store_dwordx4 v[192:195], v237, s[24:27], s77 offen sc1
    v_mfma_f32_16x16x32_bf16 a[156:159], a[244:247], v[36:39], a[156:159]
    buffer_load_dwordx4 v239, s[20:23], s54 offen lds
    s_add_u32 s54, s90, 258048
    v_mfma_f32_16x16x32_bf16 a[160:163], a[244:247], v[40:43], a[160:163]
    s_add_u32 m0, s52, 139264
    v_accvgpr_read_b32 v200, a128
    v_accvgpr_read_b32 v201, a129
    v_mfma_f32_16x16x32_bf16 a[164:167], a[244:247], v[44:47], a[164:167]
    s_waitcnt lgkmcnt(8)
    ds_read_b64_tr_b16 a[244:245], v231 offset:12288
    v_accvgpr_read_b32 v202, a130
    v_mfma_f32_16x16x32_bf16 a[144:147], a[248:251], v[48:51], a[144:147]
    ds_read_b64_tr_b16 a[246:247], v231 offset:14336
    v_accvgpr_read_b32 v203, a131
    v_mfma_f32_16x16x32_bf16 a[148:151], a[248:251], v[52:55], a[148:151]
    buffer_load_dwordx4 v239, s[20:23], s54 offen lds
    v_mfma_f32_16x16x32_bf16 a[152:155], a[248:251], v[56:59], a[152:155]
    v_cvt_pk_bf16_f32 v200, v200, v201
    v_accvgpr_read_b32 v204, a132
    v_mfma_f32_16x16x32_bf16 a[156:159], a[248:251], v[60:63], a[156:159]
    v_accvgpr_read_b32 v205, a133
    v_accvgpr_read_b32 v206, a134
    v_mfma_f32_16x16x32_bf16 a[160:163], a[248:251], v[64:67], a[160:163]
    v_accvgpr_read_b32 v207, a135
    v_cvt_pk_bf16_f32 v201, v202, v203
    v_mfma_f32_16x16x32_bf16 a[164:167], a[248:251], v[68:71], a[164:167]
    s_waitcnt lgkmcnt(8)
    v_cvt_pk_bf16_f32 v202, v204, v205
    v_cvt_pk_bf16_f32 v203, v206, v207
    v_mfma_f32_16x16x32_bf16 a[144:147], a[252:255], v[72:75], a[144:147]
    buffer_store_dwordx4 v[200:203], v237, s[24:27], s77 offen offset:1024 sc1
    v_mfma_f32_16x16x32_bf16 a[148:151], a[252:255], v[76:79], a[148:151]
    v_accvgpr_read_b32 v208, a136
    v_accvgpr_read_b32 v209, a137
    v_mfma_f32_16x16x32_bf16 a[152:155], a[252:255], v[80:83], a[152:155]
    v_accvgpr_read_b32 v210, a138
    v_accvgpr_read_b32 v211, a139
    v_mfma_f32_16x16x32_bf16 a[156:159], a[252:255], v[84:87], a[156:159]
    v_cvt_pk_bf16_f32 v208, v208, v209
    v_accvgpr_read_b32 v212, a140
    v_mfma_f32_16x16x32_bf16 a[160:163], a[252:255], v[88:91], a[160:163]
    v_accvgpr_read_b32 v213, a141
    v_accvgpr_read_b32 v214, a142
    v_mfma_f32_16x16x32_bf16 a[164:167], a[252:255], v[92:95], a[164:167]
    s_waitcnt lgkmcnt(6)
    v_accvgpr_read_b32 v215, a143
    v_cvt_pk_bf16_f32 v209, v210, v211
    v_mfma_f32_16x16x32_bf16 a[144:147], v[216:219], v[96:99], a[144:147]
    v_cvt_pk_bf16_f32 v210, v212, v213
    v_cvt_pk_bf16_f32 v211, v214, v215
    v_mfma_f32_16x16x32_bf16 a[148:151], v[216:219], v[100:103], a[148:151]
    buffer_store_dwordx4 v[208:211], v237, s[24:27], s77 offen offset:2048 sc1
    v_mfma_f32_16x16x32_bf16 a[152:155], v[216:219], v[104:107], a[152:155]
    v_mfma_f32_16x16x32_bf16 a[156:159], v[216:219], v[108:111], a[156:159]
    v_mfma_f32_16x16x32_bf16 a[160:163], v[216:219], v[112:115], a[160:163]
    v_mfma_f32_16x16x32_bf16 a[164:167], v[216:219], v[116:119], a[164:167]
    s_waitcnt lgkmcnt(4)
    v_mfma_f32_16x16x32_bf16 a[144:147], v[220:223], v[120:123], a[144:147]
    v_mfma_f32_16x16x32_bf16 a[148:151], v[220:223], v[124:127], a[148:151]
    v_mfma_f32_16x16x32_bf16 a[152:155], v[220:223], v[128:131], a[152:155]
    v_mfma_f32_16x16x32_bf16 a[156:159], v[220:223], v[132:135], a[156:159]
    v_mfma_f32_16x16x32_bf16 a[160:163], v[220:223], v[136:139], a[160:163]
    v_mfma_f32_16x16x32_bf16 a[164:167], v[220:223], v[140:143], a[164:167]
    s_waitcnt lgkmcnt(2)
    v_mfma_f32_16x16x32_bf16 a[144:147], a[240:243], v[144:147], a[144:147]
    v_mfma_f32_16x16x32_bf16 a[148:151], a[240:243], v[148:151], a[148:151]
    v_mfma_f32_16x16x32_bf16 a[152:155], a[240:243], v[152:155], a[152:155]
    s_waitcnt vmcnt(13)
    s_barrier
    v_mfma_f32_16x16x32_bf16 a[156:159], a[240:243], v[156:159], a[156:159]
    ds_read_b64_tr_b16 a[248:249], v230
    ds_read_b64_tr_b16 a[250:251], v230 offset:2048
    v_mfma_f32_16x16x32_bf16 a[160:163], a[240:243], v[160:163], a[160:163]
    ds_read_b64_tr_b16 a[252:253], v230 offset:4096
    ds_read_b64_tr_b16 a[254:255], v230 offset:6144
    v_mfma_f32_16x16x32_bf16 a[164:167], a[240:243], v[164:167], a[164:167]
    s_waitcnt lgkmcnt(4)
    ds_read_b64_tr_b16 v[216:217], v230 offset:40960
    ds_read_b64_tr_b16 v[218:219], v230 offset:43008
    v_mfma_f32_16x16x32_bf16 a[144:147], a[244:247], v[168:171], a[144:147]
    ds_read_b64_tr_b16 v[220:221], v230 offset:45056
    ds_read_b64_tr_b16 v[222:223], v230 offset:47104
    v_mfma_f32_16x16x32_bf16 a[148:151], a[244:247], v[172:175], a[148:151]
    ds_read_b64_tr_b16 a[240:241], v230 offset:8192
    ds_read_b64_tr_b16 a[242:243], v230 offset:10240
    v_mfma_f32_16x16x32_bf16 a[152:155], a[244:247], v[176:179], a[152:155]
    v_mfma_f32_16x16x32_bf16 a[156:159], a[244:247], v[180:183], a[156:159]
    v_mfma_f32_16x16x32_bf16 a[160:163], a[244:247], v[184:187], a[160:163]
    v_accvgpr_read_b32 v192, a144
    v_accvgpr_read_b32 v193, a145
    v_mfma_f32_16x16x32_bf16 a[164:167], a[244:247], v[188:191], a[164:167]
    s_waitcnt lgkmcnt(8)
    ds_read_b64_tr_b16 a[244:245], v230 offset:12288
    v_accvgpr_read_b32 v194, a146
    v_mfma_f32_16x16x32_bf16 a[168:171], a[248:251], v[0:3], a[168:171]
    ds_read_b64_tr_b16 a[246:247], v230 offset:14336
    v_accvgpr_read_b32 v195, a147
    v_mfma_f32_16x16x32_bf16 a[172:175], a[248:251], v[4:7], a[172:175]
    v_cvt_pk_bf16_f32 v192, v192, v193
    v_accvgpr_read_b32 v196, a148
    v_mfma_f32_16x16x32_bf16 a[176:179], a[248:251], v[8:11], a[176:179]
    v_accvgpr_read_b32 v197, a149
    v_accvgpr_read_b32 v198, a150
    v_mfma_f32_16x16x32_bf16 a[180:183], a[248:251], v[12:15], a[180:183]
    v_accvgpr_read_b32 v199, a151
    v_cvt_pk_bf16_f32 v193, v194, v195
    v_mfma_f32_16x16x32_bf16 a[184:187], a[248:251], v[16:19], a[184:187]
    v_cvt_pk_bf16_f32 v194, v196, v197
    v_cvt_pk_bf16_f32 v195, v198, v199
    v_mfma_f32_16x16x32_bf16 a[188:191], a[248:251], v[20:23], a[188:191]
    s_waitcnt lgkmcnt(8)
    buffer_store_dwordx4 v[192:195], v237, s[24:27], s78 offen sc1
    v_mfma_f32_16x16x32_bf16 a[168:171], a[252:255], v[24:27], a[168:171]
    ds_read_b64_tr_b16 a[248:249], v230 offset:49152
    v_accvgpr_read_b32 v200, a152
    v_mfma_f32_16x16x32_bf16 a[172:175], a[252:255], v[28:31], a[172:175]
    ds_read_b64_tr_b16 a[250:251], v230 offset:51200
    v_accvgpr_read_b32 v201, a153
    v_mfma_f32_16x16x32_bf16 a[176:179], a[252:255], v[32:35], a[176:179]
    v_accvgpr_read_b32 v202, a154
    v_accvgpr_read_b32 v203, a155
    v_mfma_f32_16x16x32_bf16 a[180:183], a[252:255], v[36:39], a[180:183]
    v_cvt_pk_bf16_f32 v200, v200, v201
    v_accvgpr_read_b32 v204, a156
    v_mfma_f32_16x16x32_bf16 a[184:187], a[252:255], v[40:43], a[184:187]
    v_accvgpr_read_b32 v205, a157
    v_accvgpr_read_b32 v206, a158
    v_mfma_f32_16x16x32_bf16 a[188:191], a[252:255], v[44:47], a[188:191]
    s_waitcnt lgkmcnt(8)
    ds_read_b64_tr_b16 a[252:253], v230 offset:53248
    v_accvgpr_read_b32 v207, a159
    v_mfma_f32_16x16x32_bf16 a[168:171], v[216:219], v[48:51], a[168:171]
    ds_read_b64_tr_b16 a[254:255], v230 offset:55296
    v_cvt_pk_bf16_f32 v201, v202, v203
    v_mfma_f32_16x16x32_bf16 a[172:175], v[216:219], v[52:55], a[172:175]
    v_cvt_pk_bf16_f32 v202, v204, v205
    v_cvt_pk_bf16_f32 v203, v206, v207
    v_mfma_f32_16x16x32_bf16 a[176:179], v[216:219], v[56:59], a[176:179]
    buffer_store_dwordx4 v[200:203], v237, s[24:27], s78 offen offset:1024 sc1
    v_mfma_f32_16x16x32_bf16 a[180:183], v[216:219], v[60:63], a[180:183]
    v_accvgpr_read_b32 v208, a160
    v_accvgpr_read_b32 v209, a161
    v_mfma_f32_16x16x32_bf16 a[184:187], v[216:219], v[64:67], a[184:187]
    v_accvgpr_read_b32 v210, a162
    v_accvgpr_read_b32 v211, a163
    v_mfma_f32_16x16x32_bf16 a[188:191], v[216:219], v[68:71], a[188:191]
    s_waitcnt lgkmcnt(8)
    v_cvt_pk_bf16_f32 v208, v208, v209
    v_accvgpr_read_b32 v212, a164
    v_mfma_f32_16x16x32_bf16 a[168:171], v[220:223], v[72:75], a[168:171]
    v_accvgpr_read_b32 v213, a165
    v_accvgpr_read_b32 v214, a166
    v_mfma_f32_16x16x32_bf16 a[172:175], v[220:223], v[76:79], a[172:175]
    v_accvgpr_read_b32 v215, a167
    v_cvt_pk_bf16_f32 v209, v210, v211
    v_mfma_f32_16x16x32_bf16 a[176:179], v[220:223], v[80:83], a[176:179]
    v_cvt_pk_bf16_f32 v210, v212, v213
    v_cvt_pk_bf16_f32 v211, v214, v215
    v_mfma_f32_16x16x32_bf16 a[180:183], v[220:223], v[84:87], a[180:183]
    buffer_store_dwordx4 v[208:211], v237, s[24:27], s78 offen offset:2048 sc1
    v_mfma_f32_16x16x32_bf16 a[184:187], v[220:223], v[88:91], a[184:187]
    v_mfma_f32_16x16x32_bf16 a[188:191], v[220:223], v[92:95], a[188:191]
    s_waitcnt lgkmcnt(6)
    v_mfma_f32_16x16x32_bf16 a[168:171], a[240:243], v[96:99], a[168:171]
    v_mfma_f32_16x16x32_bf16 a[172:175], a[240:243], v[100:103], a[172:175]
    v_mfma_f32_16x16x32_bf16 a[176:179], a[240:243], v[104:107], a[176:179]
    v_mfma_f32_16x16x32_bf16 a[180:183], a[240:243], v[108:111], a[180:183]
    v_mfma_f32_16x16x32_bf16 a[184:187], a[240:243], v[112:115], a[184:187]
    v_mfma_f32_16x16x32_bf16 a[188:191], a[240:243], v[116:119], a[188:191]
    s_waitcnt lgkmcnt(4)
    v_mfma_f32_16x16x32_bf16 a[168:171], a[244:247], v[120:123], a[168:171]
    v_mfma_f32_16x16x32_bf16 a[172:175], a[244:247], v[124:127], a[172:175]
    v_mfma_f32_16x16x32_bf16 a[176:179], a[244:247], v[128:131], a[176:179]
    v_mfma_f32_16x16x32_bf16 a[180:183], a[244:247], v[132:135], a[180:183]
    v_mfma_f32_16x16x32_bf16 a[184:187], a[244:247], v[136:139], a[184:187]
    v_mfma_f32_16x16x32_bf16 a[188:191], a[244:247], v[140:143], a[188:191]
    s_waitcnt lgkmcnt(2)
    v_mfma_f32_16x16x32_bf16 a[168:171], a[248:251], v[144:147], a[168:171]
    v_mfma_f32_16x16x32_bf16 a[172:175], a[248:251], v[148:151], a[172:175]
    v_mfma_f32_16x16x32_bf16 a[176:179], a[248:251], v[152:155], a[176:179]
    s_waitcnt vmcnt(5)
    s_barrier
    v_mfma_f32_16x16x32_bf16 a[180:183], a[248:251], v[156:159], a[180:183]
    ds_read_b64_tr_b16 v[216:217], v231 offset:16384
    ds_read_b64_tr_b16 v[218:219], v231 offset:18432
    v_mfma_f32_16x16x32_bf16 a[184:187], a[248:251], v[160:163], a[184:187]
    ds_read_b64_tr_b16 v[220:221], v231 offset:20480
    ds_read_b64_tr_b16 v[222:223], v231 offset:22528
    v_mfma_f32_16x16x32_bf16 a[188:191], a[248:251], v[164:167], a[188:191]
    s_waitcnt lgkmcnt(4)
    ds_read_b64_tr_b16 a[240:241], v230 offset:16384
    ds_read_b64_tr_b16 a[242:243], v230 offset:18432
    v_mfma_f32_16x16x32_bf16 a[168:171], a[252:255], v[168:171], a[168:171]
    ds_read_b64_tr_b16 a[244:245], v230 offset:20480
    ds_read_b64_tr_b16 a[246:247], v230 offset:22528
    v_mfma_f32_16x16x32_bf16 a[172:175], a[252:255], v[172:175], a[172:175]
    ds_read_b64_tr_b16 a[248:249], v230 offset:57344
    ds_read_b64_tr_b16 a[250:251], v230 offset:59392
    v_mfma_f32_16x16x32_bf16 a[176:179], a[252:255], v[176:179], a[176:179]
    v_mfma_f32_16x16x32_bf16 a[180:183], a[252:255], v[180:183], a[180:183]
    v_mfma_f32_16x16x32_bf16 a[184:187], a[252:255], v[184:187], a[184:187]
    v_mfma_f32_16x16x32_bf16 a[188:191], a[252:255], v[188:191], a[188:191]
    s_waitcnt lgkmcnt(8)
    ds_read_b64_tr_b16 a[252:253], v230 offset:61440
    ds_read_b64_tr_b16 a[254:255], v230 offset:63488
    v_mfma_f32_16x16x32_bf16 a[192:195], v[216:219], v[0:3], a[192:195]
    v_mfma_f32_16x16x32_bf16 a[196:199], v[216:219], v[4:7], a[196:199]
    v_mfma_f32_16x16x32_bf16 a[200:203], v[216:219], v[8:11], a[200:203]
    v_mfma_f32_16x16x32_bf16 a[204:207], v[216:219], v[12:15], a[204:207]
    v_mfma_f32_16x16x32_bf16 a[208:211], v[216:219], v[16:19], a[208:211]
    v_mfma_f32_16x16x32_bf16 a[212:215], v[216:219], v[20:23], a[212:215]
    s_waitcnt lgkmcnt(8)
    ds_read_b64_tr_b16 v[216:217], v231 offset:28672
    ds_read_b64_tr_b16 v[218:219], v231 offset:30720
    v_mfma_f32_16x16x32_bf16 a[192:195], v[220:223], v[24:27], a[192:195]
    v_mfma_f32_16x16x32_bf16 a[196:199], v[220:223], v[28:31], a[196:199]
    v_mfma_f32_16x16x32_bf16 a[200:203], v[220:223], v[32:35], a[200:203]
    v_mfma_f32_16x16x32_bf16 a[204:207], v[220:223], v[36:39], a[204:207]
    v_mfma_f32_16x16x32_bf16 a[208:211], v[220:223], v[40:43], a[208:211]
    v_mfma_f32_16x16x32_bf16 a[212:215], v[220:223], v[44:47], a[212:215]
    s_waitcnt lgkmcnt(8)
    ds_read_b64_tr_b16 v[220:221], v231 offset:24576
    ds_read_b64_tr_b16 v[222:223], v231 offset:26624
    v_mfma_f32_16x16x32_bf16 a[192:195], a[240:243], v[48:51], a[192:195]
    v_mfma_f32_16x16x32_bf16 a[196:199], a[240:243], v[52:55], a[196:199]
    v_mfma_f32_16x16x32_bf16 a[200:203], a[240:243], v[56:59], a[200:203]
    s_waitcnt vmcnt(0)
    s_barrier
    v_mfma_f32_16x16x32_bf16 a[204:207], a[240:243], v[60:63], a[204:207]
    s_cmp_lg_u32 s65, 0
    s_cbranch_scc1 L_nosig
    s_mov_b64 exec, 1
    s_nop 0
    buffer_store_dword v234, v233, s[24:27], s97 offen sc1
    s_mov_b64 exec, -1
L_nosig:
    v_mfma_f32_16x16x32_bf16 a[208:211], a[240:243], v[64:67], a[208:211]
    v_mfma_f32_16x16x32_bf16 a[212:215], a[240:243], v[68:71], a[212:215]
    s_waitcnt lgkmcnt(8)
    v_mfma_f32_16x16x32_bf16 a[192:195], a[244:247], v[72:75], a[192:195]
    v_mfma_f32_16x16x32_bf16 a[196:199], a[244:247], v[76:79], a[196:199]
    v_mfma_f32_16x16x32_bf16 a[200:203], a[244:247], v[80:83], a[200:203]
    v_mfma_f32_16x16x32_bf16 a[204:207], a[244:247], v[84:87], a[204:207]
    v_mfma_f32_16x16x32_bf16 a[208:211], a[244:247], v[88:91], a[208:211]
    v_mfma_f32_16x16x32_bf16 a[212:215], a[244:247], v[92:95], a[212:215]
    s_waitcnt lgkmcnt(6)
    v_mfma_f32_16x16x32_bf16 a[192:195], a[248:251], v[96:99], a[192:195]
    v_mfma_f32_16x16x32_bf16 a[196:199], a[248:251], v[100:103], a[196:199]
    v_mfma_f32_16x16x32_bf16 a[200:203], a[248:251], v[104:107], a[200:203]
    v_mfma_f32_16x16x32_bf16 a[204:207], a[248:251], v[108:111], a[204:207]
    v_mfma_f32_16x16x32_bf16 a[208:211], a[248:251], v[112:115], a[208:211]
    v_mfma_f32_16x16x32_bf16 a[212:215], a[248:251], v[116:119], a[212:215]
    s_waitcnt lgkmcnt(4)
    v_mfma_f32_16x16x32_bf16 a[192:195], a[252:255], v[120:123], a[192:195]
    v_mfma_f32_16x16x32_bf16 a[196:199], a[252:255], v[124:127], a[196:199]
    v_mfma_f32_16x16x32_bf16 a[200:203], a[252:255], v[128:131], a[200:203]
    v_mfma_f32_16x16x32_bf16 a[204:207], a[252:255], v[132:135], a[204:207]
    v_mfma_f32_16x16x32_bf16 a[208:211], a[252:255], v[136:139], a[208:211]
    v_mfma_f32_16x16x32_bf16 a[212:215], a[252:255], v[140:143], a[212:215]
    s_waitcnt lgkmcnt(2)
    v_mfma_f32_16x16x32_bf16 a[192:195], v[216:219], v[144:147], a[192:195]
    v_mfma_f32_16x16x32_bf16 a[196:199], v[216:219], v[148:151], a[196:199]
    v_mfma_f32_16x16x32_bf16 a[200:203], v[216:219], v[152:155], a[200:203]
    v_mfma_f32_16x16x32_bf16 a[204:207], v[216:219], v[156:159], a[204:207]
    v_mfma_f32_16x16x32_bf16 a[208:211], v[216:219], v[160:163], a[208:211]
    v_mfma_f32_16x16x32_bf16 a[212:215], v[216:219], v[164:167], a[212:215]
    s_waitcnt lgkmcnt(0)
    v_mfma_f32_16x16x32_bf16 a[192:195], v[220:223], v[168:171], a[192:195]
    v_mfma_f32_16x16x32_bf16 a[196:199], v[220:223], v[172:175], a[196:199]
    v_mfma_f32_16x16x32_bf16 a[200:203], v[220:223], v[176:179], a[200:203]
    v_mfma_f32_16x16x32_bf16 a[204:207], v[220:223], v[180:183], a[204:207]
    v_mfma_f32_16x16x32_bf16 a[208:211], v[220:223], v[184:187], a[208:211]
    v_mfma_f32_16x16x32_bf16 a[212:215], v[220:223], v[188:191], a[212:215]
    s_mov_b32 s54, 0
    s_and_b32 s55, s55, 3
    s_lshl_b32 s55, s55, 3
    buffer_load_dwordx4 v[8:11], v235, s[24:27], s97 offen sc1
    s_add_u32 s36, s66, 1
    s_and_b32 s36, s36, 3
    s_sub_u32 s36, s36, s66
    s_mul_i32 s36, s36, 12288
    s_add_u32 s37, s66, 2
    s_and_b32 s37, s37, 3
    s_sub_u32 s37, s37, s66
    s_mul_i32 s37, s37, 12288
    s_add_u32 s38, s66, 3
    s_and_b32 s38, s38, 3
    s_sub_u32 s38, s38, s66
    s_mul_i32 s38, s38, 12288
    v_lshrrev_b32 v249, 4, v237
    v_lshrrev_b32 v250, 4, v249
    v_and_b32 v249, 15, v249
    v_mul_u32_u24 v249, 2304, v249
    v_lshl_add_u32 v249, v250, 3, v249
    s_lshl_b32 s3, s65, 5
    s_add_u32 s71, s71, s3
    s_cmp_eq_u32 s66, 0
    s_cselect_b32 s3, 1, 0
    v_mov_b32 v180, s3
    s_cmp_eq_u32 s66, 1
    s_cselect_b32 s3, 1, 0
    v_mov_b32 v181, s3
    s_cmp_eq_u32 s66, 2
    s_cselect_b32 s3, 1, 0
    v_mov_b32 v182, s3
    s_cmp_eq_u32 s66, 3
    s_cselect_b32 s3, 1, 0
    v_mov_b32 v183, s3
    v_accvgpr_read_b32 v108, a168
    v_accvgpr_read_b32 v109, a169
    v_accvgpr_read_b32 v110, a170
    v_accvgpr_read_b32 v111, a171
    v_accvgpr_read_b32 v112, a172
    v_accvgpr_read_b32 v113, a173
    v_accvgpr_read_b32 v114, a174
    v_accvgpr_read_b32 v115, a175
    v_accvgpr_read_b32 v116, a176
    v_accvgpr_read_b32 v117, a177
    v_accvgpr_read_b32 v118, a178
    v_accvgpr_read_b32 v119, a179
    v_accvgpr_read_b32 v120, a180
    v_accvgpr_read_b32 v121, a181
    v_accvgpr_read_b32 v122, a182
    v_accvgpr_read_b32 v123, a183
    v_accvgpr_read_b32 v124, a184
    v_accvgpr_read_b32 v125, a185
    v_accvgpr_read_b32 v126, a186
    v_accvgpr_read_b32 v127, a187
    v_accvgpr_read_b32 v128, a188
    v_accvgpr_read_b32 v129, a189
    v_accvgpr_read_b32 v130, a190
    v_accvgpr_read_b32 v131, a191
    v_accvgpr_read_b32 v132, a192
    v_accvgpr_read_b32 v133, a193
    v_accvgpr_read_b32 v134, a194
    v_accvgpr_read_b32 v135, a195
    v_accvgpr_read_b32 v136, a196
    v_accvgpr_read_b32 v137, a197
    v_accvgpr_read_b32 v138, a198
    v_accvgpr_read_b32 v139, a199
    v_accvgpr_read_b32 v140, a200
    v_accvgpr_read_b32 v141, a201
    v_accvgpr_read_b32 v142, a202
    v_accvgpr_read_b32 v143, a203
    v_accvgpr_read_b32 v144, a204
    v_accvgpr_read_b32 v145, a205
    v_accvgpr_read_b32 v146, a206
    v_accvgpr_read_b32 v147, a207
    v_accvgpr_read_b32 v148, a208
    v_accvgpr_read_b32 v149, a209
    v_accvgpr_read_b32 v150, a210
    v_accvgpr_read_b32 v151, a211
    v_accvgpr_read_b32 v152, a212
    v_accvgpr_read_b32 v153, a213
    v_accvgpr_read_b32 v154, a214
    v_accvgpr_read_b32 v155, a215
    v_accvgpr_read_b32 v156, a144
    v_accvgpr_read_b32 v157, a145
    v_accvgpr_read_b32 v158, a146
    v_accvgpr_read_b32 v159, a147
    v_accvgpr_read_b32 v160, a148
    v_accvgpr_read_b32 v161, a149
    v_accvgpr_read_b32 v162, a150
    v_accvgpr_read_b32 v163, a151
    v_accvgpr_read_b32 v164, a152
    v_accvgpr_read_b32 v165, a153
    v_accvgpr_read_b32 v166, a154
    v_accvgpr_read_b32 v167, a155
    v_accvgpr_read_b32 v168, a156
    v_accvgpr_read_b32 v169, a157
    v_accvgpr_read_b32 v170, a158
    v_accvgpr_read_b32 v171, a159
    v_accvgpr_read_b32 v172, a160
    v_accvgpr_read_b32 v173, a161
    v_accvgpr_read_b32 v174, a162
    v_accvgpr_read_b32 v175, a163
    v_accvgpr_read_b32 v176, a164
    v_accvgpr_read_b32 v177, a165
    v_accvgpr_read_b32 v178, a166
    v_accvgpr_read_b32 v179, a167
    s_cmp_lg_u32 s65, 0
    s_cbranch_scc1 L_polled
L_pinit:
    v_readfirstlane_b32 s3, v252
    s_add_u32 s54, s54, 1
    s_cmp_ge_u32 s54, 0x80000
    s_cbranch_scc1 L_polled
    s_nop 0
    s_lshr_b32 s3, s3, s55
    s_and_b32 s3, s3, 0xff
    s_cmp_ge_u32 s3, 4
    s_cbranch_scc1 L_pchk
    s_waitcnt vmcnt(0)
    v_mov_b32 v8, 0
    v_mov_b32 v9, 0
    v_mov_b32 v10, 0
    v_mov_b32 v11, 0
    buffer_load_dword v252, v232, s[32:35], 0 offen sc1
    s_sleep 16
    s_waitcnt vmcnt(0)
    s_branch L_pinit
L_poll:
    s_sleep 2
    buffer_load_dwordx4 v[8:11], v235, s[24:27], s97 offen sc1
    s_add_u32 s54, s54, 1
L_pchk:
    s_waitcnt vmcnt(0)
    v_or_b32 v8, v8, v180
    v_or_b32 v9, v9, v181
    v_or_b32 v10, v10, v182
    v_or_b32 v11, v11, v183
    v_and_b32 v8, v8, v9
    v_and_b32 v10, v10, v11
    v_and_b32 v8, v8, v10
    s_cmp_ge_u32 s54, 0x80000
    v_readfirstlane_b32 s3, v8
    s_cbranch_scc1 L_polled
    s_nop 2
    s_cmp_lg_u32 s3, 1
    s_cbranch_scc1 L_poll
L_polled:
    s_waitcnt vmcnt(0)
    s_barrier
    s_add_u32 s81, s36, s79
    buffer_load_dwordx4 v[0:3], v237, s[24:27], s81 offen sc1
    s_add_u32 s81, s37, s79
    buffer_load_dwordx4 v[4:7], v237, s[24:27], s81 offen sc1
    s_add_u32 s81, s38, s79
    buffer_load_dwordx4 v[8:11], v237, s[24:27], s81 offen sc1
    s_add_u32 s81, s36, s79
    buffer_load_dwordx4 v[12:15], v237, s[24:27], s81 offen offset:1024 sc1
    s_add_u32 s81, s37, s79
    buffer_load_dwordx4 v[16:19], v237, s[24:27], s81 offen offset:1024 sc1
    s_add_u32 s81, s38, s79
    buffer_load_dwordx4 v[20:23], v237, s[24:27], s81 offen offset:1024 sc1
    s_add_u32 s81, s36, s79
    buffer_load_dwordx4 v[24:27], v237, s[24:27], s81 offen offset:2048 sc1
    s_add_u32 s81, s37, s79
    buffer_load_dwordx4 v[28:31], v237, s[24:27], s81 offen offset:2048 sc1
    s_add_u32 s81, s38, s79
    buffer_load_dwordx4 v[32:35], v237, s[24:27], s81 offen offset:2048 sc1
    s_add_u32 s81, s36, s80
    buffer_load_dwordx4 v[36:39], v237, s[24:27], s81 offen sc1
    s_add_u32 s81, s37, s80
    buffer_load_dwordx4 v[40:43], v237, s[24:27], s81 offen sc1
    s_add_u32 s81, s38, s80
    buffer_load_dwordx4 v[44:47], v237, s[24:27], s81 offen sc1
    s_add_u32 s81, s36, s80
    buffer_load_dwordx4 v[48:51], v237, s[24:27], s81 offen offset:1024 sc1
    s_add_u32 s81, s37, s80
    buffer_load_dwordx4 v[52:55], v237, s[24:27], s81 offen offset:1024 sc1
    s_add_u32 s81, s38, s80
    buffer_load_dwordx4 v[56:59], v237, s[24:27], s81 offen offset:1024 sc1
    s_add_u32 s81, s36, s80
    buffer_load_dwordx4 v[60:63], v237, s[24:27], s81 offen offset:2048 sc1
    s_add_u32 s81, s37, s80
    buffer_load_dwordx4 v[64:67], v237, s[24:27], s81 offen offset:2048 sc1
    s_add_u32 s81, s38, s80
    buffer_load_dwordx4 v[68:71], v237, s[24:27], s81 offen offset:2048 sc1
    s_cmp_lg_u32 s66, 0
    s_cbranch_scc1 L_no6
    s_add_u32 s81, s36, s78
    buffer_load_dwordx4 v[72:75], v237, s[24:27], s81 offen sc1
    s_add_u32 s81, s37, s78
    buffer_load_dwordx4 v[76:79], v237, s[24:27], s81 offen sc1
    s_add_u32 s81, s38, s78
    buffer_load_dwordx4 v[80:83], v237, s[24:27], s81 offen sc1
    s_add_u32 s81, s36, s78
    buffer_load_dwordx4 v[84:87], v237, s[24:27], s81 offen offset:1024 sc1
    s_add_u32 s81, s37, s78
    buffer_load_dwordx4 v[88:91], v237, s[24:27], s81 offen offset:1024 sc1
    s_add_u32 s81, s38, s78
    buffer_load_dwordx4 v[92:95], v237, s[24:27], s81 offen offset:1024 sc1
    s_add_u32 s81, s36, s78
    buffer_load_dwordx4 v[96:99], v237, s[24:27], s81 offen offset:2048 sc1
    s_add_u32 s81, s37, s78
    buffer_load_dwordx4 v[100:103], v237, s[24:27], s81 offen offset:2048 sc1
    s_add_u32 s81, s38, s78
    buffer_load_dwordx4 v[104:107], v237, s[24:27], s81 offen offset:2048 sc1
    s_add_u32 s81, s71, s42
    s_waitcnt vmcnt(24)
    v_lshlrev_b32 v184, 16, v0
    v_and_b32 v185, 0xffff0000, v0
    v_pk_add_f32 v[108:109], v[108:109], v[184:185]
    v_lshlrev_b32 v186, 16, v1
    v_and_b32 v187, 0xffff0000, v1
    v_pk_add_f32 v[110:111], v[110:111], v[186:187]
    v_lshlrev_b32 v188, 16, v2
    v_and_b32 v189, 0xffff0000, v2
    v_pk_add_f32 v[112:113], v[112:113], v[188:189]
    v_lshlrev_b32 v190, 16, v3
    v_and_b32 v191, 0xffff0000, v3
    v_pk_add_f32 v[114:115], v[114:115], v[190:191]
    v_lshlrev_b32 v184, 16, v4
    v_and_b32 v185, 0xffff0000, v4
    v_pk_add_f32 v[108:109], v[108:109], v[184:185]
    v_lshlrev_b32 v186, 16, v5
    v_and_b32 v187, 0xffff0000, v5
    v_pk_add_f32 v[110:111], v[110:111], v[186:187]
    v_lshlrev_b32 v188, 16, v6
    v_and_b32 v189, 0xffff0000, v6
    v_pk_add_f32 v[112:113], v[112:113], v[188:189]
    v_lshlrev_b32 v190, 16, v7
    v_and_b32 v191, 0xffff0000, v7
    v_pk_add_f32 v[114:115], v[114:115], v[190:191]
    v_lshlrev_b32 v184, 16, v8
    v_and_b32 v185, 0xffff0000, v8
    v_pk_add_f32 v[108:109], v[108:109], v[184:185]
    v_lshlrev_b32 v186, 16, v9
    v_and_b32 v187, 0xffff0000, v9
    v_pk_add_f32 v[110:111], v[110:111], v[186:187]
    v_lshlrev_b32 v188, 16, v10
    v_and_b32 v189, 0xffff0000, v10
    v_pk_add_f32 v[112:113], v[112:113], v[188:189]
    v_lshlrev_b32 v190, 16, v11
    v_and_b32 v191, 0xffff0000, v11
    v_pk_add_f32 v[114:115], v[114:115], v[190:191]
    v_cvt_pk_bf16_f32 v108, v108, v109
    v_cvt_pk_bf16_f32 v109, v110, v111
    v_cvt_pk_bf16_f32 v110, v112, v113
    v_cvt_pk_bf16_f32 v111, v114, v115
    buffer_store_dwordx2 v[108:109], v249, s[28:31], s81 offen
    s_add_u32 s81, s81, 36864
    buffer_store_dwordx2 v[110:111], v249, s[28:31], s81 offen
    s_add_u32 s81, s81, 36864
    s_waitcnt vmcnt(23)
    v_lshlrev_b32 v184, 16, v12
    v_and_b32 v185, 0xffff0000, v12
    v_pk_add_f32 v[116:117], v[116:117], v[184:185]
    v_lshlrev_b32 v186, 16, v13
    v_and_b32 v187, 0xffff0000, v13
    v_pk_add_f32 v[118:119], v[118:119], v[186:187]
    v_lshlrev_b32 v188, 16, v14
    v_and_b32 v189, 0xffff0000, v14
    v_pk_add_f32 v[120:121], v[120:121], v[188:189]
    v_lshlrev_b32 v190, 16, v15
    v_and_b32 v191, 0xffff0000, v15
    v_pk_add_f32 v[122:123], v[122:123], v[190:191]
    v_lshlrev_b32 v184, 16, v16
    v_and_b32 v185, 0xffff0000, v16
    v_pk_add_f32 v[116:117], v[116:117], v[184:185]
    v_lshlrev_b32 v186, 16, v17
    v_and_b32 v187, 0xffff0000, v17
    v_pk_add_f32 v[118:119], v[118:119], v[186:187]
    v_lshlrev_b32 v188, 16, v18
    v_and_b32 v189, 0xffff0000, v18
    v_pk_add_f32 v[120:121], v[120:121], v[188:189]
    v_lshlrev_b32 v190, 16, v19
    v_and_b32 v191, 0xffff0000, v19
    v_pk_add_f32 v[122:123], v[122:123], v[190:191]
    v_lshlrev_b32 v184, 16, v20
    v_and_b32 v185, 0xffff0000, v20
    v_pk_add_f32 v[116:117], v[116:117], v[184:185]
    v_lshlrev_b32 v186, 16, v21
    v_and_b32 v187, 0xffff0000, v21
    v_pk_add_f32 v[118:119], v[118:119], v[186:187]
    v_lshlrev_b32 v188, 16, v22
    v_and_b32 v189, 0xffff0000, v22
    v_pk_add_f32 v[120:121], v[120:121], v[188:189]
    v_lshlrev_b32 v190, 16, v23
    v_and_b32 v191, 0xffff0000, v23
    v_pk_add_f32 v[122:123], v[122:123], v[190:191]
    v_cvt_pk_bf16_f32 v116, v116, v117
    v_cvt_pk_bf16_f32 v117, v118, v119
    v_cvt_pk_bf16_f32 v118, v120, v121
    v_cvt_pk_bf16_f32 v119, v122, v123
    buffer_store_dwordx2 v[116:117], v249, s[28:31], s81 offen
    s_add_u32 s81, s81, 36864
    buffer_store_dwordx2 v[118:119], v249, s[28:31], s81 offen
    s_add_u32 s81, s81, 36864
    s_waitcnt vmcnt(22)
    v_lshlrev_b32 v184, 16, v24
    v_and_b32 v185, 0xffff0000, v24
    v_pk_add_f32 v[124:125], v[124:125], v[184:185]
    v_lshlrev_b32 v186, 16, v25
    v_and_b32 v187, 0xffff0000, v25
    v_pk_add_f32 v[126:127], v[126:127], v[186:187]
    v_lshlrev_b32 v188, 16, v26
    v_and_b32 v189, 0xffff0000, v26
    v_pk_add_f32 v[128:129], v[128:129], v[188:189]
    v_lshlrev_b32 v190, 16, v27
    v_and_b32 v191, 0xffff0000, v27
    v_pk_add_f32 v[130:131], v[130:131], v[190:191]
    v_lshlrev_b32 v184, 16, v28
    v_and_b32 v185, 0xffff0000, v28
    v_pk_add_f32 v[124:125], v[124:125], v[184:185]
    v_lshlrev_b32 v186, 16, v29
    v_and_b32 v187, 0xffff0000, v29
    v_pk_add_f32 v[126:127], v[126:127], v[186:187]
    v_lshlrev_b32 v188, 16, v30
    v_and_b32 v189, 0xffff0000, v30
    v_pk_add_f32 v[128:129], v[128:129], v[188:189]
    v_lshlrev_b32 v190, 16, v31
    v_and_b32 v191, 0xffff0000, v31
    v_pk_add_f32 v[130:131], v[130:131], v[190:191]
    v_lshlrev_b32 v184, 16, v32
    v_and_b32 v185, 0xffff0000, v32
    v_pk_add_f32 v[124:125], v[124:125], v[184:185]
    v_lshlrev_b32 v186, 16, v33
    v_and_b32 v187, 0xffff0000, v33
    v_pk_add_f32 v[126:127], v[126:127], v[186:187]
    v_lshlrev_b32 v188, 16, v34
    v_and_b32 v189, 0xffff0000, v34
    v_pk_add_f32 v[128:129], v[128:129], v[188:189]
    v_lshlrev_b32 v190, 16, v35
    v_and_b32 v191, 0xffff0000, v35
    v_pk_add_f32 v[130:131], v[130:131], v[190:191]
    v_cvt_pk_bf16_f32 v124, v124, v125
    v_cvt_pk_bf16_f32 v125, v126, v127
    v_cvt_pk_bf16_f32 v126, v128, v129
    v_cvt_pk_bf16_f32 v127, v130, v131
    buffer_store_dwordx2 v[124:125], v249, s[28:31], s81 offen
    s_add_u32 s81, s81, 36864
    buffer_store_dwordx2 v[126:127], v249, s[28:31], s81 offen
    s_add_u32 s81, s81, 36864
    s_add_u32 s81, s71, s43
    s_waitcnt vmcnt(21)
    v_lshlrev_b32 v184, 16, v36
    v_and_b32 v185, 0xffff0000, v36
    v_pk_add_f32 v[132:133], v[132:133], v[184:185]
    v_lshlrev_b32 v186, 16, v37
    v_and_b32 v187, 0xffff0000, v37
    v_pk_add_f32 v[134:135], v[134:135], v[186:187]
    v_lshlrev_b32 v188, 16, v38
    v_and_b32 v189, 0xffff0000, v38
    v_pk_add_f32 v[136:137], v[136:137], v[188:189]
    v_lshlrev_b32 v190, 16, v39
    v_and_b32 v191, 0xffff0000, v39
    v_pk_add_f32 v[138:139], v[138:139], v[190:191]
    v_lshlrev_b32 v184, 16, v40
    v_and_b32 v185, 0xffff0000, v40
    v_pk_add_f32 v[132:133], v[132:133], v[184:185]
    v_lshlrev_b32 v186, 16, v41
    v_and_b32 v187, 0xffff0000, v41
    v_pk_add_f32 v[134:135], v[134:135], v[186:187]
    v_lshlrev_b32 v188, 16, v42
    v_and_b32 v189, 0xffff0000, v42
    v_pk_add_f32 v[136:137], v[136:137], v[188:189]
    v_lshlrev_b32 v190, 16, v43
    v_and_b32 v191, 0xffff0000, v43
    v_pk_add_f32 v[138:139], v[138:139], v[190:191]
    v_lshlrev_b32 v184, 16, v44
    v_and_b32 v185, 0xffff0000, v44
    v_pk_add_f32 v[132:133], v[132:133], v[184:185]
    v_lshlrev_b32 v186, 16, v45
    v_and_b32 v187, 0xffff0000, v45
    v_pk_add_f32 v[134:135], v[134:135], v[186:187]
    v_lshlrev_b32 v188, 16, v46
    v_and_b32 v189, 0xffff0000, v46
    v_pk_add_f32 v[136:137], v[136:137], v[188:189]
    v_lshlrev_b32 v190, 16, v47
    v_and_b32 v191, 0xffff0000, v47
    v_pk_add_f32 v[138:139], v[138:139], v[190:191]
    v_cvt_pk_bf16_f32 v132, v132, v133
    v_cvt_pk_bf16_f32 v133, v134, v135
    v_cvt_pk_bf16_f32 v134, v136, v137
    v_cvt_pk_bf16_f32 v135, v138, v139
    buffer_store_dwordx2 v[132:133], v249, s[28:31], s81 offen
    s_add_u32 s81, s81, 36864
    buffer_store_dwordx2 v[134:135], v249, s[28:31], s81 offen
    s_add_u32 s81, s81, 36864
    s_waitcnt vmcnt(20)
    v_lshlrev_b32 v184, 16, v48
    v_and_b32 v185, 0xffff0000, v48
    v_pk_add_f32 v[140:141], v[140:141], v[184:185]
    v_lshlrev_b32 v186, 16, v49
    v_and_b32 v187, 0xffff0000, v49
    v_pk_add_f32 v[142:143], v[142:143], v[186:187]
    v_lshlrev_b32 v188, 16, v50
    v_and_b32 v189, 0xffff0000, v50
    v_pk_add_f32 v[144:145], v[144:145], v[188:189]
    v_lshlrev_b32 v190, 16, v51
    v_and_b32 v191, 0xffff0000, v51
    v_pk_add_f32 v[146:147], v[146:147], v[190:191]
    v_lshlrev_b32 v184, 16, v52
    v_and_b32 v185, 0xffff0000, v52
    v_pk_add_f32 v[140:141], v[140:141], v[184:185]
    v_lshlrev_b32 v186, 16, v53
    v_and_b32 v187, 0xffff0000, v53
    v_pk_add_f32 v[142:143], v[142:143], v[186:187]
    v_lshlrev_b32 v188, 16, v54
    v_and_b32 v189, 0xffff0000, v54
    v_pk_add_f32 v[144:145], v[144:145], v[188:189]
    v_lshlrev_b32 v190, 16, v55
    v_and_b32 v191, 0xffff0000, v55
    v_pk_add_f32 v[146:147], v[146:147], v[190:191]
    v_lshlrev_b32 v184, 16, v56
    v_and_b32 v185, 0xffff0000, v56
    v_pk_add_f32 v[140:141], v[140:141], v[184:185]
    v_lshlrev_b32 v186, 16, v57
    v_and_b32 v187, 0xffff0000, v57
    v_pk_add_f32 v[142:143], v[142:143], v[186:187]
    v_lshlrev_b32 v188, 16, v58
    v_and_b32 v189, 0xffff0000, v58
    v_pk_add_f32 v[144:145], v[144:145], v[188:189]
    v_lshlrev_b32 v190, 16, v59
    v_and_b32 v191, 0xffff0000, v59
    v_pk_add_f32 v[146:147], v[146:147], v[190:191]
    v_cvt_pk_bf16_f32 v140, v140, v141
    v_cvt_pk_bf16_f32 v141, v142, v143
    v_cvt_pk_bf16_f32 v142, v144, v145
    v_cvt_pk_bf16_f32 v143, v146, v147
    buffer_store_dwordx2 v[140:141], v249, s[28:31], s81 offen
    s_add_u32 s81, s81, 36864
    buffer_store_dwordx2 v[142:143], v249, s[28:31], s81 offen
    s_add_u32 s81, s81, 36864
    s_waitcnt vmcnt(19)
    v_lshlrev_b32 v184, 16, v60
    v_and_b32 v185, 0xffff0000, v60
    v_pk_add_f32 v[148:149], v[148:149], v[184:185]
    v_lshlrev_b32 v186, 16, v61
    v_and_b32 v187, 0xffff0000, v61
    v_pk_add_f32 v[150:151], v[150:151], v[186:187]
    v_lshlrev_b32 v188, 16, v62
    v_and_b32 v189, 0xffff0000, v62
    v_pk_add_f32 v[152:153], v[152:153], v[188:189]
    v_lshlrev_b32 v190, 16, v63
    v_and_b32 v191, 0xffff0000, v63
    v_pk_add_f32 v[154:155], v[154:155], v[190:191]
    v_lshlrev_b32 v184, 16, v64
    v_and_b32 v185, 0xffff0000, v64
    v_pk_add_f32 v[148:149], v[148:149], v[184:185]
    v_lshlrev_b32 v186, 16, v65
    v_and_b32 v187, 0xffff0000, v65
    v_pk_add_f32 v[150:151], v[150:151], v[186:187]
    v_lshlrev_b32 v188, 16, v66
    v_and_b32 v189, 0xffff0000, v66
    v_pk_add_f32 v[152:153], v[152:153], v[188:189]
    v_lshlrev_b32 v190, 16, v67
    v_and_b32 v191, 0xffff0000, v67
    v_pk_add_f32 v[154:155], v[154:155], v[190:191]
    v_lshlrev_b32 v184, 16, v68
    v_and_b32 v185, 0xffff0000, v68
    v_pk_add_f32 v[148:149], v[148:149], v[184:185]
    v_lshlrev_b32 v186, 16, v69
    v_and_b32 v187, 0xffff0000, v69
    v_pk_add_f32 v[150:151], v[150:151], v[186:187]
    v_lshlrev_b32 v188, 16, v70
    v_and_b32 v189, 0xffff0000, v70
    v_pk_add_f32 v[152:153], v[152:153], v[188:189]
    v_lshlrev_b32 v190, 16, v71
    v_and_b32 v191, 0xffff0000, v71
    v_pk_add_f32 v[154:155], v[154:155], v[190:191]
    v_cvt_pk_bf16_f32 v148, v148, v149
    v_cvt_pk_bf16_f32 v149, v150, v151
    v_cvt_pk_bf16_f32 v150, v152, v153
    v_cvt_pk_bf16_f32 v151, v154, v155
    buffer_store_dwordx2 v[148:149], v249, s[28:31], s81 offen
    s_add_u32 s81, s81, 36864
    buffer_store_dwordx2 v[150:151], v249, s[28:31], s81 offen
    s_add_u32 s81, s81, 36864
    s_add_u32 s81, s71, s41
    s_waitcnt vmcnt(18)
    v_lshlrev_b32 v184, 16, v72
    v_and_b32 v185, 0xffff0000, v72
    v_pk_add_f32 v[156:157], v[156:157], v[184:185]
    v_lshlrev_b32 v186, 16, v73
    v_and_b32 v187, 0xffff0000, v73
    v_pk_add_f32 v[158:159], v[158:159], v[186:187]
    v_lshlrev_b32 v188, 16, v74
    v_and_b32 v189, 0xffff0000, v74
    v_pk_add_f32 v[160:161], v[160:161], v[188:189]
    v_lshlrev_b32 v190, 16, v75
    v_and_b32 v191, 0xffff0000, v75
    v_pk_add_f32 v[162:163], v[162:163], v[190:191]
    v_lshlrev_b32 v184, 16, v76
    v_and_b32 v185, 0xffff0000, v76
    v_pk_add_f32 v[156:157], v[156:157], v[184:185]
    v_lshlrev_b32 v186, 16, v77
    v_and_b32 v187, 0xffff0000, v77
    v_pk_add_f32 v[158:159], v[158:159], v[186:187]
    v_lshlrev_b32 v188, 16, v78
    v_and_b32 v189, 0xffff0000, v78
    v_pk_add_f32 v[160:161], v[160:161], v[188:189]
    v_lshlrev_b32 v190, 16, v79
    v_and_b32 v191, 0xffff0000, v79
    v_pk_add_f32 v[162:163], v[162:163], v[190:191]
    v_lshlrev_b32 v184, 16, v80
    v_and_b32 v185, 0xffff0000, v80
    v_pk_add_f32 v[156:157], v[156:157], v[184:185]
    v_lshlrev_b32 v186, 16, v81
    v_and_b32 v187, 0xffff0000, v81
    v_pk_add_f32 v[158:159], v[158:159], v[186:187]
    v_lshlrev_b32 v188, 16, v82
    v_and_b32 v189, 0xffff0000, v82
    v_pk_add_f32 v[160:161], v[160:161], v[188:189]
    v_lshlrev_b32 v190, 16, v83
    v_and_b32 v191, 0xffff0000, v83
    v_pk_add_f32 v[162:163], v[162:163], v[190:191]
    v_cvt_pk_bf16_f32 v156, v156, v157
    v_cvt_pk_bf16_f32 v157, v158, v159
    v_cvt_pk_bf16_f32 v158, v160, v161
    v_cvt_pk_bf16_f32 v159, v162, v163
    buffer_store_dwordx2 v[156:157], v249, s[28:31], s81 offen
    s_add_u32 s81, s81, 36864
    buffer_store_dwordx2 v[158:159], v249, s[28:31], s81 offen
    s_add_u32 s81, s81, 36864
    s_waitcnt vmcnt(17)
    v_lshlrev_b32 v184, 16, v84
    v_and_b32 v185, 0xffff0000, v84
    v_pk_add_f32 v[164:165], v[164:165], v[184:185]
    v_lshlrev_b32 v186, 16, v85
    v_and_b32 v187, 0xffff0000, v85
    v_pk_add_f32 v[166:167], v[166:167], v[186:187]
    v_lshlrev_b32 v188, 16, v86
    v_and_b32 v189, 0xffff0000, v86
    v_pk_add_f32 v[168:169], v[168:169], v[188:189]
    v_lshlrev_b32 v190, 16, v87
    v_and_b32 v191, 0xffff0000, v87
    v_pk_add_f32 v[170:171], v[170:171], v[190:191]
    v_lshlrev_b32 v184, 16, v88
    v_and_b32 v185, 0xffff0000, v88
    v_pk_add_f32 v[164:165], v[164:165], v[184:185]
    v_lshlrev_b32 v186, 16, v89
    v_and_b32 v187, 0xffff0000, v89
    v_pk_add_f32 v[166:167], v[166:167], v[186:187]
    v_lshlrev_b32 v188, 16, v90
    v_and_b32 v189, 0xffff0000, v90
    v_pk_add_f32 v[168:169], v[168:169], v[188:189]
    v_lshlrev_b32 v190, 16, v91
    v_and_b32 v191, 0xffff0000, v91
    v_pk_add_f32 v[170:171], v[170:171], v[190:191]
    v_lshlrev_b32 v184, 16, v92
    v_and_b32 v185, 0xffff0000, v92
    v_pk_add_f32 v[164:165], v[164:165], v[184:185]
    v_lshlrev_b32 v186, 16, v93
    v_and_b32 v187, 0xffff0000, v93
    v_pk_add_f32 v[166:167], v[166:167], v[186:187]
    v_lshlrev_b32 v188, 16, v94
    v_and_b32 v189, 0xffff0000, v94
    v_pk_add_f32 v[168:169], v[168:169], v[188:189]
    v_lshlrev_b32 v190, 16, v95
    v_and_b32 v191, 0xffff0000, v95
    v_pk_add_f32 v[170:171], v[170:171], v[190:191]
    v_cvt_pk_bf16_f32 v164, v164, v165
    v_cvt_pk_bf16_f32 v165, v166, v167
    v_cvt_pk_bf16_f32 v166, v168, v169
    v_cvt_pk_bf16_f32 v167, v170, v171
    buffer_store_dwordx2 v[164:165], v249, s[28:31], s81 offen
    s_add_u32 s81, s81, 36864
    buffer_store_dwordx2 v[166:167], v249, s[28:31], s81 offen
    s_add_u32 s81, s81, 36864
    s_waitcnt vmcnt(16)
    v_lshlrev_b32 v184, 16, v96
    v_and_b32 v185, 0xffff0000, v96
    v_pk_add_f32 v[172:173], v[172:173], v[184:185]
    v_lshlrev_b32 v186, 16, v97
    v_and_b32 v187, 0xffff0000, v97
    v_pk_add_f32 v[174:175], v[174:175], v[186:187]
    v_lshlrev_b32 v188, 16, v98
    v_and_b32 v189, 0xffff0000, v98
    v_pk_add_f32 v[176:177], v[176:177], v[188:189]
    v_lshlrev_b32 v190, 16, v99
    v_and_b32 v191, 0xffff0000, v99
    v_pk_add_f32 v[178:179], v[178:179], v[190:191]
    v_lshlrev_b32 v184, 16, v100
    v_and_b32 v185, 0xffff0000, v100
    v_pk_add_f32 v[172:173], v[172:173], v[184:185]
    v_lshlrev_b32 v186, 16, v101
    v_and_b32 v187, 0xffff0000, v101
    v_pk_add_f32 v[174:175], v[174:175], v[186:187]
    v_lshlrev_b32 v188, 16, v102
    v_and_b32 v189, 0xffff0000, v102
    v_pk_add_f32 v[176:177], v[176:177], v[188:189]
    v_lshlrev_b32 v190, 16, v103
    v_and_b32 v191, 0xffff0000, v103
    v_pk_add_f32 v[178:179], v[178:179], v[190:191]
    v_lshlrev_b32 v184, 16, v104
    v_and_b32 v185, 0xffff0000, v104
    v_pk_add_f32 v[172:173], v[172:173], v[184:185]
    v_lshlrev_b32 v186, 16, v105
    v_and_b32 v187, 0xffff0000, v105
    v_pk_add_f32 v[174:175], v[174:175], v[186:187]
    v_lshlrev_b32 v188, 16, v106
    v_and_b32 v189, 0xffff0000, v106
    v_pk_add_f32 v[176:177], v[176:177], v[188:189]
    v_lshlrev_b32 v190, 16, v107
    v_and_b32 v191, 0xffff0000, v107
    v_pk_add_f32 v[178:179], v[178:179], v[190:191]
    v_cvt_pk_bf16_f32 v172, v172, v173
    v_cvt_pk_bf16_f32 v173, v174, v175
    v_cvt_pk_bf16_f32 v174, v176, v177
    v_cvt_pk_bf16_f32 v175, v178, v179
    buffer_store_dwordx2 v[172:173], v249, s[28:31], s81 offen
    s_add_u32 s81, s81, 36864
    buffer_store_dwordx2 v[174:175], v249, s[28:31], s81 offen
    s_add_u32 s81, s81, 36864
    s_branch L_fin
L_no6:
    s_add_u32 s81, s71, s42
    s_waitcnt vmcnt(15)
    v_lshlrev_b32 v184, 16, v0
    v_and_b32 v185, 0xffff0000, v0
    v_pk_add_f32 v[108:109], v[108:109], v[184:185]
    v_lshlrev_b32 v186, 16, v1
    v_and_b32 v187, 0xffff0000, v1
    v_pk_add_f32 v[110:111], v[110:111], v[186:187]
    v_lshlrev_b32 v188, 16, v2
    v_and_b32 v189, 0xffff0000, v2
    v_pk_add_f32 v[112:113], v[112:113], v[188:189]
    v_lshlrev_b32 v190, 16, v3
    v_and_b32 v191, 0xffff0000, v3
    v_pk_add_f32 v[114:115], v[114:115], v[190:191]
    v_lshlrev_b32 v184, 16, v4
    v_and_b32 v185, 0xffff0000, v4
    v_pk_add_f32 v[108:109], v[108:109], v[184:185]
    v_lshlrev_b32 v186, 16, v5
    v_and_b32 v187, 0xffff0000, v5
    v_pk_add_f32 v[110:111], v[110:111], v[186:187]
    v_lshlrev_b32 v188, 16, v6
    v_and_b32 v189, 0xffff0000, v6
    v_pk_add_f32 v[112:113], v[112:113], v[188:189]
    v_lshlrev_b32 v190, 16, v7
    v_and_b32 v191, 0xffff0000, v7
    v_pk_add_f32 v[114:115], v[114:115], v[190:191]
    v_lshlrev_b32 v184, 16, v8
    v_and_b32 v185, 0xffff0000, v8
    v_pk_add_f32 v[108:109], v[108:109], v[184:185]
    v_lshlrev_b32 v186, 16, v9
    v_and_b32 v187, 0xffff0000, v9
    v_pk_add_f32 v[110:111], v[110:111], v[186:187]
    v_lshlrev_b32 v188, 16, v10
    v_and_b32 v189, 0xffff0000, v10
    v_pk_add_f32 v[112:113], v[112:113], v[188:189]
    v_lshlrev_b32 v190, 16, v11
    v_and_b32 v191, 0xffff0000, v11
    v_pk_add_f32 v[114:115], v[114:115], v[190:191]
    v_cvt_pk_bf16_f32 v108, v108, v109
    v_cvt_pk_bf16_f32 v109, v110, v111
    v_cvt_pk_bf16_f32 v110, v112, v113
    v_cvt_pk_bf16_f32 v111, v114, v115
    buffer_store_dwordx2 v[108:109], v249, s[28:31], s81 offen
    s_add_u32 s81, s81, 36864
    buffer_store_dwordx2 v[110:111], v249, s[28:31], s81 offen
    s_add_u32 s81, s81, 36864
    s_waitcnt vmcnt(14)
    v_lshlrev_b32 v184, 16, v12
    v_and_b32 v185, 0xffff0000, v12
    v_pk_add_f32 v[116:117], v[116:117], v[184:185]
    v_lshlrev_b32 v186, 16, v13
    v_and_b32 v187, 0xffff0000, v13
    v_pk_add_f32 v[118:119], v[118:119], v[186:187]
    v_lshlrev_b32 v188, 16, v14
    v_and_b32 v189, 0xffff0000, v14
    v_pk_add_f32 v[120:121], v[120:121], v[188:189]
    v_lshlrev_b32 v190, 16, v15
    v_and_b32 v191, 0xffff0000, v15
    v_pk_add_f32 v[122:123], v[122:123], v[190:191]
    v_lshlrev_b32 v184, 16, v16
    v_and_b32 v185, 0xffff0000, v16
    v_pk_add_f32 v[116:117], v[116:117], v[184:185]
    v_lshlrev_b32 v186, 16, v17
    v_and_b32 v187, 0xffff0000, v17
    v_pk_add_f32 v[118:119], v[118:119], v[186:187]
    v_lshlrev_b32 v188, 16, v18
    v_and_b32 v189, 0xffff0000, v18
    v_pk_add_f32 v[120:121], v[120:121], v[188:189]
    v_lshlrev_b32 v190, 16, v19
    v_and_b32 v191, 0xffff0000, v19
    v_pk_add_f32 v[122:123], v[122:123], v[190:191]
    v_lshlrev_b32 v184, 16, v20
    v_and_b32 v185, 0xffff0000, v20
    v_pk_add_f32 v[116:117], v[116:117], v[184:185]
    v_lshlrev_b32 v186, 16, v21
    v_and_b32 v187, 0xffff0000, v21
    v_pk_add_f32 v[118:119], v[118:119], v[186:187]
    v_lshlrev_b32 v188, 16, v22
    v_and_b32 v189, 0xffff0000, v22
    v_pk_add_f32 v[120:121], v[120:121], v[188:189]
    v_lshlrev_b32 v190, 16, v23
    v_and_b32 v191, 0xffff0000, v23
    v_pk_add_f32 v[122:123], v[122:123], v[190:191]
    v_cvt_pk_bf16_f32 v116, v116, v117
    v_cvt_pk_bf16_f32 v117, v118, v119
    v_cvt_pk_bf16_f32 v118, v120, v121
    v_cvt_pk_bf16_f32 v119, v122, v123
    buffer_store_dwordx2 v[116:117], v249, s[28:31], s81 offen
    s_add_u32 s81, s81, 36864
    buffer_store_dwordx2 v[118:119], v249, s[28:31], s81 offen
    s_add_u32 s81, s81, 36864
    s_waitcnt vmcnt(13)
    v_lshlrev_b32 v184, 16, v24
    v_and_b32 v185, 0xffff0000, v24
    v_pk_add_f32 v[124:125], v[124:125], v[184:185]
    v_lshlrev_b32 v186, 16, v25
    v_and_b32 v187, 0xffff0000, v25
    v_pk_add_f32 v[126:127], v[126:127], v[186:187]
    v_lshlrev_b32 v188, 16, v26
    v_and_b32 v189, 0xffff0000, v26
    v_pk_add_f32 v[128:129], v[128:129], v[188:189]
    v_lshlrev_b32 v190, 16, v27
    v_and_b32 v191, 0xffff0000, v27
    v_pk_add_f32 v[130:131], v[130:131], v[190:191]
    v_lshlrev_b32 v184, 16, v28
    v_and_b32 v185, 0xffff0000, v28
    v_pk_add_f32 v[124:125], v[124:125], v[184:185]
    v_lshlrev_b32 v186, 16, v29
    v_and_b32 v187, 0xffff0000, v29
    v_pk_add_f32 v[126:127], v[126:127], v[186:187]
    v_lshlrev_b32 v188, 16, v30
    v_and_b32 v189, 0xffff0000, v30
    v_pk_add_f32 v[128:129], v[128:129], v[188:189]
    v_lshlrev_b32 v190, 16, v31
    v_and_b32 v191, 0xffff0000, v31
    v_pk_add_f32 v[130:131], v[130:131], v[190:191]
    v_lshlrev_b32 v184, 16, v32
    v_and_b32 v185, 0xffff0000, v32
    v_pk_add_f32 v[124:125], v[124:125], v[184:185]
    v_lshlrev_b32 v186, 16, v33
    v_and_b32 v187, 0xffff0000, v33
    v_pk_add_f32 v[126:127], v[126:127], v[186:187]
    v_lshlrev_b32 v188, 16, v34
    v_and_b32 v189, 0xffff0000, v34
    v_pk_add_f32 v[128:129], v[128:129], v[188:189]
    v_lshlrev_b32 v190, 16, v35
    v_and_b32 v191, 0xffff0000, v35
    v_pk_add_f32 v[130:131], v[130:131], v[190:191]
    v_cvt_pk_bf16_f32 v124, v124, v125
    v_cvt_pk_bf16_f32 v125, v126, v127
    v_cvt_pk_bf16_f32 v126, v128, v129
    v_cvt_pk_bf16_f32 v127, v130, v131
    buffer_store_dwordx2 v[124:125], v249, s[28:31], s81 offen
    s_add_u32 s81, s81, 36864
    buffer_store_dwordx2 v[126:127], v249, s[28:31], s81 offen
    s_add_u32 s81, s81, 36864
    s_add_u32 s81, s71, s43
    s_waitcnt vmcnt(12)
    v_lshlrev_b32 v184, 16, v36
    v_and_b32 v185, 0xffff0000, v36
    v_pk_add_f32 v[132:133], v[132:133], v[184:185]
    v_lshlrev_b32 v186, 16, v37
    v_and_b32 v187, 0xffff0000, v37
    v_pk_add_f32 v[134:135], v[134:135], v[186:187]
    v_lshlrev_b32 v188, 16, v38
    v_and_b32 v189, 0xffff0000, v38
    v_pk_add_f32 v[136:137], v[136:137], v[188:189]
    v_lshlrev_b32 v190, 16, v39
    v_and_b32 v191, 0xffff0000, v39
    v_pk_add_f32 v[138:139], v[138:139], v[190:191]
    v_lshlrev_b32 v184, 16, v40
    v_and_b32 v185, 0xffff0000, v40
    v_pk_add_f32 v[132:133], v[132:133], v[184:185]
    v_lshlrev_b32 v186, 16, v41
    v_and_b32 v187, 0xffff0000, v41
    v_pk_add_f32 v[134:135], v[134:135], v[186:187]
    v_lshlrev_b32 v188, 16, v42
    v_and_b32 v189, 0xffff0000, v42
    v_pk_add_f32 v[136:137], v[136:137], v[188:189]
    v_lshlrev_b32 v190, 16, v43
    v_and_b32 v191, 0xffff0000, v43
    v_pk_add_f32 v[138:139], v[138:139], v[190:191]
    v_lshlrev_b32 v184, 16, v44
    v_and_b32 v185, 0xffff0000, v44
    v_pk_add_f32 v[132:133], v[132:133], v[184:185]
    v_lshlrev_b32 v186, 16, v45
    v_and_b32 v187, 0xffff0000, v45
    v_pk_add_f32 v[134:135], v[134:135], v[186:187]
    v_lshlrev_b32 v188, 16, v46
    v_and_b32 v189, 0xffff0000, v46
    v_pk_add_f32 v[136:137], v[136:137], v[188:189]
    v_lshlrev_b32 v190, 16, v47
    v_and_b32 v191, 0xffff0000, v47
    v_pk_add_f32 v[138:139], v[138:139], v[190:191]
    v_cvt_pk_bf16_f32 v132, v132, v133
    v_cvt_pk_bf16_f32 v133, v134, v135
    v_cvt_pk_bf16_f32 v134, v136, v137
    v_cvt_pk_bf16_f32 v135, v138, v139
    buffer_store_dwordx2 v[132:133], v249, s[28:31], s81 offen
    s_add_u32 s81, s81, 36864
    buffer_store_dwordx2 v[134:135], v249, s[28:31], s81 offen
    s_add_u32 s81, s81, 36864
    s_waitcnt vmcnt(11)
    v_lshlrev_b32 v184, 16, v48
    v_and_b32 v185, 0xffff0000, v48
    v_pk_add_f32 v[140:141], v[140:141], v[184:185]
    v_lshlrev_b32 v186, 16, v49
    v_and_b32 v187, 0xffff0000, v49
    v_pk_add_f32 v[142:143], v[142:143], v[186:187]
    v_lshlrev_b32 v188, 16, v50
    v_and_b32 v189, 0xffff0000, v50
    v_pk_add_f32 v[144:145], v[144:145], v[188:189]
    v_lshlrev_b32 v190, 16, v51
    v_and_b32 v191, 0xffff0000, v51
    v_pk_add_f32 v[146:147], v[146:147], v[190:191]
    v_lshlrev_b32 v184, 16, v52
    v_and_b32 v185, 0xffff0000, v52
    v_pk_add_f32 v[140:141], v[140:141], v[184:185]
    v_lshlrev_b32 v186, 16, v53
    v_and_b32 v187, 0xffff0000, v53
    v_pk_add_f32 v[142:143], v[142:143], v[186:187]
    v_lshlrev_b32 v188, 16, v54
    v_and_b32 v189, 0xffff0000, v54
    v_pk_add_f32 v[144:145], v[144:145], v[188:189]
    v_lshlrev_b32 v190, 16, v55
    v_and_b32 v191, 0xffff0000, v55
    v_pk_add_f32 v[146:147], v[146:147], v[190:191]
    v_lshlrev_b32 v184, 16, v56
    v_and_b32 v185, 0xffff0000, v56
    v_pk_add_f32 v[140:141], v[140:141], v[184:185]
    v_lshlrev_b32 v186, 16, v57
    v_and_b32 v187, 0xffff0000, v57
    v_pk_add_f32 v[142:143], v[142:143], v[186:187]
    v_lshlrev_b32 v188, 16, v58
    v_and_b32 v189, 0xffff0000, v58
    v_pk_add_f32 v[144:145], v[144:145], v[188:189]
    v_lshlrev_b32 v190, 16, v59
    v_and_b32 v191, 0xffff0000, v59
    v_pk_add_f32 v[146:147], v[146:147], v[190:191]
    v_cvt_pk_bf16_f32 v140, v140, v141
    v_cvt_pk_bf16_f32 v141, v142, v143
    v_cvt_pk_bf16_f32 v142, v144, v145
    v_cvt_pk_bf16_f32 v143, v146, v147
    buffer_store_dwordx2 v[140:141], v249, s[28:31], s81 offen
    s_add_u32 s81, s81, 36864
    buffer_store_dwordx2 v[142:143], v249, s[28:31], s81 offen
    s_add_u32 s81, s81, 36864
    s_waitcnt vmcnt(10)
    v_lshlrev_b32 v184, 16, v60
    v_and_b32 v185, 0xffff0000, v60
    v_pk_add_f32 v[148:149], v[148:149], v[184:185]
    v_lshlrev_b32 v186, 16, v61
    v_and_b32 v187, 0xffff0000, v61
    v_pk_add_f32 v[150:151], v[150:151], v[186:187]
    v_lshlrev_b32 v188, 16, v62
    v_and_b32 v189, 0xffff0000, v62
    v_pk_add_f32 v[152:153], v[152:153], v[188:189]
    v_lshlrev_b32 v190, 16, v63
    v_and_b32 v191, 0xffff0000, v63
    v_pk_add_f32 v[154:155], v[154:155], v[190:191]
    v_lshlrev_b32 v184, 16, v64
    v_and_b32 v185, 0xffff0000, v64
    v_pk_add_f32 v[148:149], v[148:149], v[184:185]
    v_lshlrev_b32 v186, 16, v65
    v_and_b32 v187, 0xffff0000, v65
    v_pk_add_f32 v[150:151], v[150:151], v[186:187]
    v_lshlrev_b32 v188, 16, v66
    v_and_b32 v189, 0xffff0000, v66
    v_pk_add_f32 v[152:153], v[152:153], v[188:189]
    v_lshlrev_b32 v190, 16, v67
    v_and_b32 v191, 0xffff0000, v67
    v_pk_add_f32 v[154:155], v[154:155], v[190:191]
    v_lshlrev_b32 v184, 16, v68
    v_and_b32 v185, 0xffff0000, v68
    v_pk_add_f32 v[148:149], v[148:149], v[184:185]
    v_lshlrev_b32 v186, 16, v69
    v_and_b32 v187, 0xffff0000, v69
    v_pk_add_f32 v[150:151], v[150:151], v[186:187]
    v_lshlrev_b32 v188, 16, v70
    v_and_b32 v189, 0xffff0000, v70
    v_pk_add_f32 v[152:153], v[152:153], v[188:189]
    v_lshlrev_b32 v190, 16, v71
    v_and_b32 v191, 0xffff0000, v71
    v_pk_add_f32 v[154:155], v[154:155], v[190:191]
    v_cvt_pk_bf16_f32 v148, v148, v149
    v_cvt_pk_bf16_f32 v149, v150, v151
    v_cvt_pk_bf16_f32 v150, v152, v153
    v_cvt_pk_bf16_f32 v151, v154, v155
    buffer_store_dwordx2 v[148:149], v249, s[28:31], s81 offen
    s_add_u32 s81, s81, 36864
    buffer_store_dwordx2 v[150:151], v249, s[28:31], s81 offen
    s_add_u32 s81, s81, 36864
L_fin:
    s_waitcnt vmcnt(0)
    s_endpgm
L_slow0:
    s_mov_b32 s69, 0
    s_branch L_slow
L_slow1e:
    s_mov_b32 s69, 1
    s_branch L_slow
L_slow2e:
    s_mov_b32 s69, 2
    s_branch L_slow
L_af19:
    s_waitcnt vmcnt(3)
    s_branch L_afr19
L_af20:
    s_waitcnt vmcnt(3)
    s_branch L_afr20
L_af21:
    s_waitcnt vmcnt(3)
    s_branch L_afr21
L_af22:
    s_waitcnt vmcnt(3)
    s_branch L_afr22
L_af23:
    s_waitcnt vmcnt(3)
    s_branch L_afr23
L_af24:
    s_waitcnt vmcnt(3)
    s_branch L_afr24
L_af25:
    s_waitcnt vmcnt(3)
    s_branch L_afr25
L_af26:
    s_waitcnt vmcnt(3)
    s_branch L_afr26
L_af27:
    s_waitcnt vmcnt(3)
    s_branch L_afr27
L_af28:
    s_waitcnt vmcnt(3)
    s_branch L_afr28
L_af29:
    s_waitcnt vmcnt(3)
    s_branch L_afr29
L_af30:
    s_waitcnt vmcnt(3)
    s_branch L_afr30
L_af31:
    s_waitcnt vmcnt(3)
    s_branch L_afr31
L_af32:
    s_waitcnt vmcnt(3)
    s_branch L_afr32
L_af33:
    s_waitcnt vmcnt(3)
    s_branch L_afr33
L_af34:
    s_waitcnt vmcnt(3)
    s_branch L_afr34
L_af35:
    s_waitcnt vmcnt(3)
    s_branch L_afr35
L_af36:
    s_waitcnt vmcnt(3)
    s_branch L_afr36
L_af37:
    s_waitcnt vmcnt(3)
    s_branch L_afr37
L_af38:
    s_waitcnt vmcnt(3)
    s_branch L_afr38
L_af39:
    s_waitcnt vmcnt(3)
    s_branch L_afr39
L_af40:
    s_waitcnt vmcnt(3)
    s_branch L_afr40
L_af41:
    s_waitcnt vmcnt(3)
    s_branch L_afr41
L_af42:
    s_waitcnt vmcnt(3)
    s_branch L_afr42
L_af43:
    s_waitcnt vmcnt(3)
    s_branch L_afr43
L_af44:
    s_waitcnt vmcnt(3)
    s_branch L_afr44
L_af45:
    s_waitcnt vmcnt(3)
    s_branch L_afr45
L_af46:
    s_waitcnt vmcnt(3)
    s_branch L_afr46
L_af47:
    s_waitcnt vmcnt(3)
    s_branch L_afr47
L_af48:
    s_waitcnt vmcnt(3)
    s_branch L_afr48
L_af49:
    s_waitcnt vmcnt(3)
    s_branch L_afr49
L_slow:
    s_waitcnt vmcnt(0) lgkmcnt(0)
    s_nop 7
    s_mov_b32 s93, s6
    s_mov_b32 s6, s40
    s_mov_b32 s10, s40
    s_lshl_b32 s3, s68, 0
    s_add_u32 s3, s3, 131072
    s_sub_u32 s3, s44, s3
    s_and_b32 s3, s3, 0xfffe0000
    v_lshrrev_b32 v253, 4, v237
    v_and_b32 v254, 15, v253
    v_lshrrev_b32 v253, 4, v253
    v_lshlrev_b32 v255, 1, v254
    v_lshl_add_u32 v255, v253, 10, v255
    v_lshlrev_b32 v254, 8, v254
    v_lshl_add_u32 v254, v253, 4, v254
    v_mov_b32 v216, 0xff800000
    v_mov_b32 v217, 0xff800000
    v_mov_b32 v218, 0xff800000
    s_mov_b32 s81, s3
    s_mov_b32 s54, 16
L_slow1:
    buffer_load_dwordx4 v[144:147], v254, s[4:7], s81 offen
    buffer_load_dwordx4 v[148:151], v254, s[4:7], s81 offen offset:64
    buffer_load_dwordx4 v[152:155], v254, s[4:7], s81 offen offset:128
    buffer_load_dwordx4 v[156:159], v254, s[4:7], s81 offen offset:192
    s_add_u32 s81, s81, 4096
    s_waitcnt vmcnt(0)
    v_mfma_f32_16x16x32_bf16 v[160:163], v[144:147], v[96:99], 0
    v_mfma_f32_16x16x32_bf16 v[160:163], v[148:151], v[108:111], v[160:163]
    v_mfma_f32_16x16x32_bf16 v[160:163], v[152:155], v[120:123], v[160:163]
    v_mfma_f32_16x16x32_bf16 v[160:163], v[156:159], v[132:135], v[160:163]
    s_nop 7
    s_nop 7
    v_mfma_f32_16x16x32_bf16 v[164:167], v[144:147], v[100:103], 0
    v_mfma_f32_16x16x32_bf16 v[164:167], v[148:151], v[112:115], v[164:167]
    v_mfma_f32_16x16x32_bf16 v[164:167], v[152:155], v[124:127], v[164:167]
    v_mfma_f32_16x16x32_bf16 v[164:167], v[156:159], v[136:139], v[164:167]
    s_nop 7
    s_nop 7
    v_mfma_f32_16x16x32_bf16 v[168:171], v[144:147], v[104:107], 0
    v_mfma_f32_16x16x32_bf16 v[168:171], v[148:151], v[116:119], v[168:171]
    v_mfma_f32_16x16x32_bf16 v[168:171], v[152:155], v[128:131], v[168:171]
    v_mfma_f32_16x16x32_bf16 v[168:171], v[156:159], v[140:143], v[168:171]
    s_nop 7
    s_nop 7
    buffer_load_dwordx4 v[144:147], v254, s[4:7], s81 offen
    buffer_load_dwordx4 v[148:151], v254, s[4:7], s81 offen offset:64
    buffer_load_dwordx4 v[152:155], v254, s[4:7], s81 offen offset:128
    buffer_load_dwordx4 v[156:159], v254, s[4:7], s81 offen offset:192
    s_add_u32 s81, s81, 4096
    s_waitcnt vmcnt(0)
    v_mfma_f32_16x16x32_bf16 v[172:175], v[144:147], v[96:99], 0
    v_mfma_f32_16x16x32_bf16 v[172:175], v[148:151], v[108:111], v[172:175]
    v_mfma_f32_16x16x32_bf16 v[172:175], v[152:155], v[120:123], v[172:175]
    v_mfma_f32_16x16x32_bf16 v[172:175], v[156:159], v[132:135], v[172:175]
    s_nop 7
    s_nop 7
    v_mfma_f32_16x16x32_bf16 v[176:179], v[144:147], v[100:103], 0
    v_mfma_f32_16x16x32_bf16 v[176:179], v[148:151], v[112:115], v[176:179]
    v_mfma_f32_16x16x32_bf16 v[176:179], v[152:155], v[124:127], v[176:179]
    v_mfma_f32_16x16x32_bf16 v[176:179], v[156:159], v[136:139], v[176:179]
    s_nop 7
    s_nop 7
    v_mfma_f32_16x16x32_bf16 v[180:183], v[144:147], v[104:107], 0
    v_mfma_f32_16x16x32_bf16 v[180:183], v[148:151], v[116:119], v[180:183]
    v_mfma_f32_16x16x32_bf16 v[180:183], v[152:155], v[128:131], v[180:183]
    v_mfma_f32_16x16x32_bf16 v[180:183], v[156:159], v[140:143], v[180:183]
    s_nop 7
    s_nop 7
    s_sub_u32 s81, s81, 8192
    v_max3_f32 v216, v216, v160, v161
    v_max3_f32 v216, v216, v162, v163
    v_max3_f32 v216, v216, v172, v173
    v_max3_f32 v216, v216, v174, v175
    v_max3_f32 v217, v217, v164, v165
    v_max3_f32 v217, v217, v166, v167
    v_max3_f32 v217, v217, v176, v177
    v_max3_f32 v217, v217, v178, v179
    v_max3_f32 v218, v218, v168, v169
    v_max3_f32 v218, v218, v170, v171
    v_max3_f32 v218, v218, v180, v181
    v_max3_f32 v218, v218, v182, v183
    s_add_u32 s81, s81, 8192
    s_sub_u32 s54, s54, 1
    s_cmp_lg_u32 s54, 0
    s_cbranch_scc1 L_slow1
    v_mov_b32 v188, v216
    s_nop 1
    v_permlane32_swap_b32 v188, v216
    s_nop 1
    v_max_f32 v216, v216, v188
    v_mov_b32 v188, v216
    s_nop 1
    v_permlane16_swap_b32 v188, v216
    s_nop 1
    v_max_f32 v216, v216, v188
    v_sub_f32 v216, 0, v216
    v_mov_b32 v224, 0
    v_mov_b32 v188, v217
    s_nop 1
    v_permlane32_swap_b32 v188, v217
    s_nop 1
    v_max_f32 v217, v217, v188
    v_mov_b32 v188, v217
    s_nop 1
    v_permlane16_swap_b32 v188, v217
    s_nop 1
    v_max_f32 v217, v217, v188
    v_sub_f32 v217, 0, v217
    v_mov_b32 v225, 0
    v_mov_b32 v188, v218
    s_nop 1
    v_permlane32_swap_b32 v188, v218
    s_nop 1
    v_max_f32 v218, v218, v188
    v_mov_b32 v188, v218
    s_nop 1
    v_permlane16_swap_b32 v188, v218
    s_nop 1
    v_max_f32 v218, v218, v188
    v_sub_f32 v218, 0, v218
    v_mov_b32 v226, 0
    v_mov_b32 v0, 0
    v_mov_b32 v1, 0
    v_mov_b32 v2, 0
    v_mov_b32 v3, 0
    v_mov_b32 v4, 0
    v_mov_b32 v5, 0
    v_mov_b32 v6, 0
    v_mov_b32 v7, 0
    v_mov_b32 v8, 0
    v_mov_b32 v9, 0
    v_mov_b32 v10, 0
    v_mov_b32 v11, 0
    v_mov_b32 v12, 0
    v_mov_b32 v13, 0
    v_mov_b32 v14, 0
    v_mov_b32 v15, 0
    v_mov_b32 v16, 0
    v_mov_b32 v17, 0
    v_mov_b32 v18, 0
    v_mov_b32 v19, 0
    v_mov_b32 v20, 0
    v_mov_b32 v21, 0
    v_mov_b32 v22, 0
    v_mov_b32 v23, 0
    v_mov_b32 v24, 0
    v_mov_b32 v25, 0
    v_mov_b32 v26, 0
    v_mov_b32 v27, 0
    v_mov_b32 v28, 0
    v_mov_b32 v29, 0
    v_mov_b32 v30, 0
    v_mov_b32 v31, 0
    v_mov_b32 v32, 0
    v_mov_b32 v33, 0
    v_mov_b32 v34, 0
    v_mov_b32 v35, 0
    v_mov_b32 v36, 0
    v_mov_b32 v37, 0
    v_mov_b32 v38, 0
    v_mov_b32 v39, 0
    v_mov_b32 v40, 0
    v_mov_b32 v41, 0
    v_mov_b32 v42, 0
    v_mov_b32 v43, 0
    v_mov_b32 v44, 0
    v_mov_b32 v45, 0
    v_mov_b32 v46, 0
    v_mov_b32 v47, 0
    v_mov_b32 v48, 0
    v_mov_b32 v49, 0
    v_mov_b32 v50, 0
    v_mov_b32 v51, 0
    v_mov_b32 v52, 0
    v_mov_b32 v53, 0
    v_mov_b32 v54, 0
    v_mov_b32 v55, 0
    v_mov_b32 v56, 0
    v_mov_b32 v57, 0
    v_mov_b32 v58, 0
    v_mov_b32 v59, 0
    v_mov_b32 v60, 0
    v_mov_b32 v61, 0
    v_mov_b32 v62, 0
    v_mov_b32 v63, 0
    v_mov_b32 v64, 0
    v_mov_b32 v65, 0
    v_mov_b32 v66, 0
    v_mov_b32 v67, 0
    v_mov_b32 v68, 0
    v_mov_b32 v69, 0
    v_mov_b32 v70, 0
    v_mov_b32 v71, 0
    v_mov_b32 v72, 0
    v_mov_b32 v73, 0
    v_mov_b32 v74, 0
    v_mov_b32 v75, 0
    v_mov_b32 v76, 0
    v_mov_b32 v77, 0
    v_mov_b32 v78, 0
    v_mov_b32 v79, 0
    v_mov_b32 v80, 0
    v_mov_b32 v81, 0
    v_mov_b32 v82, 0
    v_mov_b32 v83, 0
    v_mov_b32 v84, 0
    v_mov_b32 v85, 0
    v_mov_b32 v86, 0
    v_mov_b32 v87, 0
    v_mov_b32 v88, 0
    v_mov_b32 v89, 0
    v_mov_b32 v90, 0
    v_mov_b32 v91, 0
    v_mov_b32 v92, 0
    v_mov_b32 v93, 0
    v_mov_b32 v94, 0
    v_mov_b32 v95, 0
    s_mov_b32 s81, s3
    s_mov_b32 s54, 16
L_slow2:
    buffer_load_dwordx4 v[144:147], v254, s[4:7], s81 offen
    buffer_load_dwordx4 v[148:151], v254, s[4:7], s81 offen offset:64
    buffer_load_dwordx4 v[152:155], v254, s[4:7], s81 offen offset:128
    buffer_load_dwordx4 v[156:159], v254, s[4:7], s81 offen offset:192
    s_add_u32 s81, s81, 4096
    s_waitcnt vmcnt(0)
    v_mov_b32 v188, v216
    v_mov_b32 v189, v216
    v_mov_b32 v190, v216
    v_mov_b32 v191, v216
    s_nop 1
    v_mfma_f32_16x16x32_bf16 v[160:163], v[144:147], v[96:99], v[188:191]
    v_mfma_f32_16x16x32_bf16 v[160:163], v[148:151], v[108:111], v[160:163]
    v_mfma_f32_16x16x32_bf16 v[160:163], v[152:155], v[120:123], v[160:163]
    v_mfma_f32_16x16x32_bf16 v[160:163], v[156:159], v[132:135], v[160:163]
    s_nop 7
    s_nop 7
    v_mov_b32 v188, v217
    v_mov_b32 v189, v217
    v_mov_b32 v190, v217
    v_mov_b32 v191, v217
    s_nop 1
    v_mfma_f32_16x16x32_bf16 v[164:167], v[144:147], v[100:103], v[188:191]
    v_mfma_f32_16x16x32_bf16 v[164:167], v[148:151], v[112:115], v[164:167]
    v_mfma_f32_16x16x32_bf16 v[164:167], v[152:155], v[124:127], v[164:167]
    v_mfma_f32_16x16x32_bf16 v[164:167], v[156:159], v[136:139], v[164:167]
    s_nop 7
    s_nop 7
    v_mov_b32 v188, v218
    v_mov_b32 v189, v218
    v_mov_b32 v190, v218
    v_mov_b32 v191, v218
    s_nop 1
    v_mfma_f32_16x16x32_bf16 v[168:171], v[144:147], v[104:107], v[188:191]
    v_mfma_f32_16x16x32_bf16 v[168:171], v[148:151], v[116:119], v[168:171]
    v_mfma_f32_16x16x32_bf16 v[168:171], v[152:155], v[128:131], v[168:171]
    v_mfma_f32_16x16x32_bf16 v[168:171], v[156:159], v[140:143], v[168:171]
    s_nop 7
    s_nop 7
    buffer_load_dwordx4 v[144:147], v254, s[4:7], s81 offen
    buffer_load_dwordx4 v[148:151], v254, s[4:7], s81 offen offset:64
    buffer_load_dwordx4 v[152:155], v254, s[4:7], s81 offen offset:128
    buffer_load_dwordx4 v[156:159], v254, s[4:7], s81 offen offset:192
    s_add_u32 s81, s81, 4096
    s_waitcnt vmcnt(0)
    v_mov_b32 v188, v216
    v_mov_b32 v189, v216
    v_mov_b32 v190, v216
    v_mov_b32 v191, v216
    s_nop 1
    v_mfma_f32_16x16x32_bf16 v[172:175], v[144:147], v[96:99], v[188:191]
    v_mfma_f32_16x16x32_bf16 v[172:175], v[148:151], v[108:111], v[172:175]
    v_mfma_f32_16x16x32_bf16 v[172:175], v[152:155], v[120:123], v[172:175]
    v_mfma_f32_16x16x32_bf16 v[172:175], v[156:159], v[132:135], v[172:175]
    s_nop 7
    s_nop 7
    v_mov_b32 v188, v217
    v_mov_b32 v189, v217
    v_mov_b32 v190, v217
    v_mov_b32 v191, v217
    s_nop 1
    v_mfma_f32_16x16x32_bf16 v[176:179], v[144:147], v[100:103], v[188:191]
    v_mfma_f32_16x16x32_bf16 v[176:179], v[148:151], v[112:115], v[176:179]
    v_mfma_f32_16x16x32_bf16 v[176:179], v[152:155], v[124:127], v[176:179]
    v_mfma_f32_16x16x32_bf16 v[176:179], v[156:159], v[136:139], v[176:179]
    s_nop 7
    s_nop 7
    v_mov_b32 v188, v218
    v_mov_b32 v189, v218
    v_mov_b32 v190, v218
    v_mov_b32 v191, v218
    s_nop 1
    v_mfma_f32_16x16x32_bf16 v[180:183], v[144:147], v[104:107], v[188:191]
    v_mfma_f32_16x16x32_bf16 v[180:183], v[148:151], v[116:119], v[180:183]
    v_mfma_f32_16x16x32_bf16 v[180:183], v[152:155], v[128:131], v[180:183]
    v_mfma_f32_16x16x32_bf16 v[180:183], v[156:159], v[140:143], v[180:183]
    s_nop 7
    s_nop 7
    s_sub_u32 s81, s81, 8192
    v_exp_f32 v160, v160
    v_exp_f32 v161, v161
    v_exp_f32 v162, v162
    v_exp_f32 v163, v163
    v_add_f32 v224, v224, v160
    v_add_f32 v224, v224, v161
    v_add_f32 v224, v224, v162
    v_add_f32 v224, v224, v163
    v_cvt_pk_bf16_f32 v192, v160, v161
    v_cvt_pk_bf16_f32 v193, v162, v163
    v_exp_f32 v172, v172
    v_exp_f32 v173, v173
    v_exp_f32 v174, v174
    v_exp_f32 v175, v175
    v_add_f32 v224, v224, v172
    v_add_f32 v224, v224, v173
    v_add_f32 v224, v224, v174
    v_add_f32 v224, v224, v175
    v_cvt_pk_bf16_f32 v194, v172, v173
    v_cvt_pk_bf16_f32 v195, v174, v175
    v_exp_f32 v164, v164
    v_exp_f32 v165, v165
    v_exp_f32 v166, v166
    v_exp_f32 v167, v167
    v_add_f32 v225, v225, v164
    v_add_f32 v225, v225, v165
    v_add_f32 v225, v225, v166
    v_add_f32 v225, v225, v167
    v_cvt_pk_bf16_f32 v196, v164, v165
    v_cvt_pk_bf16_f32 v197, v166, v167
    v_exp_f32 v176, v176
    v_exp_f32 v177, v177
    v_exp_f32 v178, v178
    v_exp_f32 v179, v179
    v_add_f32 v225, v225, v176
    v_add_f32 v225, v225, v177
    v_add_f32 v225, v225, v178
    v_add_f32 v225, v225, v179
    v_cvt_pk_bf16_f32 v198, v176, v177
    v_cvt_pk_bf16_f32 v199, v178, v179
    v_exp_f32 v168, v168
    v_exp_f32 v169, v169
    v_exp_f32 v170, v170
    v_exp_f32 v171, v171
    v_add_f32 v226, v226, v168
    v_add_f32 v226, v226, v169
    v_add_f32 v226, v226, v170
    v_add_f32 v226, v226, v171
    v_cvt_pk_bf16_f32 v200, v168, v169
    v_cvt_pk_bf16_f32 v201, v170, v171
    v_exp_f32 v180, v180
    v_exp_f32 v181, v181
    v_exp_f32 v182, v182
    v_exp_f32 v183, v183
    v_add_f32 v226, v226, v180
    v_add_f32 v226, v226, v181
    v_add_f32 v226, v226, v182
    v_add_f32 v226, v226, v183
    v_cvt_pk_bf16_f32 v202, v180, v181
    v_cvt_pk_bf16_f32 v203, v182, v183
    buffer_load_ushort v144, v255, s[8:11], s81 offen
    buffer_load_ushort v145, v255, s[8:11], s81 offen offset:256
    buffer_load_ushort v146, v255, s[8:11], s81 offen offset:512
    buffer_load_ushort v147, v255, s[8:11], s81 offen offset:768
    s_add_u32 s81, s81, 4096
    buffer_load_ushort v148, v255, s[8:11], s81 offen
    buffer_load_ushort v149, v255, s[8:11], s81 offen offset:256
    buffer_load_ushort v150, v255, s[8:11], s81 offen offset:512
    buffer_load_ushort v151, v255, s[8:11], s81 offen offset:768
    s_sub_u32 s81, s81, 4096
    s_waitcnt vmcnt(0)
    v_lshl_or_b32 v184, v145, 16, v144
    v_lshl_or_b32 v185, v147, 16, v146
    v_lshl_or_b32 v186, v149, 16, v148
    v_lshl_or_b32 v187, v151, 16, v150
    s_nop 1
    v_mfma_f32_16x16x32_bf16 v[0:3], v[184:187], v[192:195], v[0:3]
    v_mfma_f32_16x16x32_bf16 v[4:7], v[184:187], v[196:199], v[4:7]
    v_mfma_f32_16x16x32_bf16 v[8:11], v[184:187], v[200:203], v[8:11]
    s_nop 7
    buffer_load_ushort v144, v255, s[8:11], s81 offen offset:32
    buffer_load_ushort v145, v255, s[8:11], s81 offen offset:288
    buffer_load_ushort v146, v255, s[8:11], s81 offen offset:544
    buffer_load_ushort v147, v255, s[8:11], s81 offen offset:800
    s_add_u32 s81, s81, 4096
    buffer_load_ushort v148, v255, s[8:11], s81 offen offset:32
    buffer_load_ushort v149, v255, s[8:11], s81 offen offset:288
    buffer_load_ushort v150, v255, s[8:11], s81 offen offset:544
    buffer_load_ushort v151, v255, s[8:11], s81 offen offset:800
    s_sub_u32 s81, s81, 4096
    s_waitcnt vmcnt(0)
    v_lshl_or_b32 v184, v145, 16, v144
    v_lshl_or_b32 v185, v147, 16, v146
    v_lshl_or_b32 v186, v149, 16, v148
    v_lshl_or_b32 v187, v151, 16, v150
    s_nop 1
    v_mfma_f32_16x16x32_bf16 v[12:15], v[184:187], v[192:195], v[12:15]
    v_mfma_f32_16x16x32_bf16 v[16:19], v[184:187], v[196:199], v[16:19]
    v_mfma_f32_16x16x32_bf16 v[20:23], v[184:187], v[200:203], v[20:23]
    s_nop 7
    buffer_load_ushort v144, v255, s[8:11], s81 offen offset:64
    buffer_load_ushort v145, v255, s[8:11], s81 offen offset:320
    buffer_load_ushort v146, v255, s[8:11], s81 offen offset:576
    buffer_load_ushort v147, v255, s[8:11], s81 offen offset:832
    s_add_u32 s81, s81, 4096
    buffer_load_ushort v148, v255, s[8:11], s81 offen offset:64
    buffer_load_ushort v149, v255, s[8:11], s81 offen offset:320
    buffer_load_ushort v150, v255, s[8:11], s81 offen offset:576
    buffer_load_ushort v151, v255, s[8:11], s81 offen offset:832
    s_sub_u32 s81, s81, 4096
    s_waitcnt vmcnt(0)
    v_lshl_or_b32 v184, v145, 16, v144
    v_lshl_or_b32 v185, v147, 16, v146
    v_lshl_or_b32 v186, v149, 16, v148
    v_lshl_or_b32 v187, v151, 16, v150
    s_nop 1
    v_mfma_f32_16x16x32_bf16 v[24:27], v[184:187], v[192:195], v[24:27]
    v_mfma_f32_16x16x32_bf16 v[28:31], v[184:187], v[196:199], v[28:31]
    v_mfma_f32_16x16x32_bf16 v[32:35], v[184:187], v[200:203], v[32:35]
    s_nop 7
    buffer_load_ushort v144, v255, s[8:11], s81 offen offset:96
    buffer_load_ushort v145, v255, s[8:11], s81 offen offset:352
    buffer_load_ushort v146, v255, s[8:11], s81 offen offset:608
    buffer_load_ushort v147, v255, s[8:11], s81 offen offset:864
    s_add_u32 s81, s81, 4096
    buffer_load_ushort v148, v255, s[8:11], s81 offen offset:96
    buffer_load_ushort v149, v255, s[8:11], s81 offen offset:352
    buffer_load_ushort v150, v255, s[8:11], s81 offen offset:608
    buffer_load_ushort v151, v255, s[8:11], s81 offen offset:864
    s_sub_u32 s81, s81, 4096
    s_waitcnt vmcnt(0)
    v_lshl_or_b32 v184, v145, 16, v144
    v_lshl_or_b32 v185, v147, 16, v146
    v_lshl_or_b32 v186, v149, 16, v148
    v_lshl_or_b32 v187, v151, 16, v150
    s_nop 1
    v_mfma_f32_16x16x32_bf16 v[36:39], v[184:187], v[192:195], v[36:39]
    v_mfma_f32_16x16x32_bf16 v[40:43], v[184:187], v[196:199], v[40:43]
    v_mfma_f32_16x16x32_bf16 v[44:47], v[184:187], v[200:203], v[44:47]
    s_nop 7
    buffer_load_ushort v144, v255, s[8:11], s81 offen offset:128
    buffer_load_ushort v145, v255, s[8:11], s81 offen offset:384
    buffer_load_ushort v146, v255, s[8:11], s81 offen offset:640
    buffer_load_ushort v147, v255, s[8:11], s81 offen offset:896
    s_add_u32 s81, s81, 4096
    buffer_load_ushort v148, v255, s[8:11], s81 offen offset:128
    buffer_load_ushort v149, v255, s[8:11], s81 offen offset:384
    buffer_load_ushort v150, v255, s[8:11], s81 offen offset:640
    buffer_load_ushort v151, v255, s[8:11], s81 offen offset:896
    s_sub_u32 s81, s81, 4096
    s_waitcnt vmcnt(0)
    v_lshl_or_b32 v184, v145, 16, v144
    v_lshl_or_b32 v185, v147, 16, v146
    v_lshl_or_b32 v186, v149, 16, v148
    v_lshl_or_b32 v187, v151, 16, v150
    s_nop 1
    v_mfma_f32_16x16x32_bf16 v[48:51], v[184:187], v[192:195], v[48:51]
    v_mfma_f32_16x16x32_bf16 v[52:55], v[184:187], v[196:199], v[52:55]
    v_mfma_f32_16x16x32_bf16 v[56:59], v[184:187], v[200:203], v[56:59]
    s_nop 7
    buffer_load_ushort v144, v255, s[8:11], s81 offen offset:160
    buffer_load_ushort v145, v255, s[8:11], s81 offen offset:416
    buffer_load_ushort v146, v255, s[8:11], s81 offen offset:672
    buffer_load_ushort v147, v255, s[8:11], s81 offen offset:928
    s_add_u32 s81, s81, 4096
    buffer_load_ushort v148, v255, s[8:11], s81 offen offset:160
    buffer_load_ushort v149, v255, s[8:11], s81 offen offset:416
    buffer_load_ushort v150, v255, s[8:11], s81 offen offset:672
    buffer_load_ushort v151, v255, s[8:11], s81 offen offset:928
    s_sub_u32 s81, s81, 4096
    s_waitcnt vmcnt(0)
    v_lshl_or_b32 v184, v145, 16, v144
    v_lshl_or_b32 v185, v147, 16, v146
    v_lshl_or_b32 v186, v149, 16, v148
    v_lshl_or_b32 v187, v151, 16, v150
    s_nop 1
    v_mfma_f32_16x16x32_bf16 v[60:63], v[184:187], v[192:195], v[60:63]
    v_mfma_f32_16x16x32_bf16 v[64:67], v[184:187], v[196:199], v[64:67]
    v_mfma_f32_16x16x32_bf16 v[68:71], v[184:187], v[200:203], v[68:71]
    s_nop 7
    buffer_load_ushort v144, v255, s[8:11], s81 offen offset:192
    buffer_load_ushort v145, v255, s[8:11], s81 offen offset:448
    buffer_load_ushort v146, v255, s[8:11], s81 offen offset:704
    buffer_load_ushort v147, v255, s[8:11], s81 offen offset:960
    s_add_u32 s81, s81, 4096
    buffer_load_ushort v148, v255, s[8:11], s81 offen offset:192
    buffer_load_ushort v149, v255, s[8:11], s81 offen offset:448
    buffer_load_ushort v150, v255, s[8:11], s81 offen offset:704
    buffer_load_ushort v151, v255, s[8:11], s81 offen offset:960
    s_sub_u32 s81, s81, 4096
    s_waitcnt vmcnt(0)
    v_lshl_or_b32 v184, v145, 16, v144
    v_lshl_or_b32 v185, v147, 16, v146
    v_lshl_or_b32 v186, v149, 16, v148
    v_lshl_or_b32 v187, v151, 16, v150
    s_nop 1
    v_mfma_f32_16x16x32_bf16 v[72:75], v[184:187], v[192:195], v[72:75]
    v_mfma_f32_16x16x32_bf16 v[76:79], v[184:187], v[196:199], v[76:79]
    v_mfma_f32_16x16x32_bf16 v[80:83], v[184:187], v[200:203], v[80:83]
    s_nop 7
    buffer_load_ushort v144, v255, s[8:11], s81 offen offset:224
    buffer_load_ushort v145, v255, s[8:11], s81 offen offset:480
    buffer_load_ushort v146, v255, s[8:11], s81 offen offset:736
    buffer_load_ushort v147, v255, s[8:11], s81 offen offset:992
    s_add_u32 s81, s81, 4096
    buffer_load_ushort v148, v255, s[8:11], s81 offen offset:224
    buffer_load_ushort v149, v255, s[8:11], s81 offen offset:480
    buffer_load_ushort v150, v255, s[8:11], s81 offen offset:736
    buffer_load_ushort v151, v255, s[8:11], s81 offen offset:992
    s_sub_u32 s81, s81, 4096
    s_waitcnt vmcnt(0)
    v_lshl_or_b32 v184, v145, 16, v144
    v_lshl_or_b32 v185, v147, 16, v146
    v_lshl_or_b32 v186, v149, 16, v148
    v_lshl_or_b32 v187, v151, 16, v150
    s_nop 1
    v_mfma_f32_16x16x32_bf16 v[84:87], v[184:187], v[192:195], v[84:87]
    v_mfma_f32_16x16x32_bf16 v[88:91], v[184:187], v[196:199], v[88:91]
    v_mfma_f32_16x16x32_bf16 v[92:95], v[184:187], v[200:203], v[92:95]
    s_nop 7
    s_add_u32 s81, s81, 8192
    s_sub_u32 s54, s54, 1
    s_cmp_lg_u32 s54, 0
    s_cbranch_scc1 L_slow2
    s_nop 7
    s_nop 7
    s_mov_b32 s6, s93
    s_mov_b32 s10, s93
    s_cmp_eq_u32 s69, 0
    s_cbranch_scc1 L_ret0
    s_cmp_eq_u32 s69, 1
    s_cbranch_scc1 L_ret1
    s_branch L_ret2
L_end:
    s_endpgm
.section .rodata,"a"
.p2align 6
.amdhsa_kernel concat_heads__gqa_block_cached__mha_block_cached__near_ridge_kernel
  .amdhsa_next_free_vgpr 512
  .amdhsa_next_free_sgpr 102
  .amdhsa_accum_offset 256
  .amdhsa_group_segment_fixed_size 0
  .amdhsa_kernarg_size 104
  .amdhsa_user_sgpr_count 2
  .amdhsa_user_sgpr_kernarg_segment_ptr 1
  .amdhsa_system_sgpr_workgroup_id_x 1
  .amdhsa_float_denorm_mode_32 3
.end_amdhsa_kernel
```
